```python
import torch

def _softmax(x, axis=-1):
    return torch.softmax(x, dim=axis)

def _gelu(x):
    return torch.nn.functional.gelu(x, approximate='tanh')

def _silu(x):
    return torch.nn.functional.silu(x)

def _sigmoid(x):
    return torch.sigmoid(x)

def _layernorm(x, axis=-1, eps=1e-05):
    m = x.mean(dim=axis, keepdim=True)
    v = x.var(dim=axis, keepdim=True, unbiased=False)
    return (x - m) / torch.sqrt(v + eps)

def _scatter_add(tgt, idx, src, axis=0):
    return tgt.clone().index_add_(axis, idx, src)

def _segment_sum(src, seg, n):
    out = torch.zeros((n,) + src.shape[1:], dtype=src.dtype)
    return out.index_add_(0, seg, src)

def _pad(x, pw):
    flat = tuple((v for pair in reversed(pw) for v in pair))
    return torch.nn.functional.pad(x, flat)
kernel_name = 'concat_heads__softmax_full_mha__memory_aug_recurrent_mem_tr__prompt'

def setup_inputs():

    _w = lambda a: (lambda t: t.to(torch.bfloat16) if t.is_floating_point() else t)(torch.as_tensor(a))

    def _A_setup():
        B, S, D = (1, 2048, 576)
        return {'x': _w((lambda *s: torch.randn(*s, dtype=torch.bfloat16) * 0.2)(B, S, D)), 'wqkv': _w((lambda *s: torch.randn(*s, dtype=torch.bfloat16) * 0.2)(D, 3 * D)), 'wo': _w((lambda *s: torch.randn(*s, dtype=torch.bfloat16) * 0.05)(D, D))}
    _A_in = _A_setup()

    def _B_setup():
        B, S, Dm = (1, 2048, 576)
        H, Dh = (32, 128)
        M, seg = (8, 32)
        seg = min(seg, S)
        S = S // seg * seg
        return {'x': _w((lambda *s: torch.randn(*s, dtype=torch.bfloat16) * 0.05)(B, S, Dm)), 'mem0': _w((lambda *s: torch.randn(*s, dtype=torch.bfloat16) * 0.8)(B, M, Dm)), 'Wq': _w((lambda *s: torch.randn(*s, dtype=torch.bfloat16) * 1.6)(Dm, H, Dh) * Dm ** (-0.5)), 'Wk': _w((lambda *s: torch.randn(*s, dtype=torch.bfloat16) * 1.6)(Dm, H, Dh) * Dm ** (-0.5)), 'Wv': _w((lambda *s: torch.randn(*s, dtype=torch.bfloat16) * 0.8)(Dm, H, Dh) * Dm ** (-0.5)), 'Wo': _w((lambda *s: torch.randn(*s, dtype=torch.bfloat16) * 0.8)(H, Dh, Dm) * (H * Dh) ** (-0.5)), 'seg_len': seg}
    _B_in = _B_setup()
    return {'A_x': _A_in['x'], 'A_wqkv': _A_in['wqkv'], 'A_wo': _A_in['wo'], 'B_x': _B_in['x'], 'B_mem0': _B_in['mem0'], 'B_Wq': _B_in['Wq'], 'B_Wk': _B_in['Wk'], 'B_Wv': _B_in['Wv'], 'B_Wo': _B_in['Wo'], 'B_seg_len': _B_in['seg_len']}

def reference(A_x, A_wqkv, A_wo, B_x, B_mem0, B_Wq, B_Wk, B_Wv, B_Wo, B_seg_len):

    def _A_ref(x, wqkv, wo):
        B, S, D = x.shape
        H = 32
        Dh = D // H
        qkv = (lambda x, *d: x.permute(*d))((x @ wqkv).reshape(B, S, 3, H, Dh), 2, 0, 3, 1, 4)
        q, k, v = (qkv[0], qkv[1], qkv[2])
        scale = Dh ** (-0.5)
        scores = torch.einsum('bhqd,bhkd->bhqk', q, k) * scale
        p = _softmax(scores, axis=-1)
        o = torch.einsum('bhqk,bhkd->bhqd', p, v)
        return (lambda x, *d: x.permute(*d))(o, 0, 2, 1, 3).reshape(B, S, D) @ wo

    def _B_ref(x, mem0, Wq, Wk, Wv, Wo, seg_len):
        B, S, Dm = x.shape
        H, Dh = (Wq.shape[1], Wq.shape[2])
        M = mem0.shape[1]
        scale = Dh ** (-0.5)
        n_seg = S // seg_len
        L = M + seg_len
        idx = torch.arange(L)
        mask = (idx[:, None] < M) | (idx[:, None] >= idx[None, :])
        mem = mem0
        outs = []
        for s in range(n_seg):
            xs = x[:, s * seg_len:(s + 1) * seg_len, :].clone()
            h = torch.concatenate([mem, xs], axis=1)
            q = torch.einsum('btd,dhe->bhte', h, Wq)
            k = torch.einsum('btd,dhe->bhte', h, Wk)
            v = torch.einsum('btd,dhe->bhte', h, Wv)
            scores = torch.einsum('bhqe,bhke->bhqk', q, k) * scale
            scores = torch.where(mask[None, None], scores, -1000000000.0)
            p = _softmax(scores, axis=-1)
            o = torch.einsum('bhqk,bhke->bhqe', p, v)
            o = torch.einsum('bhte,hed->btd', o, Wo)
            mem = o[:, :M, :].clone()
            outs.append(o[:, M:, :])
        return torch.concatenate(outs, axis=1)
    a = _A_ref(A_x, A_wqkv, A_wo)
    b = _B_ref(B_x, B_mem0, B_Wq, B_Wk, B_Wv, B_Wo, B_seg_len)
    return torch.concatenate([a, b], axis=-1)
```

```asm
; @launch grid=(256,1,1) block=(256,1,1) lds=163840
.amdgcn_target "amdgcn-amd-amdhsa--gfx950"
.text
.globl concat_heads__softmax_full_mha__memory_aug_recurrent_mem_tr__prompt_kernel
.p2align 8
.type concat_heads__softmax_full_mha__memory_aug_recurrent_mem_tr__prompt_kernel,@function
concat_heads__softmax_full_mha__memory_aug_recurrent_mem_tr__prompt_kernel:
    s_cmp_ge_u32 s2, 256
    s_cbranch_scc1 L_end
    s_and_b32 s3, s2, 7
    s_cmp_eq_u32 s3, 0
    s_cbranch_scc1 L_chain
    s_load_dwordx16 s[64:79], s[0:1], 0
    s_load_dwordx8 s[80:87], s[0:1], 64
    s_load_dwordx2 s[88:89], s[0:1], 96
    v_lshrrev_b32 v1, 6, v0
    s_nop 0
    v_readfirstlane_b32 s28, v1
    s_waitcnt lgkmcnt(0)
    s_mov_b32 s16, s84
    s_and_b32 s17, s85, 0xffff
    s_mov_b32 s18, 0x480000
    s_mov_b32 s19, 0x20000
    s_mov_b32 s12, s86
    s_and_b32 s13, s87, 0xffff
    s_mov_b32 s14, 0x100
    s_mov_b32 s15, 0x20000
    s_mov_b32 s8, s88
    s_and_b32 s9, s89, 0xffff
    s_mov_b32 s10, 0x10000000
    s_mov_b32 s11, 0x20000
    s_sub_u32 s38, s3, 1
    s_lshl_b32 s38, s38, 5
    s_lshr_b32 s3, s2, 3
    s_add_u32 s38, s38, s3
    s_mul_i32 s40, s38, 9363
    s_lshr_b32 s40, s40, 16
    s_mul_i32 s41, s40, 7
    s_sub_u32 s41, s38, s41
    v_lshlrev_b32 v4, 7, v0
    s_mul_i32 s33, s38, 32768
    s_mov_b32 s20, s74
    s_and_b32 s21, s75, 0xffff
    s_mov_b32 s22, 0x480000
    s_mov_b32 s23, 0x20000
    buffer_load_dword v200, v4, s[20:23], s33 offen
    s_mov_b32 s20, s80
    s_and_b32 s21, s81, 0xffff
    s_mov_b32 s22, 0x480000
    s_mov_b32 s23, 0x20000
    buffer_load_dword v201, v4, s[20:23], s33 offen
    s_cmp_lg_u32 s38, 223
    s_cbranch_scc1 L_noinit
    v_lshlrev_b32 v4, 4, v0
    v_mov_b64 v[8:9], 0
    v_mov_b64 v[10:11], 0
    s_mov_b32 s33, 0x180000
    buffer_store_dwordx4 v[8:11], v4, s[8:11], s33 offen sc1
    s_add_u32 s33, s33, 4096
    buffer_store_dwordx4 v[8:11], v4, s[8:11], s33 offen sc1
    s_add_u32 s33, s33, 4096
    buffer_store_dwordx4 v[8:11], v4, s[8:11], s33 offen sc1
    s_add_u32 s33, s33, 4096
    buffer_store_dwordx4 v[8:11], v4, s[8:11], s33 offen sc1
    s_add_u32 s33, s33, 4096
    buffer_store_dwordx4 v[8:11], v4, s[8:11], s33 offen sc1
    s_add_u32 s33, s33, 4096
    s_waitcnt vmcnt(0)
    s_barrier
    v_mov_b32 v8, 12
    v_mov_b32 v9, 1
    s_mov_b64 exec, 1
    buffer_store_dword v9, v8, s[12:15], 0 offen sc1
    s_mov_b64 exec, -1
L_noinit:
    s_mov_b32 s35, s40
    s_cmp_lg_u32 s41, 6
    s_cbranch_scc1 L_noclr
    s_cmp_ge_u32 s35, 28
    s_cbranch_scc1 L_noclr
    v_lshlrev_b32 v4, 4, v0
    v_mov_b32 v8, 0xffbfffbf
    v_mov_b32 v9, 0xffbfffbf
    v_mov_b32 v10, 0xffbfffbf
    v_mov_b32 v11, 0xffbfffbf
    s_lshl_b32 s33, s35, 15
    s_mov_b32 s34, 8
    s_cmp_eq_u32 s35, 27
    s_cmov_b32 s33, 0x100000
    s_cmov_b32 s34, 16
L_clr:
    buffer_store_dwordx4 v[8:11], v4, s[8:11], s33 offen sc1
    s_add_u32 s33, s33, 4096
    s_sub_u32 s34, s34, 1
    s_cmp_lg_u32 s34, 0
    s_cbranch_scc1 L_clr
    s_waitcnt vmcnt(0)
    s_barrier
    s_cmp_lg_u32 s28, 0
    s_cbranch_scc1 L_noclr
    v_mov_b32 v28, 128
    v_mov_b32 v29, 1
    s_mov_b64 exec, 1
    buffer_atomic_add v29, v28, s[12:15], 0 offen
    s_mov_b64 exec, -1
L_noclr:
    s_mov_b32 s58, -1
    s_mov_b32 s24, s70
    s_and_b32 s25, s71, 0xffff
    s_mov_b32 s26, 0x240000
    s_mov_b32 s27, 0x20000
    s_cmp_lt_u32 s28, 2
    s_cselect_b32 s33, s76, s78
    s_cselect_b32 s34, s77, s79
    s_mov_b32 s20, s33
    s_and_b32 s21, s34, 0xffff
    s_mov_b32 s22, 0x480000
    s_mov_b32 s23, 0x20000
    s_and_b32 s33, s28, 1
    s_lshl_b32 s33, s33, 7
    s_lshl_b32 s29, s40, 8
    s_add_u32 s29, s29, s33
    s_mov_b32 s30, s41
    s_mov_b32 s31, 7
    s_mov_b32 s32, 64
    v_and_b32 v1, 63, v0
    v_lshrrev_b32 v2, 4, v1
    v_and_b32 v3, 15, v1
    s_barrier
    v_lshrrev_b32 v8, 3, v1
    v_and_b32 v9, 7, v1
    v_lshrrev_b32 v10, 1, v8
    v_xor_b32 v9, v9, v10
    v_xor_b32 v10, 4, v9
    v_mul_u32_u24 v8, 1152, v8
    v_lshl_add_u32 v4, v9, 4, v8
    v_lshl_add_u32 v5, v10, 4, v8
    v_lshrrev_b32 v8, 3, v3
    v_mul_u32_u24 v8, 9216, v8
    v_and_b32 v9, 7, v3
    v_lshl_add_u32 v8, v9, 7, v8
    v_lshrrev_b32 v9, 1, v3
    v_xor_b32 v9, v9, v2
    v_lshl_add_u32 v6, v9, 4, v8
    v_xor_b32 v7, 64, v6
    s_and_b32 s33, s28, 1
    s_cmp_eq_u32 s33, 1
    s_cselect_b64 vcc, -1, 0
    v_cndmask_b32 v16, v4, v5, vcc
    v_mov_b32 v18, v6
    v_mov_b32 v19, v7
    s_mov_b32 s37, 0
    v_lshrrev_b32 v4, 3, v1
    v_and_b32 v5, 7, v1
    v_and_b32 v6, 2, v4
    v_xor_b32 v5, v5, v6
    v_xor_b32 v6, 4, v5
    v_mul_u32_u24 v4, 8192, v4
    v_lshl_add_u32 v5, v5, 4, v4
    v_lshl_add_u32 v6, v6, 4, v4
    v_lshrrev_b32 v7, 2, v3
    v_and_b32 v8, 3, v3
    v_lshlrev_b32 v9, 10, v2
    v_lshl_add_u32 v9, v7, 7, v9
    v_lshl_add_u32 v9, v8, 3, v9
    v_lshrrev_b32 v7, 1, v7
    v_and_b32 v8, 1, v2
    v_lshl_add_u32 v7, v8, 1, v7
    v_lshlrev_b32 v7, 5, v7
    s_mul_i32 s33, s28, 20480
    s_add_u32 s33, s33, 73728
    v_add_u32 v9, s33, v9
    v_xor_b32 v10, 0, v7
    v_add_u32 v10, v10, v9
    v_xor_b32 v11, 32, v7
    v_add_u32 v11, v11, v9
    v_xor_b32 v12, 64, v7
    v_add_u32 v12, v12, v9
    v_xor_b32 v13, 96, v7
    v_add_u32 v13, v13, v9
    s_add_u32 m0, s33, 0
    s_add_u32 s34, s29, 0
    buffer_load_dwordx4 v5, s[20:23], s34 offen lds
    s_add_u32 m0, s33, 1024
    s_add_u32 s34, s29, 65536
    buffer_load_dwordx4 v6, s[20:23], s34 offen lds
    s_add_u32 m0, s33, 2048
    s_add_u32 s34, s29, 131072
    buffer_load_dwordx4 v5, s[20:23], s34 offen lds
    s_add_u32 m0, s33, 3072
    s_add_u32 s34, s29, 196608
    buffer_load_dwordx4 v6, s[20:23], s34 offen lds
    s_add_u32 m0, s33, 4096
    s_add_u32 s34, s29, 262144
    buffer_load_dwordx4 v5, s[20:23], s34 offen lds
    s_add_u32 m0, s33, 5120
    s_add_u32 s34, s29, 327680
    buffer_load_dwordx4 v6, s[20:23], s34 offen lds
    s_add_u32 m0, s33, 6144
    s_add_u32 s34, s29, 393216
    buffer_load_dwordx4 v5, s[20:23], s34 offen lds
    s_add_u32 m0, s33, 7168
    s_add_u32 s34, s29, 458752
    buffer_load_dwordx4 v6, s[20:23], s34 offen lds
    s_add_u32 m0, s33, 8192
    s_add_u32 s34, s29, 524288
    buffer_load_dwordx4 v5, s[20:23], s34 offen lds
    s_add_u32 m0, s33, 9216
    s_add_u32 s34, s29, 589824
    buffer_load_dwordx4 v6, s[20:23], s34 offen lds
    s_add_u32 m0, s33, 10240
    s_add_u32 s34, s29, 655360
    buffer_load_dwordx4 v5, s[20:23], s34 offen lds
    s_add_u32 m0, s33, 11264
    s_add_u32 s34, s29, 720896
    buffer_load_dwordx4 v6, s[20:23], s34 offen lds
    s_add_u32 m0, s33, 12288
    s_add_u32 s34, s29, 786432
    buffer_load_dwordx4 v5, s[20:23], s34 offen lds
    s_add_u32 m0, s33, 13312
    s_add_u32 s34, s29, 851968
    buffer_load_dwordx4 v6, s[20:23], s34 offen lds
    s_add_u32 m0, s33, 14336
    s_add_u32 s34, s29, 917504
    buffer_load_dwordx4 v5, s[20:23], s34 offen lds
    s_add_u32 m0, s33, 15360
    s_add_u32 s34, s29, 983040
    buffer_load_dwordx4 v6, s[20:23], s34 offen lds
    s_add_u32 m0, s33, 16384
    s_add_u32 s34, s29, 1048576
    buffer_load_dwordx4 v5, s[20:23], s34 offen lds
    s_add_u32 m0, s33, 17408
    s_add_u32 s34, s29, 1114112
    buffer_load_dwordx4 v6, s[20:23], s34 offen lds
    s_add_u32 m0, s33, 18432
    s_add_u32 s34, s29, 1179648
    buffer_load_dwordx4 v5, s[20:23], s34 offen lds
    s_add_u32 m0, s33, 19456
    s_add_u32 s34, s29, 1245184
    buffer_load_dwordx4 v6, s[20:23], s34 offen lds
    s_lshl_b32 s35, s30, 2
    s_add_u32 s35, s35, s28
    s_mul_i32 s35, s35, 9216
    s_mul_i32 s36, s28, 9216
    s_add_u32 s36, s36, 0
    s_add_u32 m0, s36, 0
    s_nop 0
    buffer_load_dwordx4 v16, s[24:27], s35 offen offset:0 sc1 lds
    s_add_u32 m0, s36, 896
    s_nop 0
    buffer_load_dwordx4 v16, s[24:27], s35 offen offset:128 sc1 lds
    s_add_u32 m0, s36, 1792
    s_nop 0
    buffer_load_dwordx4 v16, s[24:27], s35 offen offset:256 sc1 lds
    s_add_u32 m0, s36, 2688
    s_nop 0
    buffer_load_dwordx4 v16, s[24:27], s35 offen offset:384 sc1 lds
    s_add_u32 m0, s36, 3584
    s_nop 0
    buffer_load_dwordx4 v16, s[24:27], s35 offen offset:512 sc1 lds
    s_add_u32 m0, s36, 4480
    s_nop 0
    buffer_load_dwordx4 v16, s[24:27], s35 offen offset:640 sc1 lds
    s_add_u32 m0, s36, 5376
    s_nop 0
    buffer_load_dwordx4 v16, s[24:27], s35 offen offset:768 sc1 lds
    s_add_u32 m0, s36, 6272
    s_nop 0
    buffer_load_dwordx4 v16, s[24:27], s35 offen offset:896 sc1 lds
    s_add_u32 m0, s36, 7168
    s_nop 0
    buffer_load_dwordx4 v16, s[24:27], s35 offen offset:1024 sc1 lds
    s_waitcnt vmcnt(25)
    ds_read_b64_tr_b16 v[224:225], v10 offset:0
    ds_read_b64_tr_b16 v[226:227], v10 offset:512
    ds_read_b64_tr_b16 v[228:229], v11 offset:0
    ds_read_b64_tr_b16 v[230:231], v11 offset:512
    ds_read_b64_tr_b16 v[232:233], v12 offset:0
    ds_read_b64_tr_b16 v[234:235], v12 offset:512
    ds_read_b64_tr_b16 v[236:237], v13 offset:0
    ds_read_b64_tr_b16 v[238:239], v13 offset:512
    s_waitcnt lgkmcnt(0)
    s_add_u32 m0, s33, 0
    s_add_u32 s34, s29, 1310720
    buffer_load_dwordx4 v5, s[20:23], s34 offen lds
    s_add_u32 m0, s33, 1024
    s_add_u32 s34, s29, 1376256
    buffer_load_dwordx4 v6, s[20:23], s34 offen lds
    s_add_u32 m0, s33, 2048
    s_add_u32 s34, s29, 1441792
    buffer_load_dwordx4 v5, s[20:23], s34 offen lds
    s_add_u32 m0, s33, 3072
    s_add_u32 s34, s29, 1507328
    buffer_load_dwordx4 v6, s[20:23], s34 offen lds
    s_waitcnt vmcnt(25)
    ds_read_b64_tr_b16 v[240:241], v10 offset:4096
    ds_read_b64_tr_b16 v[242:243], v10 offset:4608
    ds_read_b64_tr_b16 v[244:245], v11 offset:4096
    ds_read_b64_tr_b16 v[246:247], v11 offset:4608
    ds_read_b64_tr_b16 v[248:249], v12 offset:4096
    ds_read_b64_tr_b16 v[250:251], v12 offset:4608
    ds_read_b64_tr_b16 v[252:253], v13 offset:4096
    ds_read_b64_tr_b16 v[254:255], v13 offset:4608
    s_waitcnt lgkmcnt(0)
    s_add_u32 m0, s33, 4096
    s_add_u32 s34, s29, 1572864
    buffer_load_dwordx4 v5, s[20:23], s34 offen lds
    s_add_u32 m0, s33, 5120
    s_add_u32 s34, s29, 1638400
    buffer_load_dwordx4 v6, s[20:23], s34 offen lds
    s_add_u32 m0, s33, 6144
    s_add_u32 s34, s29, 1703936
    buffer_load_dwordx4 v5, s[20:23], s34 offen lds
    s_add_u32 m0, s33, 7168
    s_add_u32 s34, s29, 1769472
    buffer_load_dwordx4 v6, s[20:23], s34 offen lds
    s_waitcnt vmcnt(25)
    ds_read_b64_tr_b16 a[0:1], v10 offset:8192
    ds_read_b64_tr_b16 a[2:3], v10 offset:8704
    ds_read_b64_tr_b16 a[4:5], v11 offset:8192
    ds_read_b64_tr_b16 a[6:7], v11 offset:8704
    ds_read_b64_tr_b16 a[8:9], v12 offset:8192
    ds_read_b64_tr_b16 a[10:11], v12 offset:8704
    ds_read_b64_tr_b16 a[12:13], v13 offset:8192
    ds_read_b64_tr_b16 a[14:15], v13 offset:8704
    s_waitcnt lgkmcnt(0)
    s_add_u32 m0, s33, 8192
    s_add_u32 s34, s29, 1835008
    buffer_load_dwordx4 v5, s[20:23], s34 offen lds
    s_add_u32 m0, s33, 9216
    s_add_u32 s34, s29, 1900544
    buffer_load_dwordx4 v6, s[20:23], s34 offen lds
    s_add_u32 m0, s33, 10240
    s_add_u32 s34, s29, 1966080
    buffer_load_dwordx4 v5, s[20:23], s34 offen lds
    s_add_u32 m0, s33, 11264
    s_add_u32 s34, s29, 2031616
    buffer_load_dwordx4 v6, s[20:23], s34 offen lds
    s_waitcnt vmcnt(25)
    ds_read_b64_tr_b16 a[16:17], v10 offset:12288
    ds_read_b64_tr_b16 a[18:19], v10 offset:12800
    ds_read_b64_tr_b16 a[20:21], v11 offset:12288
    ds_read_b64_tr_b16 a[22:23], v11 offset:12800
    ds_read_b64_tr_b16 a[24:25], v12 offset:12288
    ds_read_b64_tr_b16 a[26:27], v12 offset:12800
    ds_read_b64_tr_b16 a[28:29], v13 offset:12288
    ds_read_b64_tr_b16 a[30:31], v13 offset:12800
    s_waitcnt lgkmcnt(0)
    s_add_u32 m0, s33, 12288
    s_add_u32 s34, s29, 2097152
    buffer_load_dwordx4 v5, s[20:23], s34 offen lds
    s_add_u32 m0, s33, 13312
    s_add_u32 s34, s29, 2162688
    buffer_load_dwordx4 v6, s[20:23], s34 offen lds
    s_add_u32 m0, s33, 14336
    s_add_u32 s34, s29, 2228224
    buffer_load_dwordx4 v5, s[20:23], s34 offen lds
    s_add_u32 m0, s33, 15360
    s_add_u32 s34, s29, 2293760
    buffer_load_dwordx4 v6, s[20:23], s34 offen lds
    s_waitcnt vmcnt(25)
    ds_read_b64_tr_b16 a[32:33], v10 offset:16384
    ds_read_b64_tr_b16 a[34:35], v10 offset:16896
    ds_read_b64_tr_b16 a[36:37], v11 offset:16384
    ds_read_b64_tr_b16 a[38:39], v11 offset:16896
    ds_read_b64_tr_b16 a[40:41], v12 offset:16384
    ds_read_b64_tr_b16 a[42:43], v12 offset:16896
    ds_read_b64_tr_b16 a[44:45], v13 offset:16384
    ds_read_b64_tr_b16 a[46:47], v13 offset:16896
    s_waitcnt lgkmcnt(0)
    s_add_u32 m0, s33, 16384
    s_add_u32 s34, s29, 2359296
    buffer_load_dwordx4 v5, s[20:23], s34 offen lds
    s_add_u32 m0, s33, 17408
    s_add_u32 s34, s29, 2424832
    buffer_load_dwordx4 v6, s[20:23], s34 offen lds
    s_add_u32 m0, s33, 18432
    s_add_u32 s34, s29, 2490368
    buffer_load_dwordx4 v5, s[20:23], s34 offen lds
    s_add_u32 m0, s33, 19456
    s_add_u32 s34, s29, 2555904
    buffer_load_dwordx4 v6, s[20:23], s34 offen lds
    s_waitcnt vmcnt(16)
    ds_read_b64_tr_b16 a[48:49], v10 offset:0
    ds_read_b64_tr_b16 a[50:51], v10 offset:512
    ds_read_b64_tr_b16 a[52:53], v11 offset:0
    ds_read_b64_tr_b16 a[54:55], v11 offset:512
    ds_read_b64_tr_b16 a[56:57], v12 offset:0
    ds_read_b64_tr_b16 a[58:59], v12 offset:512
    ds_read_b64_tr_b16 a[60:61], v13 offset:0
    ds_read_b64_tr_b16 a[62:63], v13 offset:512
    s_waitcnt lgkmcnt(0)
    s_add_u32 m0, s33, 0
    s_add_u32 s34, s29, 2621440
    buffer_load_dwordx4 v5, s[20:23], s34 offen lds
    s_add_u32 m0, s33, 1024
    s_add_u32 s34, s29, 2686976
    buffer_load_dwordx4 v6, s[20:23], s34 offen lds
    s_add_u32 m0, s33, 2048
    s_add_u32 s34, s29, 2752512
    buffer_load_dwordx4 v5, s[20:23], s34 offen lds
    s_add_u32 m0, s33, 3072
    s_add_u32 s34, s29, 2818048
    buffer_load_dwordx4 v6, s[20:23], s34 offen lds
    s_waitcnt vmcnt(16)
    ds_read_b64_tr_b16 a[64:65], v10 offset:4096
    ds_read_b64_tr_b16 a[66:67], v10 offset:4608
    ds_read_b64_tr_b16 a[68:69], v11 offset:4096
    ds_read_b64_tr_b16 a[70:71], v11 offset:4608
    ds_read_b64_tr_b16 a[72:73], v12 offset:4096
    ds_read_b64_tr_b16 a[74:75], v12 offset:4608
    ds_read_b64_tr_b16 a[76:77], v13 offset:4096
    ds_read_b64_tr_b16 a[78:79], v13 offset:4608
    s_waitcnt lgkmcnt(0)
    s_add_u32 m0, s33, 4096
    s_add_u32 s34, s29, 2883584
    buffer_load_dwordx4 v5, s[20:23], s34 offen lds
    s_add_u32 m0, s33, 5120
    s_add_u32 s34, s29, 2949120
    buffer_load_dwordx4 v6, s[20:23], s34 offen lds
    s_add_u32 m0, s33, 6144
    s_add_u32 s34, s29, 3014656
    buffer_load_dwordx4 v5, s[20:23], s34 offen lds
    s_add_u32 m0, s33, 7168
    s_add_u32 s34, s29, 3080192
    buffer_load_dwordx4 v6, s[20:23], s34 offen lds
    s_waitcnt vmcnt(16)
    ds_read_b64_tr_b16 a[80:81], v10 offset:8192
    ds_read_b64_tr_b16 a[82:83], v10 offset:8704
    ds_read_b64_tr_b16 a[84:85], v11 offset:8192
    ds_read_b64_tr_b16 a[86:87], v11 offset:8704
    ds_read_b64_tr_b16 a[88:89], v12 offset:8192
    ds_read_b64_tr_b16 a[90:91], v12 offset:8704
    ds_read_b64_tr_b16 a[92:93], v13 offset:8192
    ds_read_b64_tr_b16 a[94:95], v13 offset:8704
    s_waitcnt lgkmcnt(0)
    s_add_u32 m0, s33, 8192
    s_add_u32 s34, s29, 3145728
    buffer_load_dwordx4 v5, s[20:23], s34 offen lds
    s_add_u32 m0, s33, 9216
    s_add_u32 s34, s29, 3211264
    buffer_load_dwordx4 v6, s[20:23], s34 offen lds
    s_add_u32 m0, s33, 10240
    s_add_u32 s34, s29, 3276800
    buffer_load_dwordx4 v5, s[20:23], s34 offen lds
    s_add_u32 m0, s33, 11264
    s_add_u32 s34, s29, 3342336
    buffer_load_dwordx4 v6, s[20:23], s34 offen lds
    s_waitcnt vmcnt(16)
    ds_read_b64_tr_b16 a[96:97], v10 offset:12288
    ds_read_b64_tr_b16 a[98:99], v10 offset:12800
    ds_read_b64_tr_b16 a[100:101], v11 offset:12288
    ds_read_b64_tr_b16 a[102:103], v11 offset:12800
    ds_read_b64_tr_b16 a[104:105], v12 offset:12288
    ds_read_b64_tr_b16 a[106:107], v12 offset:12800
    ds_read_b64_tr_b16 a[108:109], v13 offset:12288
    ds_read_b64_tr_b16 a[110:111], v13 offset:12800
    s_waitcnt lgkmcnt(0)
    s_add_u32 m0, s33, 12288
    s_add_u32 s34, s29, 3407872
    buffer_load_dwordx4 v5, s[20:23], s34 offen lds
    s_add_u32 m0, s33, 13312
    s_add_u32 s34, s29, 3473408
    buffer_load_dwordx4 v6, s[20:23], s34 offen lds
    s_add_u32 m0, s33, 14336
    s_add_u32 s34, s29, 3538944
    buffer_load_dwordx4 v5, s[20:23], s34 offen lds
    s_add_u32 m0, s33, 15360
    s_add_u32 s34, s29, 3604480
    buffer_load_dwordx4 v6, s[20:23], s34 offen lds
    s_waitcnt vmcnt(16)
    ds_read_b64_tr_b16 a[112:113], v10 offset:16384
    ds_read_b64_tr_b16 a[114:115], v10 offset:16896
    ds_read_b64_tr_b16 a[116:117], v11 offset:16384
    ds_read_b64_tr_b16 a[118:119], v11 offset:16896
    ds_read_b64_tr_b16 a[120:121], v12 offset:16384
    ds_read_b64_tr_b16 a[122:123], v12 offset:16896
    ds_read_b64_tr_b16 a[124:125], v13 offset:16384
    ds_read_b64_tr_b16 a[126:127], v13 offset:16896
    s_waitcnt lgkmcnt(0)
    s_add_u32 m0, s33, 16384
    s_add_u32 s34, s29, 3670016
    buffer_load_dwordx4 v5, s[20:23], s34 offen lds
    s_add_u32 m0, s33, 17408
    s_add_u32 s34, s29, 3735552
    buffer_load_dwordx4 v6, s[20:23], s34 offen lds
    s_add_u32 m0, s33, 18432
    s_add_u32 s34, s29, 3801088
    buffer_load_dwordx4 v5, s[20:23], s34 offen lds
    s_add_u32 m0, s33, 19456
    s_add_u32 s34, s29, 3866624
    buffer_load_dwordx4 v6, s[20:23], s34 offen lds
    s_waitcnt vmcnt(16)
    ds_read_b64_tr_b16 a[128:129], v10 offset:0
    ds_read_b64_tr_b16 a[130:131], v10 offset:512
    ds_read_b64_tr_b16 a[132:133], v11 offset:0
    ds_read_b64_tr_b16 a[134:135], v11 offset:512
    ds_read_b64_tr_b16 a[136:137], v12 offset:0
    ds_read_b64_tr_b16 a[138:139], v12 offset:512
    ds_read_b64_tr_b16 a[140:141], v13 offset:0
    ds_read_b64_tr_b16 a[142:143], v13 offset:512
    s_waitcnt lgkmcnt(0)
    s_add_u32 m0, s33, 0
    s_add_u32 s34, s29, 3932160
    buffer_load_dwordx4 v5, s[20:23], s34 offen lds
    s_add_u32 m0, s33, 1024
    s_add_u32 s34, s29, 3997696
    buffer_load_dwordx4 v6, s[20:23], s34 offen lds
    s_add_u32 m0, s33, 2048
    s_add_u32 s34, s29, 4063232
    buffer_load_dwordx4 v5, s[20:23], s34 offen lds
    s_add_u32 m0, s33, 3072
    s_add_u32 s34, s29, 4128768
    buffer_load_dwordx4 v6, s[20:23], s34 offen lds
    s_waitcnt vmcnt(16)
    ds_read_b64_tr_b16 a[144:145], v10 offset:4096
    ds_read_b64_tr_b16 a[146:147], v10 offset:4608
    ds_read_b64_tr_b16 a[148:149], v11 offset:4096
    ds_read_b64_tr_b16 a[150:151], v11 offset:4608
    ds_read_b64_tr_b16 a[152:153], v12 offset:4096
    ds_read_b64_tr_b16 a[154:155], v12 offset:4608
    ds_read_b64_tr_b16 a[156:157], v13 offset:4096
    ds_read_b64_tr_b16 a[158:159], v13 offset:4608
    s_waitcnt lgkmcnt(0)
    s_add_u32 m0, s33, 4096
    s_add_u32 s34, s29, 4194304
    buffer_load_dwordx4 v5, s[20:23], s34 offen lds
    s_add_u32 m0, s33, 5120
    s_add_u32 s34, s29, 4259840
    buffer_load_dwordx4 v6, s[20:23], s34 offen lds
    s_add_u32 m0, s33, 6144
    s_add_u32 s34, s29, 4325376
    buffer_load_dwordx4 v5, s[20:23], s34 offen lds
    s_add_u32 m0, s33, 7168
    s_add_u32 s34, s29, 4390912
    buffer_load_dwordx4 v6, s[20:23], s34 offen lds
    s_waitcnt vmcnt(16)
    ds_read_b64_tr_b16 a[160:161], v10 offset:8192
    ds_read_b64_tr_b16 a[162:163], v10 offset:8704
    ds_read_b64_tr_b16 a[164:165], v11 offset:8192
    ds_read_b64_tr_b16 a[166:167], v11 offset:8704
    ds_read_b64_tr_b16 a[168:169], v12 offset:8192
    ds_read_b64_tr_b16 a[170:171], v12 offset:8704
    ds_read_b64_tr_b16 a[172:173], v13 offset:8192
    ds_read_b64_tr_b16 a[174:175], v13 offset:8704
    s_waitcnt lgkmcnt(0)
    s_add_u32 m0, s33, 8192
    s_add_u32 s34, s29, 4456448
    buffer_load_dwordx4 v5, s[20:23], s34 offen lds
    s_add_u32 m0, s33, 9216
    s_add_u32 s34, s29, 4521984
    buffer_load_dwordx4 v6, s[20:23], s34 offen lds
    s_add_u32 m0, s33, 10240
    s_add_u32 s34, s29, 4587520
    buffer_load_dwordx4 v5, s[20:23], s34 offen lds
    s_add_u32 m0, s33, 11264
    s_add_u32 s34, s29, 4653056
    buffer_load_dwordx4 v6, s[20:23], s34 offen lds
    s_waitcnt vmcnt(16)
    ds_read_b64_tr_b16 a[176:177], v10 offset:12288
    ds_read_b64_tr_b16 a[178:179], v10 offset:12800
    ds_read_b64_tr_b16 a[180:181], v11 offset:12288
    ds_read_b64_tr_b16 a[182:183], v11 offset:12800
    ds_read_b64_tr_b16 a[184:185], v12 offset:12288
    ds_read_b64_tr_b16 a[186:187], v12 offset:12800
    ds_read_b64_tr_b16 a[188:189], v13 offset:12288
    ds_read_b64_tr_b16 a[190:191], v13 offset:12800
    s_waitcnt lgkmcnt(0)
    s_waitcnt vmcnt(12)
    ds_read_b64_tr_b16 a[192:193], v10 offset:16384
    ds_read_b64_tr_b16 a[194:195], v10 offset:16896
    ds_read_b64_tr_b16 a[196:197], v11 offset:16384
    ds_read_b64_tr_b16 a[198:199], v11 offset:16896
    ds_read_b64_tr_b16 a[200:201], v12 offset:16384
    ds_read_b64_tr_b16 a[202:203], v12 offset:16896
    ds_read_b64_tr_b16 a[204:205], v13 offset:16384
    ds_read_b64_tr_b16 a[206:207], v13 offset:16896
    s_waitcnt lgkmcnt(0)
    s_waitcnt vmcnt(8)
    ds_read_b64_tr_b16 a[208:209], v10 offset:0
    ds_read_b64_tr_b16 a[210:211], v10 offset:512
    ds_read_b64_tr_b16 a[212:213], v11 offset:0
    ds_read_b64_tr_b16 a[214:215], v11 offset:512
    ds_read_b64_tr_b16 a[216:217], v12 offset:0
    ds_read_b64_tr_b16 a[218:219], v12 offset:512
    ds_read_b64_tr_b16 a[220:221], v13 offset:0
    ds_read_b64_tr_b16 a[222:223], v13 offset:512
    s_waitcnt lgkmcnt(0)
    s_waitcnt vmcnt(4)
    ds_read_b64_tr_b16 a[224:225], v10 offset:4096
    ds_read_b64_tr_b16 a[226:227], v10 offset:4608
    ds_read_b64_tr_b16 a[228:229], v11 offset:4096
    ds_read_b64_tr_b16 a[230:231], v11 offset:4608
    ds_read_b64_tr_b16 a[232:233], v12 offset:4096
    ds_read_b64_tr_b16 a[234:235], v12 offset:4608
    ds_read_b64_tr_b16 a[236:237], v13 offset:4096
    ds_read_b64_tr_b16 a[238:239], v13 offset:4608
    s_waitcnt lgkmcnt(0)
    s_waitcnt vmcnt(0)
    ds_read_b64_tr_b16 a[240:241], v10 offset:8192
    ds_read_b64_tr_b16 a[242:243], v10 offset:8704
    ds_read_b64_tr_b16 a[244:245], v11 offset:8192
    ds_read_b64_tr_b16 a[246:247], v11 offset:8704
    ds_read_b64_tr_b16 a[248:249], v12 offset:8192
    ds_read_b64_tr_b16 a[250:251], v12 offset:8704
    ds_read_b64_tr_b16 a[252:253], v13 offset:8192
    ds_read_b64_tr_b16 a[254:255], v13 offset:8704
    s_waitcnt lgkmcnt(0)
    v_mov_b32 v4, v16
    v_mov_b32 v6, v18
    v_mov_b32 v7, v19
    s_waitcnt vmcnt(0)
    s_mov_b32 s39, 0
    v_mov_b32 v28, 12
L_poll_1:
    buffer_load_dword v29, v28, s[12:15], 0 offen sc1
    s_add_u32 s39, s39, 1
    s_cmp_gt_u32 s39, 4000000
    s_cbranch_scc1 L_fail
    s_waitcnt vmcnt(0)
    v_readfirstlane_b32 s33, v29
    s_nop 0
    s_cmp_ge_u32 s33, 1
    s_cbranch_scc1 L_poll_1_d
    s_sleep 2
    s_branch L_poll_1
L_poll_1_d:
    s_cmp_lt_u32 s28, 2
    s_cbranch_scc1 L_pg_kv_1
L_pg_kv_0:
L_pgl_kv_0:
    s_waitcnt vmcnt(5)
    s_barrier
    s_cmp_lg_u32 s28, 0
    s_cbranch_scc1 L_kvp_2
    s_cmp_lt_i32 s58, 1
    s_cbranch_scc1 L_kvp_2
    s_lshl_b32 s33, s40, 5
    s_add_u32 s33, s33, s41
    s_lshl_b32 s33, s33, 2
    s_add_u32 s33, s33, 0x180000
    v_mov_b32 v28, s33
    v_mov_b32 v29, s58
    s_mov_b64 exec, 1
    buffer_store_dword v29, v28, s[8:11], 0 offen sc1
    s_mov_b64 exec, -1
L_kvp_2:
    s_add_u32 s58, s58, 1
    v_add_u32 v8, s37, v6
    v_add_u32 v9, s37, v7
    s_add_u32 s34, s30, s31
    s_min_u32 s34, s34, 63
    s_xor_b32 s37, s37, 36864
    s_lshl_b32 s35, s34, 2
    s_add_u32 s35, s35, s28
    s_mul_i32 s35, s35, 9216
    s_mul_i32 s36, s28, 9216
    s_add_u32 s36, s36, s37
    ds_read_b128 v[32:35], v8 offset:0
    ds_read_b128 v[36:39], v8 offset:18432
    ds_read_b128 v[40:43], v9 offset:0
    ds_read_b128 v[44:47], v9 offset:18432
    ds_read_b128 v[48:51], v8 offset:1024
    ds_read_b128 v[52:55], v8 offset:19456
    ds_read_b128 v[56:59], v9 offset:1024
    s_waitcnt lgkmcnt(6)
    v_mfma_f32_16x16x32_bf16 v[64:67], v[32:35], v[224:227], 0
    ds_read_b128 v[60:63], v9 offset:19456
    v_mfma_f32_16x16x32_bf16 v[68:71], v[32:35], v[228:231], 0
    s_add_u32 m0, s36, 0
    s_nop 0
    buffer_load_dwordx4 v4, s[24:27], s35 offen offset:0 sc1 lds
    v_mfma_f32_16x16x32_bf16 v[72:75], v[32:35], v[232:235], 0
    v_mfma_f32_16x16x32_bf16 v[76:79], v[32:35], v[236:239], 0
    s_waitcnt lgkmcnt(6)
    v_mfma_f32_16x16x32_bf16 v[80:83], v[36:39], v[224:227], 0
    ds_read_b128 v[32:35], v8 offset:2048
    v_mfma_f32_16x16x32_bf16 v[84:87], v[36:39], v[228:231], 0
    v_mfma_f32_16x16x32_bf16 v[88:91], v[36:39], v[232:235], 0
    v_mfma_f32_16x16x32_bf16 v[92:95], v[36:39], v[236:239], 0
    s_waitcnt lgkmcnt(6)
    v_mfma_f32_16x16x32_bf16 v[64:67], v[40:43], v[240:243], v[64:67]
    ds_read_b128 v[36:39], v8 offset:20480
    v_mfma_f32_16x16x32_bf16 v[68:71], v[40:43], v[244:247], v[68:71]
    s_add_u32 m0, s36, 896
    s_nop 0
    buffer_load_dwordx4 v4, s[24:27], s35 offen offset:128 sc1 lds
    v_mfma_f32_16x16x32_bf16 v[72:75], v[40:43], v[248:251], v[72:75]
    v_mfma_f32_16x16x32_bf16 v[76:79], v[40:43], v[252:255], v[76:79]
    s_waitcnt lgkmcnt(6)
    v_mfma_f32_16x16x32_bf16 v[80:83], v[44:47], v[240:243], v[80:83]
    ds_read_b128 v[40:43], v9 offset:2048
    v_mfma_f32_16x16x32_bf16 v[84:87], v[44:47], v[244:247], v[84:87]
    v_mfma_f32_16x16x32_bf16 v[88:91], v[44:47], v[248:251], v[88:91]
    v_mfma_f32_16x16x32_bf16 v[92:95], v[44:47], v[252:255], v[92:95]
    s_waitcnt lgkmcnt(6)
    v_mfma_f32_16x16x32_bf16 v[64:67], v[48:51], a[0:3], v[64:67]
    ds_read_b128 v[44:47], v9 offset:20480
    v_mfma_f32_16x16x32_bf16 v[68:71], v[48:51], a[4:7], v[68:71]
    s_add_u32 m0, s36, 1792
    s_nop 0
    buffer_load_dwordx4 v4, s[24:27], s35 offen offset:256 sc1 lds
    v_mfma_f32_16x16x32_bf16 v[72:75], v[48:51], a[8:11], v[72:75]
    v_mfma_f32_16x16x32_bf16 v[76:79], v[48:51], a[12:15], v[76:79]
    s_waitcnt lgkmcnt(6)
    v_mfma_f32_16x16x32_bf16 v[80:83], v[52:55], a[0:3], v[80:83]
    ds_read_b128 v[48:51], v8 offset:3072
    v_mfma_f32_16x16x32_bf16 v[84:87], v[52:55], a[4:7], v[84:87]
    v_mfma_f32_16x16x32_bf16 v[88:91], v[52:55], a[8:11], v[88:91]
    v_mfma_f32_16x16x32_bf16 v[92:95], v[52:55], a[12:15], v[92:95]
    s_waitcnt lgkmcnt(6)
    v_mfma_f32_16x16x32_bf16 v[64:67], v[56:59], a[16:19], v[64:67]
    ds_read_b128 v[52:55], v8 offset:21504
    v_mfma_f32_16x16x32_bf16 v[68:71], v[56:59], a[20:23], v[68:71]
    s_add_u32 m0, s36, 2688
    s_nop 0
    buffer_load_dwordx4 v4, s[24:27], s35 offen offset:384 sc1 lds
    v_mfma_f32_16x16x32_bf16 v[72:75], v[56:59], a[24:27], v[72:75]
    v_mfma_f32_16x16x32_bf16 v[76:79], v[56:59], a[28:31], v[76:79]
    s_waitcnt lgkmcnt(6)
    v_mfma_f32_16x16x32_bf16 v[80:83], v[60:63], a[16:19], v[80:83]
    ds_read_b128 v[56:59], v9 offset:3072
    v_mfma_f32_16x16x32_bf16 v[84:87], v[60:63], a[20:23], v[84:87]
    v_mfma_f32_16x16x32_bf16 v[88:91], v[60:63], a[24:27], v[88:91]
    v_mfma_f32_16x16x32_bf16 v[92:95], v[60:63], a[28:31], v[92:95]
    s_waitcnt lgkmcnt(6)
    v_mfma_f32_16x16x32_bf16 v[64:67], v[32:35], a[32:35], v[64:67]
    ds_read_b128 v[60:63], v9 offset:21504
    v_mfma_f32_16x16x32_bf16 v[68:71], v[32:35], a[36:39], v[68:71]
    s_add_u32 m0, s36, 3584
    s_nop 0
    buffer_load_dwordx4 v4, s[24:27], s35 offen offset:512 sc1 lds
    v_mfma_f32_16x16x32_bf16 v[72:75], v[32:35], a[40:43], v[72:75]
    v_mfma_f32_16x16x32_bf16 v[76:79], v[32:35], a[44:47], v[76:79]
    s_waitcnt lgkmcnt(6)
    v_mfma_f32_16x16x32_bf16 v[80:83], v[36:39], a[32:35], v[80:83]
    ds_read_b128 v[32:35], v8 offset:4096
    v_mfma_f32_16x16x32_bf16 v[84:87], v[36:39], a[36:39], v[84:87]
    v_mfma_f32_16x16x32_bf16 v[88:91], v[36:39], a[40:43], v[88:91]
    v_mfma_f32_16x16x32_bf16 v[92:95], v[36:39], a[44:47], v[92:95]
    s_waitcnt lgkmcnt(6)
    v_mfma_f32_16x16x32_bf16 v[64:67], v[40:43], a[48:51], v[64:67]
    ds_read_b128 v[36:39], v8 offset:22528
    v_mfma_f32_16x16x32_bf16 v[68:71], v[40:43], a[52:55], v[68:71]
    s_add_u32 m0, s36, 4480
    s_nop 0
    buffer_load_dwordx4 v4, s[24:27], s35 offen offset:640 sc1 lds
    v_mfma_f32_16x16x32_bf16 v[72:75], v[40:43], a[56:59], v[72:75]
    v_mfma_f32_16x16x32_bf16 v[76:79], v[40:43], a[60:63], v[76:79]
    s_waitcnt lgkmcnt(6)
    v_mfma_f32_16x16x32_bf16 v[80:83], v[44:47], a[48:51], v[80:83]
    ds_read_b128 v[40:43], v9 offset:4096
    v_mfma_f32_16x16x32_bf16 v[84:87], v[44:47], a[52:55], v[84:87]
    v_mfma_f32_16x16x32_bf16 v[88:91], v[44:47], a[56:59], v[88:91]
    v_mfma_f32_16x16x32_bf16 v[92:95], v[44:47], a[60:63], v[92:95]
    s_waitcnt lgkmcnt(6)
    v_mfma_f32_16x16x32_bf16 v[64:67], v[48:51], a[64:67], v[64:67]
    ds_read_b128 v[44:47], v9 offset:22528
    v_mfma_f32_16x16x32_bf16 v[68:71], v[48:51], a[68:71], v[68:71]
    s_add_u32 m0, s36, 5376
    s_nop 0
    buffer_load_dwordx4 v4, s[24:27], s35 offen offset:768 sc1 lds
    v_mfma_f32_16x16x32_bf16 v[72:75], v[48:51], a[72:75], v[72:75]
    v_mfma_f32_16x16x32_bf16 v[76:79], v[48:51], a[76:79], v[76:79]
    s_waitcnt lgkmcnt(6)
    v_mfma_f32_16x16x32_bf16 v[80:83], v[52:55], a[64:67], v[80:83]
    ds_read_b128 v[48:51], v8 offset:5120
    v_mfma_f32_16x16x32_bf16 v[84:87], v[52:55], a[68:71], v[84:87]
    v_mfma_f32_16x16x32_bf16 v[88:91], v[52:55], a[72:75], v[88:91]
    v_mfma_f32_16x16x32_bf16 v[92:95], v[52:55], a[76:79], v[92:95]
    s_waitcnt lgkmcnt(6)
    v_mfma_f32_16x16x32_bf16 v[64:67], v[56:59], a[80:83], v[64:67]
    ds_read_b128 v[52:55], v8 offset:23552
    v_mfma_f32_16x16x32_bf16 v[68:71], v[56:59], a[84:87], v[68:71]
    s_add_u32 m0, s36, 6272
    s_nop 0
    buffer_load_dwordx4 v4, s[24:27], s35 offen offset:896 sc1 lds
    v_mfma_f32_16x16x32_bf16 v[72:75], v[56:59], a[88:91], v[72:75]
    v_mfma_f32_16x16x32_bf16 v[76:79], v[56:59], a[92:95], v[76:79]
    s_waitcnt lgkmcnt(6)
    v_mfma_f32_16x16x32_bf16 v[80:83], v[60:63], a[80:83], v[80:83]
    ds_read_b128 v[56:59], v9 offset:5120
    v_mfma_f32_16x16x32_bf16 v[84:87], v[60:63], a[84:87], v[84:87]
    v_mfma_f32_16x16x32_bf16 v[88:91], v[60:63], a[88:91], v[88:91]
    v_mfma_f32_16x16x32_bf16 v[92:95], v[60:63], a[92:95], v[92:95]
    s_waitcnt lgkmcnt(6)
    v_mfma_f32_16x16x32_bf16 v[64:67], v[32:35], a[96:99], v[64:67]
    ds_read_b128 v[60:63], v9 offset:23552
    v_mfma_f32_16x16x32_bf16 v[68:71], v[32:35], a[100:103], v[68:71]
    s_add_u32 m0, s36, 7168
    s_nop 0
    buffer_load_dwordx4 v4, s[24:27], s35 offen offset:1024 sc1 lds
    v_mfma_f32_16x16x32_bf16 v[72:75], v[32:35], a[104:107], v[72:75]
    v_mfma_f32_16x16x32_bf16 v[76:79], v[32:35], a[108:111], v[76:79]
    s_waitcnt lgkmcnt(6)
    v_mfma_f32_16x16x32_bf16 v[80:83], v[36:39], a[96:99], v[80:83]
    ds_read_b128 v[32:35], v8 offset:6144
    v_mfma_f32_16x16x32_bf16 v[84:87], v[36:39], a[100:103], v[84:87]
    v_mfma_f32_16x16x32_bf16 v[88:91], v[36:39], a[104:107], v[88:91]
    v_mfma_f32_16x16x32_bf16 v[92:95], v[36:39], a[108:111], v[92:95]
    s_waitcnt lgkmcnt(6)
    v_mfma_f32_16x16x32_bf16 v[64:67], v[40:43], a[112:115], v[64:67]
    ds_read_b128 v[36:39], v8 offset:24576
    v_mfma_f32_16x16x32_bf16 v[68:71], v[40:43], a[116:119], v[68:71]
    v_mfma_f32_16x16x32_bf16 v[72:75], v[40:43], a[120:123], v[72:75]
    v_mfma_f32_16x16x32_bf16 v[76:79], v[40:43], a[124:127], v[76:79]
    s_waitcnt lgkmcnt(6)
    v_mfma_f32_16x16x32_bf16 v[80:83], v[44:47], a[112:115], v[80:83]
    ds_read_b128 v[40:43], v9 offset:6144
    v_mfma_f32_16x16x32_bf16 v[84:87], v[44:47], a[116:119], v[84:87]
    v_mfma_f32_16x16x32_bf16 v[88:91], v[44:47], a[120:123], v[88:91]
    v_mfma_f32_16x16x32_bf16 v[92:95], v[44:47], a[124:127], v[92:95]
    s_waitcnt lgkmcnt(6)
    v_mfma_f32_16x16x32_bf16 v[64:67], v[48:51], a[128:131], v[64:67]
    ds_read_b128 v[44:47], v9 offset:24576
    v_mfma_f32_16x16x32_bf16 v[68:71], v[48:51], a[132:135], v[68:71]
    v_mfma_f32_16x16x32_bf16 v[72:75], v[48:51], a[136:139], v[72:75]
    v_mfma_f32_16x16x32_bf16 v[76:79], v[48:51], a[140:143], v[76:79]
    s_waitcnt lgkmcnt(6)
    v_mfma_f32_16x16x32_bf16 v[80:83], v[52:55], a[128:131], v[80:83]
    ds_read_b128 v[48:51], v8 offset:7168
    v_mfma_f32_16x16x32_bf16 v[84:87], v[52:55], a[132:135], v[84:87]
    v_mfma_f32_16x16x32_bf16 v[88:91], v[52:55], a[136:139], v[88:91]
    v_mfma_f32_16x16x32_bf16 v[92:95], v[52:55], a[140:143], v[92:95]
    s_waitcnt lgkmcnt(6)
    v_mfma_f32_16x16x32_bf16 v[64:67], v[56:59], a[144:147], v[64:67]
    ds_read_b128 v[52:55], v8 offset:25600
    v_mfma_f32_16x16x32_bf16 v[68:71], v[56:59], a[148:151], v[68:71]
    v_mfma_f32_16x16x32_bf16 v[72:75], v[56:59], a[152:155], v[72:75]
    v_mfma_f32_16x16x32_bf16 v[76:79], v[56:59], a[156:159], v[76:79]
    s_waitcnt lgkmcnt(6)
    v_mfma_f32_16x16x32_bf16 v[80:83], v[60:63], a[144:147], v[80:83]
    ds_read_b128 v[56:59], v9 offset:7168
    v_mfma_f32_16x16x32_bf16 v[84:87], v[60:63], a[148:151], v[84:87]
    v_mfma_f32_16x16x32_bf16 v[88:91], v[60:63], a[152:155], v[88:91]
    v_mfma_f32_16x16x32_bf16 v[92:95], v[60:63], a[156:159], v[92:95]
    s_waitcnt lgkmcnt(6)
    v_mfma_f32_16x16x32_bf16 v[64:67], v[32:35], a[160:163], v[64:67]
    ds_read_b128 v[60:63], v9 offset:25600
    v_mfma_f32_16x16x32_bf16 v[68:71], v[32:35], a[164:167], v[68:71]
    v_mfma_f32_16x16x32_bf16 v[72:75], v[32:35], a[168:171], v[72:75]
    v_mfma_f32_16x16x32_bf16 v[76:79], v[32:35], a[172:175], v[76:79]
    s_waitcnt lgkmcnt(6)
    v_mfma_f32_16x16x32_bf16 v[80:83], v[36:39], a[160:163], v[80:83]
    ds_read_b128 v[32:35], v8 offset:8192
    v_mfma_f32_16x16x32_bf16 v[84:87], v[36:39], a[164:167], v[84:87]
    v_mfma_f32_16x16x32_bf16 v[88:91], v[36:39], a[168:171], v[88:91]
    v_mfma_f32_16x16x32_bf16 v[92:95], v[36:39], a[172:175], v[92:95]
    s_waitcnt lgkmcnt(6)
    v_mfma_f32_16x16x32_bf16 v[64:67], v[40:43], a[176:179], v[64:67]
    ds_read_b128 v[36:39], v8 offset:26624
    v_mfma_f32_16x16x32_bf16 v[68:71], v[40:43], a[180:183], v[68:71]
    v_mfma_f32_16x16x32_bf16 v[72:75], v[40:43], a[184:187], v[72:75]
    v_mfma_f32_16x16x32_bf16 v[76:79], v[40:43], a[188:191], v[76:79]
    s_waitcnt lgkmcnt(6)
    v_mfma_f32_16x16x32_bf16 v[80:83], v[44:47], a[176:179], v[80:83]
    ds_read_b128 v[40:43], v9 offset:8192
    v_mfma_f32_16x16x32_bf16 v[84:87], v[44:47], a[180:183], v[84:87]
    v_mfma_f32_16x16x32_bf16 v[88:91], v[44:47], a[184:187], v[88:91]
    v_mfma_f32_16x16x32_bf16 v[92:95], v[44:47], a[188:191], v[92:95]
    s_waitcnt lgkmcnt(6)
    v_mfma_f32_16x16x32_bf16 v[64:67], v[48:51], a[192:195], v[64:67]
    ds_read_b128 v[44:47], v9 offset:26624
    v_mfma_f32_16x16x32_bf16 v[68:71], v[48:51], a[196:199], v[68:71]
    v_mfma_f32_16x16x32_bf16 v[72:75], v[48:51], a[200:203], v[72:75]
    v_mfma_f32_16x16x32_bf16 v[76:79], v[48:51], a[204:207], v[76:79]
    s_waitcnt lgkmcnt(6)
    v_mfma_f32_16x16x32_bf16 v[80:83], v[52:55], a[192:195], v[80:83]
    v_mfma_f32_16x16x32_bf16 v[84:87], v[52:55], a[196:199], v[84:87]
    v_mfma_f32_16x16x32_bf16 v[88:91], v[52:55], a[200:203], v[88:91]
    v_mfma_f32_16x16x32_bf16 v[92:95], v[52:55], a[204:207], v[92:95]
    s_waitcnt lgkmcnt(5)
    v_mfma_f32_16x16x32_bf16 v[64:67], v[56:59], a[208:211], v[64:67]
    v_mfma_f32_16x16x32_bf16 v[68:71], v[56:59], a[212:215], v[68:71]
    v_mfma_f32_16x16x32_bf16 v[72:75], v[56:59], a[216:219], v[72:75]
    v_mfma_f32_16x16x32_bf16 v[76:79], v[56:59], a[220:223], v[76:79]
    s_waitcnt lgkmcnt(4)
    v_mfma_f32_16x16x32_bf16 v[80:83], v[60:63], a[208:211], v[80:83]
    v_mfma_f32_16x16x32_bf16 v[84:87], v[60:63], a[212:215], v[84:87]
    v_mfma_f32_16x16x32_bf16 v[88:91], v[60:63], a[216:219], v[88:91]
    v_mfma_f32_16x16x32_bf16 v[92:95], v[60:63], a[220:223], v[92:95]
    s_waitcnt lgkmcnt(3)
    v_mfma_f32_16x16x32_bf16 v[64:67], v[32:35], a[224:227], v[64:67]
    v_mfma_f32_16x16x32_bf16 v[68:71], v[32:35], a[228:231], v[68:71]
    v_mfma_f32_16x16x32_bf16 v[72:75], v[32:35], a[232:235], v[72:75]
    v_mfma_f32_16x16x32_bf16 v[76:79], v[32:35], a[236:239], v[76:79]
    s_waitcnt lgkmcnt(2)
    v_mfma_f32_16x16x32_bf16 v[80:83], v[36:39], a[224:227], v[80:83]
    v_mfma_f32_16x16x32_bf16 v[84:87], v[36:39], a[228:231], v[84:87]
    v_mfma_f32_16x16x32_bf16 v[88:91], v[36:39], a[232:235], v[88:91]
    v_mfma_f32_16x16x32_bf16 v[92:95], v[36:39], a[236:239], v[92:95]
    s_waitcnt lgkmcnt(1)
    v_mfma_f32_16x16x32_bf16 v[64:67], v[40:43], a[240:243], v[64:67]
    v_mfma_f32_16x16x32_bf16 v[68:71], v[40:43], a[244:247], v[68:71]
    v_mfma_f32_16x16x32_bf16 v[72:75], v[40:43], a[248:251], v[72:75]
    v_mfma_f32_16x16x32_bf16 v[76:79], v[40:43], a[252:255], v[76:79]
    s_waitcnt lgkmcnt(0)
    v_mfma_f32_16x16x32_bf16 v[80:83], v[44:47], a[240:243], v[80:83]
    v_mfma_f32_16x16x32_bf16 v[84:87], v[44:47], a[244:247], v[84:87]
    v_mfma_f32_16x16x32_bf16 v[88:91], v[44:47], a[248:251], v[88:91]
    v_mfma_f32_16x16x32_bf16 v[92:95], v[44:47], a[252:255], v[92:95]
    s_lshl_b32 s33, s30, 5
    s_add_u32 s33, s33, s40
    s_lshl_b32 s33, s33, 13
    s_and_b32 s34, s28, 1
    s_lshl_b32 s34, s34, 12
    s_add_u32 s33, s33, s34
    s_add_u32 s33, s33, 0x2000000
    v_lshlrev_b32 v10, 4, v1
    v_cvt_pk_bf16_f32 v12, v64, v65
    v_cvt_pk_bf16_f32 v13, v66, v67
    v_cvt_pk_bf16_f32 v14, v80, v81
    v_cvt_pk_bf16_f32 v15, v82, v83
    buffer_store_dwordx4 v[12:15], v10, s[8:11], s33 offen offset:0 sc1
    v_cvt_pk_bf16_f32 v16, v68, v69
    v_cvt_pk_bf16_f32 v17, v70, v71
    v_cvt_pk_bf16_f32 v18, v84, v85
    v_cvt_pk_bf16_f32 v19, v86, v87
    buffer_store_dwordx4 v[16:19], v10, s[8:11], s33 offen offset:1024 sc1
    v_cvt_pk_bf16_f32 v20, v72, v73
    v_cvt_pk_bf16_f32 v21, v74, v75
    v_cvt_pk_bf16_f32 v22, v88, v89
    v_cvt_pk_bf16_f32 v23, v90, v91
    buffer_store_dwordx4 v[20:23], v10, s[8:11], s33 offen offset:2048 sc1
    v_cvt_pk_bf16_f32 v24, v76, v77
    v_cvt_pk_bf16_f32 v25, v78, v79
    v_cvt_pk_bf16_f32 v26, v92, v93
    v_cvt_pk_bf16_f32 v27, v94, v95
    buffer_store_dwordx4 v[24:27], v10, s[8:11], s33 offen offset:3072 sc1
    s_lshl_b32 s33, s30, 5
    s_add_u32 s33, s33, s40
    s_lshl_b32 s33, s33, 2
    s_add_u32 s33, s33, s28
    s_lshl_b32 s33, s33, 10
    s_add_u32 s33, s33, 0x4100000
    v_mov_b32 v100, 0xffbfffbf
    v_mov_b32 v101, 0xffbfffbf
    v_mov_b32 v102, 0xffbfffbf
    v_mov_b32 v103, 0xffbfffbf
    buffer_store_dwordx4 v[100:103], v10, s[8:11], s33 offen sc1
    s_add_u32 s30, s30, s31
    s_cmp_lt_u32 s30, s32
    s_cbranch_scc1 L_pgl_kv_0
    s_waitcnt vmcnt(0)
    s_barrier
    s_add_u32 s58, s58, 1
    s_cmp_lg_u32 s28, 0
    s_cbranch_scc1 L_kvp_3
    s_cmp_lt_i32 s58, 1
    s_cbranch_scc1 L_kvp_3
    s_lshl_b32 s33, s40, 5
    s_add_u32 s33, s33, s41
    s_lshl_b32 s33, s33, 2
    s_add_u32 s33, s33, 0x180000
    v_mov_b32 v28, s33
    v_mov_b32 v29, s58
    s_mov_b64 exec, 1
    buffer_store_dword v29, v28, s[8:11], 0 offen sc1
    s_mov_b64 exec, -1
L_kvp_3:
    s_branch L_pgd_kv
L_pg_kv_1:
L_pgl_kv_1:
    s_waitcnt vmcnt(5)
    s_barrier
    s_cmp_lg_u32 s28, 0
    s_cbranch_scc1 L_kvp_4
    s_cmp_lt_i32 s58, 1
    s_cbranch_scc1 L_kvp_4
    s_lshl_b32 s33, s40, 5
    s_add_u32 s33, s33, s41
    s_lshl_b32 s33, s33, 2
    s_add_u32 s33, s33, 0x180000
    v_mov_b32 v28, s33
    v_mov_b32 v29, s58
    s_mov_b64 exec, 1
    buffer_store_dword v29, v28, s[8:11], 0 offen sc1
    s_mov_b64 exec, -1
L_kvp_4:
    s_add_u32 s58, s58, 1
    v_add_u32 v8, s37, v6
    v_add_u32 v9, s37, v7
    s_add_u32 s34, s30, s31
    s_min_u32 s34, s34, 63
    s_xor_b32 s37, s37, 36864
    s_lshl_b32 s35, s34, 2
    s_add_u32 s35, s35, s28
    s_mul_i32 s35, s35, 9216
    s_mul_i32 s36, s28, 9216
    s_add_u32 s36, s36, s37
    ds_read_b128 v[32:35], v8 offset:0
    ds_read_b128 v[36:39], v8 offset:18432
    ds_read_b128 v[40:43], v9 offset:0
    ds_read_b128 v[44:47], v9 offset:18432
    ds_read_b128 v[48:51], v8 offset:1024
    ds_read_b128 v[52:55], v8 offset:19456
    ds_read_b128 v[56:59], v9 offset:1024
    s_waitcnt lgkmcnt(6)
    v_mfma_f32_16x16x32_bf16 v[64:67], v[224:227], v[32:35], 0
    ds_read_b128 v[60:63], v9 offset:19456
    v_mfma_f32_16x16x32_bf16 v[68:71], v[228:231], v[32:35], 0
    s_add_u32 m0, s36, 0
    s_nop 0
    buffer_load_dwordx4 v4, s[24:27], s35 offen offset:0 sc1 lds
    v_mfma_f32_16x16x32_bf16 v[72:75], v[232:235], v[32:35], 0
    v_mfma_f32_16x16x32_bf16 v[76:79], v[236:239], v[32:35], 0
    s_waitcnt lgkmcnt(6)
    v_mfma_f32_16x16x32_bf16 v[80:83], v[224:227], v[36:39], 0
    ds_read_b128 v[32:35], v8 offset:2048
    v_mfma_f32_16x16x32_bf16 v[84:87], v[228:231], v[36:39], 0
    v_mfma_f32_16x16x32_bf16 v[88:91], v[232:235], v[36:39], 0
    v_mfma_f32_16x16x32_bf16 v[92:95], v[236:239], v[36:39], 0
    s_waitcnt lgkmcnt(6)
    v_mfma_f32_16x16x32_bf16 v[64:67], v[240:243], v[40:43], v[64:67]
    ds_read_b128 v[36:39], v8 offset:20480
    v_mfma_f32_16x16x32_bf16 v[68:71], v[244:247], v[40:43], v[68:71]
    s_add_u32 m0, s36, 896
    s_nop 0
    buffer_load_dwordx4 v4, s[24:27], s35 offen offset:128 sc1 lds
    v_mfma_f32_16x16x32_bf16 v[72:75], v[248:251], v[40:43], v[72:75]
    v_mfma_f32_16x16x32_bf16 v[76:79], v[252:255], v[40:43], v[76:79]
    s_waitcnt lgkmcnt(6)
    v_mfma_f32_16x16x32_bf16 v[80:83], v[240:243], v[44:47], v[80:83]
    ds_read_b128 v[40:43], v9 offset:2048
    v_mfma_f32_16x16x32_bf16 v[84:87], v[244:247], v[44:47], v[84:87]
    v_mfma_f32_16x16x32_bf16 v[88:91], v[248:251], v[44:47], v[88:91]
    v_mfma_f32_16x16x32_bf16 v[92:95], v[252:255], v[44:47], v[92:95]
    s_waitcnt lgkmcnt(6)
    v_mfma_f32_16x16x32_bf16 v[64:67], a[0:3], v[48:51], v[64:67]
    ds_read_b128 v[44:47], v9 offset:20480
    v_mfma_f32_16x16x32_bf16 v[68:71], a[4:7], v[48:51], v[68:71]
    s_add_u32 m0, s36, 1792
    s_nop 0
    buffer_load_dwordx4 v4, s[24:27], s35 offen offset:256 sc1 lds
    v_mfma_f32_16x16x32_bf16 v[72:75], a[8:11], v[48:51], v[72:75]
    v_mfma_f32_16x16x32_bf16 v[76:79], a[12:15], v[48:51], v[76:79]
    s_waitcnt lgkmcnt(6)
    v_mfma_f32_16x16x32_bf16 v[80:83], a[0:3], v[52:55], v[80:83]
    ds_read_b128 v[48:51], v8 offset:3072
    v_mfma_f32_16x16x32_bf16 v[84:87], a[4:7], v[52:55], v[84:87]
    v_mfma_f32_16x16x32_bf16 v[88:91], a[8:11], v[52:55], v[88:91]
    v_mfma_f32_16x16x32_bf16 v[92:95], a[12:15], v[52:55], v[92:95]
    s_waitcnt lgkmcnt(6)
    v_mfma_f32_16x16x32_bf16 v[64:67], a[16:19], v[56:59], v[64:67]
    ds_read_b128 v[52:55], v8 offset:21504
    v_mfma_f32_16x16x32_bf16 v[68:71], a[20:23], v[56:59], v[68:71]
    s_add_u32 m0, s36, 2688
    s_nop 0
    buffer_load_dwordx4 v4, s[24:27], s35 offen offset:384 sc1 lds
    v_mfma_f32_16x16x32_bf16 v[72:75], a[24:27], v[56:59], v[72:75]
    v_mfma_f32_16x16x32_bf16 v[76:79], a[28:31], v[56:59], v[76:79]
    s_waitcnt lgkmcnt(6)
    v_mfma_f32_16x16x32_bf16 v[80:83], a[16:19], v[60:63], v[80:83]
    ds_read_b128 v[56:59], v9 offset:3072
    v_mfma_f32_16x16x32_bf16 v[84:87], a[20:23], v[60:63], v[84:87]
    v_mfma_f32_16x16x32_bf16 v[88:91], a[24:27], v[60:63], v[88:91]
    v_mfma_f32_16x16x32_bf16 v[92:95], a[28:31], v[60:63], v[92:95]
    s_waitcnt lgkmcnt(6)
    v_mfma_f32_16x16x32_bf16 v[64:67], a[32:35], v[32:35], v[64:67]
    ds_read_b128 v[60:63], v9 offset:21504
    v_mfma_f32_16x16x32_bf16 v[68:71], a[36:39], v[32:35], v[68:71]
    s_add_u32 m0, s36, 3584
    s_nop 0
    buffer_load_dwordx4 v4, s[24:27], s35 offen offset:512 sc1 lds
    v_mfma_f32_16x16x32_bf16 v[72:75], a[40:43], v[32:35], v[72:75]
    v_mfma_f32_16x16x32_bf16 v[76:79], a[44:47], v[32:35], v[76:79]
    s_waitcnt lgkmcnt(6)
    v_mfma_f32_16x16x32_bf16 v[80:83], a[32:35], v[36:39], v[80:83]
    ds_read_b128 v[32:35], v8 offset:4096
    v_mfma_f32_16x16x32_bf16 v[84:87], a[36:39], v[36:39], v[84:87]
    v_mfma_f32_16x16x32_bf16 v[88:91], a[40:43], v[36:39], v[88:91]
    v_mfma_f32_16x16x32_bf16 v[92:95], a[44:47], v[36:39], v[92:95]
    s_waitcnt lgkmcnt(6)
    v_mfma_f32_16x16x32_bf16 v[64:67], a[48:51], v[40:43], v[64:67]
    ds_read_b128 v[36:39], v8 offset:22528
    v_mfma_f32_16x16x32_bf16 v[68:71], a[52:55], v[40:43], v[68:71]
    s_add_u32 m0, s36, 4480
    s_nop 0
    buffer_load_dwordx4 v4, s[24:27], s35 offen offset:640 sc1 lds
    v_mfma_f32_16x16x32_bf16 v[72:75], a[56:59], v[40:43], v[72:75]
    v_mfma_f32_16x16x32_bf16 v[76:79], a[60:63], v[40:43], v[76:79]
    s_waitcnt lgkmcnt(6)
    v_mfma_f32_16x16x32_bf16 v[80:83], a[48:51], v[44:47], v[80:83]
    ds_read_b128 v[40:43], v9 offset:4096
    v_mfma_f32_16x16x32_bf16 v[84:87], a[52:55], v[44:47], v[84:87]
    v_mfma_f32_16x16x32_bf16 v[88:91], a[56:59], v[44:47], v[88:91]
    v_mfma_f32_16x16x32_bf16 v[92:95], a[60:63], v[44:47], v[92:95]
    s_waitcnt lgkmcnt(6)
    v_mfma_f32_16x16x32_bf16 v[64:67], a[64:67], v[48:51], v[64:67]
    ds_read_b128 v[44:47], v9 offset:22528
    v_mfma_f32_16x16x32_bf16 v[68:71], a[68:71], v[48:51], v[68:71]
    s_add_u32 m0, s36, 5376
    s_nop 0
    buffer_load_dwordx4 v4, s[24:27], s35 offen offset:768 sc1 lds
    v_mfma_f32_16x16x32_bf16 v[72:75], a[72:75], v[48:51], v[72:75]
    v_mfma_f32_16x16x32_bf16 v[76:79], a[76:79], v[48:51], v[76:79]
    s_waitcnt lgkmcnt(6)
    v_mfma_f32_16x16x32_bf16 v[80:83], a[64:67], v[52:55], v[80:83]
    ds_read_b128 v[48:51], v8 offset:5120
    v_mfma_f32_16x16x32_bf16 v[84:87], a[68:71], v[52:55], v[84:87]
    v_mfma_f32_16x16x32_bf16 v[88:91], a[72:75], v[52:55], v[88:91]
    v_mfma_f32_16x16x32_bf16 v[92:95], a[76:79], v[52:55], v[92:95]
    s_waitcnt lgkmcnt(6)
    v_mfma_f32_16x16x32_bf16 v[64:67], a[80:83], v[56:59], v[64:67]
    ds_read_b128 v[52:55], v8 offset:23552
    v_mfma_f32_16x16x32_bf16 v[68:71], a[84:87], v[56:59], v[68:71]
    s_add_u32 m0, s36, 6272
    s_nop 0
    buffer_load_dwordx4 v4, s[24:27], s35 offen offset:896 sc1 lds
    v_mfma_f32_16x16x32_bf16 v[72:75], a[88:91], v[56:59], v[72:75]
    v_mfma_f32_16x16x32_bf16 v[76:79], a[92:95], v[56:59], v[76:79]
    s_waitcnt lgkmcnt(6)
    v_mfma_f32_16x16x32_bf16 v[80:83], a[80:83], v[60:63], v[80:83]
    ds_read_b128 v[56:59], v9 offset:5120
    v_mfma_f32_16x16x32_bf16 v[84:87], a[84:87], v[60:63], v[84:87]
    v_mfma_f32_16x16x32_bf16 v[88:91], a[88:91], v[60:63], v[88:91]
    v_mfma_f32_16x16x32_bf16 v[92:95], a[92:95], v[60:63], v[92:95]
    s_waitcnt lgkmcnt(6)
    v_mfma_f32_16x16x32_bf16 v[64:67], a[96:99], v[32:35], v[64:67]
    ds_read_b128 v[60:63], v9 offset:23552
    v_mfma_f32_16x16x32_bf16 v[68:71], a[100:103], v[32:35], v[68:71]
    s_add_u32 m0, s36, 7168
    s_nop 0
    buffer_load_dwordx4 v4, s[24:27], s35 offen offset:1024 sc1 lds
    v_mfma_f32_16x16x32_bf16 v[72:75], a[104:107], v[32:35], v[72:75]
    v_mfma_f32_16x16x32_bf16 v[76:79], a[108:111], v[32:35], v[76:79]
    s_waitcnt lgkmcnt(6)
    v_mfma_f32_16x16x32_bf16 v[80:83], a[96:99], v[36:39], v[80:83]
    ds_read_b128 v[32:35], v8 offset:6144
    v_mfma_f32_16x16x32_bf16 v[84:87], a[100:103], v[36:39], v[84:87]
    v_mfma_f32_16x16x32_bf16 v[88:91], a[104:107], v[36:39], v[88:91]
    v_mfma_f32_16x16x32_bf16 v[92:95], a[108:111], v[36:39], v[92:95]
    s_waitcnt lgkmcnt(6)
    v_mfma_f32_16x16x32_bf16 v[64:67], a[112:115], v[40:43], v[64:67]
    ds_read_b128 v[36:39], v8 offset:24576
    v_mfma_f32_16x16x32_bf16 v[68:71], a[116:119], v[40:43], v[68:71]
    v_mfma_f32_16x16x32_bf16 v[72:75], a[120:123], v[40:43], v[72:75]
    v_mfma_f32_16x16x32_bf16 v[76:79], a[124:127], v[40:43], v[76:79]
    s_waitcnt lgkmcnt(6)
    v_mfma_f32_16x16x32_bf16 v[80:83], a[112:115], v[44:47], v[80:83]
    ds_read_b128 v[40:43], v9 offset:6144
    v_mfma_f32_16x16x32_bf16 v[84:87], a[116:119], v[44:47], v[84:87]
    v_mfma_f32_16x16x32_bf16 v[88:91], a[120:123], v[44:47], v[88:91]
    v_mfma_f32_16x16x32_bf16 v[92:95], a[124:127], v[44:47], v[92:95]
    s_waitcnt lgkmcnt(6)
    v_mfma_f32_16x16x32_bf16 v[64:67], a[128:131], v[48:51], v[64:67]
    ds_read_b128 v[44:47], v9 offset:24576
    v_mfma_f32_16x16x32_bf16 v[68:71], a[132:135], v[48:51], v[68:71]
    v_mfma_f32_16x16x32_bf16 v[72:75], a[136:139], v[48:51], v[72:75]
    v_mfma_f32_16x16x32_bf16 v[76:79], a[140:143], v[48:51], v[76:79]
    s_waitcnt lgkmcnt(6)
    v_mfma_f32_16x16x32_bf16 v[80:83], a[128:131], v[52:55], v[80:83]
    ds_read_b128 v[48:51], v8 offset:7168
    v_mfma_f32_16x16x32_bf16 v[84:87], a[132:135], v[52:55], v[84:87]
    v_mfma_f32_16x16x32_bf16 v[88:91], a[136:139], v[52:55], v[88:91]
    v_mfma_f32_16x16x32_bf16 v[92:95], a[140:143], v[52:55], v[92:95]
    s_waitcnt lgkmcnt(6)
    v_mfma_f32_16x16x32_bf16 v[64:67], a[144:147], v[56:59], v[64:67]
    ds_read_b128 v[52:55], v8 offset:25600
    v_mfma_f32_16x16x32_bf16 v[68:71], a[148:151], v[56:59], v[68:71]
    v_mfma_f32_16x16x32_bf16 v[72:75], a[152:155], v[56:59], v[72:75]
    v_mfma_f32_16x16x32_bf16 v[76:79], a[156:159], v[56:59], v[76:79]
    s_waitcnt lgkmcnt(6)
    v_mfma_f32_16x16x32_bf16 v[80:83], a[144:147], v[60:63], v[80:83]
    ds_read_b128 v[56:59], v9 offset:7168
    v_mfma_f32_16x16x32_bf16 v[84:87], a[148:151], v[60:63], v[84:87]
    v_mfma_f32_16x16x32_bf16 v[88:91], a[152:155], v[60:63], v[88:91]
    v_mfma_f32_16x16x32_bf16 v[92:95], a[156:159], v[60:63], v[92:95]
    s_waitcnt lgkmcnt(6)
    v_mfma_f32_16x16x32_bf16 v[64:67], a[160:163], v[32:35], v[64:67]
    ds_read_b128 v[60:63], v9 offset:25600
    v_mfma_f32_16x16x32_bf16 v[68:71], a[164:167], v[32:35], v[68:71]
    v_mfma_f32_16x16x32_bf16 v[72:75], a[168:171], v[32:35], v[72:75]
    v_mfma_f32_16x16x32_bf16 v[76:79], a[172:175], v[32:35], v[76:79]
    s_waitcnt lgkmcnt(6)
    v_mfma_f32_16x16x32_bf16 v[80:83], a[160:163], v[36:39], v[80:83]
    ds_read_b128 v[32:35], v8 offset:8192
    v_mfma_f32_16x16x32_bf16 v[84:87], a[164:167], v[36:39], v[84:87]
    v_mfma_f32_16x16x32_bf16 v[88:91], a[168:171], v[36:39], v[88:91]
    v_mfma_f32_16x16x32_bf16 v[92:95], a[172:175], v[36:39], v[92:95]
    s_waitcnt lgkmcnt(6)
    v_mfma_f32_16x16x32_bf16 v[64:67], a[176:179], v[40:43], v[64:67]
    ds_read_b128 v[36:39], v8 offset:26624
    v_mfma_f32_16x16x32_bf16 v[68:71], a[180:183], v[40:43], v[68:71]
    v_mfma_f32_16x16x32_bf16 v[72:75], a[184:187], v[40:43], v[72:75]
    v_mfma_f32_16x16x32_bf16 v[76:79], a[188:191], v[40:43], v[76:79]
    s_waitcnt lgkmcnt(6)
    v_mfma_f32_16x16x32_bf16 v[80:83], a[176:179], v[44:47], v[80:83]
    ds_read_b128 v[40:43], v9 offset:8192
    v_mfma_f32_16x16x32_bf16 v[84:87], a[180:183], v[44:47], v[84:87]
    v_mfma_f32_16x16x32_bf16 v[88:91], a[184:187], v[44:47], v[88:91]
    v_mfma_f32_16x16x32_bf16 v[92:95], a[188:191], v[44:47], v[92:95]
    s_waitcnt lgkmcnt(6)
    v_mfma_f32_16x16x32_bf16 v[64:67], a[192:195], v[48:51], v[64:67]
    ds_read_b128 v[44:47], v9 offset:26624
    v_mfma_f32_16x16x32_bf16 v[68:71], a[196:199], v[48:51], v[68:71]
    v_mfma_f32_16x16x32_bf16 v[72:75], a[200:203], v[48:51], v[72:75]
    v_mfma_f32_16x16x32_bf16 v[76:79], a[204:207], v[48:51], v[76:79]
    s_waitcnt lgkmcnt(6)
    v_mfma_f32_16x16x32_bf16 v[80:83], a[192:195], v[52:55], v[80:83]
    v_mfma_f32_16x16x32_bf16 v[84:87], a[196:199], v[52:55], v[84:87]
    v_mfma_f32_16x16x32_bf16 v[88:91], a[200:203], v[52:55], v[88:91]
    v_mfma_f32_16x16x32_bf16 v[92:95], a[204:207], v[52:55], v[92:95]
    s_waitcnt lgkmcnt(5)
    v_mfma_f32_16x16x32_bf16 v[64:67], a[208:211], v[56:59], v[64:67]
    v_mfma_f32_16x16x32_bf16 v[68:71], a[212:215], v[56:59], v[68:71]
    v_mfma_f32_16x16x32_bf16 v[72:75], a[216:219], v[56:59], v[72:75]
    v_mfma_f32_16x16x32_bf16 v[76:79], a[220:223], v[56:59], v[76:79]
    s_waitcnt lgkmcnt(4)
    v_mfma_f32_16x16x32_bf16 v[80:83], a[208:211], v[60:63], v[80:83]
    v_mfma_f32_16x16x32_bf16 v[84:87], a[212:215], v[60:63], v[84:87]
    v_mfma_f32_16x16x32_bf16 v[88:91], a[216:219], v[60:63], v[88:91]
    v_mfma_f32_16x16x32_bf16 v[92:95], a[220:223], v[60:63], v[92:95]
    s_waitcnt lgkmcnt(3)
    v_mfma_f32_16x16x32_bf16 v[64:67], a[224:227], v[32:35], v[64:67]
    v_mfma_f32_16x16x32_bf16 v[68:71], a[228:231], v[32:35], v[68:71]
    v_mfma_f32_16x16x32_bf16 v[72:75], a[232:235], v[32:35], v[72:75]
    v_mfma_f32_16x16x32_bf16 v[76:79], a[236:239], v[32:35], v[76:79]
    s_waitcnt lgkmcnt(2)
    v_mfma_f32_16x16x32_bf16 v[80:83], a[224:227], v[36:39], v[80:83]
    v_mfma_f32_16x16x32_bf16 v[84:87], a[228:231], v[36:39], v[84:87]
    v_mfma_f32_16x16x32_bf16 v[88:91], a[232:235], v[36:39], v[88:91]
    v_mfma_f32_16x16x32_bf16 v[92:95], a[236:239], v[36:39], v[92:95]
    s_waitcnt lgkmcnt(1)
    v_mfma_f32_16x16x32_bf16 v[64:67], a[240:243], v[40:43], v[64:67]
    v_mfma_f32_16x16x32_bf16 v[68:71], a[244:247], v[40:43], v[68:71]
    v_mfma_f32_16x16x32_bf16 v[72:75], a[248:251], v[40:43], v[72:75]
    v_mfma_f32_16x16x32_bf16 v[76:79], a[252:255], v[40:43], v[76:79]
    s_waitcnt lgkmcnt(0)
    v_mfma_f32_16x16x32_bf16 v[80:83], a[240:243], v[44:47], v[80:83]
    v_mfma_f32_16x16x32_bf16 v[84:87], a[244:247], v[44:47], v[84:87]
    v_mfma_f32_16x16x32_bf16 v[88:91], a[248:251], v[44:47], v[88:91]
    v_mfma_f32_16x16x32_bf16 v[92:95], a[252:255], v[44:47], v[92:95]
    s_lshl_b32 s33, s30, 5
    s_add_u32 s33, s33, s40
    s_lshl_b32 s33, s33, 13
    s_and_b32 s34, s28, 1
    s_lshl_b32 s34, s34, 11
    s_add_u32 s33, s33, s34
    s_add_u32 s33, s33, 0x1000000
    v_lshlrev_b32 v10, 4, v1
    v_cvt_pk_bf16_f32 v12, v64, v65
    v_cvt_pk_bf16_f32 v13, v68, v69
    v_cvt_pk_bf16_f32 v14, v66, v67
    v_cvt_pk_bf16_f32 v15, v70, v71
    buffer_store_dwordx4 v[12:15], v10, s[8:11], s33 offen offset:0 sc1
    v_cvt_pk_bf16_f32 v16, v72, v73
    v_cvt_pk_bf16_f32 v17, v76, v77
    v_cvt_pk_bf16_f32 v18, v74, v75
    v_cvt_pk_bf16_f32 v19, v78, v79
    buffer_store_dwordx4 v[16:19], v10, s[8:11], s33 offen offset:1024 sc1
    v_cvt_pk_bf16_f32 v20, v80, v81
    v_cvt_pk_bf16_f32 v21, v84, v85
    v_cvt_pk_bf16_f32 v22, v82, v83
    v_cvt_pk_bf16_f32 v23, v86, v87
    s_add_u32 s33, s33, 4096
    buffer_store_dwordx4 v[20:23], v10, s[8:11], s33 offen offset:0 sc1
    v_cvt_pk_bf16_f32 v24, v88, v89
    v_cvt_pk_bf16_f32 v25, v92, v93
    v_cvt_pk_bf16_f32 v26, v90, v91
    v_cvt_pk_bf16_f32 v27, v94, v95
    buffer_store_dwordx4 v[24:27], v10, s[8:11], s33 offen offset:1024 sc1
    s_lshl_b32 s33, s30, 5
    s_add_u32 s33, s33, s40
    s_lshl_b32 s33, s33, 2
    s_add_u32 s33, s33, s28
    s_lshl_b32 s33, s33, 10
    s_add_u32 s33, s33, 0x4100000
    v_mov_b32 v100, 0xffbfffbf
    v_mov_b32 v101, 0xffbfffbf
    v_mov_b32 v102, 0xffbfffbf
    v_mov_b32 v103, 0xffbfffbf
    buffer_store_dwordx4 v[100:103], v10, s[8:11], s33 offen sc1
    s_add_u32 s30, s30, s31
    s_cmp_lt_u32 s30, s32
    s_cbranch_scc1 L_pgl_kv_1
    s_waitcnt vmcnt(0)
    s_barrier
    s_add_u32 s58, s58, 1
    s_cmp_lg_u32 s28, 0
    s_cbranch_scc1 L_kvp_5
    s_cmp_lt_i32 s58, 1
    s_cbranch_scc1 L_kvp_5
    s_lshl_b32 s33, s40, 5
    s_add_u32 s33, s33, s41
    s_lshl_b32 s33, s33, 2
    s_add_u32 s33, s33, 0x180000
    v_mov_b32 v28, s33
    v_mov_b32 v29, s58
    s_mov_b64 exec, 1
    buffer_store_dword v29, v28, s[8:11], 0 offen sc1
    s_mov_b64 exec, -1
L_kvp_5:
L_pgd_kv:
    s_cmp_ge_u32 s38, 216
    s_cbranch_scc1 L_noa1
    s_mul_i32 s40, s38, 3641
    s_lshr_b32 s40, s40, 16
    s_mul_i32 s41, s40, 18
    s_sub_u32 s41, s38, s41
    s_mov_b32 s24, s64
    s_and_b32 s25, s65, 0xffff
    s_mov_b32 s26, 0x240000
    s_mov_b32 s27, 0x20000
    s_mov_b32 s20, s66
    s_and_b32 s21, s67, 0xffff
    s_mov_b32 s22, 0x1e6000
    s_mov_b32 s23, 0x20000
    s_lshl_b32 s33, s40, 2
    s_add_u32 s33, s33, s28
    s_mul_i32 s29, s33, 72
    s_mov_b32 s30, s41
    s_mov_b32 s31, 18
    s_mov_b32 s32, 64
    s_and_b32 s42, s33, 15
    s_lshl_b32 s42, s42, 1
    v_and_b32 v1, 63, v0
    v_lshrrev_b32 v2, 4, v1
    v_and_b32 v3, 15, v1
    s_barrier
    v_lshrrev_b32 v8, 3, v1
    v_and_b32 v9, 7, v1
    v_lshrrev_b32 v10, 1, v8
    v_xor_b32 v9, v9, v10
    v_xor_b32 v10, 4, v9
    v_mul_u32_u24 v8, 1152, v8
    v_lshl_add_u32 v4, v9, 4, v8
    v_lshl_add_u32 v5, v10, 4, v8
    v_lshrrev_b32 v8, 3, v3
    v_mul_u32_u24 v8, 9216, v8
    v_and_b32 v9, 7, v3
    v_lshl_add_u32 v8, v9, 7, v8
    v_lshrrev_b32 v9, 1, v3
    v_xor_b32 v9, v9, v2
    v_lshl_add_u32 v6, v9, 4, v8
    v_xor_b32 v7, 64, v6
    s_and_b32 s33, s28, 1
    s_cmp_eq_u32 s33, 1
    s_cselect_b64 vcc, -1, 0
    v_cndmask_b32 v16, v4, v5, vcc
    v_mov_b32 v18, v6
    v_mov_b32 v19, v7
    s_mov_b32 s37, 0
    v_lshrrev_b32 v4, 3, v1
    v_and_b32 v5, 7, v1
    v_and_b32 v6, 2, v4
    v_xor_b32 v5, v5, v6
    v_xor_b32 v6, 4, v5
    v_mul_u32_u24 v4, 3456, v4
    v_and_b32 v7, 1, v5
    v_lshl_add_u32 v7, v7, 4, v4
    v_bfe_u32 v8, v5, 1, 1
    v_lshl_add_u32 v7, v8, 2, v7
    v_lshrrev_b32 v8, 2, v5
    v_mul_u32_u24 v8, 36, v8
    v_add_u32 v5, v7, v8
    v_and_b32 v7, 1, v6
    v_lshl_add_u32 v7, v7, 4, v4
    v_bfe_u32 v8, v6, 1, 1
    v_lshl_add_u32 v7, v8, 2, v7
    v_lshrrev_b32 v8, 2, v6
    v_mul_u32_u24 v8, 36, v8
    v_add_u32 v6, v7, v8
    v_lshrrev_b32 v7, 2, v3
    v_and_b32 v8, 3, v3
    v_lshlrev_b32 v9, 10, v2
    v_lshl_add_u32 v9, v7, 7, v9
    v_lshl_add_u32 v9, v8, 3, v9
    v_lshrrev_b32 v7, 1, v7
    v_and_b32 v8, 1, v2
    v_lshl_add_u32 v7, v8, 1, v7
    v_lshlrev_b32 v7, 5, v7
    s_mul_i32 s33, s28, 20480
    s_add_u32 s33, s33, 73728
    v_add_u32 v9, s33, v9
    v_xor_b32 v10, 0, v7
    v_add_u32 v10, v10, v9
    v_xor_b32 v11, 32, v7
    v_add_u32 v11, v11, v9
    v_xor_b32 v12, 64, v7
    v_add_u32 v12, v12, v9
    v_xor_b32 v13, 96, v7
    v_add_u32 v13, v13, v9
    s_add_u32 m0, s33, 0
    s_add_u32 s34, s29, 0
    buffer_load_dwordx4 v5, s[20:23], s34 offen lds
    s_add_u32 m0, s33, 1024
    s_add_u32 s34, s29, 27648
    buffer_load_dwordx4 v6, s[20:23], s34 offen lds
    s_add_u32 m0, s33, 2048
    s_add_u32 s34, s29, 55296
    buffer_load_dwordx4 v5, s[20:23], s34 offen lds
    s_add_u32 m0, s33, 3072
    s_add_u32 s34, s29, 82944
    buffer_load_dwordx4 v6, s[20:23], s34 offen lds
    s_add_u32 m0, s33, 4096
    s_add_u32 s34, s29, 110592
    buffer_load_dwordx4 v5, s[20:23], s34 offen lds
    s_add_u32 m0, s33, 5120
    s_add_u32 s34, s29, 138240
    buffer_load_dwordx4 v6, s[20:23], s34 offen lds
    s_add_u32 m0, s33, 6144
    s_add_u32 s34, s29, 165888
    buffer_load_dwordx4 v5, s[20:23], s34 offen lds
    s_add_u32 m0, s33, 7168
    s_add_u32 s34, s29, 193536
    buffer_load_dwordx4 v6, s[20:23], s34 offen lds
    s_add_u32 m0, s33, 8192
    s_add_u32 s34, s29, 221184
    buffer_load_dwordx4 v5, s[20:23], s34 offen lds
    s_add_u32 m0, s33, 9216
    s_add_u32 s34, s29, 248832
    buffer_load_dwordx4 v6, s[20:23], s34 offen lds
    s_add_u32 m0, s33, 10240
    s_add_u32 s34, s29, 276480
    buffer_load_dwordx4 v5, s[20:23], s34 offen lds
    s_add_u32 m0, s33, 11264
    s_add_u32 s34, s29, 304128
    buffer_load_dwordx4 v6, s[20:23], s34 offen lds
    s_add_u32 m0, s33, 12288
    s_add_u32 s34, s29, 331776
    buffer_load_dwordx4 v5, s[20:23], s34 offen lds
    s_add_u32 m0, s33, 13312
    s_add_u32 s34, s29, 359424
    buffer_load_dwordx4 v6, s[20:23], s34 offen lds
    s_add_u32 m0, s33, 14336
    s_add_u32 s34, s29, 387072
    buffer_load_dwordx4 v5, s[20:23], s34 offen lds
    s_add_u32 m0, s33, 15360
    s_add_u32 s34, s29, 414720
    buffer_load_dwordx4 v6, s[20:23], s34 offen lds
    s_add_u32 m0, s33, 16384
    s_add_u32 s34, s29, 442368
    buffer_load_dwordx4 v5, s[20:23], s34 offen lds
    s_add_u32 m0, s33, 17408
    s_add_u32 s34, s29, 470016
    buffer_load_dwordx4 v6, s[20:23], s34 offen lds
    s_add_u32 m0, s33, 18432
    s_add_u32 s34, s29, 497664
    buffer_load_dwordx4 v5, s[20:23], s34 offen lds
    s_add_u32 m0, s33, 19456
    s_add_u32 s34, s29, 525312
    buffer_load_dwordx4 v6, s[20:23], s34 offen lds
    s_lshl_b32 s35, s30, 2
    s_add_u32 s35, s35, s28
    s_mul_i32 s35, s35, 9216
    s_mul_i32 s36, s28, 9216
    s_add_u32 s36, s36, 0
    s_add_u32 m0, s36, 0
    s_nop 0
    buffer_load_dwordx4 v16, s[24:27], s35 offen offset:0 sc1 lds
    s_add_u32 m0, s36, 896
    s_nop 0
    buffer_load_dwordx4 v16, s[24:27], s35 offen offset:128 sc1 lds
    s_add_u32 m0, s36, 1792
    s_nop 0
    buffer_load_dwordx4 v16, s[24:27], s35 offen offset:256 sc1 lds
    s_add_u32 m0, s36, 2688
    s_nop 0
    buffer_load_dwordx4 v16, s[24:27], s35 offen offset:384 sc1 lds
    s_add_u32 m0, s36, 3584
    s_nop 0
    buffer_load_dwordx4 v16, s[24:27], s35 offen offset:512 sc1 lds
    s_add_u32 m0, s36, 4480
    s_nop 0
    buffer_load_dwordx4 v16, s[24:27], s35 offen offset:640 sc1 lds
    s_add_u32 m0, s36, 5376
    s_nop 0
    buffer_load_dwordx4 v16, s[24:27], s35 offen offset:768 sc1 lds
    s_add_u32 m0, s36, 6272
    s_nop 0
    buffer_load_dwordx4 v16, s[24:27], s35 offen offset:896 sc1 lds
    s_add_u32 m0, s36, 7168
    s_nop 0
    buffer_load_dwordx4 v16, s[24:27], s35 offen offset:1024 sc1 lds
    s_waitcnt vmcnt(25)
    ds_read_b64_tr_b16 v[224:225], v10 offset:0
    ds_read_b64_tr_b16 v[226:227], v10 offset:512
    ds_read_b64_tr_b16 v[228:229], v11 offset:0
    ds_read_b64_tr_b16 v[230:231], v11 offset:512
    ds_read_b64_tr_b16 v[232:233], v12 offset:0
    ds_read_b64_tr_b16 v[234:235], v12 offset:512
    ds_read_b64_tr_b16 v[236:237], v13 offset:0
    ds_read_b64_tr_b16 v[238:239], v13 offset:512
    s_waitcnt lgkmcnt(0)
    s_add_u32 m0, s33, 0
    s_add_u32 s34, s29, 552960
    buffer_load_dwordx4 v5, s[20:23], s34 offen lds
    s_add_u32 m0, s33, 1024
    s_add_u32 s34, s29, 580608
    buffer_load_dwordx4 v6, s[20:23], s34 offen lds
    s_add_u32 m0, s33, 2048
    s_add_u32 s34, s29, 608256
    buffer_load_dwordx4 v5, s[20:23], s34 offen lds
    s_add_u32 m0, s33, 3072
    s_add_u32 s34, s29, 635904
    buffer_load_dwordx4 v6, s[20:23], s34 offen lds
    s_waitcnt vmcnt(25)
    ds_read_b64_tr_b16 v[240:241], v10 offset:4096
    ds_read_b64_tr_b16 v[242:243], v10 offset:4608
    ds_read_b64_tr_b16 v[244:245], v11 offset:4096
    ds_read_b64_tr_b16 v[246:247], v11 offset:4608
    ds_read_b64_tr_b16 v[248:249], v12 offset:4096
    ds_read_b64_tr_b16 v[250:251], v12 offset:4608
    ds_read_b64_tr_b16 v[252:253], v13 offset:4096
    ds_read_b64_tr_b16 v[254:255], v13 offset:4608
    s_waitcnt lgkmcnt(0)
    s_add_u32 m0, s33, 4096
    s_add_u32 s34, s29, 663552
    buffer_load_dwordx4 v5, s[20:23], s34 offen lds
    s_add_u32 m0, s33, 5120
    s_add_u32 s34, s29, 691200
    buffer_load_dwordx4 v6, s[20:23], s34 offen lds
    s_add_u32 m0, s33, 6144
    s_add_u32 s34, s29, 718848
    buffer_load_dwordx4 v5, s[20:23], s34 offen lds
    s_add_u32 m0, s33, 7168
    s_add_u32 s34, s29, 746496
    buffer_load_dwordx4 v6, s[20:23], s34 offen lds
    s_waitcnt vmcnt(25)
    ds_read_b64_tr_b16 a[0:1], v10 offset:8192
    ds_read_b64_tr_b16 a[2:3], v10 offset:8704
    ds_read_b64_tr_b16 a[4:5], v11 offset:8192
    ds_read_b64_tr_b16 a[6:7], v11 offset:8704
    ds_read_b64_tr_b16 a[8:9], v12 offset:8192
    ds_read_b64_tr_b16 a[10:11], v12 offset:8704
    ds_read_b64_tr_b16 a[12:13], v13 offset:8192
    ds_read_b64_tr_b16 a[14:15], v13 offset:8704
    s_waitcnt lgkmcnt(0)
    s_add_u32 m0, s33, 8192
    s_add_u32 s34, s29, 774144
    buffer_load_dwordx4 v5, s[20:23], s34 offen lds
    s_add_u32 m0, s33, 9216
    s_add_u32 s34, s29, 801792
    buffer_load_dwordx4 v6, s[20:23], s34 offen lds
    s_add_u32 m0, s33, 10240
    s_add_u32 s34, s29, 829440
    buffer_load_dwordx4 v5, s[20:23], s34 offen lds
    s_add_u32 m0, s33, 11264
    s_add_u32 s34, s29, 857088
    buffer_load_dwordx4 v6, s[20:23], s34 offen lds
    s_waitcnt vmcnt(25)
    ds_read_b64_tr_b16 a[16:17], v10 offset:12288
    ds_read_b64_tr_b16 a[18:19], v10 offset:12800
    ds_read_b64_tr_b16 a[20:21], v11 offset:12288
    ds_read_b64_tr_b16 a[22:23], v11 offset:12800
    ds_read_b64_tr_b16 a[24:25], v12 offset:12288
    ds_read_b64_tr_b16 a[26:27], v12 offset:12800
    ds_read_b64_tr_b16 a[28:29], v13 offset:12288
    ds_read_b64_tr_b16 a[30:31], v13 offset:12800
    s_waitcnt lgkmcnt(0)
    s_add_u32 m0, s33, 12288
    s_add_u32 s34, s29, 884736
    buffer_load_dwordx4 v5, s[20:23], s34 offen lds
    s_add_u32 m0, s33, 13312
    s_add_u32 s34, s29, 912384
    buffer_load_dwordx4 v6, s[20:23], s34 offen lds
    s_add_u32 m0, s33, 14336
    s_add_u32 s34, s29, 940032
    buffer_load_dwordx4 v5, s[20:23], s34 offen lds
    s_add_u32 m0, s33, 15360
    s_add_u32 s34, s29, 967680
    buffer_load_dwordx4 v6, s[20:23], s34 offen lds
    s_waitcnt vmcnt(25)
    ds_read_b64_tr_b16 a[32:33], v10 offset:16384
    ds_read_b64_tr_b16 a[34:35], v10 offset:16896
    ds_read_b64_tr_b16 a[36:37], v11 offset:16384
    ds_read_b64_tr_b16 a[38:39], v11 offset:16896
    ds_read_b64_tr_b16 a[40:41], v12 offset:16384
    ds_read_b64_tr_b16 a[42:43], v12 offset:16896
    ds_read_b64_tr_b16 a[44:45], v13 offset:16384
    ds_read_b64_tr_b16 a[46:47], v13 offset:16896
    s_waitcnt lgkmcnt(0)
    s_add_u32 m0, s33, 16384
    s_add_u32 s34, s29, 995328
    buffer_load_dwordx4 v5, s[20:23], s34 offen lds
    s_add_u32 m0, s33, 17408
    s_add_u32 s34, s29, 1022976
    buffer_load_dwordx4 v6, s[20:23], s34 offen lds
    s_add_u32 m0, s33, 18432
    s_add_u32 s34, s29, 1050624
    buffer_load_dwordx4 v5, s[20:23], s34 offen lds
    s_add_u32 m0, s33, 19456
    s_add_u32 s34, s29, 1078272
    buffer_load_dwordx4 v6, s[20:23], s34 offen lds
    s_waitcnt vmcnt(16)
    ds_read_b64_tr_b16 a[48:49], v10 offset:0
    ds_read_b64_tr_b16 a[50:51], v10 offset:512
    ds_read_b64_tr_b16 a[52:53], v11 offset:0
    ds_read_b64_tr_b16 a[54:55], v11 offset:512
    ds_read_b64_tr_b16 a[56:57], v12 offset:0
    ds_read_b64_tr_b16 a[58:59], v12 offset:512
    ds_read_b64_tr_b16 a[60:61], v13 offset:0
    ds_read_b64_tr_b16 a[62:63], v13 offset:512
    s_waitcnt lgkmcnt(0)
    s_add_u32 m0, s33, 0
    s_add_u32 s34, s29, 1105920
    buffer_load_dwordx4 v5, s[20:23], s34 offen lds
    s_add_u32 m0, s33, 1024
    s_add_u32 s34, s29, 1133568
    buffer_load_dwordx4 v6, s[20:23], s34 offen lds
    s_add_u32 m0, s33, 2048
    s_add_u32 s34, s29, 1161216
    buffer_load_dwordx4 v5, s[20:23], s34 offen lds
    s_add_u32 m0, s33, 3072
    s_add_u32 s34, s29, 1188864
    buffer_load_dwordx4 v6, s[20:23], s34 offen lds
    s_waitcnt vmcnt(16)
    ds_read_b64_tr_b16 a[64:65], v10 offset:4096
    ds_read_b64_tr_b16 a[66:67], v10 offset:4608
    ds_read_b64_tr_b16 a[68:69], v11 offset:4096
    ds_read_b64_tr_b16 a[70:71], v11 offset:4608
    ds_read_b64_tr_b16 a[72:73], v12 offset:4096
    ds_read_b64_tr_b16 a[74:75], v12 offset:4608
    ds_read_b64_tr_b16 a[76:77], v13 offset:4096
    ds_read_b64_tr_b16 a[78:79], v13 offset:4608
    s_waitcnt lgkmcnt(0)
    s_add_u32 m0, s33, 4096
    s_add_u32 s34, s29, 1216512
    buffer_load_dwordx4 v5, s[20:23], s34 offen lds
    s_add_u32 m0, s33, 5120
    s_add_u32 s34, s29, 1244160
    buffer_load_dwordx4 v6, s[20:23], s34 offen lds
    s_add_u32 m0, s33, 6144
    s_add_u32 s34, s29, 1271808
    buffer_load_dwordx4 v5, s[20:23], s34 offen lds
    s_add_u32 m0, s33, 7168
    s_add_u32 s34, s29, 1299456
    buffer_load_dwordx4 v6, s[20:23], s34 offen lds
    s_waitcnt vmcnt(16)
    ds_read_b64_tr_b16 a[80:81], v10 offset:8192
    ds_read_b64_tr_b16 a[82:83], v10 offset:8704
    ds_read_b64_tr_b16 a[84:85], v11 offset:8192
    ds_read_b64_tr_b16 a[86:87], v11 offset:8704
    ds_read_b64_tr_b16 a[88:89], v12 offset:8192
    ds_read_b64_tr_b16 a[90:91], v12 offset:8704
    ds_read_b64_tr_b16 a[92:93], v13 offset:8192
    ds_read_b64_tr_b16 a[94:95], v13 offset:8704
    s_waitcnt lgkmcnt(0)
    s_add_u32 m0, s33, 8192
    s_add_u32 s34, s29, 1327104
    buffer_load_dwordx4 v5, s[20:23], s34 offen lds
    s_add_u32 m0, s33, 9216
    s_add_u32 s34, s29, 1354752
    buffer_load_dwordx4 v6, s[20:23], s34 offen lds
    s_add_u32 m0, s33, 10240
    s_add_u32 s34, s29, 1382400
    buffer_load_dwordx4 v5, s[20:23], s34 offen lds
    s_add_u32 m0, s33, 11264
    s_add_u32 s34, s29, 1410048
    buffer_load_dwordx4 v6, s[20:23], s34 offen lds
    s_waitcnt vmcnt(16)
    ds_read_b64_tr_b16 a[96:97], v10 offset:12288
    ds_read_b64_tr_b16 a[98:99], v10 offset:12800
    ds_read_b64_tr_b16 a[100:101], v11 offset:12288
    ds_read_b64_tr_b16 a[102:103], v11 offset:12800
    ds_read_b64_tr_b16 a[104:105], v12 offset:12288
    ds_read_b64_tr_b16 a[106:107], v12 offset:12800
    ds_read_b64_tr_b16 a[108:109], v13 offset:12288
    ds_read_b64_tr_b16 a[110:111], v13 offset:12800
    s_waitcnt lgkmcnt(0)
    s_add_u32 m0, s33, 12288
    s_add_u32 s34, s29, 1437696
    buffer_load_dwordx4 v5, s[20:23], s34 offen lds
    s_add_u32 m0, s33, 13312
    s_add_u32 s34, s29, 1465344
    buffer_load_dwordx4 v6, s[20:23], s34 offen lds
    s_add_u32 m0, s33, 14336
    s_add_u32 s34, s29, 1492992
    buffer_load_dwordx4 v5, s[20:23], s34 offen lds
    s_add_u32 m0, s33, 15360
    s_add_u32 s34, s29, 1520640
    buffer_load_dwordx4 v6, s[20:23], s34 offen lds
    s_waitcnt vmcnt(16)
    ds_read_b64_tr_b16 a[112:113], v10 offset:16384
    ds_read_b64_tr_b16 a[114:115], v10 offset:16896
    ds_read_b64_tr_b16 a[116:117], v11 offset:16384
    ds_read_b64_tr_b16 a[118:119], v11 offset:16896
    ds_read_b64_tr_b16 a[120:121], v12 offset:16384
    ds_read_b64_tr_b16 a[122:123], v12 offset:16896
    ds_read_b64_tr_b16 a[124:125], v13 offset:16384
    ds_read_b64_tr_b16 a[126:127], v13 offset:16896
    s_waitcnt lgkmcnt(0)
    s_add_u32 m0, s33, 16384
    s_add_u32 s34, s29, 1548288
    buffer_load_dwordx4 v5, s[20:23], s34 offen lds
    s_add_u32 m0, s33, 17408
    s_add_u32 s34, s29, 1575936
    buffer_load_dwordx4 v6, s[20:23], s34 offen lds
    s_add_u32 m0, s33, 18432
    s_add_u32 s34, s29, 1603584
    buffer_load_dwordx4 v5, s[20:23], s34 offen lds
    s_add_u32 m0, s33, 19456
    s_add_u32 s34, s29, 1631232
    buffer_load_dwordx4 v6, s[20:23], s34 offen lds
    s_waitcnt vmcnt(16)
    ds_read_b64_tr_b16 a[128:129], v10 offset:0
    ds_read_b64_tr_b16 a[130:131], v10 offset:512
    ds_read_b64_tr_b16 a[132:133], v11 offset:0
    ds_read_b64_tr_b16 a[134:135], v11 offset:512
    ds_read_b64_tr_b16 a[136:137], v12 offset:0
    ds_read_b64_tr_b16 a[138:139], v12 offset:512
    ds_read_b64_tr_b16 a[140:141], v13 offset:0
    ds_read_b64_tr_b16 a[142:143], v13 offset:512
    s_waitcnt lgkmcnt(0)
    s_add_u32 m0, s33, 0
    s_add_u32 s34, s29, 1658880
    buffer_load_dwordx4 v5, s[20:23], s34 offen lds
    s_add_u32 m0, s33, 1024
    s_add_u32 s34, s29, 1686528
    buffer_load_dwordx4 v6, s[20:23], s34 offen lds
    s_add_u32 m0, s33, 2048
    s_add_u32 s34, s29, 1714176
    buffer_load_dwordx4 v5, s[20:23], s34 offen lds
    s_add_u32 m0, s33, 3072
    s_add_u32 s34, s29, 1741824
    buffer_load_dwordx4 v6, s[20:23], s34 offen lds
    s_waitcnt vmcnt(16)
    ds_read_b64_tr_b16 a[144:145], v10 offset:4096
    ds_read_b64_tr_b16 a[146:147], v10 offset:4608
    ds_read_b64_tr_b16 a[148:149], v11 offset:4096
    ds_read_b64_tr_b16 a[150:151], v11 offset:4608
    ds_read_b64_tr_b16 a[152:153], v12 offset:4096
    ds_read_b64_tr_b16 a[154:155], v12 offset:4608
    ds_read_b64_tr_b16 a[156:157], v13 offset:4096
    ds_read_b64_tr_b16 a[158:159], v13 offset:4608
    s_waitcnt lgkmcnt(0)
    s_add_u32 m0, s33, 4096
    s_add_u32 s34, s29, 1769472
    buffer_load_dwordx4 v5, s[20:23], s34 offen lds
    s_add_u32 m0, s33, 5120
    s_add_u32 s34, s29, 1797120
    buffer_load_dwordx4 v6, s[20:23], s34 offen lds
    s_add_u32 m0, s33, 6144
    s_add_u32 s34, s29, 1824768
    buffer_load_dwordx4 v5, s[20:23], s34 offen lds
    s_add_u32 m0, s33, 7168
    s_add_u32 s34, s29, 1852416
    buffer_load_dwordx4 v6, s[20:23], s34 offen lds
    s_waitcnt vmcnt(16)
    ds_read_b64_tr_b16 a[160:161], v10 offset:8192
    ds_read_b64_tr_b16 a[162:163], v10 offset:8704
    ds_read_b64_tr_b16 a[164:165], v11 offset:8192
    ds_read_b64_tr_b16 a[166:167], v11 offset:8704
    ds_read_b64_tr_b16 a[168:169], v12 offset:8192
    ds_read_b64_tr_b16 a[170:171], v12 offset:8704
    ds_read_b64_tr_b16 a[172:173], v13 offset:8192
    ds_read_b64_tr_b16 a[174:175], v13 offset:8704
    s_waitcnt lgkmcnt(0)
    s_add_u32 m0, s33, 8192
    s_add_u32 s34, s29, 1880064
    buffer_load_dwordx4 v5, s[20:23], s34 offen lds
    s_add_u32 m0, s33, 9216
    s_add_u32 s34, s29, 1907712
    buffer_load_dwordx4 v6, s[20:23], s34 offen lds
    s_add_u32 m0, s33, 10240
    s_add_u32 s34, s29, 1935360
    buffer_load_dwordx4 v5, s[20:23], s34 offen lds
    s_add_u32 m0, s33, 11264
    s_add_u32 s34, s29, 1963008
    buffer_load_dwordx4 v6, s[20:23], s34 offen lds
    s_waitcnt vmcnt(16)
    ds_read_b64_tr_b16 a[176:177], v10 offset:12288
    ds_read_b64_tr_b16 a[178:179], v10 offset:12800
    ds_read_b64_tr_b16 a[180:181], v11 offset:12288
    ds_read_b64_tr_b16 a[182:183], v11 offset:12800
    ds_read_b64_tr_b16 a[184:185], v12 offset:12288
    ds_read_b64_tr_b16 a[186:187], v12 offset:12800
    ds_read_b64_tr_b16 a[188:189], v13 offset:12288
    ds_read_b64_tr_b16 a[190:191], v13 offset:12800
    s_waitcnt lgkmcnt(0)
    s_waitcnt vmcnt(12)
    ds_read_b64_tr_b16 a[192:193], v10 offset:16384
    ds_read_b64_tr_b16 a[194:195], v10 offset:16896
    ds_read_b64_tr_b16 a[196:197], v11 offset:16384
    ds_read_b64_tr_b16 a[198:199], v11 offset:16896
    ds_read_b64_tr_b16 a[200:201], v12 offset:16384
    ds_read_b64_tr_b16 a[202:203], v12 offset:16896
    ds_read_b64_tr_b16 a[204:205], v13 offset:16384
    ds_read_b64_tr_b16 a[206:207], v13 offset:16896
    s_waitcnt lgkmcnt(0)
    s_waitcnt vmcnt(8)
    ds_read_b64_tr_b16 a[208:209], v10 offset:0
    ds_read_b64_tr_b16 a[210:211], v10 offset:512
    ds_read_b64_tr_b16 a[212:213], v11 offset:0
    ds_read_b64_tr_b16 a[214:215], v11 offset:512
    ds_read_b64_tr_b16 a[216:217], v12 offset:0
    ds_read_b64_tr_b16 a[218:219], v12 offset:512
    ds_read_b64_tr_b16 a[220:221], v13 offset:0
    ds_read_b64_tr_b16 a[222:223], v13 offset:512
    s_waitcnt lgkmcnt(0)
    s_waitcnt vmcnt(4)
    ds_read_b64_tr_b16 a[224:225], v10 offset:4096
    ds_read_b64_tr_b16 a[226:227], v10 offset:4608
    ds_read_b64_tr_b16 a[228:229], v11 offset:4096
    ds_read_b64_tr_b16 a[230:231], v11 offset:4608
    ds_read_b64_tr_b16 a[232:233], v12 offset:4096
    ds_read_b64_tr_b16 a[234:235], v12 offset:4608
    ds_read_b64_tr_b16 a[236:237], v13 offset:4096
    ds_read_b64_tr_b16 a[238:239], v13 offset:4608
    s_waitcnt lgkmcnt(0)
    s_waitcnt vmcnt(0)
    ds_read_b64_tr_b16 a[240:241], v10 offset:8192
    ds_read_b64_tr_b16 a[242:243], v10 offset:8704
    ds_read_b64_tr_b16 a[244:245], v11 offset:8192
    ds_read_b64_tr_b16 a[246:247], v11 offset:8704
    ds_read_b64_tr_b16 a[248:249], v12 offset:8192
    ds_read_b64_tr_b16 a[250:251], v12 offset:8704
    ds_read_b64_tr_b16 a[252:253], v13 offset:8192
    ds_read_b64_tr_b16 a[254:255], v13 offset:8704
    s_waitcnt lgkmcnt(0)
    v_mov_b32 v4, v16
    v_mov_b32 v6, v18
    v_mov_b32 v7, v19
    s_waitcnt vmcnt(0)
    s_cmp_lt_u32 s40, 8
    s_cbranch_scc1 L_pg_a1_1
L_pg_a1_0:
L_pgl_a1_0:
    s_waitcnt vmcnt(8)
    s_barrier
    v_add_u32 v8, s37, v6
    v_add_u32 v9, s37, v7
    s_add_u32 s34, s30, s31
    s_min_u32 s34, s34, 63
    s_xor_b32 s37, s37, 36864
    s_lshl_b32 s35, s34, 2
    s_add_u32 s35, s35, s28
    s_mul_i32 s35, s35, 9216
    s_mul_i32 s36, s28, 9216
    s_add_u32 s36, s36, s37
    ds_read_b128 v[32:35], v8 offset:0
    ds_read_b128 v[36:39], v8 offset:18432
    ds_read_b128 v[40:43], v9 offset:0
    ds_read_b128 v[44:47], v9 offset:18432
    ds_read_b128 v[48:51], v8 offset:1024
    ds_read_b128 v[52:55], v8 offset:19456
    ds_read_b128 v[56:59], v9 offset:1024
    s_waitcnt lgkmcnt(6)
    v_mfma_f32_16x16x32_bf16 v[64:67], v[32:35], v[224:227], 0
    ds_read_b128 v[60:63], v9 offset:19456
    v_mfma_f32_16x16x32_bf16 v[68:71], v[32:35], v[228:231], 0
    s_add_u32 m0, s36, 0
    s_nop 0
    buffer_load_dwordx4 v4, s[24:27], s35 offen offset:0 sc1 lds
    v_mfma_f32_16x16x32_bf16 v[72:75], v[32:35], v[232:235], 0
    v_mfma_f32_16x16x32_bf16 v[76:79], v[32:35], v[236:239], 0
    s_waitcnt lgkmcnt(6)
    v_mfma_f32_16x16x32_bf16 v[80:83], v[36:39], v[224:227], 0
    ds_read_b128 v[32:35], v8 offset:2048
    v_mfma_f32_16x16x32_bf16 v[84:87], v[36:39], v[228:231], 0
    v_mfma_f32_16x16x32_bf16 v[88:91], v[36:39], v[232:235], 0
    v_mfma_f32_16x16x32_bf16 v[92:95], v[36:39], v[236:239], 0
    s_waitcnt lgkmcnt(6)
    v_mfma_f32_16x16x32_bf16 v[64:67], v[40:43], v[240:243], v[64:67]
    ds_read_b128 v[36:39], v8 offset:20480
    v_mfma_f32_16x16x32_bf16 v[68:71], v[40:43], v[244:247], v[68:71]
    s_add_u32 m0, s36, 896
    s_nop 0
    buffer_load_dwordx4 v4, s[24:27], s35 offen offset:128 sc1 lds
    v_mfma_f32_16x16x32_bf16 v[72:75], v[40:43], v[248:251], v[72:75]
    v_mfma_f32_16x16x32_bf16 v[76:79], v[40:43], v[252:255], v[76:79]
    s_waitcnt lgkmcnt(6)
    v_mfma_f32_16x16x32_bf16 v[80:83], v[44:47], v[240:243], v[80:83]
    ds_read_b128 v[40:43], v9 offset:2048
    v_mfma_f32_16x16x32_bf16 v[84:87], v[44:47], v[244:247], v[84:87]
    v_mfma_f32_16x16x32_bf16 v[88:91], v[44:47], v[248:251], v[88:91]
    v_mfma_f32_16x16x32_bf16 v[92:95], v[44:47], v[252:255], v[92:95]
    s_waitcnt lgkmcnt(6)
    v_mfma_f32_16x16x32_bf16 v[64:67], v[48:51], a[0:3], v[64:67]
    ds_read_b128 v[44:47], v9 offset:20480
    v_mfma_f32_16x16x32_bf16 v[68:71], v[48:51], a[4:7], v[68:71]
    s_add_u32 m0, s36, 1792
    s_nop 0
    buffer_load_dwordx4 v4, s[24:27], s35 offen offset:256 sc1 lds
    v_mfma_f32_16x16x32_bf16 v[72:75], v[48:51], a[8:11], v[72:75]
    v_mfma_f32_16x16x32_bf16 v[76:79], v[48:51], a[12:15], v[76:79]
    s_waitcnt lgkmcnt(6)
    v_mfma_f32_16x16x32_bf16 v[80:83], v[52:55], a[0:3], v[80:83]
    ds_read_b128 v[48:51], v8 offset:3072
    v_mfma_f32_16x16x32_bf16 v[84:87], v[52:55], a[4:7], v[84:87]
    v_mfma_f32_16x16x32_bf16 v[88:91], v[52:55], a[8:11], v[88:91]
    v_mfma_f32_16x16x32_bf16 v[92:95], v[52:55], a[12:15], v[92:95]
    s_waitcnt lgkmcnt(6)
    v_mfma_f32_16x16x32_bf16 v[64:67], v[56:59], a[16:19], v[64:67]
    ds_read_b128 v[52:55], v8 offset:21504
    v_mfma_f32_16x16x32_bf16 v[68:71], v[56:59], a[20:23], v[68:71]
    s_add_u32 m0, s36, 2688
    s_nop 0
    buffer_load_dwordx4 v4, s[24:27], s35 offen offset:384 sc1 lds
    v_mfma_f32_16x16x32_bf16 v[72:75], v[56:59], a[24:27], v[72:75]
    v_mfma_f32_16x16x32_bf16 v[76:79], v[56:59], a[28:31], v[76:79]
    s_waitcnt lgkmcnt(6)
    v_mfma_f32_16x16x32_bf16 v[80:83], v[60:63], a[16:19], v[80:83]
    ds_read_b128 v[56:59], v9 offset:3072
    v_mfma_f32_16x16x32_bf16 v[84:87], v[60:63], a[20:23], v[84:87]
    v_mfma_f32_16x16x32_bf16 v[88:91], v[60:63], a[24:27], v[88:91]
    v_mfma_f32_16x16x32_bf16 v[92:95], v[60:63], a[28:31], v[92:95]
    s_waitcnt lgkmcnt(6)
    v_mfma_f32_16x16x32_bf16 v[64:67], v[32:35], a[32:35], v[64:67]
    ds_read_b128 v[60:63], v9 offset:21504
    v_mfma_f32_16x16x32_bf16 v[68:71], v[32:35], a[36:39], v[68:71]
    s_add_u32 m0, s36, 3584
    s_nop 0
    buffer_load_dwordx4 v4, s[24:27], s35 offen offset:512 sc1 lds
    v_mfma_f32_16x16x32_bf16 v[72:75], v[32:35], a[40:43], v[72:75]
    v_mfma_f32_16x16x32_bf16 v[76:79], v[32:35], a[44:47], v[76:79]
    s_waitcnt lgkmcnt(6)
    v_mfma_f32_16x16x32_bf16 v[80:83], v[36:39], a[32:35], v[80:83]
    ds_read_b128 v[32:35], v8 offset:4096
    v_mfma_f32_16x16x32_bf16 v[84:87], v[36:39], a[36:39], v[84:87]
    v_mfma_f32_16x16x32_bf16 v[88:91], v[36:39], a[40:43], v[88:91]
    v_mfma_f32_16x16x32_bf16 v[92:95], v[36:39], a[44:47], v[92:95]
    s_waitcnt lgkmcnt(6)
    v_mfma_f32_16x16x32_bf16 v[64:67], v[40:43], a[48:51], v[64:67]
    ds_read_b128 v[36:39], v8 offset:22528
    v_mfma_f32_16x16x32_bf16 v[68:71], v[40:43], a[52:55], v[68:71]
    s_add_u32 m0, s36, 4480
    s_nop 0
    buffer_load_dwordx4 v4, s[24:27], s35 offen offset:640 sc1 lds
    v_mfma_f32_16x16x32_bf16 v[72:75], v[40:43], a[56:59], v[72:75]
    v_mfma_f32_16x16x32_bf16 v[76:79], v[40:43], a[60:63], v[76:79]
    s_waitcnt lgkmcnt(6)
    v_mfma_f32_16x16x32_bf16 v[80:83], v[44:47], a[48:51], v[80:83]
    ds_read_b128 v[40:43], v9 offset:4096
    v_mfma_f32_16x16x32_bf16 v[84:87], v[44:47], a[52:55], v[84:87]
    v_mfma_f32_16x16x32_bf16 v[88:91], v[44:47], a[56:59], v[88:91]
    v_mfma_f32_16x16x32_bf16 v[92:95], v[44:47], a[60:63], v[92:95]
    s_waitcnt lgkmcnt(6)
    v_mfma_f32_16x16x32_bf16 v[64:67], v[48:51], a[64:67], v[64:67]
    ds_read_b128 v[44:47], v9 offset:22528
    v_mfma_f32_16x16x32_bf16 v[68:71], v[48:51], a[68:71], v[68:71]
    s_add_u32 m0, s36, 5376
    s_nop 0
    buffer_load_dwordx4 v4, s[24:27], s35 offen offset:768 sc1 lds
    v_mfma_f32_16x16x32_bf16 v[72:75], v[48:51], a[72:75], v[72:75]
    v_mfma_f32_16x16x32_bf16 v[76:79], v[48:51], a[76:79], v[76:79]
    s_waitcnt lgkmcnt(6)
    v_mfma_f32_16x16x32_bf16 v[80:83], v[52:55], a[64:67], v[80:83]
    ds_read_b128 v[48:51], v8 offset:5120
    v_mfma_f32_16x16x32_bf16 v[84:87], v[52:55], a[68:71], v[84:87]
    v_mfma_f32_16x16x32_bf16 v[88:91], v[52:55], a[72:75], v[88:91]
    v_mfma_f32_16x16x32_bf16 v[92:95], v[52:55], a[76:79], v[92:95]
    s_waitcnt lgkmcnt(6)
    v_mfma_f32_16x16x32_bf16 v[64:67], v[56:59], a[80:83], v[64:67]
    ds_read_b128 v[52:55], v8 offset:23552
    v_mfma_f32_16x16x32_bf16 v[68:71], v[56:59], a[84:87], v[68:71]
    s_add_u32 m0, s36, 6272
    s_nop 0
    buffer_load_dwordx4 v4, s[24:27], s35 offen offset:896 sc1 lds
    v_mfma_f32_16x16x32_bf16 v[72:75], v[56:59], a[88:91], v[72:75]
    v_mfma_f32_16x16x32_bf16 v[76:79], v[56:59], a[92:95], v[76:79]
    s_waitcnt lgkmcnt(6)
    v_mfma_f32_16x16x32_bf16 v[80:83], v[60:63], a[80:83], v[80:83]
    ds_read_b128 v[56:59], v9 offset:5120
    v_mfma_f32_16x16x32_bf16 v[84:87], v[60:63], a[84:87], v[84:87]
    v_mfma_f32_16x16x32_bf16 v[88:91], v[60:63], a[88:91], v[88:91]
    v_mfma_f32_16x16x32_bf16 v[92:95], v[60:63], a[92:95], v[92:95]
    s_waitcnt lgkmcnt(6)
    v_mfma_f32_16x16x32_bf16 v[64:67], v[32:35], a[96:99], v[64:67]
    ds_read_b128 v[60:63], v9 offset:23552
    v_mfma_f32_16x16x32_bf16 v[68:71], v[32:35], a[100:103], v[68:71]
    s_add_u32 m0, s36, 7168
    s_nop 0
    buffer_load_dwordx4 v4, s[24:27], s35 offen offset:1024 sc1 lds
    v_mfma_f32_16x16x32_bf16 v[72:75], v[32:35], a[104:107], v[72:75]
    v_mfma_f32_16x16x32_bf16 v[76:79], v[32:35], a[108:111], v[76:79]
    s_waitcnt lgkmcnt(6)
    v_mfma_f32_16x16x32_bf16 v[80:83], v[36:39], a[96:99], v[80:83]
    ds_read_b128 v[32:35], v8 offset:6144
    v_mfma_f32_16x16x32_bf16 v[84:87], v[36:39], a[100:103], v[84:87]
    v_mfma_f32_16x16x32_bf16 v[88:91], v[36:39], a[104:107], v[88:91]
    v_mfma_f32_16x16x32_bf16 v[92:95], v[36:39], a[108:111], v[92:95]
    s_waitcnt lgkmcnt(6)
    v_mfma_f32_16x16x32_bf16 v[64:67], v[40:43], a[112:115], v[64:67]
    ds_read_b128 v[36:39], v8 offset:24576
    v_mfma_f32_16x16x32_bf16 v[68:71], v[40:43], a[116:119], v[68:71]
    v_mfma_f32_16x16x32_bf16 v[72:75], v[40:43], a[120:123], v[72:75]
    v_mfma_f32_16x16x32_bf16 v[76:79], v[40:43], a[124:127], v[76:79]
    s_waitcnt lgkmcnt(6)
    v_mfma_f32_16x16x32_bf16 v[80:83], v[44:47], a[112:115], v[80:83]
    ds_read_b128 v[40:43], v9 offset:6144
    v_mfma_f32_16x16x32_bf16 v[84:87], v[44:47], a[116:119], v[84:87]
    v_mfma_f32_16x16x32_bf16 v[88:91], v[44:47], a[120:123], v[88:91]
    v_mfma_f32_16x16x32_bf16 v[92:95], v[44:47], a[124:127], v[92:95]
    s_waitcnt lgkmcnt(6)
    v_mfma_f32_16x16x32_bf16 v[64:67], v[48:51], a[128:131], v[64:67]
    ds_read_b128 v[44:47], v9 offset:24576
    v_mfma_f32_16x16x32_bf16 v[68:71], v[48:51], a[132:135], v[68:71]
    v_mfma_f32_16x16x32_bf16 v[72:75], v[48:51], a[136:139], v[72:75]
    v_mfma_f32_16x16x32_bf16 v[76:79], v[48:51], a[140:143], v[76:79]
    s_waitcnt lgkmcnt(6)
    v_mfma_f32_16x16x32_bf16 v[80:83], v[52:55], a[128:131], v[80:83]
    ds_read_b128 v[48:51], v8 offset:7168
    v_mfma_f32_16x16x32_bf16 v[84:87], v[52:55], a[132:135], v[84:87]
    v_mfma_f32_16x16x32_bf16 v[88:91], v[52:55], a[136:139], v[88:91]
    v_mfma_f32_16x16x32_bf16 v[92:95], v[52:55], a[140:143], v[92:95]
    s_waitcnt lgkmcnt(6)
    v_mfma_f32_16x16x32_bf16 v[64:67], v[56:59], a[144:147], v[64:67]
    ds_read_b128 v[52:55], v8 offset:25600
    v_mfma_f32_16x16x32_bf16 v[68:71], v[56:59], a[148:151], v[68:71]
    v_mfma_f32_16x16x32_bf16 v[72:75], v[56:59], a[152:155], v[72:75]
    v_mfma_f32_16x16x32_bf16 v[76:79], v[56:59], a[156:159], v[76:79]
    s_waitcnt lgkmcnt(6)
    v_mfma_f32_16x16x32_bf16 v[80:83], v[60:63], a[144:147], v[80:83]
    ds_read_b128 v[56:59], v9 offset:7168
    v_mfma_f32_16x16x32_bf16 v[84:87], v[60:63], a[148:151], v[84:87]
    v_mfma_f32_16x16x32_bf16 v[88:91], v[60:63], a[152:155], v[88:91]
    v_mfma_f32_16x16x32_bf16 v[92:95], v[60:63], a[156:159], v[92:95]
    s_waitcnt lgkmcnt(6)
    v_mfma_f32_16x16x32_bf16 v[64:67], v[32:35], a[160:163], v[64:67]
    ds_read_b128 v[60:63], v9 offset:25600
    v_mfma_f32_16x16x32_bf16 v[68:71], v[32:35], a[164:167], v[68:71]
    v_mfma_f32_16x16x32_bf16 v[72:75], v[32:35], a[168:171], v[72:75]
    v_mfma_f32_16x16x32_bf16 v[76:79], v[32:35], a[172:175], v[76:79]
    s_waitcnt lgkmcnt(6)
    v_mfma_f32_16x16x32_bf16 v[80:83], v[36:39], a[160:163], v[80:83]
    ds_read_b128 v[32:35], v8 offset:8192
    v_mfma_f32_16x16x32_bf16 v[84:87], v[36:39], a[164:167], v[84:87]
    v_mfma_f32_16x16x32_bf16 v[88:91], v[36:39], a[168:171], v[88:91]
    v_mfma_f32_16x16x32_bf16 v[92:95], v[36:39], a[172:175], v[92:95]
    s_waitcnt lgkmcnt(6)
    v_mfma_f32_16x16x32_bf16 v[64:67], v[40:43], a[176:179], v[64:67]
    ds_read_b128 v[36:39], v8 offset:26624
    v_mfma_f32_16x16x32_bf16 v[68:71], v[40:43], a[180:183], v[68:71]
    v_mfma_f32_16x16x32_bf16 v[72:75], v[40:43], a[184:187], v[72:75]
    v_mfma_f32_16x16x32_bf16 v[76:79], v[40:43], a[188:191], v[76:79]
    s_waitcnt lgkmcnt(6)
    v_mfma_f32_16x16x32_bf16 v[80:83], v[44:47], a[176:179], v[80:83]
    ds_read_b128 v[40:43], v9 offset:8192
    v_mfma_f32_16x16x32_bf16 v[84:87], v[44:47], a[180:183], v[84:87]
    v_mfma_f32_16x16x32_bf16 v[88:91], v[44:47], a[184:187], v[88:91]
    v_mfma_f32_16x16x32_bf16 v[92:95], v[44:47], a[188:191], v[92:95]
    s_waitcnt lgkmcnt(6)
    v_mfma_f32_16x16x32_bf16 v[64:67], v[48:51], a[192:195], v[64:67]
    ds_read_b128 v[44:47], v9 offset:26624
    v_mfma_f32_16x16x32_bf16 v[68:71], v[48:51], a[196:199], v[68:71]
    v_mfma_f32_16x16x32_bf16 v[72:75], v[48:51], a[200:203], v[72:75]
    v_mfma_f32_16x16x32_bf16 v[76:79], v[48:51], a[204:207], v[76:79]
    s_waitcnt lgkmcnt(6)
    v_mfma_f32_16x16x32_bf16 v[80:83], v[52:55], a[192:195], v[80:83]
    v_mfma_f32_16x16x32_bf16 v[84:87], v[52:55], a[196:199], v[84:87]
    v_mfma_f32_16x16x32_bf16 v[88:91], v[52:55], a[200:203], v[88:91]
    v_mfma_f32_16x16x32_bf16 v[92:95], v[52:55], a[204:207], v[92:95]
    s_waitcnt lgkmcnt(5)
    v_mfma_f32_16x16x32_bf16 v[64:67], v[56:59], a[208:211], v[64:67]
    v_mfma_f32_16x16x32_bf16 v[68:71], v[56:59], a[212:215], v[68:71]
    v_mfma_f32_16x16x32_bf16 v[72:75], v[56:59], a[216:219], v[72:75]
    v_mfma_f32_16x16x32_bf16 v[76:79], v[56:59], a[220:223], v[76:79]
    s_waitcnt lgkmcnt(4)
    v_mfma_f32_16x16x32_bf16 v[80:83], v[60:63], a[208:211], v[80:83]
    v_mfma_f32_16x16x32_bf16 v[84:87], v[60:63], a[212:215], v[84:87]
    v_mfma_f32_16x16x32_bf16 v[88:91], v[60:63], a[216:219], v[88:91]
    v_mfma_f32_16x16x32_bf16 v[92:95], v[60:63], a[220:223], v[92:95]
    s_waitcnt lgkmcnt(3)
    v_mfma_f32_16x16x32_bf16 v[64:67], v[32:35], a[224:227], v[64:67]
    v_mfma_f32_16x16x32_bf16 v[68:71], v[32:35], a[228:231], v[68:71]
    v_mfma_f32_16x16x32_bf16 v[72:75], v[32:35], a[232:235], v[72:75]
    v_mfma_f32_16x16x32_bf16 v[76:79], v[32:35], a[236:239], v[76:79]
    s_waitcnt lgkmcnt(2)
    v_mfma_f32_16x16x32_bf16 v[80:83], v[36:39], a[224:227], v[80:83]
    v_mfma_f32_16x16x32_bf16 v[84:87], v[36:39], a[228:231], v[84:87]
    v_mfma_f32_16x16x32_bf16 v[88:91], v[36:39], a[232:235], v[88:91]
    v_mfma_f32_16x16x32_bf16 v[92:95], v[36:39], a[236:239], v[92:95]
    s_waitcnt lgkmcnt(1)
    v_mfma_f32_16x16x32_bf16 v[64:67], v[40:43], a[240:243], v[64:67]
    v_mfma_f32_16x16x32_bf16 v[68:71], v[40:43], a[244:247], v[68:71]
    v_mfma_f32_16x16x32_bf16 v[72:75], v[40:43], a[248:251], v[72:75]
    v_mfma_f32_16x16x32_bf16 v[76:79], v[40:43], a[252:255], v[76:79]
    s_waitcnt lgkmcnt(0)
    v_mfma_f32_16x16x32_bf16 v[80:83], v[44:47], a[240:243], v[80:83]
    v_mfma_f32_16x16x32_bf16 v[84:87], v[44:47], a[244:247], v[84:87]
    v_mfma_f32_16x16x32_bf16 v[88:91], v[44:47], a[248:251], v[88:91]
    v_mfma_f32_16x16x32_bf16 v[92:95], v[44:47], a[252:255], v[92:95]
    v_and_b32 v10, 1, v2
    v_mul_u32_u24 v10, 304, v10
    v_lshl_add_u32 v10, v3, 4, v10
    v_lshrrev_b32 v11, 1, v2
    v_lshl_add_u32 v10, v11, 3, v10
    s_mul_i32 s44, s42, 0x28000
    s_mul_i32 s46, s30, 1216
    s_add_u32 s44, s44, s46
    s_add_u32 s44, s44, 0x6812000
    s_mov_b32 s46, 0xc000c000
    s_mov_b32 s47, 0xc000c000
    v_cvt_pk_bf16_f32 v12, v64, v65
    v_cvt_pk_bf16_f32 v13, v66, v67
    v_cvt_pk_bf16_f32 v14, v68, v69
    v_cvt_pk_bf16_f32 v15, v70, v71
    buffer_store_dwordx2 v[12:13], v10, s[8:11], s44 offen offset:0 sc1
    s_mov_b64 exec, s[46:47]
    buffer_store_dwordx2 v[14:15], v10, s[8:11], s44 offen offset:32 sc1
    s_mov_b64 exec, -1
    v_cvt_pk_bf16_f32 v16, v80, v81
    v_cvt_pk_bf16_f32 v17, v82, v83
    v_cvt_pk_bf16_f32 v18, v84, v85
    v_cvt_pk_bf16_f32 v19, v86, v87
    buffer_store_dwordx2 v[16:17], v10, s[8:11], s44 offen offset:608 sc1
    s_mov_b64 exec, s[46:47]
    buffer_store_dwordx2 v[18:19], v10, s[8:11], s44 offen offset:640 sc1
    s_mov_b64 exec, -1
    s_add_u32 s44, s44, 0x28000
    v_cvt_pk_bf16_f32 v20, v72, v73
    v_cvt_pk_bf16_f32 v21, v74, v75
    v_cvt_pk_bf16_f32 v22, v76, v77
    v_cvt_pk_bf16_f32 v23, v78, v79
    buffer_store_dwordx2 v[20:21], v10, s[8:11], s44 offen offset:0 sc1
    s_mov_b64 exec, s[46:47]
    buffer_store_dwordx2 v[22:23], v10, s[8:11], s44 offen offset:32 sc1
    s_mov_b64 exec, -1
    v_cvt_pk_bf16_f32 v24, v88, v89
    v_cvt_pk_bf16_f32 v25, v90, v91
    v_cvt_pk_bf16_f32 v26, v92, v93
    v_cvt_pk_bf16_f32 v27, v94, v95
    buffer_store_dwordx2 v[24:25], v10, s[8:11], s44 offen offset:608 sc1
    s_mov_b64 exec, s[46:47]
    buffer_store_dwordx2 v[26:27], v10, s[8:11], s44 offen offset:640 sc1
    s_mov_b64 exec, -1
    s_add_u32 s30, s30, s31
    s_cmp_lt_u32 s30, s32
    s_cbranch_scc1 L_pgl_a1_0
    s_waitcnt vmcnt(0)
    s_barrier
    s_branch L_pgd_a1
L_pg_a1_1:
L_pgl_a1_1:
    s_waitcnt vmcnt(8)
    s_barrier
    v_add_u32 v8, s37, v6
    v_add_u32 v9, s37, v7
    s_add_u32 s34, s30, s31
    s_min_u32 s34, s34, 63
    s_xor_b32 s37, s37, 36864
    s_lshl_b32 s35, s34, 2
    s_add_u32 s35, s35, s28
    s_mul_i32 s35, s35, 9216
    s_mul_i32 s36, s28, 9216
    s_add_u32 s36, s36, s37
    ds_read_b128 v[32:35], v8 offset:0
    ds_read_b128 v[36:39], v8 offset:18432
    ds_read_b128 v[40:43], v9 offset:0
    ds_read_b128 v[44:47], v9 offset:18432
    ds_read_b128 v[48:51], v8 offset:1024
    ds_read_b128 v[52:55], v8 offset:19456
    ds_read_b128 v[56:59], v9 offset:1024
    s_waitcnt lgkmcnt(6)
    v_mfma_f32_16x16x32_bf16 v[64:67], v[224:227], v[32:35], 0
    ds_read_b128 v[60:63], v9 offset:19456
    v_mfma_f32_16x16x32_bf16 v[68:71], v[228:231], v[32:35], 0
    s_add_u32 m0, s36, 0
    s_nop 0
    buffer_load_dwordx4 v4, s[24:27], s35 offen offset:0 sc1 lds
    v_mfma_f32_16x16x32_bf16 v[72:75], v[232:235], v[32:35], 0
    v_mfma_f32_16x16x32_bf16 v[76:79], v[236:239], v[32:35], 0
    s_waitcnt lgkmcnt(6)
    v_mfma_f32_16x16x32_bf16 v[80:83], v[224:227], v[36:39], 0
    ds_read_b128 v[32:35], v8 offset:2048
    v_mfma_f32_16x16x32_bf16 v[84:87], v[228:231], v[36:39], 0
    v_mfma_f32_16x16x32_bf16 v[88:91], v[232:235], v[36:39], 0
    v_mfma_f32_16x16x32_bf16 v[92:95], v[236:239], v[36:39], 0
    s_waitcnt lgkmcnt(6)
    v_mfma_f32_16x16x32_bf16 v[64:67], v[240:243], v[40:43], v[64:67]
    ds_read_b128 v[36:39], v8 offset:20480
    v_mfma_f32_16x16x32_bf16 v[68:71], v[244:247], v[40:43], v[68:71]
    s_add_u32 m0, s36, 896
    s_nop 0
    buffer_load_dwordx4 v4, s[24:27], s35 offen offset:128 sc1 lds
    v_mfma_f32_16x16x32_bf16 v[72:75], v[248:251], v[40:43], v[72:75]
    v_mfma_f32_16x16x32_bf16 v[76:79], v[252:255], v[40:43], v[76:79]
    s_waitcnt lgkmcnt(6)
    v_mfma_f32_16x16x32_bf16 v[80:83], v[240:243], v[44:47], v[80:83]
    ds_read_b128 v[40:43], v9 offset:2048
    v_mfma_f32_16x16x32_bf16 v[84:87], v[244:247], v[44:47], v[84:87]
    v_mfma_f32_16x16x32_bf16 v[88:91], v[248:251], v[44:47], v[88:91]
    v_mfma_f32_16x16x32_bf16 v[92:95], v[252:255], v[44:47], v[92:95]
    s_waitcnt lgkmcnt(6)
    v_mfma_f32_16x16x32_bf16 v[64:67], a[0:3], v[48:51], v[64:67]
    ds_read_b128 v[44:47], v9 offset:20480
    v_mfma_f32_16x16x32_bf16 v[68:71], a[4:7], v[48:51], v[68:71]
    s_add_u32 m0, s36, 1792
    s_nop 0
    buffer_load_dwordx4 v4, s[24:27], s35 offen offset:256 sc1 lds
    v_mfma_f32_16x16x32_bf16 v[72:75], a[8:11], v[48:51], v[72:75]
    v_mfma_f32_16x16x32_bf16 v[76:79], a[12:15], v[48:51], v[76:79]
    s_waitcnt lgkmcnt(6)
    v_mfma_f32_16x16x32_bf16 v[80:83], a[0:3], v[52:55], v[80:83]
    ds_read_b128 v[48:51], v8 offset:3072
    v_mfma_f32_16x16x32_bf16 v[84:87], a[4:7], v[52:55], v[84:87]
    v_mfma_f32_16x16x32_bf16 v[88:91], a[8:11], v[52:55], v[88:91]
    v_mfma_f32_16x16x32_bf16 v[92:95], a[12:15], v[52:55], v[92:95]
    s_waitcnt lgkmcnt(6)
    v_mfma_f32_16x16x32_bf16 v[64:67], a[16:19], v[56:59], v[64:67]
    ds_read_b128 v[52:55], v8 offset:21504
    v_mfma_f32_16x16x32_bf16 v[68:71], a[20:23], v[56:59], v[68:71]
    s_add_u32 m0, s36, 2688
    s_nop 0
    buffer_load_dwordx4 v4, s[24:27], s35 offen offset:384 sc1 lds
    v_mfma_f32_16x16x32_bf16 v[72:75], a[24:27], v[56:59], v[72:75]
    v_mfma_f32_16x16x32_bf16 v[76:79], a[28:31], v[56:59], v[76:79]
    s_waitcnt lgkmcnt(6)
    v_mfma_f32_16x16x32_bf16 v[80:83], a[16:19], v[60:63], v[80:83]
    ds_read_b128 v[56:59], v9 offset:3072
    v_mfma_f32_16x16x32_bf16 v[84:87], a[20:23], v[60:63], v[84:87]
    v_mfma_f32_16x16x32_bf16 v[88:91], a[24:27], v[60:63], v[88:91]
    v_mfma_f32_16x16x32_bf16 v[92:95], a[28:31], v[60:63], v[92:95]
    s_waitcnt lgkmcnt(6)
    v_mfma_f32_16x16x32_bf16 v[64:67], a[32:35], v[32:35], v[64:67]
    ds_read_b128 v[60:63], v9 offset:21504
    v_mfma_f32_16x16x32_bf16 v[68:71], a[36:39], v[32:35], v[68:71]
    s_add_u32 m0, s36, 3584
    s_nop 0
    buffer_load_dwordx4 v4, s[24:27], s35 offen offset:512 sc1 lds
    v_mfma_f32_16x16x32_bf16 v[72:75], a[40:43], v[32:35], v[72:75]
    v_mfma_f32_16x16x32_bf16 v[76:79], a[44:47], v[32:35], v[76:79]
    s_waitcnt lgkmcnt(6)
    v_mfma_f32_16x16x32_bf16 v[80:83], a[32:35], v[36:39], v[80:83]
    ds_read_b128 v[32:35], v8 offset:4096
    v_mfma_f32_16x16x32_bf16 v[84:87], a[36:39], v[36:39], v[84:87]
    v_mfma_f32_16x16x32_bf16 v[88:91], a[40:43], v[36:39], v[88:91]
    v_mfma_f32_16x16x32_bf16 v[92:95], a[44:47], v[36:39], v[92:95]
    s_waitcnt lgkmcnt(6)
    v_mfma_f32_16x16x32_bf16 v[64:67], a[48:51], v[40:43], v[64:67]
    ds_read_b128 v[36:39], v8 offset:22528
    v_mfma_f32_16x16x32_bf16 v[68:71], a[52:55], v[40:43], v[68:71]
    s_add_u32 m0, s36, 4480
    s_nop 0
    buffer_load_dwordx4 v4, s[24:27], s35 offen offset:640 sc1 lds
    v_mfma_f32_16x16x32_bf16 v[72:75], a[56:59], v[40:43], v[72:75]
    v_mfma_f32_16x16x32_bf16 v[76:79], a[60:63], v[40:43], v[76:79]
    s_waitcnt lgkmcnt(6)
    v_mfma_f32_16x16x32_bf16 v[80:83], a[48:51], v[44:47], v[80:83]
    ds_read_b128 v[40:43], v9 offset:4096
    v_mfma_f32_16x16x32_bf16 v[84:87], a[52:55], v[44:47], v[84:87]
    v_mfma_f32_16x16x32_bf16 v[88:91], a[56:59], v[44:47], v[88:91]
    v_mfma_f32_16x16x32_bf16 v[92:95], a[60:63], v[44:47], v[92:95]
    s_waitcnt lgkmcnt(6)
    v_mfma_f32_16x16x32_bf16 v[64:67], a[64:67], v[48:51], v[64:67]
    ds_read_b128 v[44:47], v9 offset:22528
    v_mfma_f32_16x16x32_bf16 v[68:71], a[68:71], v[48:51], v[68:71]
    s_add_u32 m0, s36, 5376
    s_nop 0
    buffer_load_dwordx4 v4, s[24:27], s35 offen offset:768 sc1 lds
    v_mfma_f32_16x16x32_bf16 v[72:75], a[72:75], v[48:51], v[72:75]
    v_mfma_f32_16x16x32_bf16 v[76:79], a[76:79], v[48:51], v[76:79]
    s_waitcnt lgkmcnt(6)
    v_mfma_f32_16x16x32_bf16 v[80:83], a[64:67], v[52:55], v[80:83]
    ds_read_b128 v[48:51], v8 offset:5120
    v_mfma_f32_16x16x32_bf16 v[84:87], a[68:71], v[52:55], v[84:87]
    v_mfma_f32_16x16x32_bf16 v[88:91], a[72:75], v[52:55], v[88:91]
    v_mfma_f32_16x16x32_bf16 v[92:95], a[76:79], v[52:55], v[92:95]
    s_waitcnt lgkmcnt(6)
    v_mfma_f32_16x16x32_bf16 v[64:67], a[80:83], v[56:59], v[64:67]
    ds_read_b128 v[52:55], v8 offset:23552
    v_mfma_f32_16x16x32_bf16 v[68:71], a[84:87], v[56:59], v[68:71]
    s_add_u32 m0, s36, 6272
    s_nop 0
    buffer_load_dwordx4 v4, s[24:27], s35 offen offset:896 sc1 lds
    v_mfma_f32_16x16x32_bf16 v[72:75], a[88:91], v[56:59], v[72:75]
    v_mfma_f32_16x16x32_bf16 v[76:79], a[92:95], v[56:59], v[76:79]
    s_waitcnt lgkmcnt(6)
    v_mfma_f32_16x16x32_bf16 v[80:83], a[80:83], v[60:63], v[80:83]
    ds_read_b128 v[56:59], v9 offset:5120
    v_mfma_f32_16x16x32_bf16 v[84:87], a[84:87], v[60:63], v[84:87]
    v_mfma_f32_16x16x32_bf16 v[88:91], a[88:91], v[60:63], v[88:91]
    v_mfma_f32_16x16x32_bf16 v[92:95], a[92:95], v[60:63], v[92:95]
    s_waitcnt lgkmcnt(6)
    v_mfma_f32_16x16x32_bf16 v[64:67], a[96:99], v[32:35], v[64:67]
    ds_read_b128 v[60:63], v9 offset:23552
    v_mfma_f32_16x16x32_bf16 v[68:71], a[100:103], v[32:35], v[68:71]
    s_add_u32 m0, s36, 7168
    s_nop 0
    buffer_load_dwordx4 v4, s[24:27], s35 offen offset:1024 sc1 lds
    v_mfma_f32_16x16x32_bf16 v[72:75], a[104:107], v[32:35], v[72:75]
    v_mfma_f32_16x16x32_bf16 v[76:79], a[108:111], v[32:35], v[76:79]
    s_waitcnt lgkmcnt(6)
    v_mfma_f32_16x16x32_bf16 v[80:83], a[96:99], v[36:39], v[80:83]
    ds_read_b128 v[32:35], v8 offset:6144
    v_mfma_f32_16x16x32_bf16 v[84:87], a[100:103], v[36:39], v[84:87]
    v_mfma_f32_16x16x32_bf16 v[88:91], a[104:107], v[36:39], v[88:91]
    v_mfma_f32_16x16x32_bf16 v[92:95], a[108:111], v[36:39], v[92:95]
    s_waitcnt lgkmcnt(6)
    v_mfma_f32_16x16x32_bf16 v[64:67], a[112:115], v[40:43], v[64:67]
    ds_read_b128 v[36:39], v8 offset:24576
    v_mfma_f32_16x16x32_bf16 v[68:71], a[116:119], v[40:43], v[68:71]
    v_mfma_f32_16x16x32_bf16 v[72:75], a[120:123], v[40:43], v[72:75]
    v_mfma_f32_16x16x32_bf16 v[76:79], a[124:127], v[40:43], v[76:79]
    s_waitcnt lgkmcnt(6)
    v_mfma_f32_16x16x32_bf16 v[80:83], a[112:115], v[44:47], v[80:83]
    ds_read_b128 v[40:43], v9 offset:6144
    v_mfma_f32_16x16x32_bf16 v[84:87], a[116:119], v[44:47], v[84:87]
    v_mfma_f32_16x16x32_bf16 v[88:91], a[120:123], v[44:47], v[88:91]
    v_mfma_f32_16x16x32_bf16 v[92:95], a[124:127], v[44:47], v[92:95]
    s_waitcnt lgkmcnt(6)
    v_mfma_f32_16x16x32_bf16 v[64:67], a[128:131], v[48:51], v[64:67]
    ds_read_b128 v[44:47], v9 offset:24576
    v_mfma_f32_16x16x32_bf16 v[68:71], a[132:135], v[48:51], v[68:71]
    v_mfma_f32_16x16x32_bf16 v[72:75], a[136:139], v[48:51], v[72:75]
    v_mfma_f32_16x16x32_bf16 v[76:79], a[140:143], v[48:51], v[76:79]
    s_waitcnt lgkmcnt(6)
    v_mfma_f32_16x16x32_bf16 v[80:83], a[128:131], v[52:55], v[80:83]
    ds_read_b128 v[48:51], v8 offset:7168
    v_mfma_f32_16x16x32_bf16 v[84:87], a[132:135], v[52:55], v[84:87]
    v_mfma_f32_16x16x32_bf16 v[88:91], a[136:139], v[52:55], v[88:91]
    v_mfma_f32_16x16x32_bf16 v[92:95], a[140:143], v[52:55], v[92:95]
    s_waitcnt lgkmcnt(6)
    v_mfma_f32_16x16x32_bf16 v[64:67], a[144:147], v[56:59], v[64:67]
    ds_read_b128 v[52:55], v8 offset:25600
    v_mfma_f32_16x16x32_bf16 v[68:71], a[148:151], v[56:59], v[68:71]
    v_mfma_f32_16x16x32_bf16 v[72:75], a[152:155], v[56:59], v[72:75]
    v_mfma_f32_16x16x32_bf16 v[76:79], a[156:159], v[56:59], v[76:79]
    s_waitcnt lgkmcnt(6)
    v_mfma_f32_16x16x32_bf16 v[80:83], a[144:147], v[60:63], v[80:83]
    ds_read_b128 v[56:59], v9 offset:7168
    v_mfma_f32_16x16x32_bf16 v[84:87], a[148:151], v[60:63], v[84:87]
    v_mfma_f32_16x16x32_bf16 v[88:91], a[152:155], v[60:63], v[88:91]
    v_mfma_f32_16x16x32_bf16 v[92:95], a[156:159], v[60:63], v[92:95]
    s_waitcnt lgkmcnt(6)
    v_mfma_f32_16x16x32_bf16 v[64:67], a[160:163], v[32:35], v[64:67]
    ds_read_b128 v[60:63], v9 offset:25600
    v_mfma_f32_16x16x32_bf16 v[68:71], a[164:167], v[32:35], v[68:71]
    v_mfma_f32_16x16x32_bf16 v[72:75], a[168:171], v[32:35], v[72:75]
    v_mfma_f32_16x16x32_bf16 v[76:79], a[172:175], v[32:35], v[76:79]
    s_waitcnt lgkmcnt(6)
    v_mfma_f32_16x16x32_bf16 v[80:83], a[160:163], v[36:39], v[80:83]
    ds_read_b128 v[32:35], v8 offset:8192
    v_mfma_f32_16x16x32_bf16 v[84:87], a[164:167], v[36:39], v[84:87]
    v_mfma_f32_16x16x32_bf16 v[88:91], a[168:171], v[36:39], v[88:91]
    v_mfma_f32_16x16x32_bf16 v[92:95], a[172:175], v[36:39], v[92:95]
    s_waitcnt lgkmcnt(6)
    v_mfma_f32_16x16x32_bf16 v[64:67], a[176:179], v[40:43], v[64:67]
    ds_read_b128 v[36:39], v8 offset:26624
    v_mfma_f32_16x16x32_bf16 v[68:71], a[180:183], v[40:43], v[68:71]
    v_mfma_f32_16x16x32_bf16 v[72:75], a[184:187], v[40:43], v[72:75]
    v_mfma_f32_16x16x32_bf16 v[76:79], a[188:191], v[40:43], v[76:79]
    s_waitcnt lgkmcnt(6)
    v_mfma_f32_16x16x32_bf16 v[80:83], a[176:179], v[44:47], v[80:83]
    ds_read_b128 v[40:43], v9 offset:8192
    v_mfma_f32_16x16x32_bf16 v[84:87], a[180:183], v[44:47], v[84:87]
    v_mfma_f32_16x16x32_bf16 v[88:91], a[184:187], v[44:47], v[88:91]
    v_mfma_f32_16x16x32_bf16 v[92:95], a[188:191], v[44:47], v[92:95]
    s_waitcnt lgkmcnt(6)
    v_mfma_f32_16x16x32_bf16 v[64:67], a[192:195], v[48:51], v[64:67]
    ds_read_b128 v[44:47], v9 offset:26624
    v_mfma_f32_16x16x32_bf16 v[68:71], a[196:199], v[48:51], v[68:71]
    v_mfma_f32_16x16x32_bf16 v[72:75], a[200:203], v[48:51], v[72:75]
    v_mfma_f32_16x16x32_bf16 v[76:79], a[204:207], v[48:51], v[76:79]
    s_waitcnt lgkmcnt(6)
    v_mfma_f32_16x16x32_bf16 v[80:83], a[192:195], v[52:55], v[80:83]
    v_mfma_f32_16x16x32_bf16 v[84:87], a[196:199], v[52:55], v[84:87]
    v_mfma_f32_16x16x32_bf16 v[88:91], a[200:203], v[52:55], v[88:91]
    v_mfma_f32_16x16x32_bf16 v[92:95], a[204:207], v[52:55], v[92:95]
    s_waitcnt lgkmcnt(5)
    v_mfma_f32_16x16x32_bf16 v[64:67], a[208:211], v[56:59], v[64:67]
    v_mfma_f32_16x16x32_bf16 v[68:71], a[212:215], v[56:59], v[68:71]
    v_mfma_f32_16x16x32_bf16 v[72:75], a[216:219], v[56:59], v[72:75]
    v_mfma_f32_16x16x32_bf16 v[76:79], a[220:223], v[56:59], v[76:79]
    s_waitcnt lgkmcnt(4)
    v_mfma_f32_16x16x32_bf16 v[80:83], a[208:211], v[60:63], v[80:83]
    v_mfma_f32_16x16x32_bf16 v[84:87], a[212:215], v[60:63], v[84:87]
    v_mfma_f32_16x16x32_bf16 v[88:91], a[216:219], v[60:63], v[88:91]
    v_mfma_f32_16x16x32_bf16 v[92:95], a[220:223], v[60:63], v[92:95]
    s_waitcnt lgkmcnt(3)
    v_mfma_f32_16x16x32_bf16 v[64:67], a[224:227], v[32:35], v[64:67]
    v_mfma_f32_16x16x32_bf16 v[68:71], a[228:231], v[32:35], v[68:71]
    v_mfma_f32_16x16x32_bf16 v[72:75], a[232:235], v[32:35], v[72:75]
    v_mfma_f32_16x16x32_bf16 v[76:79], a[236:239], v[32:35], v[76:79]
    s_waitcnt lgkmcnt(2)
    v_mfma_f32_16x16x32_bf16 v[80:83], a[224:227], v[36:39], v[80:83]
    v_mfma_f32_16x16x32_bf16 v[84:87], a[228:231], v[36:39], v[84:87]
    v_mfma_f32_16x16x32_bf16 v[88:91], a[232:235], v[36:39], v[88:91]
    v_mfma_f32_16x16x32_bf16 v[92:95], a[236:239], v[36:39], v[92:95]
    s_waitcnt lgkmcnt(1)
    v_mfma_f32_16x16x32_bf16 v[64:67], a[240:243], v[40:43], v[64:67]
    v_mfma_f32_16x16x32_bf16 v[68:71], a[244:247], v[40:43], v[68:71]
    v_mfma_f32_16x16x32_bf16 v[72:75], a[248:251], v[40:43], v[72:75]
    v_mfma_f32_16x16x32_bf16 v[76:79], a[252:255], v[40:43], v[76:79]
    s_waitcnt lgkmcnt(0)
    v_mfma_f32_16x16x32_bf16 v[80:83], a[240:243], v[44:47], v[80:83]
    v_mfma_f32_16x16x32_bf16 v[84:87], a[244:247], v[44:47], v[84:87]
    v_mfma_f32_16x16x32_bf16 v[88:91], a[248:251], v[44:47], v[88:91]
    v_mfma_f32_16x16x32_bf16 v[92:95], a[252:255], v[44:47], v[92:95]
    v_lshrrev_b32 v10, 1, v2
    v_lshlrev_b32 v10, 9, v10
    v_lshl_add_u32 v10, v3, 4, v10
    v_and_b32 v11, 1, v2
    v_lshl_add_u32 v10, v11, 3, v10
    v_lshlrev_b32 v11, 2, v3
    s_mov_b32 s33, 0x28000
    s_mov_b32 s34, 0x6800000
    s_mov_b32 s35, 0x28000
    s_mov_b32 s36, 0x6810000
    s_cmp_lt_u32 s40, 4
    s_cmov_b32 s33, 0x10000
    s_cmov_b32 s34, 0x6000000
    s_cmov_b32 s35, 0x2000
    s_cmov_b32 s36, 0x6200000
    s_mul_i32 s44, s42, s33
    s_add_u32 s44, s44, s34
    s_lshl_b32 s46, s30, 10
    s_add_u32 s44, s44, s46
    s_mul_i32 s45, s42, s35
    s_add_u32 s45, s45, s36
    s_lshl_b32 s46, s30, 7
    s_add_u32 s45, s45, s46
    s_mov_b32 s46, 0
    s_mov_b32 s47, 0xffff0000
    v_cvt_pk_bf16_f32 v12, v64, v65
    v_cvt_pk_bf16_f32 v13, v66, v67
    v_cvt_pk_bf16_f32 v14, v70, v71
    buffer_store_dwordx2 v[12:13], v10, s[8:11], s44 offen offset:0 sc1
    s_mov_b64 exec, s[46:47]
    buffer_store_dword v14, v11, s[8:11], s45 offen offset:0 sc1
    s_mov_b64 exec, -1
    v_cvt_pk_bf16_f32 v16, v80, v81
    v_cvt_pk_bf16_f32 v17, v82, v83
    v_cvt_pk_bf16_f32 v18, v86, v87
    buffer_store_dwordx2 v[16:17], v10, s[8:11], s44 offen offset:256 sc1
    s_mov_b64 exec, s[46:47]
    buffer_store_dword v18, v11, s[8:11], s45 offen offset:64 sc1
    s_mov_b64 exec, -1
    s_add_u32 s44, s44, s33
    s_add_u32 s45, s45, s35
    v_cvt_pk_bf16_f32 v20, v72, v73
    v_cvt_pk_bf16_f32 v21, v74, v75
    v_cvt_pk_bf16_f32 v22, v78, v79
    buffer_store_dwordx2 v[20:21], v10, s[8:11], s44 offen offset:0 sc1
    s_mov_b64 exec, s[46:47]
    buffer_store_dword v22, v11, s[8:11], s45 offen offset:0 sc1
    s_mov_b64 exec, -1
    v_cvt_pk_bf16_f32 v24, v88, v89
    v_cvt_pk_bf16_f32 v25, v90, v91
    v_cvt_pk_bf16_f32 v26, v94, v95
    buffer_store_dwordx2 v[24:25], v10, s[8:11], s44 offen offset:256 sc1
    s_mov_b64 exec, s[46:47]
    buffer_store_dword v26, v11, s[8:11], s45 offen offset:64 sc1
    s_mov_b64 exec, -1
    s_add_u32 s30, s30, s31
    s_cmp_lt_u32 s30, s32
    s_cbranch_scc1 L_pgl_a1_1
    s_waitcnt vmcnt(0)
    s_barrier
L_pgd_a1:
    s_and_b32 s34, s40, 3
    s_lshl_b32 s34, s34, 7
    s_add_u32 s34, s34, 0x184080
    s_cmp_lg_u32 s28, 0
    s_cbranch_scc1 L_sig_6
    v_mov_b32 v28, s34
    v_mov_b32 v29, 1
    s_mov_b64 exec, 1
    buffer_atomic_add v29, v28, s[8:11], 0 offen
    s_mov_b64 exec, -1
L_sig_6:
L_noa1:
    s_mul_i32 s40, s38, 4682
    s_lshr_b32 s40, s40, 16
    s_mul_i32 s41, s40, 14
    s_sub_u32 s41, s38, s41
    s_mov_b32 s24, s70
    s_and_b32 s25, s71, 0xffff
    s_mov_b32 s26, 0x240000
    s_mov_b32 s27, 0x20000
    s_mov_b32 s20, s74
    s_and_b32 s21, s75, 0xffff
    s_mov_b32 s22, 0x480000
    s_mov_b32 s23, 0x20000
    s_lshl_b32 s33, s28, 7
    s_lshl_b32 s29, s40, 9
    s_add_u32 s29, s29, s33
    s_mov_b32 s30, s41
    s_mov_b32 s31, 14
    s_mov_b32 s32, 64
    v_and_b32 v1, 63, v0
    v_lshrrev_b32 v2, 4, v1
    v_and_b32 v3, 15, v1
    s_barrier
    v_lshrrev_b32 v8, 3, v1
    v_and_b32 v9, 7, v1
    v_lshrrev_b32 v10, 1, v8
    v_xor_b32 v9, v9, v10
    v_xor_b32 v10, 4, v9
    v_mul_u32_u24 v8, 1152, v8
    v_lshl_add_u32 v4, v9, 4, v8
    v_lshl_add_u32 v5, v10, 4, v8
    v_lshrrev_b32 v8, 3, v3
    v_mul_u32_u24 v8, 9216, v8
    v_and_b32 v9, 7, v3
    v_lshl_add_u32 v8, v9, 7, v8
    v_lshrrev_b32 v9, 1, v3
    v_xor_b32 v9, v9, v2
    v_lshl_add_u32 v6, v9, 4, v8
    v_xor_b32 v7, 64, v6
    s_and_b32 s33, s28, 1
    s_cmp_eq_u32 s33, 1
    s_cselect_b64 vcc, -1, 0
    v_cndmask_b32 v16, v4, v5, vcc
    v_mov_b32 v18, v6
    v_mov_b32 v19, v7
    s_mov_b32 s37, 0
    v_lshrrev_b32 v4, 3, v1
    v_and_b32 v5, 7, v1
    v_and_b32 v6, 2, v4
    v_xor_b32 v5, v5, v6
    v_xor_b32 v6, 4, v5
    v_mul_u32_u24 v4, 8192, v4
    v_lshl_add_u32 v5, v5, 4, v4
    v_lshl_add_u32 v6, v6, 4, v4
    v_lshrrev_b32 v7, 2, v3
    v_and_b32 v8, 3, v3
    v_lshlrev_b32 v9, 10, v2
    v_lshl_add_u32 v9, v7, 7, v9
    v_lshl_add_u32 v9, v8, 3, v9
    v_lshrrev_b32 v7, 1, v7
    v_and_b32 v8, 1, v2
    v_lshl_add_u32 v7, v8, 1, v7
    v_lshlrev_b32 v7, 5, v7
    s_mul_i32 s33, s28, 20480
    s_add_u32 s33, s33, 73728
    v_add_u32 v9, s33, v9
    v_xor_b32 v10, 0, v7
    v_add_u32 v10, v10, v9
    v_xor_b32 v11, 32, v7
    v_add_u32 v11, v11, v9
    v_xor_b32 v12, 64, v7
    v_add_u32 v12, v12, v9
    v_xor_b32 v13, 96, v7
    v_add_u32 v13, v13, v9
    s_add_u32 m0, s33, 0
    s_add_u32 s34, s29, 0
    buffer_load_dwordx4 v5, s[20:23], s34 offen lds
    s_add_u32 m0, s33, 1024
    s_add_u32 s34, s29, 65536
    buffer_load_dwordx4 v6, s[20:23], s34 offen lds
    s_add_u32 m0, s33, 2048
    s_add_u32 s34, s29, 131072
    buffer_load_dwordx4 v5, s[20:23], s34 offen lds
    s_add_u32 m0, s33, 3072
    s_add_u32 s34, s29, 196608
    buffer_load_dwordx4 v6, s[20:23], s34 offen lds
    s_add_u32 m0, s33, 4096
    s_add_u32 s34, s29, 262144
    buffer_load_dwordx4 v5, s[20:23], s34 offen lds
    s_add_u32 m0, s33, 5120
    s_add_u32 s34, s29, 327680
    buffer_load_dwordx4 v6, s[20:23], s34 offen lds
    s_add_u32 m0, s33, 6144
    s_add_u32 s34, s29, 393216
    buffer_load_dwordx4 v5, s[20:23], s34 offen lds
    s_add_u32 m0, s33, 7168
    s_add_u32 s34, s29, 458752
    buffer_load_dwordx4 v6, s[20:23], s34 offen lds
    s_add_u32 m0, s33, 8192
    s_add_u32 s34, s29, 524288
    buffer_load_dwordx4 v5, s[20:23], s34 offen lds
    s_add_u32 m0, s33, 9216
    s_add_u32 s34, s29, 589824
    buffer_load_dwordx4 v6, s[20:23], s34 offen lds
    s_add_u32 m0, s33, 10240
    s_add_u32 s34, s29, 655360
    buffer_load_dwordx4 v5, s[20:23], s34 offen lds
    s_add_u32 m0, s33, 11264
    s_add_u32 s34, s29, 720896
    buffer_load_dwordx4 v6, s[20:23], s34 offen lds
    s_add_u32 m0, s33, 12288
    s_add_u32 s34, s29, 786432
    buffer_load_dwordx4 v5, s[20:23], s34 offen lds
    s_add_u32 m0, s33, 13312
    s_add_u32 s34, s29, 851968
    buffer_load_dwordx4 v6, s[20:23], s34 offen lds
    s_add_u32 m0, s33, 14336
    s_add_u32 s34, s29, 917504
    buffer_load_dwordx4 v5, s[20:23], s34 offen lds
    s_add_u32 m0, s33, 15360
    s_add_u32 s34, s29, 983040
    buffer_load_dwordx4 v6, s[20:23], s34 offen lds
    s_add_u32 m0, s33, 16384
    s_add_u32 s34, s29, 1048576
    buffer_load_dwordx4 v5, s[20:23], s34 offen lds
    s_add_u32 m0, s33, 17408
    s_add_u32 s34, s29, 1114112
    buffer_load_dwordx4 v6, s[20:23], s34 offen lds
    s_add_u32 m0, s33, 18432
    s_add_u32 s34, s29, 1179648
    buffer_load_dwordx4 v5, s[20:23], s34 offen lds
    s_add_u32 m0, s33, 19456
    s_add_u32 s34, s29, 1245184
    buffer_load_dwordx4 v6, s[20:23], s34 offen lds
    s_lshl_b32 s35, s30, 2
    s_add_u32 s35, s35, s28
    s_mul_i32 s35, s35, 9216
    s_mul_i32 s36, s28, 9216
    s_add_u32 s36, s36, 0
    s_add_u32 m0, s36, 0
    s_nop 0
    buffer_load_dwordx4 v16, s[24:27], s35 offen offset:0 sc1 lds
    s_add_u32 m0, s36, 896
    s_nop 0
    buffer_load_dwordx4 v16, s[24:27], s35 offen offset:128 sc1 lds
    s_add_u32 m0, s36, 1792
    s_nop 0
    buffer_load_dwordx4 v16, s[24:27], s35 offen offset:256 sc1 lds
    s_add_u32 m0, s36, 2688
    s_nop 0
    buffer_load_dwordx4 v16, s[24:27], s35 offen offset:384 sc1 lds
    s_add_u32 m0, s36, 3584
    s_nop 0
    buffer_load_dwordx4 v16, s[24:27], s35 offen offset:512 sc1 lds
    s_add_u32 m0, s36, 4480
    s_nop 0
    buffer_load_dwordx4 v16, s[24:27], s35 offen offset:640 sc1 lds
    s_add_u32 m0, s36, 5376
    s_nop 0
    buffer_load_dwordx4 v16, s[24:27], s35 offen offset:768 sc1 lds
    s_add_u32 m0, s36, 6272
    s_nop 0
    buffer_load_dwordx4 v16, s[24:27], s35 offen offset:896 sc1 lds
    s_add_u32 m0, s36, 7168
    s_nop 0
    buffer_load_dwordx4 v16, s[24:27], s35 offen offset:1024 sc1 lds
    s_waitcnt vmcnt(25)
    ds_read_b64_tr_b16 v[224:225], v10 offset:0
    ds_read_b64_tr_b16 v[226:227], v10 offset:512
    ds_read_b64_tr_b16 v[228:229], v11 offset:0
    ds_read_b64_tr_b16 v[230:231], v11 offset:512
    ds_read_b64_tr_b16 v[232:233], v12 offset:0
    ds_read_b64_tr_b16 v[234:235], v12 offset:512
    ds_read_b64_tr_b16 v[236:237], v13 offset:0
    ds_read_b64_tr_b16 v[238:239], v13 offset:512
    s_waitcnt lgkmcnt(0)
    s_add_u32 m0, s33, 0
    s_add_u32 s34, s29, 1310720
    buffer_load_dwordx4 v5, s[20:23], s34 offen lds
    s_add_u32 m0, s33, 1024
    s_add_u32 s34, s29, 1376256
    buffer_load_dwordx4 v6, s[20:23], s34 offen lds
    s_add_u32 m0, s33, 2048
    s_add_u32 s34, s29, 1441792
    buffer_load_dwordx4 v5, s[20:23], s34 offen lds
    s_add_u32 m0, s33, 3072
    s_add_u32 s34, s29, 1507328
    buffer_load_dwordx4 v6, s[20:23], s34 offen lds
    s_waitcnt vmcnt(25)
    ds_read_b64_tr_b16 v[240:241], v10 offset:4096
    ds_read_b64_tr_b16 v[242:243], v10 offset:4608
    ds_read_b64_tr_b16 v[244:245], v11 offset:4096
    ds_read_b64_tr_b16 v[246:247], v11 offset:4608
    ds_read_b64_tr_b16 v[248:249], v12 offset:4096
    ds_read_b64_tr_b16 v[250:251], v12 offset:4608
    ds_read_b64_tr_b16 v[252:253], v13 offset:4096
    ds_read_b64_tr_b16 v[254:255], v13 offset:4608
    s_waitcnt lgkmcnt(0)
    s_add_u32 m0, s33, 4096
    s_add_u32 s34, s29, 1572864
    buffer_load_dwordx4 v5, s[20:23], s34 offen lds
    s_add_u32 m0, s33, 5120
    s_add_u32 s34, s29, 1638400
    buffer_load_dwordx4 v6, s[20:23], s34 offen lds
    s_add_u32 m0, s33, 6144
    s_add_u32 s34, s29, 1703936
    buffer_load_dwordx4 v5, s[20:23], s34 offen lds
    s_add_u32 m0, s33, 7168
    s_add_u32 s34, s29, 1769472
    buffer_load_dwordx4 v6, s[20:23], s34 offen lds
    s_waitcnt vmcnt(25)
    ds_read_b64_tr_b16 a[0:1], v10 offset:8192
    ds_read_b64_tr_b16 a[2:3], v10 offset:8704
    ds_read_b64_tr_b16 a[4:5], v11 offset:8192
    ds_read_b64_tr_b16 a[6:7], v11 offset:8704
    ds_read_b64_tr_b16 a[8:9], v12 offset:8192
    ds_read_b64_tr_b16 a[10:11], v12 offset:8704
    ds_read_b64_tr_b16 a[12:13], v13 offset:8192
    ds_read_b64_tr_b16 a[14:15], v13 offset:8704
    s_waitcnt lgkmcnt(0)
    s_add_u32 m0, s33, 8192
    s_add_u32 s34, s29, 1835008
    buffer_load_dwordx4 v5, s[20:23], s34 offen lds
    s_add_u32 m0, s33, 9216
    s_add_u32 s34, s29, 1900544
    buffer_load_dwordx4 v6, s[20:23], s34 offen lds
    s_add_u32 m0, s33, 10240
    s_add_u32 s34, s29, 1966080
    buffer_load_dwordx4 v5, s[20:23], s34 offen lds
    s_add_u32 m0, s33, 11264
    s_add_u32 s34, s29, 2031616
    buffer_load_dwordx4 v6, s[20:23], s34 offen lds
    s_waitcnt vmcnt(25)
    ds_read_b64_tr_b16 a[16:17], v10 offset:12288
    ds_read_b64_tr_b16 a[18:19], v10 offset:12800
    ds_read_b64_tr_b16 a[20:21], v11 offset:12288
    ds_read_b64_tr_b16 a[22:23], v11 offset:12800
    ds_read_b64_tr_b16 a[24:25], v12 offset:12288
    ds_read_b64_tr_b16 a[26:27], v12 offset:12800
    ds_read_b64_tr_b16 a[28:29], v13 offset:12288
    ds_read_b64_tr_b16 a[30:31], v13 offset:12800
    s_waitcnt lgkmcnt(0)
    s_add_u32 m0, s33, 12288
    s_add_u32 s34, s29, 2097152
    buffer_load_dwordx4 v5, s[20:23], s34 offen lds
    s_add_u32 m0, s33, 13312
    s_add_u32 s34, s29, 2162688
    buffer_load_dwordx4 v6, s[20:23], s34 offen lds
    s_add_u32 m0, s33, 14336
    s_add_u32 s34, s29, 2228224
    buffer_load_dwordx4 v5, s[20:23], s34 offen lds
    s_add_u32 m0, s33, 15360
    s_add_u32 s34, s29, 2293760
    buffer_load_dwordx4 v6, s[20:23], s34 offen lds
    s_waitcnt vmcnt(25)
    ds_read_b64_tr_b16 a[32:33], v10 offset:16384
    ds_read_b64_tr_b16 a[34:35], v10 offset:16896
    ds_read_b64_tr_b16 a[36:37], v11 offset:16384
    ds_read_b64_tr_b16 a[38:39], v11 offset:16896
    ds_read_b64_tr_b16 a[40:41], v12 offset:16384
    ds_read_b64_tr_b16 a[42:43], v12 offset:16896
    ds_read_b64_tr_b16 a[44:45], v13 offset:16384
    ds_read_b64_tr_b16 a[46:47], v13 offset:16896
    s_waitcnt lgkmcnt(0)
    s_add_u32 m0, s33, 16384
    s_add_u32 s34, s29, 2359296
    buffer_load_dwordx4 v5, s[20:23], s34 offen lds
    s_add_u32 m0, s33, 17408
    s_add_u32 s34, s29, 2424832
    buffer_load_dwordx4 v6, s[20:23], s34 offen lds
    s_add_u32 m0, s33, 18432
    s_add_u32 s34, s29, 2490368
    buffer_load_dwordx4 v5, s[20:23], s34 offen lds
    s_add_u32 m0, s33, 19456
    s_add_u32 s34, s29, 2555904
    buffer_load_dwordx4 v6, s[20:23], s34 offen lds
    s_waitcnt vmcnt(16)
    ds_read_b64_tr_b16 a[48:49], v10 offset:0
    ds_read_b64_tr_b16 a[50:51], v10 offset:512
    ds_read_b64_tr_b16 a[52:53], v11 offset:0
    ds_read_b64_tr_b16 a[54:55], v11 offset:512
    ds_read_b64_tr_b16 a[56:57], v12 offset:0
    ds_read_b64_tr_b16 a[58:59], v12 offset:512
    ds_read_b64_tr_b16 a[60:61], v13 offset:0
    ds_read_b64_tr_b16 a[62:63], v13 offset:512
    s_waitcnt lgkmcnt(0)
    s_add_u32 m0, s33, 0
    s_add_u32 s34, s29, 2621440
    buffer_load_dwordx4 v5, s[20:23], s34 offen lds
    s_add_u32 m0, s33, 1024
    s_add_u32 s34, s29, 2686976
    buffer_load_dwordx4 v6, s[20:23], s34 offen lds
    s_add_u32 m0, s33, 2048
    s_add_u32 s34, s29, 2752512
    buffer_load_dwordx4 v5, s[20:23], s34 offen lds
    s_add_u32 m0, s33, 3072
    s_add_u32 s34, s29, 2818048
    buffer_load_dwordx4 v6, s[20:23], s34 offen lds
    s_waitcnt vmcnt(16)
    ds_read_b64_tr_b16 a[64:65], v10 offset:4096
    ds_read_b64_tr_b16 a[66:67], v10 offset:4608
    ds_read_b64_tr_b16 a[68:69], v11 offset:4096
    ds_read_b64_tr_b16 a[70:71], v11 offset:4608
    ds_read_b64_tr_b16 a[72:73], v12 offset:4096
    ds_read_b64_tr_b16 a[74:75], v12 offset:4608
    ds_read_b64_tr_b16 a[76:77], v13 offset:4096
    ds_read_b64_tr_b16 a[78:79], v13 offset:4608
    s_waitcnt lgkmcnt(0)
    s_add_u32 m0, s33, 4096
    s_add_u32 s34, s29, 2883584
    buffer_load_dwordx4 v5, s[20:23], s34 offen lds
    s_add_u32 m0, s33, 5120
    s_add_u32 s34, s29, 2949120
    buffer_load_dwordx4 v6, s[20:23], s34 offen lds
    s_add_u32 m0, s33, 6144
    s_add_u32 s34, s29, 3014656
    buffer_load_dwordx4 v5, s[20:23], s34 offen lds
    s_add_u32 m0, s33, 7168
    s_add_u32 s34, s29, 3080192
    buffer_load_dwordx4 v6, s[20:23], s34 offen lds
    s_waitcnt vmcnt(16)
    ds_read_b64_tr_b16 a[80:81], v10 offset:8192
    ds_read_b64_tr_b16 a[82:83], v10 offset:8704
    ds_read_b64_tr_b16 a[84:85], v11 offset:8192
    ds_read_b64_tr_b16 a[86:87], v11 offset:8704
    ds_read_b64_tr_b16 a[88:89], v12 offset:8192
    ds_read_b64_tr_b16 a[90:91], v12 offset:8704
    ds_read_b64_tr_b16 a[92:93], v13 offset:8192
    ds_read_b64_tr_b16 a[94:95], v13 offset:8704
    s_waitcnt lgkmcnt(0)
    s_add_u32 m0, s33, 8192
    s_add_u32 s34, s29, 3145728
    buffer_load_dwordx4 v5, s[20:23], s34 offen lds
    s_add_u32 m0, s33, 9216
    s_add_u32 s34, s29, 3211264
    buffer_load_dwordx4 v6, s[20:23], s34 offen lds
    s_add_u32 m0, s33, 10240
    s_add_u32 s34, s29, 3276800
    buffer_load_dwordx4 v5, s[20:23], s34 offen lds
    s_add_u32 m0, s33, 11264
    s_add_u32 s34, s29, 3342336
    buffer_load_dwordx4 v6, s[20:23], s34 offen lds
    s_waitcnt vmcnt(16)
    ds_read_b64_tr_b16 a[96:97], v10 offset:12288
    ds_read_b64_tr_b16 a[98:99], v10 offset:12800
    ds_read_b64_tr_b16 a[100:101], v11 offset:12288
    ds_read_b64_tr_b16 a[102:103], v11 offset:12800
    ds_read_b64_tr_b16 a[104:105], v12 offset:12288
    ds_read_b64_tr_b16 a[106:107], v12 offset:12800
    ds_read_b64_tr_b16 a[108:109], v13 offset:12288
    ds_read_b64_tr_b16 a[110:111], v13 offset:12800
    s_waitcnt lgkmcnt(0)
    s_add_u32 m0, s33, 12288
    s_add_u32 s34, s29, 3407872
    buffer_load_dwordx4 v5, s[20:23], s34 offen lds
    s_add_u32 m0, s33, 13312
    s_add_u32 s34, s29, 3473408
    buffer_load_dwordx4 v6, s[20:23], s34 offen lds
    s_add_u32 m0, s33, 14336
    s_add_u32 s34, s29, 3538944
    buffer_load_dwordx4 v5, s[20:23], s34 offen lds
    s_add_u32 m0, s33, 15360
    s_add_u32 s34, s29, 3604480
    buffer_load_dwordx4 v6, s[20:23], s34 offen lds
    s_waitcnt vmcnt(16)
    ds_read_b64_tr_b16 a[112:113], v10 offset:16384
    ds_read_b64_tr_b16 a[114:115], v10 offset:16896
    ds_read_b64_tr_b16 a[116:117], v11 offset:16384
    ds_read_b64_tr_b16 a[118:119], v11 offset:16896
    ds_read_b64_tr_b16 a[120:121], v12 offset:16384
    ds_read_b64_tr_b16 a[122:123], v12 offset:16896
    ds_read_b64_tr_b16 a[124:125], v13 offset:16384
    ds_read_b64_tr_b16 a[126:127], v13 offset:16896
    s_waitcnt lgkmcnt(0)
    s_add_u32 m0, s33, 16384
    s_add_u32 s34, s29, 3670016
    buffer_load_dwordx4 v5, s[20:23], s34 offen lds
    s_add_u32 m0, s33, 17408
    s_add_u32 s34, s29, 3735552
    buffer_load_dwordx4 v6, s[20:23], s34 offen lds
    s_add_u32 m0, s33, 18432
    s_add_u32 s34, s29, 3801088
    buffer_load_dwordx4 v5, s[20:23], s34 offen lds
    s_add_u32 m0, s33, 19456
    s_add_u32 s34, s29, 3866624
    buffer_load_dwordx4 v6, s[20:23], s34 offen lds
    s_waitcnt vmcnt(16)
    ds_read_b64_tr_b16 a[128:129], v10 offset:0
    ds_read_b64_tr_b16 a[130:131], v10 offset:512
    ds_read_b64_tr_b16 a[132:133], v11 offset:0
    ds_read_b64_tr_b16 a[134:135], v11 offset:512
    ds_read_b64_tr_b16 a[136:137], v12 offset:0
    ds_read_b64_tr_b16 a[138:139], v12 offset:512
    ds_read_b64_tr_b16 a[140:141], v13 offset:0
    ds_read_b64_tr_b16 a[142:143], v13 offset:512
    s_waitcnt lgkmcnt(0)
    s_add_u32 m0, s33, 0
    s_add_u32 s34, s29, 3932160
    buffer_load_dwordx4 v5, s[20:23], s34 offen lds
    s_add_u32 m0, s33, 1024
    s_add_u32 s34, s29, 3997696
    buffer_load_dwordx4 v6, s[20:23], s34 offen lds
    s_add_u32 m0, s33, 2048
    s_add_u32 s34, s29, 4063232
    buffer_load_dwordx4 v5, s[20:23], s34 offen lds
    s_add_u32 m0, s33, 3072
    s_add_u32 s34, s29, 4128768
    buffer_load_dwordx4 v6, s[20:23], s34 offen lds
    s_waitcnt vmcnt(16)
    ds_read_b64_tr_b16 a[144:145], v10 offset:4096
    ds_read_b64_tr_b16 a[146:147], v10 offset:4608
    ds_read_b64_tr_b16 a[148:149], v11 offset:4096
    ds_read_b64_tr_b16 a[150:151], v11 offset:4608
    ds_read_b64_tr_b16 a[152:153], v12 offset:4096
    ds_read_b64_tr_b16 a[154:155], v12 offset:4608
    ds_read_b64_tr_b16 a[156:157], v13 offset:4096
    ds_read_b64_tr_b16 a[158:159], v13 offset:4608
    s_waitcnt lgkmcnt(0)
    s_add_u32 m0, s33, 4096
    s_add_u32 s34, s29, 4194304
    buffer_load_dwordx4 v5, s[20:23], s34 offen lds
    s_add_u32 m0, s33, 5120
    s_add_u32 s34, s29, 4259840
    buffer_load_dwordx4 v6, s[20:23], s34 offen lds
    s_add_u32 m0, s33, 6144
    s_add_u32 s34, s29, 4325376
    buffer_load_dwordx4 v5, s[20:23], s34 offen lds
    s_add_u32 m0, s33, 7168
    s_add_u32 s34, s29, 4390912
    buffer_load_dwordx4 v6, s[20:23], s34 offen lds
    s_waitcnt vmcnt(16)
    ds_read_b64_tr_b16 a[160:161], v10 offset:8192
    ds_read_b64_tr_b16 a[162:163], v10 offset:8704
    ds_read_b64_tr_b16 a[164:165], v11 offset:8192
    ds_read_b64_tr_b16 a[166:167], v11 offset:8704
    ds_read_b64_tr_b16 a[168:169], v12 offset:8192
    ds_read_b64_tr_b16 a[170:171], v12 offset:8704
    ds_read_b64_tr_b16 a[172:173], v13 offset:8192
    ds_read_b64_tr_b16 a[174:175], v13 offset:8704
    s_waitcnt lgkmcnt(0)
    s_add_u32 m0, s33, 8192
    s_add_u32 s34, s29, 4456448
    buffer_load_dwordx4 v5, s[20:23], s34 offen lds
    s_add_u32 m0, s33, 9216
    s_add_u32 s34, s29, 4521984
    buffer_load_dwordx4 v6, s[20:23], s34 offen lds
    s_add_u32 m0, s33, 10240
    s_add_u32 s34, s29, 4587520
    buffer_load_dwordx4 v5, s[20:23], s34 offen lds
    s_add_u32 m0, s33, 11264
    s_add_u32 s34, s29, 4653056
    buffer_load_dwordx4 v6, s[20:23], s34 offen lds
    s_waitcnt vmcnt(16)
    ds_read_b64_tr_b16 a[176:177], v10 offset:12288
    ds_read_b64_tr_b16 a[178:179], v10 offset:12800
    ds_read_b64_tr_b16 a[180:181], v11 offset:12288
    ds_read_b64_tr_b16 a[182:183], v11 offset:12800
    ds_read_b64_tr_b16 a[184:185], v12 offset:12288
    ds_read_b64_tr_b16 a[186:187], v12 offset:12800
    ds_read_b64_tr_b16 a[188:189], v13 offset:12288
    ds_read_b64_tr_b16 a[190:191], v13 offset:12800
    s_waitcnt lgkmcnt(0)
    s_waitcnt vmcnt(12)
    ds_read_b64_tr_b16 a[192:193], v10 offset:16384
    ds_read_b64_tr_b16 a[194:195], v10 offset:16896
    ds_read_b64_tr_b16 a[196:197], v11 offset:16384
    ds_read_b64_tr_b16 a[198:199], v11 offset:16896
    ds_read_b64_tr_b16 a[200:201], v12 offset:16384
    ds_read_b64_tr_b16 a[202:203], v12 offset:16896
    ds_read_b64_tr_b16 a[204:205], v13 offset:16384
    ds_read_b64_tr_b16 a[206:207], v13 offset:16896
    s_waitcnt lgkmcnt(0)
    s_waitcnt vmcnt(8)
    ds_read_b64_tr_b16 a[208:209], v10 offset:0
    ds_read_b64_tr_b16 a[210:211], v10 offset:512
    ds_read_b64_tr_b16 a[212:213], v11 offset:0
    ds_read_b64_tr_b16 a[214:215], v11 offset:512
    ds_read_b64_tr_b16 a[216:217], v12 offset:0
    ds_read_b64_tr_b16 a[218:219], v12 offset:512
    ds_read_b64_tr_b16 a[220:221], v13 offset:0
    ds_read_b64_tr_b16 a[222:223], v13 offset:512
    s_waitcnt lgkmcnt(0)
    s_waitcnt vmcnt(4)
    ds_read_b64_tr_b16 a[224:225], v10 offset:4096
    ds_read_b64_tr_b16 a[226:227], v10 offset:4608
    ds_read_b64_tr_b16 a[228:229], v11 offset:4096
    ds_read_b64_tr_b16 a[230:231], v11 offset:4608
    ds_read_b64_tr_b16 a[232:233], v12 offset:4096
    ds_read_b64_tr_b16 a[234:235], v12 offset:4608
    ds_read_b64_tr_b16 a[236:237], v13 offset:4096
    ds_read_b64_tr_b16 a[238:239], v13 offset:4608
    s_waitcnt lgkmcnt(0)
    s_waitcnt vmcnt(0)
    ds_read_b64_tr_b16 a[240:241], v10 offset:8192
    ds_read_b64_tr_b16 a[242:243], v10 offset:8704
    ds_read_b64_tr_b16 a[244:245], v11 offset:8192
    ds_read_b64_tr_b16 a[246:247], v11 offset:8704
    ds_read_b64_tr_b16 a[248:249], v12 offset:8192
    ds_read_b64_tr_b16 a[250:251], v12 offset:8704
    ds_read_b64_tr_b16 a[252:253], v13 offset:8192
    ds_read_b64_tr_b16 a[254:255], v13 offset:8704
    s_waitcnt lgkmcnt(0)
    v_mov_b32 v4, v16
    v_mov_b32 v6, v18
    v_mov_b32 v7, v19
    s_waitcnt vmcnt(0)
    s_nop 0
L_pg_q_1:
L_pgl_q_1:
    s_waitcnt vmcnt(4)
    s_barrier
    v_add_u32 v8, s37, v6
    v_add_u32 v9, s37, v7
    s_add_u32 s34, s30, s31
    s_min_u32 s34, s34, 63
    s_xor_b32 s37, s37, 36864
    s_lshl_b32 s35, s34, 2
    s_add_u32 s35, s35, s28
    s_mul_i32 s35, s35, 9216
    s_mul_i32 s36, s28, 9216
    s_add_u32 s36, s36, s37
    ds_read_b128 v[32:35], v8 offset:0
    ds_read_b128 v[36:39], v8 offset:18432
    ds_read_b128 v[40:43], v9 offset:0
    ds_read_b128 v[44:47], v9 offset:18432
    ds_read_b128 v[48:51], v8 offset:1024
    ds_read_b128 v[52:55], v8 offset:19456
    ds_read_b128 v[56:59], v9 offset:1024
    s_waitcnt lgkmcnt(6)
    v_mfma_f32_16x16x32_bf16 v[64:67], v[224:227], v[32:35], 0
    ds_read_b128 v[60:63], v9 offset:19456
    v_mfma_f32_16x16x32_bf16 v[68:71], v[228:231], v[32:35], 0
    s_add_u32 m0, s36, 0
    s_nop 0
    buffer_load_dwordx4 v4, s[24:27], s35 offen offset:0 sc1 lds
    v_mfma_f32_16x16x32_bf16 v[72:75], v[232:235], v[32:35], 0
    v_mfma_f32_16x16x32_bf16 v[76:79], v[236:239], v[32:35], 0
    s_waitcnt lgkmcnt(6)
    v_mfma_f32_16x16x32_bf16 v[80:83], v[224:227], v[36:39], 0
    ds_read_b128 v[32:35], v8 offset:2048
    v_mfma_f32_16x16x32_bf16 v[84:87], v[228:231], v[36:39], 0
    v_mfma_f32_16x16x32_bf16 v[88:91], v[232:235], v[36:39], 0
    v_mfma_f32_16x16x32_bf16 v[92:95], v[236:239], v[36:39], 0
    s_waitcnt lgkmcnt(6)
    v_mfma_f32_16x16x32_bf16 v[64:67], v[240:243], v[40:43], v[64:67]
    ds_read_b128 v[36:39], v8 offset:20480
    v_mfma_f32_16x16x32_bf16 v[68:71], v[244:247], v[40:43], v[68:71]
    s_add_u32 m0, s36, 896
    s_nop 0
    buffer_load_dwordx4 v4, s[24:27], s35 offen offset:128 sc1 lds
    v_mfma_f32_16x16x32_bf16 v[72:75], v[248:251], v[40:43], v[72:75]
    v_mfma_f32_16x16x32_bf16 v[76:79], v[252:255], v[40:43], v[76:79]
    s_waitcnt lgkmcnt(6)
    v_mfma_f32_16x16x32_bf16 v[80:83], v[240:243], v[44:47], v[80:83]
    ds_read_b128 v[40:43], v9 offset:2048
    v_mfma_f32_16x16x32_bf16 v[84:87], v[244:247], v[44:47], v[84:87]
    v_mfma_f32_16x16x32_bf16 v[88:91], v[248:251], v[44:47], v[88:91]
    v_mfma_f32_16x16x32_bf16 v[92:95], v[252:255], v[44:47], v[92:95]
    s_waitcnt lgkmcnt(6)
    v_mfma_f32_16x16x32_bf16 v[64:67], a[0:3], v[48:51], v[64:67]
    ds_read_b128 v[44:47], v9 offset:20480
    v_mfma_f32_16x16x32_bf16 v[68:71], a[4:7], v[48:51], v[68:71]
    s_add_u32 m0, s36, 1792
    s_nop 0
    buffer_load_dwordx4 v4, s[24:27], s35 offen offset:256 sc1 lds
    v_mfma_f32_16x16x32_bf16 v[72:75], a[8:11], v[48:51], v[72:75]
    v_mfma_f32_16x16x32_bf16 v[76:79], a[12:15], v[48:51], v[76:79]
    s_waitcnt lgkmcnt(6)
    v_mfma_f32_16x16x32_bf16 v[80:83], a[0:3], v[52:55], v[80:83]
    ds_read_b128 v[48:51], v8 offset:3072
    v_mfma_f32_16x16x32_bf16 v[84:87], a[4:7], v[52:55], v[84:87]
    v_mfma_f32_16x16x32_bf16 v[88:91], a[8:11], v[52:55], v[88:91]
    v_mfma_f32_16x16x32_bf16 v[92:95], a[12:15], v[52:55], v[92:95]
    s_waitcnt lgkmcnt(6)
    v_mfma_f32_16x16x32_bf16 v[64:67], a[16:19], v[56:59], v[64:67]
    ds_read_b128 v[52:55], v8 offset:21504
    v_mfma_f32_16x16x32_bf16 v[68:71], a[20:23], v[56:59], v[68:71]
    s_add_u32 m0, s36, 2688
    s_nop 0
    buffer_load_dwordx4 v4, s[24:27], s35 offen offset:384 sc1 lds
    v_mfma_f32_16x16x32_bf16 v[72:75], a[24:27], v[56:59], v[72:75]
    v_mfma_f32_16x16x32_bf16 v[76:79], a[28:31], v[56:59], v[76:79]
    s_waitcnt lgkmcnt(6)
    v_mfma_f32_16x16x32_bf16 v[80:83], a[16:19], v[60:63], v[80:83]
    ds_read_b128 v[56:59], v9 offset:3072
    v_mfma_f32_16x16x32_bf16 v[84:87], a[20:23], v[60:63], v[84:87]
    v_mfma_f32_16x16x32_bf16 v[88:91], a[24:27], v[60:63], v[88:91]
    v_mfma_f32_16x16x32_bf16 v[92:95], a[28:31], v[60:63], v[92:95]
    s_waitcnt lgkmcnt(6)
    v_mfma_f32_16x16x32_bf16 v[64:67], a[32:35], v[32:35], v[64:67]
    ds_read_b128 v[60:63], v9 offset:21504
    v_mfma_f32_16x16x32_bf16 v[68:71], a[36:39], v[32:35], v[68:71]
    s_add_u32 m0, s36, 3584
    s_nop 0
    buffer_load_dwordx4 v4, s[24:27], s35 offen offset:512 sc1 lds
    v_mfma_f32_16x16x32_bf16 v[72:75], a[40:43], v[32:35], v[72:75]
    v_mfma_f32_16x16x32_bf16 v[76:79], a[44:47], v[32:35], v[76:79]
    s_waitcnt lgkmcnt(6)
    v_mfma_f32_16x16x32_bf16 v[80:83], a[32:35], v[36:39], v[80:83]
    ds_read_b128 v[32:35], v8 offset:4096
    v_mfma_f32_16x16x32_bf16 v[84:87], a[36:39], v[36:39], v[84:87]
    v_mfma_f32_16x16x32_bf16 v[88:91], a[40:43], v[36:39], v[88:91]
    v_mfma_f32_16x16x32_bf16 v[92:95], a[44:47], v[36:39], v[92:95]
    s_waitcnt lgkmcnt(6)
    v_mfma_f32_16x16x32_bf16 v[64:67], a[48:51], v[40:43], v[64:67]
    ds_read_b128 v[36:39], v8 offset:22528
    v_mfma_f32_16x16x32_bf16 v[68:71], a[52:55], v[40:43], v[68:71]
    s_add_u32 m0, s36, 4480
    s_nop 0
    buffer_load_dwordx4 v4, s[24:27], s35 offen offset:640 sc1 lds
    v_mfma_f32_16x16x32_bf16 v[72:75], a[56:59], v[40:43], v[72:75]
    v_mfma_f32_16x16x32_bf16 v[76:79], a[60:63], v[40:43], v[76:79]
    s_waitcnt lgkmcnt(6)
    v_mfma_f32_16x16x32_bf16 v[80:83], a[48:51], v[44:47], v[80:83]
    ds_read_b128 v[40:43], v9 offset:4096
    v_mfma_f32_16x16x32_bf16 v[84:87], a[52:55], v[44:47], v[84:87]
    v_mfma_f32_16x16x32_bf16 v[88:91], a[56:59], v[44:47], v[88:91]
    v_mfma_f32_16x16x32_bf16 v[92:95], a[60:63], v[44:47], v[92:95]
    s_waitcnt lgkmcnt(6)
    v_mfma_f32_16x16x32_bf16 v[64:67], a[64:67], v[48:51], v[64:67]
    ds_read_b128 v[44:47], v9 offset:22528
    v_mfma_f32_16x16x32_bf16 v[68:71], a[68:71], v[48:51], v[68:71]
    s_add_u32 m0, s36, 5376
    s_nop 0
    buffer_load_dwordx4 v4, s[24:27], s35 offen offset:768 sc1 lds
    v_mfma_f32_16x16x32_bf16 v[72:75], a[72:75], v[48:51], v[72:75]
    v_mfma_f32_16x16x32_bf16 v[76:79], a[76:79], v[48:51], v[76:79]
    s_waitcnt lgkmcnt(6)
    v_mfma_f32_16x16x32_bf16 v[80:83], a[64:67], v[52:55], v[80:83]
    ds_read_b128 v[48:51], v8 offset:5120
    v_mfma_f32_16x16x32_bf16 v[84:87], a[68:71], v[52:55], v[84:87]
    v_mfma_f32_16x16x32_bf16 v[88:91], a[72:75], v[52:55], v[88:91]
    v_mfma_f32_16x16x32_bf16 v[92:95], a[76:79], v[52:55], v[92:95]
    s_waitcnt lgkmcnt(6)
    v_mfma_f32_16x16x32_bf16 v[64:67], a[80:83], v[56:59], v[64:67]
    ds_read_b128 v[52:55], v8 offset:23552
    v_mfma_f32_16x16x32_bf16 v[68:71], a[84:87], v[56:59], v[68:71]
    s_add_u32 m0, s36, 6272
    s_nop 0
    buffer_load_dwordx4 v4, s[24:27], s35 offen offset:896 sc1 lds
    v_mfma_f32_16x16x32_bf16 v[72:75], a[88:91], v[56:59], v[72:75]
    v_mfma_f32_16x16x32_bf16 v[76:79], a[92:95], v[56:59], v[76:79]
    s_waitcnt lgkmcnt(6)
    v_mfma_f32_16x16x32_bf16 v[80:83], a[80:83], v[60:63], v[80:83]
    ds_read_b128 v[56:59], v9 offset:5120
    v_mfma_f32_16x16x32_bf16 v[84:87], a[84:87], v[60:63], v[84:87]
    v_mfma_f32_16x16x32_bf16 v[88:91], a[88:91], v[60:63], v[88:91]
    v_mfma_f32_16x16x32_bf16 v[92:95], a[92:95], v[60:63], v[92:95]
    s_waitcnt lgkmcnt(6)
    v_mfma_f32_16x16x32_bf16 v[64:67], a[96:99], v[32:35], v[64:67]
    ds_read_b128 v[60:63], v9 offset:23552
    v_mfma_f32_16x16x32_bf16 v[68:71], a[100:103], v[32:35], v[68:71]
    s_add_u32 m0, s36, 7168
    s_nop 0
    buffer_load_dwordx4 v4, s[24:27], s35 offen offset:1024 sc1 lds
    v_mfma_f32_16x16x32_bf16 v[72:75], a[104:107], v[32:35], v[72:75]
    v_mfma_f32_16x16x32_bf16 v[76:79], a[108:111], v[32:35], v[76:79]
    s_waitcnt lgkmcnt(6)
    v_mfma_f32_16x16x32_bf16 v[80:83], a[96:99], v[36:39], v[80:83]
    ds_read_b128 v[32:35], v8 offset:6144
    v_mfma_f32_16x16x32_bf16 v[84:87], a[100:103], v[36:39], v[84:87]
    v_mfma_f32_16x16x32_bf16 v[88:91], a[104:107], v[36:39], v[88:91]
    v_mfma_f32_16x16x32_bf16 v[92:95], a[108:111], v[36:39], v[92:95]
    s_waitcnt lgkmcnt(6)
    v_mfma_f32_16x16x32_bf16 v[64:67], a[112:115], v[40:43], v[64:67]
    ds_read_b128 v[36:39], v8 offset:24576
    v_mfma_f32_16x16x32_bf16 v[68:71], a[116:119], v[40:43], v[68:71]
    v_mfma_f32_16x16x32_bf16 v[72:75], a[120:123], v[40:43], v[72:75]
    v_mfma_f32_16x16x32_bf16 v[76:79], a[124:127], v[40:43], v[76:79]
    s_waitcnt lgkmcnt(6)
    v_mfma_f32_16x16x32_bf16 v[80:83], a[112:115], v[44:47], v[80:83]
    ds_read_b128 v[40:43], v9 offset:6144
    v_mfma_f32_16x16x32_bf16 v[84:87], a[116:119], v[44:47], v[84:87]
    v_mfma_f32_16x16x32_bf16 v[88:91], a[120:123], v[44:47], v[88:91]
    v_mfma_f32_16x16x32_bf16 v[92:95], a[124:127], v[44:47], v[92:95]
    s_waitcnt lgkmcnt(6)
    v_mfma_f32_16x16x32_bf16 v[64:67], a[128:131], v[48:51], v[64:67]
    ds_read_b128 v[44:47], v9 offset:24576
    v_mfma_f32_16x16x32_bf16 v[68:71], a[132:135], v[48:51], v[68:71]
    v_mfma_f32_16x16x32_bf16 v[72:75], a[136:139], v[48:51], v[72:75]
    v_mfma_f32_16x16x32_bf16 v[76:79], a[140:143], v[48:51], v[76:79]
    s_waitcnt lgkmcnt(6)
    v_mfma_f32_16x16x32_bf16 v[80:83], a[128:131], v[52:55], v[80:83]
    ds_read_b128 v[48:51], v8 offset:7168
    v_mfma_f32_16x16x32_bf16 v[84:87], a[132:135], v[52:55], v[84:87]
    v_mfma_f32_16x16x32_bf16 v[88:91], a[136:139], v[52:55], v[88:91]
    v_mfma_f32_16x16x32_bf16 v[92:95], a[140:143], v[52:55], v[92:95]
    s_waitcnt lgkmcnt(6)
    v_mfma_f32_16x16x32_bf16 v[64:67], a[144:147], v[56:59], v[64:67]
    ds_read_b128 v[52:55], v8 offset:25600
    v_mfma_f32_16x16x32_bf16 v[68:71], a[148:151], v[56:59], v[68:71]
    v_mfma_f32_16x16x32_bf16 v[72:75], a[152:155], v[56:59], v[72:75]
    v_mfma_f32_16x16x32_bf16 v[76:79], a[156:159], v[56:59], v[76:79]
    s_waitcnt lgkmcnt(6)
    v_mfma_f32_16x16x32_bf16 v[80:83], a[144:147], v[60:63], v[80:83]
    ds_read_b128 v[56:59], v9 offset:7168
    v_mfma_f32_16x16x32_bf16 v[84:87], a[148:151], v[60:63], v[84:87]
    v_mfma_f32_16x16x32_bf16 v[88:91], a[152:155], v[60:63], v[88:91]
    v_mfma_f32_16x16x32_bf16 v[92:95], a[156:159], v[60:63], v[92:95]
    s_waitcnt lgkmcnt(6)
    v_mfma_f32_16x16x32_bf16 v[64:67], a[160:163], v[32:35], v[64:67]
    ds_read_b128 v[60:63], v9 offset:25600
    v_mfma_f32_16x16x32_bf16 v[68:71], a[164:167], v[32:35], v[68:71]
    v_mfma_f32_16x16x32_bf16 v[72:75], a[168:171], v[32:35], v[72:75]
    v_mfma_f32_16x16x32_bf16 v[76:79], a[172:175], v[32:35], v[76:79]
    s_waitcnt lgkmcnt(6)
    v_mfma_f32_16x16x32_bf16 v[80:83], a[160:163], v[36:39], v[80:83]
    ds_read_b128 v[32:35], v8 offset:8192
    v_mfma_f32_16x16x32_bf16 v[84:87], a[164:167], v[36:39], v[84:87]
    v_mfma_f32_16x16x32_bf16 v[88:91], a[168:171], v[36:39], v[88:91]
    v_mfma_f32_16x16x32_bf16 v[92:95], a[172:175], v[36:39], v[92:95]
    s_waitcnt lgkmcnt(6)
    v_mfma_f32_16x16x32_bf16 v[64:67], a[176:179], v[40:43], v[64:67]
    ds_read_b128 v[36:39], v8 offset:26624
    v_mfma_f32_16x16x32_bf16 v[68:71], a[180:183], v[40:43], v[68:71]
    v_mfma_f32_16x16x32_bf16 v[72:75], a[184:187], v[40:43], v[72:75]
    v_mfma_f32_16x16x32_bf16 v[76:79], a[188:191], v[40:43], v[76:79]
    s_waitcnt lgkmcnt(6)
    v_mfma_f32_16x16x32_bf16 v[80:83], a[176:179], v[44:47], v[80:83]
    ds_read_b128 v[40:43], v9 offset:8192
    v_mfma_f32_16x16x32_bf16 v[84:87], a[180:183], v[44:47], v[84:87]
    v_mfma_f32_16x16x32_bf16 v[88:91], a[184:187], v[44:47], v[88:91]
    v_mfma_f32_16x16x32_bf16 v[92:95], a[188:191], v[44:47], v[92:95]
    s_waitcnt lgkmcnt(6)
    v_mfma_f32_16x16x32_bf16 v[64:67], a[192:195], v[48:51], v[64:67]
    ds_read_b128 v[44:47], v9 offset:26624
    v_mfma_f32_16x16x32_bf16 v[68:71], a[196:199], v[48:51], v[68:71]
    v_mfma_f32_16x16x32_bf16 v[72:75], a[200:203], v[48:51], v[72:75]
    v_mfma_f32_16x16x32_bf16 v[76:79], a[204:207], v[48:51], v[76:79]
    s_waitcnt lgkmcnt(6)
    v_mfma_f32_16x16x32_bf16 v[80:83], a[192:195], v[52:55], v[80:83]
    v_mfma_f32_16x16x32_bf16 v[84:87], a[196:199], v[52:55], v[84:87]
    v_mfma_f32_16x16x32_bf16 v[88:91], a[200:203], v[52:55], v[88:91]
    v_mfma_f32_16x16x32_bf16 v[92:95], a[204:207], v[52:55], v[92:95]
    s_waitcnt lgkmcnt(5)
    v_mfma_f32_16x16x32_bf16 v[64:67], a[208:211], v[56:59], v[64:67]
    v_mfma_f32_16x16x32_bf16 v[68:71], a[212:215], v[56:59], v[68:71]
    v_mfma_f32_16x16x32_bf16 v[72:75], a[216:219], v[56:59], v[72:75]
    v_mfma_f32_16x16x32_bf16 v[76:79], a[220:223], v[56:59], v[76:79]
    s_waitcnt lgkmcnt(4)
    v_mfma_f32_16x16x32_bf16 v[80:83], a[208:211], v[60:63], v[80:83]
    v_mfma_f32_16x16x32_bf16 v[84:87], a[212:215], v[60:63], v[84:87]
    v_mfma_f32_16x16x32_bf16 v[88:91], a[216:219], v[60:63], v[88:91]
    v_mfma_f32_16x16x32_bf16 v[92:95], a[220:223], v[60:63], v[92:95]
    s_waitcnt lgkmcnt(3)
    v_mfma_f32_16x16x32_bf16 v[64:67], a[224:227], v[32:35], v[64:67]
    v_mfma_f32_16x16x32_bf16 v[68:71], a[228:231], v[32:35], v[68:71]
    v_mfma_f32_16x16x32_bf16 v[72:75], a[232:235], v[32:35], v[72:75]
    v_mfma_f32_16x16x32_bf16 v[76:79], a[236:239], v[32:35], v[76:79]
    s_waitcnt lgkmcnt(2)
    v_mfma_f32_16x16x32_bf16 v[80:83], a[224:227], v[36:39], v[80:83]
    v_mfma_f32_16x16x32_bf16 v[84:87], a[228:231], v[36:39], v[84:87]
    v_mfma_f32_16x16x32_bf16 v[88:91], a[232:235], v[36:39], v[88:91]
    v_mfma_f32_16x16x32_bf16 v[92:95], a[236:239], v[36:39], v[92:95]
    s_waitcnt lgkmcnt(1)
    v_mfma_f32_16x16x32_bf16 v[64:67], a[240:243], v[40:43], v[64:67]
    v_mfma_f32_16x16x32_bf16 v[68:71], a[244:247], v[40:43], v[68:71]
    v_mfma_f32_16x16x32_bf16 v[72:75], a[248:251], v[40:43], v[72:75]
    v_mfma_f32_16x16x32_bf16 v[76:79], a[252:255], v[40:43], v[76:79]
    s_waitcnt lgkmcnt(0)
    v_mfma_f32_16x16x32_bf16 v[80:83], a[240:243], v[44:47], v[80:83]
    v_mfma_f32_16x16x32_bf16 v[84:87], a[244:247], v[44:47], v[84:87]
    v_mfma_f32_16x16x32_bf16 v[88:91], a[248:251], v[44:47], v[88:91]
    v_mfma_f32_16x16x32_bf16 v[92:95], a[252:255], v[44:47], v[92:95]
    s_lshl_b32 s33, s30, 4
    s_add_u32 s33, s33, s40
    s_lshl_b32 s33, s33, 1
    s_lshr_b32 s34, s28, 1
    s_add_u32 s33, s33, s34
    s_lshl_b32 s33, s33, 13
    s_and_b32 s34, s28, 1
    s_lshl_b32 s34, s34, 11
    s_add_u32 s33, s33, s34
    s_add_u32 s33, s33, 0x3000000
    v_lshlrev_b32 v10, 4, v1
    v_cvt_pk_bf16_f32 v12, v64, v65
    v_cvt_pk_bf16_f32 v13, v68, v69
    v_cvt_pk_bf16_f32 v14, v66, v67
    v_cvt_pk_bf16_f32 v15, v70, v71
    buffer_store_dwordx4 v[12:15], v10, s[8:11], s33 offen offset:0 sc1
    v_cvt_pk_bf16_f32 v16, v72, v73
    v_cvt_pk_bf16_f32 v17, v76, v77
    v_cvt_pk_bf16_f32 v18, v74, v75
    v_cvt_pk_bf16_f32 v19, v78, v79
    buffer_store_dwordx4 v[16:19], v10, s[8:11], s33 offen offset:1024 sc1
    v_cvt_pk_bf16_f32 v20, v80, v81
    v_cvt_pk_bf16_f32 v21, v84, v85
    v_cvt_pk_bf16_f32 v22, v82, v83
    v_cvt_pk_bf16_f32 v23, v86, v87
    s_add_u32 s33, s33, 4096
    buffer_store_dwordx4 v[20:23], v10, s[8:11], s33 offen offset:0 sc1
    v_cvt_pk_bf16_f32 v24, v88, v89
    v_cvt_pk_bf16_f32 v25, v92, v93
    v_cvt_pk_bf16_f32 v26, v90, v91
    v_cvt_pk_bf16_f32 v27, v94, v95
    buffer_store_dwordx4 v[24:27], v10, s[8:11], s33 offen offset:1024 sc1
    s_add_u32 s30, s30, s31
    s_cmp_lt_u32 s30, s32
    s_cbranch_scc1 L_pgl_q_1
    s_waitcnt vmcnt(0)
    s_barrier
L_pgd_q:
    s_cmp_lg_u32 s28, 0
    s_cbranch_scc1 L_sig_7
    v_mov_b32 v28, 0x184000
    v_mov_b32 v29, 1
    s_mov_b64 exec, 1
    buffer_atomic_add v29, v28, s[8:11], 0 offen
    s_mov_b64 exec, -1
L_sig_7:
    s_mul_i32 s40, s38, 9363
    s_lshr_b32 s40, s40, 16
    s_mul_i32 s41, s40, 7
    s_sub_u32 s41, s38, s41
    v_and_b32 v1, 63, v0
    v_lshrrev_b32 v2, 4, v1
    v_and_b32 v3, 15, v1
    s_barrier
    s_lshr_b32 s34, s40, 3
    s_lshl_b32 s34, s34, 7
    s_add_u32 s34, s34, 0x184080
    s_mov_b32 s39, 0
    v_mov_b32 v28, s34
L_poll_8:
    buffer_load_dword v29, v28, s[8:11], 0 offen sc1
    s_add_u32 s39, s39, 1
    s_cmp_gt_u32 s39, 4000000
    s_cbranch_scc1 L_fail
    s_waitcnt vmcnt(0)
    v_readfirstlane_b32 s33, v29
    s_nop 0
    s_cmp_ge_u32 s33, 54
    s_cbranch_scc1 L_poll_8_d
    s_sleep 2
    s_branch L_poll_8
L_poll_8_d:
    v_lshlrev_b32 v4, 4, v1
    s_mul_i32 s33, s40, 0x28000
    s_add_u32 s33, s33, 0x6800000
    s_mul_i32 s34, s28, 37888
    s_add_u32 s33, s33, s34
    s_add_u32 m0, s34, 0
    s_add_u32 s35, s33, 0
    buffer_load_dwordx4 v4, s[8:11], s35 offen offset:0 sc1 lds
    buffer_load_dwordx4 v4, s[8:11], s35 offen offset:1024 sc1 lds
    buffer_load_dwordx4 v4, s[8:11], s35 offen offset:2048 sc1 lds
    buffer_load_dwordx4 v4, s[8:11], s35 offen offset:3072 sc1 lds
    s_add_u32 m0, s34, 4096
    s_add_u32 s35, s33, 4096
    buffer_load_dwordx4 v4, s[8:11], s35 offen offset:0 sc1 lds
    buffer_load_dwordx4 v4, s[8:11], s35 offen offset:1024 sc1 lds
    buffer_load_dwordx4 v4, s[8:11], s35 offen offset:2048 sc1 lds
    buffer_load_dwordx4 v4, s[8:11], s35 offen offset:3072 sc1 lds
    s_add_u32 m0, s34, 8192
    s_add_u32 s35, s33, 8192
    buffer_load_dwordx4 v4, s[8:11], s35 offen offset:0 sc1 lds
    buffer_load_dwordx4 v4, s[8:11], s35 offen offset:1024 sc1 lds
    buffer_load_dwordx4 v4, s[8:11], s35 offen offset:2048 sc1 lds
    buffer_load_dwordx4 v4, s[8:11], s35 offen offset:3072 sc1 lds
    s_add_u32 m0, s34, 12288
    s_add_u32 s35, s33, 12288
    buffer_load_dwordx4 v4, s[8:11], s35 offen offset:0 sc1 lds
    buffer_load_dwordx4 v4, s[8:11], s35 offen offset:1024 sc1 lds
    buffer_load_dwordx4 v4, s[8:11], s35 offen offset:2048 sc1 lds
    buffer_load_dwordx4 v4, s[8:11], s35 offen offset:3072 sc1 lds
    s_add_u32 m0, s34, 16384
    s_add_u32 s35, s33, 16384
    buffer_load_dwordx4 v4, s[8:11], s35 offen offset:0 sc1 lds
    buffer_load_dwordx4 v4, s[8:11], s35 offen offset:1024 sc1 lds
    buffer_load_dwordx4 v4, s[8:11], s35 offen offset:2048 sc1 lds
    buffer_load_dwordx4 v4, s[8:11], s35 offen offset:3072 sc1 lds
    s_add_u32 m0, s34, 20480
    s_add_u32 s35, s33, 20480
    buffer_load_dwordx4 v4, s[8:11], s35 offen offset:0 sc1 lds
    buffer_load_dwordx4 v4, s[8:11], s35 offen offset:1024 sc1 lds
    buffer_load_dwordx4 v4, s[8:11], s35 offen offset:2048 sc1 lds
    buffer_load_dwordx4 v4, s[8:11], s35 offen offset:3072 sc1 lds
    s_add_u32 m0, s34, 24576
    s_add_u32 s35, s33, 24576
    buffer_load_dwordx4 v4, s[8:11], s35 offen offset:0 sc1 lds
    buffer_load_dwordx4 v4, s[8:11], s35 offen offset:1024 sc1 lds
    buffer_load_dwordx4 v4, s[8:11], s35 offen offset:2048 sc1 lds
    buffer_load_dwordx4 v4, s[8:11], s35 offen offset:3072 sc1 lds
    s_add_u32 m0, s34, 28672
    s_add_u32 s35, s33, 28672
    buffer_load_dwordx4 v4, s[8:11], s35 offen offset:0 sc1 lds
    buffer_load_dwordx4 v4, s[8:11], s35 offen offset:1024 sc1 lds
    buffer_load_dwordx4 v4, s[8:11], s35 offen offset:2048 sc1 lds
    buffer_load_dwordx4 v4, s[8:11], s35 offen offset:3072 sc1 lds
    s_add_u32 m0, s34, 32768
    s_add_u32 s35, s33, 32768
    buffer_load_dwordx4 v4, s[8:11], s35 offen offset:0 sc1 lds
    buffer_load_dwordx4 v4, s[8:11], s35 offen offset:1024 sc1 lds
    buffer_load_dwordx4 v4, s[8:11], s35 offen offset:2048 sc1 lds
    buffer_load_dwordx4 v4, s[8:11], s35 offen offset:3072 sc1 lds
    s_add_u32 m0, s34, 36864
    s_add_u32 s35, s33, 36864
    buffer_load_dwordx4 v4, s[8:11], s35 offen offset:0 sc1 lds
    s_mov_b32 s44, 0x3eae1a93
    s_mov_b32 s45, 0x41000000
    s_mov_b32 s48, -1
    s_mov_b32 s49, 0
    v_and_b32 v8, 31, v1
    v_lshlrev_b32 v5, 2, v8
    v_lshrrev_b32 v9, 5, v1
    v_min_u32 v10, 18, v8
    v_mul_u32_u24 v6, 304, v9
    v_lshl_add_u32 v6, v10, 4, v6
    v_mul_u32_u24 v7, 304, v0
    v_add_u32 v7, 74016, v7
    v_mov_b32 v12, 0x3f803f80
    v_mov_b32 v13, 0x3f803f80
    v_mov_b32 v14, 0x3f803f80
    v_mov_b32 v15, 0x3f803f80
    s_lshl_b32 s46, s41, 2
    s_add_u32 s46, s46, s28
    s_waitcnt vmcnt(0)
    s_barrier
    ds_write_b128 v7, v[12:15]
    s_waitcnt lgkmcnt(0)
    s_barrier
    v_mov_b32 v41, 0
    v_mov_b64 v[42:43], 0
    v_mov_b32 v45, 0
    v_mov_b64 v[46:47], 0
    v_mov_b32 v49, 0
    v_mov_b64 v[50:51], 0
    v_mov_b32 v53, 0
    v_mov_b64 v[54:55], 0
    v_mov_b32 v21, 0
    v_mov_b64 v[22:23], 0
L_a2_q:
    s_cmp_ge_u32 s46, 64
    s_cbranch_scc1 L_a2_done
    s_lshl_b32 s33, s40, 6
    s_add_u32 s33, s33, s46
    s_lshl_b32 s34, s33, 10
    s_add_u32 s34, s34, 0x6000000
    s_lshl_b32 s35, s33, 7
    s_add_u32 s35, s35, 0x6200000
    buffer_load_dwordx4 v[16:19], v4, s[8:11], s34 offen sc1
    buffer_load_dword v186, v5, s[8:11], s35 offen sc1
    v_mov_b32 v188, v4
    v_add_u32 v189, 65536, v5
    v_add_u32 v190, 73728, v6
    v_mov_b32 v185, 0x7149f2ca
    s_mov_b32 s47, 0
    v_mov_b64 v[104:105], 0
    v_mov_b64 v[106:107], 0
    v_mov_b64 v[108:109], 0
    v_mov_b64 v[110:111], 0
    v_mov_b64 v[112:113], 0
    v_mov_b64 v[114:115], 0
    v_mov_b64 v[116:117], 0
    v_mov_b64 v[118:119], 0
    v_mov_b64 v[88:89], 0
    v_mov_b64 v[90:91], 0
    v_mov_b64 v[92:93], 0
    v_mov_b64 v[94:95], 0
    v_mov_b64 v[96:97], 0
    v_mov_b64 v[98:99], 0
    v_mov_b64 v[100:101], 0
    v_mov_b64 v[102:103], 0
    ds_read_b128 v[24:27], v188 offset:0
    ds_read_b32 v40, v189 offset:0
    ds_read_b128 v[28:31], v188 offset:1024
    ds_read_b32 v44, v189 offset:128
    ds_read_b128 v[32:35], v188 offset:2048
    ds_read_b32 v48, v189 offset:256
    ds_read_b128 v[36:39], v188 offset:3072
    ds_read_b32 v52, v189 offset:384
    ds_read_b128 v[72:75], v190 offset:0
    ds_read_b128 v[76:79], v190 offset:608
    ds_read_b128 v[80:83], v190 offset:1216
    ds_read_b128 v[84:87], v190 offset:1824
    s_waitcnt vmcnt(0)
    v_cndmask_b32 v20, 0, v186, s[48:49]
    s_waitcnt lgkmcnt(8)
    v_mfma_f32_32x32x16_bf16 v[120:135], v[24:27], v[16:19], 0
    v_mfma_f32_32x32x16_bf16 v[120:135], v[40:43], v[20:23], v[120:135]
    v_mfma_f32_32x32x16_bf16 v[136:151], v[28:31], v[16:19], 0
    v_mfma_f32_32x32x16_bf16 v[136:151], v[44:47], v[20:23], v[136:151]
    s_nop 11
L_a2_loop:
    s_waitcnt lgkmcnt(0)
    v_mfma_f32_32x32x16_bf16 v[104:119], v[72:75], v[88:91], v[104:119]
    ds_read_b128 v[56:59], v190 offset:0
    v_max3_f32 v184, v120, v121, v122
    v_max_f32 v186, v123, v124
    v_max3_f32 v184, v125, v126, v184
    v_max3_f32 v186, v127, v128, v186
    v_mfma_f32_32x32x16_bf16 v[104:119], v[76:79], v[92:95], v[104:119]
    ds_read_b128 v[60:63], v190 offset:608
    v_max3_f32 v184, v129, v130, v184
    v_max3_f32 v186, v131, v132, v186
    v_max3_f32 v184, v133, v134, v184
    v_max3_f32 v186, v135, v136, v186
    v_mfma_f32_32x32x16_bf16 v[104:119], v[80:83], v[96:99], v[104:119]
    ds_read_b128 v[64:67], v190 offset:1216
    v_max3_f32 v184, v137, v138, v184
    v_max3_f32 v186, v139, v140, v186
    v_max3_f32 v184, v141, v142, v184
    v_max3_f32 v186, v143, v144, v186
    v_mfma_f32_32x32x16_bf16 v[104:119], v[84:87], v[100:103], v[104:119]
    ds_read_b128 v[68:71], v190 offset:1824
    v_max3_f32 v184, v145, v146, v184
    v_max3_f32 v186, v147, v148, v186
    v_max3_f32 v184, v149, v150, v184
    v_max3_f32 v184, v151, v184, v186
    v_fma_f32 v186, v184, s44, v185
    v_cmp_lt_f32 vcc, s45, v186
    v_mfma_f32_32x32x16_bf16 v[152:167], v[32:35], v[16:19], 0
    s_cbranch_vccnz L_a2_resc0
L_a2_back0:
    v_fma_f32 v120, v120, s44, v185
    v_fma_f32 v121, v121, s44, v185
    v_exp_f32 v120, v120
    v_exp_f32 v121, v121
    v_fma_f32 v122, v122, s44, v185
    v_fma_f32 v123, v123, s44, v185
    v_exp_f32 v122, v122
    v_exp_f32 v123, v123
    v_cvt_pk_bf16_f32 v88, v120, v121
    v_fma_f32 v124, v124, s44, v185
    v_mfma_f32_32x32x16_bf16 v[152:167], v[48:51], v[20:23], v[152:167]
    ds_read_b128 v[24:27], v188 offset:4096
    v_fma_f32 v125, v125, s44, v185
    v_exp_f32 v124, v124
    v_exp_f32 v125, v125
    v_cvt_pk_bf16_f32 v89, v122, v123
    v_fma_f32 v126, v126, s44, v185
    v_fma_f32 v127, v127, s44, v185
    v_exp_f32 v126, v126
    v_exp_f32 v127, v127
    v_cvt_pk_bf16_f32 v90, v124, v125
    v_fma_f32 v128, v128, s44, v185
    v_mfma_f32_32x32x16_bf16 v[168:183], v[36:39], v[16:19], 0
    ds_read_b32 v40, v189 offset:512
    v_fma_f32 v129, v129, s44, v185
    v_exp_f32 v128, v128
    v_exp_f32 v129, v129
    v_cvt_pk_bf16_f32 v91, v126, v127
    v_fma_f32 v130, v130, s44, v185
    v_fma_f32 v131, v131, s44, v185
    v_exp_f32 v130, v130
    v_exp_f32 v131, v131
    v_cvt_pk_bf16_f32 v92, v128, v129
    v_fma_f32 v132, v132, s44, v185
    v_mfma_f32_32x32x16_bf16 v[168:183], v[52:55], v[20:23], v[168:183]
    ds_read_b128 v[28:31], v188 offset:5120
    v_fma_f32 v133, v133, s44, v185
    v_exp_f32 v132, v132
    v_exp_f32 v133, v133
    v_cvt_pk_bf16_f32 v93, v130, v131
    v_fma_f32 v134, v134, s44, v185
    v_fma_f32 v135, v135, s44, v185
    v_exp_f32 v134, v134
    v_exp_f32 v135, v135
    v_cvt_pk_bf16_f32 v94, v132, v133
    v_fma_f32 v136, v136, s44, v185
    ds_read_b32 v44, v189 offset:640
    v_fma_f32 v137, v137, s44, v185
    v_exp_f32 v136, v136
    v_exp_f32 v137, v137
    v_cvt_pk_bf16_f32 v95, v134, v135
    v_fma_f32 v138, v138, s44, v185
    v_fma_f32 v139, v139, s44, v185
    v_exp_f32 v138, v138
    v_exp_f32 v139, v139
    v_cvt_pk_bf16_f32 v96, v136, v137
    v_fma_f32 v140, v140, s44, v185
    v_fma_f32 v141, v141, s44, v185
    v_exp_f32 v140, v140
    v_exp_f32 v141, v141
    v_cvt_pk_bf16_f32 v97, v138, v139
    v_fma_f32 v142, v142, s44, v185
    v_fma_f32 v143, v143, s44, v185
    v_exp_f32 v142, v142
    v_exp_f32 v143, v143
    v_cvt_pk_bf16_f32 v98, v140, v141
    v_fma_f32 v144, v144, s44, v185
    v_fma_f32 v145, v145, s44, v185
    v_exp_f32 v144, v144
    v_exp_f32 v145, v145
    v_cvt_pk_bf16_f32 v99, v142, v143
    v_fma_f32 v146, v146, s44, v185
    v_fma_f32 v147, v147, s44, v185
    v_exp_f32 v146, v146
    v_exp_f32 v147, v147
    v_cvt_pk_bf16_f32 v100, v144, v145
    v_fma_f32 v148, v148, s44, v185
    v_fma_f32 v149, v149, s44, v185
    v_exp_f32 v148, v148
    v_exp_f32 v149, v149
    v_cvt_pk_bf16_f32 v101, v146, v147
    v_fma_f32 v150, v150, s44, v185
    v_fma_f32 v151, v151, s44, v185
    v_exp_f32 v150, v150
    v_exp_f32 v151, v151
    v_cvt_pk_bf16_f32 v102, v148, v149
    v_cvt_pk_bf16_f32 v103, v150, v151
    s_waitcnt lgkmcnt(4)
    v_mfma_f32_32x32x16_bf16 v[104:119], v[56:59], v[88:91], v[104:119]
    ds_read_b128 v[72:75], v190 offset:2432
    v_max3_f32 v184, v152, v153, v154
    v_max_f32 v186, v155, v156
    v_max3_f32 v184, v157, v158, v184
    v_max3_f32 v186, v159, v160, v186
    v_mfma_f32_32x32x16_bf16 v[104:119], v[60:63], v[92:95], v[104:119]
    ds_read_b128 v[76:79], v190 offset:3040
    v_max3_f32 v184, v161, v162, v184
    v_max3_f32 v186, v163, v164, v186
    v_max3_f32 v184, v165, v166, v184
    v_max3_f32 v186, v167, v168, v186
    v_mfma_f32_32x32x16_bf16 v[104:119], v[64:67], v[96:99], v[104:119]
    ds_read_b128 v[80:83], v190 offset:3648
    v_max3_f32 v184, v169, v170, v184
    v_max3_f32 v186, v171, v172, v186
    v_max3_f32 v184, v173, v174, v184
    v_max3_f32 v186, v175, v176, v186
    v_mfma_f32_32x32x16_bf16 v[104:119], v[68:71], v[100:103], v[104:119]
    ds_read_b128 v[84:87], v190 offset:4256
    v_max3_f32 v184, v177, v178, v184
    v_max3_f32 v186, v179, v180, v186
    v_max3_f32 v184, v181, v182, v184
    v_max3_f32 v184, v183, v184, v186
    v_fma_f32 v186, v184, s44, v185
    v_cmp_lt_f32 vcc, s45, v186
    s_waitcnt lgkmcnt(4)
    v_mfma_f32_32x32x16_bf16 v[120:135], v[24:27], v[16:19], 0
    s_cbranch_vccnz L_a2_resc1
L_a2_back1:
    v_fma_f32 v152, v152, s44, v185
    v_fma_f32 v153, v153, s44, v185
    v_exp_f32 v152, v152
    v_exp_f32 v153, v153
    v_fma_f32 v154, v154, s44, v185
    v_fma_f32 v155, v155, s44, v185
    v_exp_f32 v154, v154
    v_exp_f32 v155, v155
    v_cvt_pk_bf16_f32 v88, v152, v153
    v_fma_f32 v156, v156, s44, v185
    v_mfma_f32_32x32x16_bf16 v[120:135], v[40:43], v[20:23], v[120:135]
    ds_read_b128 v[32:35], v188 offset:6144
    v_fma_f32 v157, v157, s44, v185
    v_exp_f32 v156, v156
    v_exp_f32 v157, v157
    v_cvt_pk_bf16_f32 v89, v154, v155
    v_fma_f32 v158, v158, s44, v185
    v_fma_f32 v159, v159, s44, v185
    v_exp_f32 v158, v158
    v_exp_f32 v159, v159
    v_cvt_pk_bf16_f32 v90, v156, v157
    v_fma_f32 v160, v160, s44, v185
    v_mfma_f32_32x32x16_bf16 v[136:151], v[28:31], v[16:19], 0
    ds_read_b32 v48, v189 offset:768
    v_fma_f32 v161, v161, s44, v185
    v_exp_f32 v160, v160
    v_exp_f32 v161, v161
    v_cvt_pk_bf16_f32 v91, v158, v159
    v_fma_f32 v162, v162, s44, v185
    v_fma_f32 v163, v163, s44, v185
    v_exp_f32 v162, v162
    v_exp_f32 v163, v163
    v_cvt_pk_bf16_f32 v92, v160, v161
    v_fma_f32 v164, v164, s44, v185
    v_mfma_f32_32x32x16_bf16 v[136:151], v[44:47], v[20:23], v[136:151]
    ds_read_b128 v[36:39], v188 offset:7168
    v_fma_f32 v165, v165, s44, v185
    v_exp_f32 v164, v164
    v_exp_f32 v165, v165
    v_cvt_pk_bf16_f32 v93, v162, v163
    v_fma_f32 v166, v166, s44, v185
    v_fma_f32 v167, v167, s44, v185
    v_exp_f32 v166, v166
    v_exp_f32 v167, v167
    v_cvt_pk_bf16_f32 v94, v164, v165
    v_fma_f32 v168, v168, s44, v185
    ds_read_b32 v52, v189 offset:896
    v_fma_f32 v169, v169, s44, v185
    v_exp_f32 v168, v168
    v_exp_f32 v169, v169
    v_cvt_pk_bf16_f32 v95, v166, v167
    v_fma_f32 v170, v170, s44, v185
    v_fma_f32 v171, v171, s44, v185
    v_exp_f32 v170, v170
    v_exp_f32 v171, v171
    v_cvt_pk_bf16_f32 v96, v168, v169
    v_fma_f32 v172, v172, s44, v185
    v_fma_f32 v173, v173, s44, v185
    v_exp_f32 v172, v172
    v_exp_f32 v173, v173
    v_cvt_pk_bf16_f32 v97, v170, v171
    v_fma_f32 v174, v174, s44, v185
    v_fma_f32 v175, v175, s44, v185
    v_exp_f32 v174, v174
    v_exp_f32 v175, v175
    v_cvt_pk_bf16_f32 v98, v172, v173
    v_fma_f32 v176, v176, s44, v185
    v_fma_f32 v177, v177, s44, v185
    v_exp_f32 v176, v176
    v_exp_f32 v177, v177
    v_cvt_pk_bf16_f32 v99, v174, v175
    v_fma_f32 v178, v178, s44, v185
    v_fma_f32 v179, v179, s44, v185
    v_exp_f32 v178, v178
    v_exp_f32 v179, v179
    v_cvt_pk_bf16_f32 v100, v176, v177
    v_fma_f32 v180, v180, s44, v185
    v_fma_f32 v181, v181, s44, v185
    v_exp_f32 v180, v180
    v_exp_f32 v181, v181
    v_cvt_pk_bf16_f32 v101, v178, v179
    v_fma_f32 v182, v182, s44, v185
    v_fma_f32 v183, v183, s44, v185
    v_exp_f32 v182, v182
    v_exp_f32 v183, v183
    v_cvt_pk_bf16_f32 v102, v180, v181
    v_cvt_pk_bf16_f32 v103, v182, v183
    v_add_u32 v188, 4096, v188
    v_add_u32 v189, 512, v189
    v_add_u32 v190, 4864, v190
    s_add_u32 s47, s47, 1
    s_cmp_lt_u32 s47, 16
    s_cbranch_scc1 L_a2_loop
    s_waitcnt lgkmcnt(0)
    v_mfma_f32_32x32x16_bf16 v[104:119], v[72:75], v[88:91], v[104:119]
    v_mfma_f32_32x32x16_bf16 v[104:119], v[76:79], v[92:95], v[104:119]
    v_mfma_f32_32x32x16_bf16 v[104:119], v[80:83], v[96:99], v[104:119]
    v_mfma_f32_32x32x16_bf16 v[104:119], v[84:87], v[100:103], v[104:119]
    s_nop 11
    v_rcp_f32 v186, v114
    v_and_b32 v8, 31, v1
    v_mul_u32_u24 v8, 1152, v8
    v_lshrrev_b32 v9, 5, v1
    v_lshl_add_u32 v8, v9, 3, v8
    s_mul_i32 s33, s46, 36864
    s_mul_i32 s34, s40, 36
    s_add_u32 s33, s33, s34
    s_add_u32 s33, s33, 0x7000000
    v_mul_f32 v104, v104, v186
    v_mul_f32 v105, v105, v186
    v_mul_f32 v106, v106, v186
    v_mul_f32 v107, v107, v186
    v_mul_f32 v108, v108, v186
    v_mul_f32 v109, v109, v186
    v_mul_f32 v110, v110, v186
    v_mul_f32 v111, v111, v186
    v_mul_f32 v112, v112, v186
    v_mul_f32 v113, v113, v186
    v_cvt_pk_bf16_f32 v88, v104, v105
    v_cvt_pk_bf16_f32 v89, v106, v107
    v_cvt_pk_bf16_f32 v90, v108, v109
    v_cvt_pk_bf16_f32 v91, v110, v111
    v_cvt_pk_bf16_f32 v92, v112, v113
    buffer_store_dwordx2 v[88:89], v8, s[8:11], s33 offen sc1
    buffer_store_dwordx2 v[90:91], v8, s[8:11], s33 offen offset:16 sc1
    s_mov_b64 exec, s[48:49]
    buffer_store_dword v92, v8, s[8:11], s33 offen offset:32 sc1
    s_mov_b64 exec, -1
    s_add_u32 s46, s46, 28
    s_nop 0
    s_branch L_a2_q
L_a2_resc0:
    s_nop 15
    v_mov_b32 v186, v184
    s_nop 1
    v_permlane32_swap_b32 v184, v186
    v_max_f32 v184, v184, v186
    v_mul_f32 v184, s44, v184
    v_max_f32 v184, v184, -v185
    v_add_f32 v187, v185, v184
    v_exp_f32 v187, -v187
    v_sub_f32 v185, 0, v184
    v_mul_f32 v104, v104, v187
    v_mul_f32 v105, v105, v187
    v_mul_f32 v106, v106, v187
    v_mul_f32 v107, v107, v187
    v_mul_f32 v108, v108, v187
    v_mul_f32 v109, v109, v187
    v_mul_f32 v110, v110, v187
    v_mul_f32 v111, v111, v187
    v_mul_f32 v112, v112, v187
    v_mul_f32 v113, v113, v187
    v_mul_f32 v114, v114, v187
    v_mul_f32 v115, v115, v187
    v_mul_f32 v116, v116, v187
    v_mul_f32 v117, v117, v187
    v_mul_f32 v118, v118, v187
    v_mul_f32 v119, v119, v187
    s_nop 1
    s_branch L_a2_back0
L_a2_resc1:
    s_nop 15
    v_mov_b32 v186, v184
    s_nop 1
    v_permlane32_swap_b32 v184, v186
    v_max_f32 v184, v184, v186
    v_mul_f32 v184, s44, v184
    v_max_f32 v184, v184, -v185
    v_add_f32 v187, v185, v184
    v_exp_f32 v187, -v187
    v_sub_f32 v185, 0, v184
    v_mul_f32 v104, v104, v187
    v_mul_f32 v105, v105, v187
    v_mul_f32 v106, v106, v187
    v_mul_f32 v107, v107, v187
    v_mul_f32 v108, v108, v187
    v_mul_f32 v109, v109, v187
    v_mul_f32 v110, v110, v187
    v_mul_f32 v111, v111, v187
    v_mul_f32 v112, v112, v187
    v_mul_f32 v113, v113, v187
    v_mul_f32 v114, v114, v187
    v_mul_f32 v115, v115, v187
    v_mul_f32 v116, v116, v187
    v_mul_f32 v117, v117, v187
    v_mul_f32 v118, v118, v187
    v_mul_f32 v119, v119, v187
    s_nop 1
    s_branch L_a2_back1
L_a2_done:
    s_waitcnt vmcnt(0)
    s_barrier
    s_cmp_lg_u32 s28, 0
    s_cbranch_scc1 L_sig_9
    v_mov_b32 v28, 0x184400
    v_mov_b32 v29, 1
    s_mov_b64 exec, 1
    buffer_atomic_add v29, v28, s[8:11], 0 offen
    s_mov_b64 exec, -1
L_sig_9:
    s_cmp_ge_u32 s41, 2
    s_cbranch_scc1 L_brole
    s_lshl_b32 s43, s40, 1
    s_add_u32 s43, s43, s41
    s_cmp_eq_u32 s43, 63
    s_cbranch_scc1 L_end
    s_mul_i32 s40, s43, 3121
    s_lshr_b32 s40, s40, 16
    s_mul_i32 s41, s40, 21
    s_sub_u32 s41, s43, s41
    s_add_u32 s33, s88, 0x7000000
    s_addc_u32 s34, s89, 0
    s_mov_b32 s24, s33
    s_and_b32 s25, s34, 0xffff
    s_mov_b32 s26, 0x240000
    s_mov_b32 s27, 0x20000
    s_mov_b32 s20, s68
    s_and_b32 s21, s69, 0xffff
    s_mov_b32 s22, 0xa2000
    s_mov_b32 s23, 0x20000
    s_lshl_b32 s33, s40, 2
    s_add_u32 s33, s33, s28
    s_mul_i32 s29, s33, 96
    s_mov_b32 s30, s41
    s_mov_b32 s31, 21
    s_mov_b32 s32, 64
    v_and_b32 v1, 63, v0
    v_lshrrev_b32 v2, 4, v1
    v_and_b32 v3, 15, v1
    s_barrier
    v_lshrrev_b32 v8, 3, v1
    v_and_b32 v9, 7, v1
    v_lshrrev_b32 v10, 1, v8
    v_xor_b32 v9, v9, v10
    v_xor_b32 v10, 4, v9
    v_mul_u32_u24 v8, 1152, v8
    v_lshl_add_u32 v4, v9, 4, v8
    v_lshl_add_u32 v5, v10, 4, v8
    v_lshrrev_b32 v8, 3, v3
    v_mul_u32_u24 v8, 9216, v8
    v_and_b32 v9, 7, v3
    v_lshl_add_u32 v8, v9, 7, v8
    v_lshrrev_b32 v9, 1, v3
    v_xor_b32 v9, v9, v2
    v_lshl_add_u32 v6, v9, 4, v8
    v_xor_b32 v7, 64, v6
    s_and_b32 s33, s28, 1
    s_cmp_eq_u32 s33, 1
    s_cselect_b64 vcc, -1, 0
    v_cndmask_b32 v16, v4, v5, vcc
    v_mov_b32 v18, v6
    v_mov_b32 v19, v7
    s_mov_b32 s37, 0
    v_lshrrev_b32 v4, 3, v1
    v_and_b32 v5, 7, v1
    v_and_b32 v6, 2, v4
    v_xor_b32 v5, v5, v6
    v_xor_b32 v6, 4, v5
    v_min_u32 v5, 5, v5
    v_min_u32 v6, 5, v6
    v_mul_u32_u24 v4, 1152, v4
    v_lshl_add_u32 v5, v5, 4, v4
    v_lshl_add_u32 v6, v6, 4, v4
    v_lshrrev_b32 v7, 2, v3
    v_and_b32 v8, 3, v3
    v_lshlrev_b32 v9, 10, v2
    v_lshl_add_u32 v9, v7, 7, v9
    v_lshl_add_u32 v9, v8, 3, v9
    v_lshrrev_b32 v7, 1, v7
    v_and_b32 v8, 1, v2
    v_lshl_add_u32 v7, v8, 1, v7
    v_lshlrev_b32 v7, 5, v7
    s_mul_i32 s33, s28, 20480
    s_add_u32 s33, s33, 73728
    v_add_u32 v9, s33, v9
    v_xor_b32 v10, 0, v7
    v_add_u32 v10, v10, v9
    v_xor_b32 v11, 32, v7
    v_add_u32 v11, v11, v9
    v_xor_b32 v12, 64, v7
    v_add_u32 v12, v12, v9
    s_add_u32 m0, s33, 0
    s_add_u32 s34, s29, 0
    buffer_load_dwordx4 v5, s[20:23], s34 offen lds
    s_add_u32 m0, s33, 1024
    s_add_u32 s34, s29, 9216
    buffer_load_dwordx4 v6, s[20:23], s34 offen lds
    s_add_u32 m0, s33, 2048
    s_add_u32 s34, s29, 18432
    buffer_load_dwordx4 v5, s[20:23], s34 offen lds
    s_add_u32 m0, s33, 3072
    s_add_u32 s34, s29, 27648
    buffer_load_dwordx4 v6, s[20:23], s34 offen lds
    s_add_u32 m0, s33, 4096
    s_add_u32 s34, s29, 36864
    buffer_load_dwordx4 v5, s[20:23], s34 offen lds
    s_add_u32 m0, s33, 5120
    s_add_u32 s34, s29, 46080
    buffer_load_dwordx4 v6, s[20:23], s34 offen lds
    s_add_u32 m0, s33, 6144
    s_add_u32 s34, s29, 55296
    buffer_load_dwordx4 v5, s[20:23], s34 offen lds
    s_add_u32 m0, s33, 7168
    s_add_u32 s34, s29, 64512
    buffer_load_dwordx4 v6, s[20:23], s34 offen lds
    s_add_u32 m0, s33, 8192
    s_add_u32 s34, s29, 73728
    buffer_load_dwordx4 v5, s[20:23], s34 offen lds
    s_add_u32 m0, s33, 9216
    s_add_u32 s34, s29, 82944
    buffer_load_dwordx4 v6, s[20:23], s34 offen lds
    s_add_u32 m0, s33, 10240
    s_add_u32 s34, s29, 92160
    buffer_load_dwordx4 v5, s[20:23], s34 offen lds
    s_add_u32 m0, s33, 11264
    s_add_u32 s34, s29, 101376
    buffer_load_dwordx4 v6, s[20:23], s34 offen lds
    s_add_u32 m0, s33, 12288
    s_add_u32 s34, s29, 110592
    buffer_load_dwordx4 v5, s[20:23], s34 offen lds
    s_add_u32 m0, s33, 13312
    s_add_u32 s34, s29, 119808
    buffer_load_dwordx4 v6, s[20:23], s34 offen lds
    s_add_u32 m0, s33, 14336
    s_add_u32 s34, s29, 129024
    buffer_load_dwordx4 v5, s[20:23], s34 offen lds
    s_add_u32 m0, s33, 15360
    s_add_u32 s34, s29, 138240
    buffer_load_dwordx4 v6, s[20:23], s34 offen lds
    s_add_u32 m0, s33, 16384
    s_add_u32 s34, s29, 147456
    buffer_load_dwordx4 v5, s[20:23], s34 offen lds
    s_add_u32 m0, s33, 17408
    s_add_u32 s34, s29, 156672
    buffer_load_dwordx4 v6, s[20:23], s34 offen lds
    s_add_u32 m0, s33, 18432
    s_add_u32 s34, s29, 165888
    buffer_load_dwordx4 v5, s[20:23], s34 offen lds
    s_add_u32 m0, s33, 19456
    s_add_u32 s34, s29, 175104
    buffer_load_dwordx4 v6, s[20:23], s34 offen lds
    s_waitcnt vmcnt(16)
    ds_read_b64_tr_b16 v[224:225], v10 offset:0
    ds_read_b64_tr_b16 v[226:227], v10 offset:512
    ds_read_b64_tr_b16 v[228:229], v11 offset:0
    ds_read_b64_tr_b16 v[230:231], v11 offset:512
    ds_read_b64_tr_b16 v[232:233], v12 offset:0
    ds_read_b64_tr_b16 v[234:235], v12 offset:512
    s_waitcnt lgkmcnt(0)
    s_add_u32 m0, s33, 0
    s_add_u32 s34, s29, 184320
    buffer_load_dwordx4 v5, s[20:23], s34 offen lds
    s_add_u32 m0, s33, 1024
    s_add_u32 s34, s29, 193536
    buffer_load_dwordx4 v6, s[20:23], s34 offen lds
    s_add_u32 m0, s33, 2048
    s_add_u32 s34, s29, 202752
    buffer_load_dwordx4 v5, s[20:23], s34 offen lds
    s_add_u32 m0, s33, 3072
    s_add_u32 s34, s29, 211968
    buffer_load_dwordx4 v6, s[20:23], s34 offen lds
    s_waitcnt vmcnt(16)
    ds_read_b64_tr_b16 v[236:237], v10 offset:4096
    ds_read_b64_tr_b16 v[238:239], v10 offset:4608
    ds_read_b64_tr_b16 v[240:241], v11 offset:4096
    ds_read_b64_tr_b16 v[242:243], v11 offset:4608
    ds_read_b64_tr_b16 v[244:245], v12 offset:4096
    ds_read_b64_tr_b16 v[246:247], v12 offset:4608
    s_waitcnt lgkmcnt(0)
    s_add_u32 m0, s33, 4096
    s_add_u32 s34, s29, 221184
    buffer_load_dwordx4 v5, s[20:23], s34 offen lds
    s_add_u32 m0, s33, 5120
    s_add_u32 s34, s29, 230400
    buffer_load_dwordx4 v6, s[20:23], s34 offen lds
    s_add_u32 m0, s33, 6144
    s_add_u32 s34, s29, 239616
    buffer_load_dwordx4 v5, s[20:23], s34 offen lds
    s_add_u32 m0, s33, 7168
    s_add_u32 s34, s29, 248832
    buffer_load_dwordx4 v6, s[20:23], s34 offen lds
    s_waitcnt vmcnt(16)
    ds_read_b64_tr_b16 v[248:249], v10 offset:8192
    ds_read_b64_tr_b16 v[250:251], v10 offset:8704
    ds_read_b64_tr_b16 v[252:253], v11 offset:8192
    ds_read_b64_tr_b16 v[254:255], v11 offset:8704
    ds_read_b64_tr_b16 a[0:1], v12 offset:8192
    ds_read_b64_tr_b16 a[2:3], v12 offset:8704
    s_waitcnt lgkmcnt(0)
    s_add_u32 m0, s33, 8192
    s_add_u32 s34, s29, 258048
    buffer_load_dwordx4 v5, s[20:23], s34 offen lds
    s_add_u32 m0, s33, 9216
    s_add_u32 s34, s29, 267264
    buffer_load_dwordx4 v6, s[20:23], s34 offen lds
    s_add_u32 m0, s33, 10240
    s_add_u32 s34, s29, 276480
    buffer_load_dwordx4 v5, s[20:23], s34 offen lds
    s_add_u32 m0, s33, 11264
    s_add_u32 s34, s29, 285696
    buffer_load_dwordx4 v6, s[20:23], s34 offen lds
    s_waitcnt vmcnt(16)
    ds_read_b64_tr_b16 a[4:5], v10 offset:12288
    ds_read_b64_tr_b16 a[6:7], v10 offset:12800
    ds_read_b64_tr_b16 a[8:9], v11 offset:12288
    ds_read_b64_tr_b16 a[10:11], v11 offset:12800
    ds_read_b64_tr_b16 a[12:13], v12 offset:12288
    ds_read_b64_tr_b16 a[14:15], v12 offset:12800
    s_waitcnt lgkmcnt(0)
    s_add_u32 m0, s33, 12288
    s_add_u32 s34, s29, 294912
    buffer_load_dwordx4 v5, s[20:23], s34 offen lds
    s_add_u32 m0, s33, 13312
    s_add_u32 s34, s29, 304128
    buffer_load_dwordx4 v6, s[20:23], s34 offen lds
    s_add_u32 m0, s33, 14336
    s_add_u32 s34, s29, 313344
    buffer_load_dwordx4 v5, s[20:23], s34 offen lds
    s_add_u32 m0, s33, 15360
    s_add_u32 s34, s29, 322560
    buffer_load_dwordx4 v6, s[20:23], s34 offen lds
    s_waitcnt vmcnt(16)
    ds_read_b64_tr_b16 a[16:17], v10 offset:16384
    ds_read_b64_tr_b16 a[18:19], v10 offset:16896
    ds_read_b64_tr_b16 a[20:21], v11 offset:16384
    ds_read_b64_tr_b16 a[22:23], v11 offset:16896
    ds_read_b64_tr_b16 a[24:25], v12 offset:16384
    ds_read_b64_tr_b16 a[26:27], v12 offset:16896
    s_waitcnt lgkmcnt(0)
    s_add_u32 m0, s33, 16384
    s_add_u32 s34, s29, 331776
    buffer_load_dwordx4 v5, s[20:23], s34 offen lds
    s_add_u32 m0, s33, 17408
    s_add_u32 s34, s29, 340992
    buffer_load_dwordx4 v6, s[20:23], s34 offen lds
    s_add_u32 m0, s33, 18432
    s_add_u32 s34, s29, 350208
    buffer_load_dwordx4 v5, s[20:23], s34 offen lds
    s_add_u32 m0, s33, 19456
    s_add_u32 s34, s29, 359424
    buffer_load_dwordx4 v6, s[20:23], s34 offen lds
    s_waitcnt vmcnt(16)
    ds_read_b64_tr_b16 a[28:29], v10 offset:0
    ds_read_b64_tr_b16 a[30:31], v10 offset:512
    ds_read_b64_tr_b16 a[32:33], v11 offset:0
    ds_read_b64_tr_b16 a[34:35], v11 offset:512
    ds_read_b64_tr_b16 a[36:37], v12 offset:0
    ds_read_b64_tr_b16 a[38:39], v12 offset:512
    s_waitcnt lgkmcnt(0)
    s_add_u32 m0, s33, 0
    s_add_u32 s34, s29, 368640
    buffer_load_dwordx4 v5, s[20:23], s34 offen lds
    s_add_u32 m0, s33, 1024
    s_add_u32 s34, s29, 377856
    buffer_load_dwordx4 v6, s[20:23], s34 offen lds
    s_add_u32 m0, s33, 2048
    s_add_u32 s34, s29, 387072
    buffer_load_dwordx4 v5, s[20:23], s34 offen lds
    s_add_u32 m0, s33, 3072
    s_add_u32 s34, s29, 396288
    buffer_load_dwordx4 v6, s[20:23], s34 offen lds
    s_waitcnt vmcnt(16)
    ds_read_b64_tr_b16 a[40:41], v10 offset:4096
    ds_read_b64_tr_b16 a[42:43], v10 offset:4608
    ds_read_b64_tr_b16 a[44:45], v11 offset:4096
    ds_read_b64_tr_b16 a[46:47], v11 offset:4608
    ds_read_b64_tr_b16 a[48:49], v12 offset:4096
    ds_read_b64_tr_b16 a[50:51], v12 offset:4608
    s_waitcnt lgkmcnt(0)
    s_add_u32 m0, s33, 4096
    s_add_u32 s34, s29, 405504
    buffer_load_dwordx4 v5, s[20:23], s34 offen lds
    s_add_u32 m0, s33, 5120
    s_add_u32 s34, s29, 414720
    buffer_load_dwordx4 v6, s[20:23], s34 offen lds
    s_add_u32 m0, s33, 6144
    s_add_u32 s34, s29, 423936
    buffer_load_dwordx4 v5, s[20:23], s34 offen lds
    s_add_u32 m0, s33, 7168
    s_add_u32 s34, s29, 433152
    buffer_load_dwordx4 v6, s[20:23], s34 offen lds
    s_waitcnt vmcnt(16)
    ds_read_b64_tr_b16 a[52:53], v10 offset:8192
    ds_read_b64_tr_b16 a[54:55], v10 offset:8704
    ds_read_b64_tr_b16 a[56:57], v11 offset:8192
    ds_read_b64_tr_b16 a[58:59], v11 offset:8704
    ds_read_b64_tr_b16 a[60:61], v12 offset:8192
    ds_read_b64_tr_b16 a[62:63], v12 offset:8704
    s_waitcnt lgkmcnt(0)
    s_add_u32 m0, s33, 8192
    s_add_u32 s34, s29, 442368
    buffer_load_dwordx4 v5, s[20:23], s34 offen lds
    s_add_u32 m0, s33, 9216
    s_add_u32 s34, s29, 451584
    buffer_load_dwordx4 v6, s[20:23], s34 offen lds
    s_add_u32 m0, s33, 10240
    s_add_u32 s34, s29, 460800
    buffer_load_dwordx4 v5, s[20:23], s34 offen lds
    s_add_u32 m0, s33, 11264
    s_add_u32 s34, s29, 470016
    buffer_load_dwordx4 v6, s[20:23], s34 offen lds
    s_waitcnt vmcnt(16)
    ds_read_b64_tr_b16 a[64:65], v10 offset:12288
    ds_read_b64_tr_b16 a[66:67], v10 offset:12800
    ds_read_b64_tr_b16 a[68:69], v11 offset:12288
    ds_read_b64_tr_b16 a[70:71], v11 offset:12800
    ds_read_b64_tr_b16 a[72:73], v12 offset:12288
    ds_read_b64_tr_b16 a[74:75], v12 offset:12800
    s_waitcnt lgkmcnt(0)
    s_add_u32 m0, s33, 12288
    s_add_u32 s34, s29, 479232
    buffer_load_dwordx4 v5, s[20:23], s34 offen lds
    s_add_u32 m0, s33, 13312
    s_add_u32 s34, s29, 488448
    buffer_load_dwordx4 v6, s[20:23], s34 offen lds
    s_add_u32 m0, s33, 14336
    s_add_u32 s34, s29, 497664
    buffer_load_dwordx4 v5, s[20:23], s34 offen lds
    s_add_u32 m0, s33, 15360
    s_add_u32 s34, s29, 506880
    buffer_load_dwordx4 v6, s[20:23], s34 offen lds
    s_waitcnt vmcnt(16)
    ds_read_b64_tr_b16 a[76:77], v10 offset:16384
    ds_read_b64_tr_b16 a[78:79], v10 offset:16896
    ds_read_b64_tr_b16 a[80:81], v11 offset:16384
    ds_read_b64_tr_b16 a[82:83], v11 offset:16896
    ds_read_b64_tr_b16 a[84:85], v12 offset:16384
    ds_read_b64_tr_b16 a[86:87], v12 offset:16896
    s_waitcnt lgkmcnt(0)
    s_add_u32 m0, s33, 16384
    s_add_u32 s34, s29, 516096
    buffer_load_dwordx4 v5, s[20:23], s34 offen lds
    s_add_u32 m0, s33, 17408
    s_add_u32 s34, s29, 525312
    buffer_load_dwordx4 v6, s[20:23], s34 offen lds
    s_add_u32 m0, s33, 18432
    s_add_u32 s34, s29, 534528
    buffer_load_dwordx4 v5, s[20:23], s34 offen lds
    s_add_u32 m0, s33, 19456
    s_add_u32 s34, s29, 543744
    buffer_load_dwordx4 v6, s[20:23], s34 offen lds
    s_waitcnt vmcnt(16)
    ds_read_b64_tr_b16 a[88:89], v10 offset:0
    ds_read_b64_tr_b16 a[90:91], v10 offset:512
    ds_read_b64_tr_b16 a[92:93], v11 offset:0
    ds_read_b64_tr_b16 a[94:95], v11 offset:512
    ds_read_b64_tr_b16 a[96:97], v12 offset:0
    ds_read_b64_tr_b16 a[98:99], v12 offset:512
    s_waitcnt lgkmcnt(0)
    s_add_u32 m0, s33, 0
    s_add_u32 s34, s29, 552960
    buffer_load_dwordx4 v5, s[20:23], s34 offen lds
    s_add_u32 m0, s33, 1024
    s_add_u32 s34, s29, 562176
    buffer_load_dwordx4 v6, s[20:23], s34 offen lds
    s_add_u32 m0, s33, 2048
    s_add_u32 s34, s29, 571392
    buffer_load_dwordx4 v5, s[20:23], s34 offen lds
    s_add_u32 m0, s33, 3072
    s_add_u32 s34, s29, 580608
    buffer_load_dwordx4 v6, s[20:23], s34 offen lds
    s_waitcnt vmcnt(16)
    ds_read_b64_tr_b16 a[100:101], v10 offset:4096
    ds_read_b64_tr_b16 a[102:103], v10 offset:4608
    ds_read_b64_tr_b16 a[104:105], v11 offset:4096
    ds_read_b64_tr_b16 a[106:107], v11 offset:4608
    ds_read_b64_tr_b16 a[108:109], v12 offset:4096
    ds_read_b64_tr_b16 a[110:111], v12 offset:4608
    s_waitcnt lgkmcnt(0)
    s_add_u32 m0, s33, 4096
    s_add_u32 s34, s29, 589824
    buffer_load_dwordx4 v5, s[20:23], s34 offen lds
    s_add_u32 m0, s33, 5120
    s_add_u32 s34, s29, 599040
    buffer_load_dwordx4 v6, s[20:23], s34 offen lds
    s_add_u32 m0, s33, 6144
    s_add_u32 s34, s29, 608256
    buffer_load_dwordx4 v5, s[20:23], s34 offen lds
    s_add_u32 m0, s33, 7168
    s_add_u32 s34, s29, 617472
    buffer_load_dwordx4 v6, s[20:23], s34 offen lds
    s_waitcnt vmcnt(16)
    ds_read_b64_tr_b16 a[112:113], v10 offset:8192
    ds_read_b64_tr_b16 a[114:115], v10 offset:8704
    ds_read_b64_tr_b16 a[116:117], v11 offset:8192
    ds_read_b64_tr_b16 a[118:119], v11 offset:8704
    ds_read_b64_tr_b16 a[120:121], v12 offset:8192
    ds_read_b64_tr_b16 a[122:123], v12 offset:8704
    s_waitcnt lgkmcnt(0)
    s_add_u32 m0, s33, 8192
    s_add_u32 s34, s29, 626688
    buffer_load_dwordx4 v5, s[20:23], s34 offen lds
    s_add_u32 m0, s33, 9216
    s_add_u32 s34, s29, 635904
    buffer_load_dwordx4 v6, s[20:23], s34 offen lds
    s_add_u32 m0, s33, 10240
    s_add_u32 s34, s29, 645120
    buffer_load_dwordx4 v5, s[20:23], s34 offen lds
    s_add_u32 m0, s33, 11264
    s_add_u32 s34, s29, 654336
    buffer_load_dwordx4 v6, s[20:23], s34 offen lds
    s_waitcnt vmcnt(16)
    ds_read_b64_tr_b16 a[124:125], v10 offset:12288
    ds_read_b64_tr_b16 a[126:127], v10 offset:12800
    ds_read_b64_tr_b16 a[128:129], v11 offset:12288
    ds_read_b64_tr_b16 a[130:131], v11 offset:12800
    ds_read_b64_tr_b16 a[132:133], v12 offset:12288
    ds_read_b64_tr_b16 a[134:135], v12 offset:12800
    s_waitcnt lgkmcnt(0)
    s_waitcnt vmcnt(12)
    ds_read_b64_tr_b16 a[136:137], v10 offset:16384
    ds_read_b64_tr_b16 a[138:139], v10 offset:16896
    ds_read_b64_tr_b16 a[140:141], v11 offset:16384
    ds_read_b64_tr_b16 a[142:143], v11 offset:16896
    ds_read_b64_tr_b16 a[144:145], v12 offset:16384
    ds_read_b64_tr_b16 a[146:147], v12 offset:16896
    s_waitcnt lgkmcnt(0)
    s_waitcnt vmcnt(8)
    ds_read_b64_tr_b16 a[148:149], v10 offset:0
    ds_read_b64_tr_b16 a[150:151], v10 offset:512
    ds_read_b64_tr_b16 a[152:153], v11 offset:0
    ds_read_b64_tr_b16 a[154:155], v11 offset:512
    ds_read_b64_tr_b16 a[156:157], v12 offset:0
    ds_read_b64_tr_b16 a[158:159], v12 offset:512
    s_waitcnt lgkmcnt(0)
    s_waitcnt vmcnt(4)
    ds_read_b64_tr_b16 a[160:161], v10 offset:4096
    ds_read_b64_tr_b16 a[162:163], v10 offset:4608
    ds_read_b64_tr_b16 a[164:165], v11 offset:4096
    ds_read_b64_tr_b16 a[166:167], v11 offset:4608
    ds_read_b64_tr_b16 a[168:169], v12 offset:4096
    ds_read_b64_tr_b16 a[170:171], v12 offset:4608
    s_waitcnt lgkmcnt(0)
    s_waitcnt vmcnt(0)
    ds_read_b64_tr_b16 a[172:173], v10 offset:8192
    ds_read_b64_tr_b16 a[174:175], v10 offset:8704
    ds_read_b64_tr_b16 a[176:177], v11 offset:8192
    ds_read_b64_tr_b16 a[178:179], v11 offset:8704
    ds_read_b64_tr_b16 a[180:181], v12 offset:8192
    ds_read_b64_tr_b16 a[182:183], v12 offset:8704
    s_waitcnt lgkmcnt(0)
    s_mov_b32 s39, 0
    v_mov_b32 v28, 0x184400
L_poll_10:
    buffer_load_dword v29, v28, s[8:11], 0 offen sc1
    s_add_u32 s39, s39, 1
    s_cmp_gt_u32 s39, 4000000
    s_cbranch_scc1 L_fail
    s_waitcnt vmcnt(0)
    v_readfirstlane_b32 s33, v29
    s_nop 0
    s_cmp_ge_u32 s33, 224
    s_cbranch_scc1 L_poll_10_d
    s_sleep 2
    s_branch L_poll_10
L_poll_10_d:
    s_lshl_b32 s35, s30, 2
    s_add_u32 s35, s35, s28
    s_mul_i32 s35, s35, 9216
    s_mul_i32 s36, s28, 9216
    s_add_u32 s36, s36, 0
    s_add_u32 m0, s36, 0
    s_nop 0
    buffer_load_dwordx4 v16, s[24:27], s35 offen offset:0 sc1 lds
    s_add_u32 m0, s36, 896
    s_nop 0
    buffer_load_dwordx4 v16, s[24:27], s35 offen offset:128 sc1 lds
    s_add_u32 m0, s36, 1792
    s_nop 0
    buffer_load_dwordx4 v16, s[24:27], s35 offen offset:256 sc1 lds
    s_add_u32 m0, s36, 2688
    s_nop 0
    buffer_load_dwordx4 v16, s[24:27], s35 offen offset:384 sc1 lds
    s_add_u32 m0, s36, 3584
    s_nop 0
    buffer_load_dwordx4 v16, s[24:27], s35 offen offset:512 sc1 lds
    s_add_u32 m0, s36, 4480
    s_nop 0
    buffer_load_dwordx4 v16, s[24:27], s35 offen offset:640 sc1 lds
    s_add_u32 m0, s36, 5376
    s_nop 0
    buffer_load_dwordx4 v16, s[24:27], s35 offen offset:768 sc1 lds
    s_add_u32 m0, s36, 6272
    s_nop 0
    buffer_load_dwordx4 v16, s[24:27], s35 offen offset:896 sc1 lds
    s_add_u32 m0, s36, 7168
    s_nop 0
    buffer_load_dwordx4 v16, s[24:27], s35 offen offset:1024 sc1 lds
    v_mov_b32 v4, v16
    v_mov_b32 v6, v18
    v_mov_b32 v7, v19
    s_waitcnt vmcnt(0)
    s_nop 0
L_pg_a3_1:
L_pgl_a3_1:
    s_waitcnt vmcnt(6)
    s_barrier
    v_add_u32 v8, s37, v6
    v_add_u32 v9, s37, v7
    s_add_u32 s34, s30, s31
    s_min_u32 s34, s34, 63
    s_xor_b32 s37, s37, 36864
    s_lshl_b32 s35, s34, 2
    s_add_u32 s35, s35, s28
    s_mul_i32 s35, s35, 9216
    s_mul_i32 s36, s28, 9216
    s_add_u32 s36, s36, s37
    ds_read_b128 v[32:35], v8 offset:0
    ds_read_b128 v[36:39], v8 offset:18432
    ds_read_b128 v[40:43], v9 offset:0
    ds_read_b128 v[44:47], v9 offset:18432
    ds_read_b128 v[48:51], v8 offset:1024
    ds_read_b128 v[52:55], v8 offset:19456
    ds_read_b128 v[56:59], v9 offset:1024
    s_waitcnt lgkmcnt(6)
    v_mfma_f32_16x16x32_bf16 v[64:67], v[224:227], v[32:35], 0
    ds_read_b128 v[60:63], v9 offset:19456
    v_mfma_f32_16x16x32_bf16 v[68:71], v[228:231], v[32:35], 0
    s_add_u32 m0, s36, 0
    s_nop 0
    buffer_load_dwordx4 v4, s[24:27], s35 offen offset:0 sc1 lds
    v_mfma_f32_16x16x32_bf16 v[72:75], v[232:235], v[32:35], 0
    s_waitcnt lgkmcnt(6)
    v_mfma_f32_16x16x32_bf16 v[76:79], v[224:227], v[36:39], 0
    ds_read_b128 v[32:35], v8 offset:2048
    v_mfma_f32_16x16x32_bf16 v[80:83], v[228:231], v[36:39], 0
    v_mfma_f32_16x16x32_bf16 v[84:87], v[232:235], v[36:39], 0
    s_waitcnt lgkmcnt(6)
    v_mfma_f32_16x16x32_bf16 v[64:67], v[236:239], v[40:43], v[64:67]
    ds_read_b128 v[36:39], v8 offset:20480
    v_mfma_f32_16x16x32_bf16 v[68:71], v[240:243], v[40:43], v[68:71]
    s_add_u32 m0, s36, 896
    s_nop 0
    buffer_load_dwordx4 v4, s[24:27], s35 offen offset:128 sc1 lds
    v_mfma_f32_16x16x32_bf16 v[72:75], v[244:247], v[40:43], v[72:75]
    s_waitcnt lgkmcnt(6)
    v_mfma_f32_16x16x32_bf16 v[76:79], v[236:239], v[44:47], v[76:79]
    ds_read_b128 v[40:43], v9 offset:2048
    v_mfma_f32_16x16x32_bf16 v[80:83], v[240:243], v[44:47], v[80:83]
    v_mfma_f32_16x16x32_bf16 v[84:87], v[244:247], v[44:47], v[84:87]
    s_waitcnt lgkmcnt(6)
    v_mfma_f32_16x16x32_bf16 v[64:67], v[248:251], v[48:51], v[64:67]
    ds_read_b128 v[44:47], v9 offset:20480
    v_mfma_f32_16x16x32_bf16 v[68:71], v[252:255], v[48:51], v[68:71]
    s_add_u32 m0, s36, 1792
    s_nop 0
    buffer_load_dwordx4 v4, s[24:27], s35 offen offset:256 sc1 lds
    v_mfma_f32_16x16x32_bf16 v[72:75], a[0:3], v[48:51], v[72:75]
    s_waitcnt lgkmcnt(6)
    v_mfma_f32_16x16x32_bf16 v[76:79], v[248:251], v[52:55], v[76:79]
    ds_read_b128 v[48:51], v8 offset:3072
    v_mfma_f32_16x16x32_bf16 v[80:83], v[252:255], v[52:55], v[80:83]
    v_mfma_f32_16x16x32_bf16 v[84:87], a[0:3], v[52:55], v[84:87]
    s_waitcnt lgkmcnt(6)
    v_mfma_f32_16x16x32_bf16 v[64:67], a[4:7], v[56:59], v[64:67]
    ds_read_b128 v[52:55], v8 offset:21504
    v_mfma_f32_16x16x32_bf16 v[68:71], a[8:11], v[56:59], v[68:71]
    s_add_u32 m0, s36, 2688
    s_nop 0
    buffer_load_dwordx4 v4, s[24:27], s35 offen offset:384 sc1 lds
    v_mfma_f32_16x16x32_bf16 v[72:75], a[12:15], v[56:59], v[72:75]
    s_waitcnt lgkmcnt(6)
    v_mfma_f32_16x16x32_bf16 v[76:79], a[4:7], v[60:63], v[76:79]
    ds_read_b128 v[56:59], v9 offset:3072
    v_mfma_f32_16x16x32_bf16 v[80:83], a[8:11], v[60:63], v[80:83]
    v_mfma_f32_16x16x32_bf16 v[84:87], a[12:15], v[60:63], v[84:87]
    s_waitcnt lgkmcnt(6)
    v_mfma_f32_16x16x32_bf16 v[64:67], a[16:19], v[32:35], v[64:67]
    ds_read_b128 v[60:63], v9 offset:21504
    v_mfma_f32_16x16x32_bf16 v[68:71], a[20:23], v[32:35], v[68:71]
    s_add_u32 m0, s36, 3584
    s_nop 0
    buffer_load_dwordx4 v4, s[24:27], s35 offen offset:512 sc1 lds
    v_mfma_f32_16x16x32_bf16 v[72:75], a[24:27], v[32:35], v[72:75]
    s_waitcnt lgkmcnt(6)
    v_mfma_f32_16x16x32_bf16 v[76:79], a[16:19], v[36:39], v[76:79]
    ds_read_b128 v[32:35], v8 offset:4096
    v_mfma_f32_16x16x32_bf16 v[80:83], a[20:23], v[36:39], v[80:83]
    v_mfma_f32_16x16x32_bf16 v[84:87], a[24:27], v[36:39], v[84:87]
    s_waitcnt lgkmcnt(6)
    v_mfma_f32_16x16x32_bf16 v[64:67], a[28:31], v[40:43], v[64:67]
    ds_read_b128 v[36:39], v8 offset:22528
    v_mfma_f32_16x16x32_bf16 v[68:71], a[32:35], v[40:43], v[68:71]
    s_add_u32 m0, s36, 4480
    s_nop 0
    buffer_load_dwordx4 v4, s[24:27], s35 offen offset:640 sc1 lds
    v_mfma_f32_16x16x32_bf16 v[72:75], a[36:39], v[40:43], v[72:75]
    s_waitcnt lgkmcnt(6)
    v_mfma_f32_16x16x32_bf16 v[76:79], a[28:31], v[44:47], v[76:79]
    ds_read_b128 v[40:43], v9 offset:4096
    v_mfma_f32_16x16x32_bf16 v[80:83], a[32:35], v[44:47], v[80:83]
    v_mfma_f32_16x16x32_bf16 v[84:87], a[36:39], v[44:47], v[84:87]
    s_waitcnt lgkmcnt(6)
    v_mfma_f32_16x16x32_bf16 v[64:67], a[40:43], v[48:51], v[64:67]
    ds_read_b128 v[44:47], v9 offset:22528
    v_mfma_f32_16x16x32_bf16 v[68:71], a[44:47], v[48:51], v[68:71]
    s_add_u32 m0, s36, 5376
    s_nop 0
    buffer_load_dwordx4 v4, s[24:27], s35 offen offset:768 sc1 lds
    v_mfma_f32_16x16x32_bf16 v[72:75], a[48:51], v[48:51], v[72:75]
    s_waitcnt lgkmcnt(6)
    v_mfma_f32_16x16x32_bf16 v[76:79], a[40:43], v[52:55], v[76:79]
    ds_read_b128 v[48:51], v8 offset:5120
    v_mfma_f32_16x16x32_bf16 v[80:83], a[44:47], v[52:55], v[80:83]
    v_mfma_f32_16x16x32_bf16 v[84:87], a[48:51], v[52:55], v[84:87]
    s_waitcnt lgkmcnt(6)
    v_mfma_f32_16x16x32_bf16 v[64:67], a[52:55], v[56:59], v[64:67]
    ds_read_b128 v[52:55], v8 offset:23552
    v_mfma_f32_16x16x32_bf16 v[68:71], a[56:59], v[56:59], v[68:71]
    s_add_u32 m0, s36, 6272
    s_nop 0
    buffer_load_dwordx4 v4, s[24:27], s35 offen offset:896 sc1 lds
    v_mfma_f32_16x16x32_bf16 v[72:75], a[60:63], v[56:59], v[72:75]
    s_waitcnt lgkmcnt(6)
    v_mfma_f32_16x16x32_bf16 v[76:79], a[52:55], v[60:63], v[76:79]
    ds_read_b128 v[56:59], v9 offset:5120
    v_mfma_f32_16x16x32_bf16 v[80:83], a[56:59], v[60:63], v[80:83]
    v_mfma_f32_16x16x32_bf16 v[84:87], a[60:63], v[60:63], v[84:87]
    s_waitcnt lgkmcnt(6)
    v_mfma_f32_16x16x32_bf16 v[64:67], a[64:67], v[32:35], v[64:67]
    ds_read_b128 v[60:63], v9 offset:23552
    v_mfma_f32_16x16x32_bf16 v[68:71], a[68:71], v[32:35], v[68:71]
    s_add_u32 m0, s36, 7168
    s_nop 0
    buffer_load_dwordx4 v4, s[24:27], s35 offen offset:1024 sc1 lds
    v_mfma_f32_16x16x32_bf16 v[72:75], a[72:75], v[32:35], v[72:75]
    s_waitcnt lgkmcnt(6)
    v_mfma_f32_16x16x32_bf16 v[76:79], a[64:67], v[36:39], v[76:79]
    ds_read_b128 v[32:35], v8 offset:6144
    v_mfma_f32_16x16x32_bf16 v[80:83], a[68:71], v[36:39], v[80:83]
    v_mfma_f32_16x16x32_bf16 v[84:87], a[72:75], v[36:39], v[84:87]
    s_waitcnt lgkmcnt(6)
    v_mfma_f32_16x16x32_bf16 v[64:67], a[76:79], v[40:43], v[64:67]
    ds_read_b128 v[36:39], v8 offset:24576
    v_mfma_f32_16x16x32_bf16 v[68:71], a[80:83], v[40:43], v[68:71]
    v_mfma_f32_16x16x32_bf16 v[72:75], a[84:87], v[40:43], v[72:75]
    s_waitcnt lgkmcnt(6)
    v_mfma_f32_16x16x32_bf16 v[76:79], a[76:79], v[44:47], v[76:79]
    ds_read_b128 v[40:43], v9 offset:6144
    v_mfma_f32_16x16x32_bf16 v[80:83], a[80:83], v[44:47], v[80:83]
    v_mfma_f32_16x16x32_bf16 v[84:87], a[84:87], v[44:47], v[84:87]
    s_waitcnt lgkmcnt(6)
    v_mfma_f32_16x16x32_bf16 v[64:67], a[88:91], v[48:51], v[64:67]
    ds_read_b128 v[44:47], v9 offset:24576
    v_mfma_f32_16x16x32_bf16 v[68:71], a[92:95], v[48:51], v[68:71]
    v_mfma_f32_16x16x32_bf16 v[72:75], a[96:99], v[48:51], v[72:75]
    s_waitcnt lgkmcnt(6)
    v_mfma_f32_16x16x32_bf16 v[76:79], a[88:91], v[52:55], v[76:79]
    ds_read_b128 v[48:51], v8 offset:7168
    v_mfma_f32_16x16x32_bf16 v[80:83], a[92:95], v[52:55], v[80:83]
    v_mfma_f32_16x16x32_bf16 v[84:87], a[96:99], v[52:55], v[84:87]
    s_waitcnt lgkmcnt(6)
    v_mfma_f32_16x16x32_bf16 v[64:67], a[100:103], v[56:59], v[64:67]
    ds_read_b128 v[52:55], v8 offset:25600
    v_mfma_f32_16x16x32_bf16 v[68:71], a[104:107], v[56:59], v[68:71]
    v_mfma_f32_16x16x32_bf16 v[72:75], a[108:111], v[56:59], v[72:75]
    s_waitcnt lgkmcnt(6)
    v_mfma_f32_16x16x32_bf16 v[76:79], a[100:103], v[60:63], v[76:79]
    ds_read_b128 v[56:59], v9 offset:7168
    v_mfma_f32_16x16x32_bf16 v[80:83], a[104:107], v[60:63], v[80:83]
    v_mfma_f32_16x16x32_bf16 v[84:87], a[108:111], v[60:63], v[84:87]
    s_waitcnt lgkmcnt(6)
    v_mfma_f32_16x16x32_bf16 v[64:67], a[112:115], v[32:35], v[64:67]
    ds_read_b128 v[60:63], v9 offset:25600
    v_mfma_f32_16x16x32_bf16 v[68:71], a[116:119], v[32:35], v[68:71]
    v_mfma_f32_16x16x32_bf16 v[72:75], a[120:123], v[32:35], v[72:75]
    s_waitcnt lgkmcnt(6)
    v_mfma_f32_16x16x32_bf16 v[76:79], a[112:115], v[36:39], v[76:79]
    ds_read_b128 v[32:35], v8 offset:8192
    v_mfma_f32_16x16x32_bf16 v[80:83], a[116:119], v[36:39], v[80:83]
    v_mfma_f32_16x16x32_bf16 v[84:87], a[120:123], v[36:39], v[84:87]
    s_waitcnt lgkmcnt(6)
    v_mfma_f32_16x16x32_bf16 v[64:67], a[124:127], v[40:43], v[64:67]
    ds_read_b128 v[36:39], v8 offset:26624
    v_mfma_f32_16x16x32_bf16 v[68:71], a[128:131], v[40:43], v[68:71]
    v_mfma_f32_16x16x32_bf16 v[72:75], a[132:135], v[40:43], v[72:75]
    s_waitcnt lgkmcnt(6)
    v_mfma_f32_16x16x32_bf16 v[76:79], a[124:127], v[44:47], v[76:79]
    ds_read_b128 v[40:43], v9 offset:8192
    v_mfma_f32_16x16x32_bf16 v[80:83], a[128:131], v[44:47], v[80:83]
    v_mfma_f32_16x16x32_bf16 v[84:87], a[132:135], v[44:47], v[84:87]
    s_waitcnt lgkmcnt(6)
    v_mfma_f32_16x16x32_bf16 v[64:67], a[136:139], v[48:51], v[64:67]
    ds_read_b128 v[44:47], v9 offset:26624
    v_mfma_f32_16x16x32_bf16 v[68:71], a[140:143], v[48:51], v[68:71]
    v_mfma_f32_16x16x32_bf16 v[72:75], a[144:147], v[48:51], v[72:75]
    s_waitcnt lgkmcnt(6)
    v_mfma_f32_16x16x32_bf16 v[76:79], a[136:139], v[52:55], v[76:79]
    v_mfma_f32_16x16x32_bf16 v[80:83], a[140:143], v[52:55], v[80:83]
    v_mfma_f32_16x16x32_bf16 v[84:87], a[144:147], v[52:55], v[84:87]
    s_waitcnt lgkmcnt(5)
    v_mfma_f32_16x16x32_bf16 v[64:67], a[148:151], v[56:59], v[64:67]
    v_mfma_f32_16x16x32_bf16 v[68:71], a[152:155], v[56:59], v[68:71]
    v_mfma_f32_16x16x32_bf16 v[72:75], a[156:159], v[56:59], v[72:75]
    s_waitcnt lgkmcnt(4)
    v_mfma_f32_16x16x32_bf16 v[76:79], a[148:151], v[60:63], v[76:79]
    v_mfma_f32_16x16x32_bf16 v[80:83], a[152:155], v[60:63], v[80:83]
    v_mfma_f32_16x16x32_bf16 v[84:87], a[156:159], v[60:63], v[84:87]
    s_waitcnt lgkmcnt(3)
    v_mfma_f32_16x16x32_bf16 v[64:67], a[160:163], v[32:35], v[64:67]
    v_mfma_f32_16x16x32_bf16 v[68:71], a[164:167], v[32:35], v[68:71]
    v_mfma_f32_16x16x32_bf16 v[72:75], a[168:171], v[32:35], v[72:75]
    s_waitcnt lgkmcnt(2)
    v_mfma_f32_16x16x32_bf16 v[76:79], a[160:163], v[36:39], v[76:79]
    v_mfma_f32_16x16x32_bf16 v[80:83], a[164:167], v[36:39], v[80:83]
    v_mfma_f32_16x16x32_bf16 v[84:87], a[168:171], v[36:39], v[84:87]
    s_waitcnt lgkmcnt(1)
    v_mfma_f32_16x16x32_bf16 v[64:67], a[172:175], v[40:43], v[64:67]
    v_mfma_f32_16x16x32_bf16 v[68:71], a[176:179], v[40:43], v[68:71]
    v_mfma_f32_16x16x32_bf16 v[72:75], a[180:183], v[40:43], v[72:75]
    s_waitcnt lgkmcnt(0)
    v_mfma_f32_16x16x32_bf16 v[76:79], a[172:175], v[44:47], v[76:79]
    v_mfma_f32_16x16x32_bf16 v[80:83], a[176:179], v[44:47], v[80:83]
    v_mfma_f32_16x16x32_bf16 v[84:87], a[180:183], v[44:47], v[84:87]
    v_mul_u32_u24 v10, 2304, v3
    v_lshl_add_u32 v10, v2, 3, v10
    s_mul_i32 s44, s30, 73728
    s_add_u32 s44, s44, s29
    v_cvt_pk_bf16_f32 v12, v64, v65
    v_cvt_pk_bf16_f32 v13, v66, v67
    buffer_store_dwordx2 v[12:13], v10, s[16:19], s44 offen offset:0
    v_cvt_pk_bf16_f32 v14, v68, v69
    v_cvt_pk_bf16_f32 v15, v70, v71
    buffer_store_dwordx2 v[14:15], v10, s[16:19], s44 offen offset:32
    v_cvt_pk_bf16_f32 v16, v72, v73
    v_cvt_pk_bf16_f32 v17, v74, v75
    buffer_store_dwordx2 v[16:17], v10, s[16:19], s44 offen offset:64
    s_add_u32 s44, s44, 36864
    v_cvt_pk_bf16_f32 v18, v76, v77
    v_cvt_pk_bf16_f32 v19, v78, v79
    buffer_store_dwordx2 v[18:19], v10, s[16:19], s44 offen offset:0
    v_cvt_pk_bf16_f32 v20, v80, v81
    v_cvt_pk_bf16_f32 v21, v82, v83
    buffer_store_dwordx2 v[20:21], v10, s[16:19], s44 offen offset:32
    v_cvt_pk_bf16_f32 v22, v84, v85
    v_cvt_pk_bf16_f32 v23, v86, v87
    buffer_store_dwordx2 v[22:23], v10, s[16:19], s44 offen offset:64
    s_add_u32 s30, s30, s31
    s_cmp_lt_u32 s30, s32
    s_cbranch_scc1 L_pgl_a3_1
    s_waitcnt vmcnt(0)
    s_barrier
L_pgd_a3:
    s_branch L_end
L_brole:
    s_cmp_ge_u32 s41, 4
    s_cbranch_scc1 L_b3role
    s_sub_u32 s42, s41, 2
    s_lshl_b32 s42, s42, 2
    s_add_u32 s42, s42, s28
    s_mov_b32 s39, 0
    v_mov_b32 v28, 0x184000
L_poll_11:
    buffer_load_dword v29, v28, s[8:11], 0 offen sc1
    s_add_u32 s39, s39, 1
    s_cmp_gt_u32 s39, 4000000
    s_cbranch_scc1 L_fail
    s_waitcnt vmcnt(0)
    v_readfirstlane_b32 s33, v29
    s_nop 0
    s_cmp_ge_u32 s33, 224
    s_cbranch_scc1 L_poll_11_d
    s_sleep 2
    s_branch L_poll_11
L_poll_11_d:
    v_and_b32 v1, 63, v0
    v_lshrrev_b32 v2, 4, v1
    v_and_b32 v3, 15, v1
    s_barrier
    s_mov_b32 s44, 0x3e0293ee
    s_mov_b32 s56, -1
    s_mov_b32 s57, 0
    v_lshlrev_b32 v4, 4, v1
    v_and_b32 v8, 1, v2
    v_lshlrev_b32 v5, 4, v3
    v_lshl_add_u32 v5, v8, 3, v5
    v_lshrrev_b32 v8, 2, v3
    v_and_b32 v9, 1, v8
    v_lshrrev_b32 v8, 1, v8
    v_lshlrev_b32 v6, 6, v2
    v_lshl_add_u32 v6, v9, 4, v6
    v_lshl_add_u32 v6, v8, 8, v6
    v_and_b32 v9, 1, v1
    v_lshl_add_u32 v6, v9, 3, v6
    s_lshl_b32 s45, s28, 11
    s_add_u32 s45, s45, 0
    v_add_u32 v6, s45, v6
    v_lshlrev_b32 v8, 2, v2
    v_mov_b32 v7, 0xff800000
    v_and_b32 v10, 0x200, v4
    v_add_u32 v10, v10, v4
    v_add_u32 v10, 0x200, v10
    v_add_u32 v9, 0, v8
    v_cmp_le_u32 s[48:49], v9, v3
    v_add_u32 v9, 1, v8
    v_cmp_le_u32 s[50:51], v9, v3
    v_add_u32 v9, 2, v8
    v_cmp_le_u32 s[52:53], v9, v3
    v_add_u32 v9, 3, v8
    v_cmp_le_u32 s[54:55], v9, v3
    v_add_u32 v9, s45, v4
    v_mov_b32 v11, 0
L_b2_loop:
    s_cmp_ge_u32 s42, 64
    s_cbranch_scc1 L_b2_done
    s_lshl_b32 s33, s42, 5
    s_add_u32 s33, s33, s40
    s_lshl_b32 s36, s33, 12
    s_lshl_b32 s33, s33, 13
    s_add_u32 s34, s33, 0x3000000
    buffer_load_dwordx4 v[16:19], v4, s[8:11], s34 offen offset:0 sc1
    buffer_load_dwordx4 v[20:23], v4, s[8:11], s34 offen offset:1024 sc1
    buffer_load_dwordx4 v[24:27], v4, s[8:11], s34 offen offset:2048 sc1
    buffer_load_dwordx4 v[28:31], v4, s[8:11], s34 offen offset:3072 sc1
    s_add_u32 s34, s33, 0x3001000
    buffer_load_dwordx4 v[32:35], v4, s[8:11], s34 offen offset:0 sc1
    buffer_load_dwordx4 v[36:39], v4, s[8:11], s34 offen offset:1024 sc1
    buffer_load_dwordx4 v[40:43], v4, s[8:11], s34 offen offset:2048 sc1
    buffer_load_dwordx4 v[44:47], v4, s[8:11], s34 offen offset:3072 sc1
    s_add_u32 s34, s33, 0x1000000
    buffer_load_dwordx4 v[48:51], v4, s[8:11], s34 offen offset:0 sc1
    buffer_load_dwordx4 v[52:55], v4, s[8:11], s34 offen offset:1024 sc1
    buffer_load_dwordx4 v[56:59], v4, s[8:11], s34 offen offset:2048 sc1
    buffer_load_dwordx4 v[60:63], v4, s[8:11], s34 offen offset:3072 sc1
    s_add_u32 s34, s33, 0x1001000
    buffer_load_dwordx4 v[64:67], v4, s[8:11], s34 offen offset:0 sc1
    buffer_load_dwordx4 v[68:71], v4, s[8:11], s34 offen offset:1024 sc1
    buffer_load_dwordx4 v[72:75], v4, s[8:11], s34 offen offset:2048 sc1
    buffer_load_dwordx4 v[76:79], v4, s[8:11], s34 offen offset:3072 sc1
    s_add_u32 s34, s33, 0x2000000
    buffer_load_dwordx4 v[80:83], v4, s[8:11], s34 offen offset:0 sc1
    buffer_load_dwordx4 v[84:87], v4, s[8:11], s34 offen offset:1024 sc1
    buffer_load_dwordx4 v[88:91], v4, s[8:11], s34 offen offset:2048 sc1
    buffer_load_dwordx4 v[92:95], v4, s[8:11], s34 offen offset:3072 sc1
    s_add_u32 s34, s33, 0x2001000
    buffer_load_dwordx4 v[96:99], v4, s[8:11], s34 offen offset:0 sc1
    buffer_load_dwordx4 v[100:103], v4, s[8:11], s34 offen offset:1024 sc1
    buffer_load_dwordx4 v[104:107], v4, s[8:11], s34 offen offset:2048 sc1
    buffer_load_dwordx4 v[108:111], v4, s[8:11], s34 offen offset:3072 sc1
    s_waitcnt vmcnt(8)
    v_mfma_f32_16x16x32_bf16 v[144:147], v[48:51], v[16:19], 0
    v_mfma_f32_16x16x32_bf16 v[148:151], v[48:51], v[32:35], 0
    v_mfma_f32_16x16x32_bf16 v[152:155], v[64:67], v[32:35], 0
    v_mfma_f32_16x16x32_bf16 v[144:147], v[52:55], v[20:23], v[144:147]
    v_mfma_f32_16x16x32_bf16 v[148:151], v[52:55], v[36:39], v[148:151]
    v_mfma_f32_16x16x32_bf16 v[152:155], v[68:71], v[36:39], v[152:155]
    v_mfma_f32_16x16x32_bf16 v[144:147], v[56:59], v[24:27], v[144:147]
    v_mfma_f32_16x16x32_bf16 v[148:151], v[56:59], v[40:43], v[148:151]
    v_mfma_f32_16x16x32_bf16 v[152:155], v[72:75], v[40:43], v[152:155]
    v_mfma_f32_16x16x32_bf16 v[144:147], v[60:63], v[28:31], v[144:147]
    v_mfma_f32_16x16x32_bf16 v[148:151], v[60:63], v[44:47], v[148:151]
    v_mfma_f32_16x16x32_bf16 v[152:155], v[76:79], v[44:47], v[152:155]
    v_cndmask_b32 v144, v7, v144, s[48:49]
    v_cndmask_b32 v145, v7, v145, s[50:51]
    v_cndmask_b32 v146, v7, v146, s[52:53]
    v_cndmask_b32 v147, v7, v147, s[54:55]
    s_nop 3
    v_cndmask_b32 v152, v7, v152, s[48:49]
    v_cndmask_b32 v153, v7, v153, s[50:51]
    v_cndmask_b32 v154, v7, v154, s[52:53]
    v_cndmask_b32 v155, v7, v155, s[54:55]
    s_add_u32 s34, s36, 0x4100000
    s_add_u32 s35, s34, 2048
    s_mov_b32 s39, 0
    s_mov_b32 s58, 0xffbfffbf
    s_sub_u32 s33, s34, 131072
    s_add_u32 s59, s34, 131072
    s_cmp_lt_u32 s42, 60
    s_cselect_b32 s33, s59, s33
L_b2_pre:
    buffer_load_dword v12, v11, s[8:11], s33 offen sc1
    s_add_u32 s39, s39, 1
    s_cmp_gt_u32 s39, 4000000
    s_cbranch_scc1 L_fail
    s_waitcnt vmcnt(0)
    v_cmp_eq_u32 vcc, s58, v12
    s_cbranch_vccz L_b2_full
    s_sleep 8
    s_branch L_b2_pre
L_b2_full:
    buffer_load_dwordx4 v[244:247], v10, s[8:11], s34 offen sc1
    buffer_load_dwordx4 v[248:251], v10, s[8:11], s35 offen sc1
    buffer_load_dwordx2 v[112:113], v5, s[8:11], s34 offen offset:0 sc1
    buffer_load_dwordx2 v[114:115], v5, s[8:11], s34 offen offset:256 sc1
    buffer_load_dwordx2 v[116:117], v5, s[8:11], s34 offen offset:1024 sc1
    buffer_load_dwordx2 v[118:119], v5, s[8:11], s34 offen offset:1280 sc1
    buffer_load_dwordx2 v[120:121], v5, s[8:11], s34 offen offset:2048 sc1
    buffer_load_dwordx2 v[122:123], v5, s[8:11], s34 offen offset:2304 sc1
    buffer_load_dwordx2 v[124:125], v5, s[8:11], s34 offen offset:3072 sc1
    buffer_load_dwordx2 v[126:127], v5, s[8:11], s34 offen offset:3328 sc1
    s_add_u32 s39, s39, 1
    s_cmp_gt_u32 s39, 4000000
    s_cbranch_scc1 L_fail
    s_waitcnt vmcnt(0)
    ds_write_b128 v9, v[244:247]
    ds_write_b128 v9, v[248:251] offset:1024
    v_max3_u32 v12, v244, v245, v246
    v_max3_u32 v13, v247, v248, v249
    v_max3_u32 v12, v250, v251, v12
    v_max3_u32 v13, v112, v113, v13
    v_max3_u32 v12, v114, v115, v12
    v_max3_u32 v13, v116, v117, v13
    v_max3_u32 v12, v118, v119, v12
    v_max3_u32 v13, v120, v121, v13
    v_max3_u32 v12, v122, v123, v12
    v_max3_u32 v13, v124, v125, v13
    v_max3_u32 v12, v126, v127, v12
    v_max_u32 v12, v12, v13
    v_cmp_le_u32 vcc, s58, v12
    s_cbranch_vccz L_b2_ok
    v_cmp_eq_u32 vcc, s58, v244
    v_cmp_eq_u32 s[60:61], s58, v245
    s_nop 0
    s_or_b64 vcc, vcc, s[60:61]
    v_cmp_eq_u32 s[60:61], s58, v246
    s_nop 0
    s_or_b64 vcc, vcc, s[60:61]
    v_cmp_eq_u32 s[60:61], s58, v247
    s_nop 0
    s_or_b64 vcc, vcc, s[60:61]
    v_cmp_eq_u32 s[60:61], s58, v248
    s_nop 0
    s_or_b64 vcc, vcc, s[60:61]
    v_cmp_eq_u32 s[60:61], s58, v249
    s_nop 0
    s_or_b64 vcc, vcc, s[60:61]
    v_cmp_eq_u32 s[60:61], s58, v250
    s_nop 0
    s_or_b64 vcc, vcc, s[60:61]
    v_cmp_eq_u32 s[60:61], s58, v251
    s_nop 0
    s_or_b64 vcc, vcc, s[60:61]
    v_cmp_eq_u32 s[60:61], s58, v112
    s_nop 0
    s_or_b64 vcc, vcc, s[60:61]
    v_cmp_eq_u32 s[60:61], s58, v113
    s_nop 0
    s_or_b64 vcc, vcc, s[60:61]
    v_cmp_eq_u32 s[60:61], s58, v114
    s_nop 0
    s_or_b64 vcc, vcc, s[60:61]
    v_cmp_eq_u32 s[60:61], s58, v115
    s_nop 0
    s_or_b64 vcc, vcc, s[60:61]
    v_cmp_eq_u32 s[60:61], s58, v116
    s_nop 0
    s_or_b64 vcc, vcc, s[60:61]
    v_cmp_eq_u32 s[60:61], s58, v117
    s_nop 0
    s_or_b64 vcc, vcc, s[60:61]
    v_cmp_eq_u32 s[60:61], s58, v118
    s_nop 0
    s_or_b64 vcc, vcc, s[60:61]
    v_cmp_eq_u32 s[60:61], s58, v119
    s_nop 0
    s_or_b64 vcc, vcc, s[60:61]
    v_cmp_eq_u32 s[60:61], s58, v120
    s_nop 0
    s_or_b64 vcc, vcc, s[60:61]
    v_cmp_eq_u32 s[60:61], s58, v121
    s_nop 0
    s_or_b64 vcc, vcc, s[60:61]
    v_cmp_eq_u32 s[60:61], s58, v122
    s_nop 0
    s_or_b64 vcc, vcc, s[60:61]
    v_cmp_eq_u32 s[60:61], s58, v123
    s_nop 0
    s_or_b64 vcc, vcc, s[60:61]
    v_cmp_eq_u32 s[60:61], s58, v124
    s_nop 0
    s_or_b64 vcc, vcc, s[60:61]
    v_cmp_eq_u32 s[60:61], s58, v125
    s_nop 0
    s_or_b64 vcc, vcc, s[60:61]
    v_cmp_eq_u32 s[60:61], s58, v126
    s_nop 0
    s_or_b64 vcc, vcc, s[60:61]
    v_cmp_eq_u32 s[60:61], s58, v127
    s_nop 0
    s_or_b64 vcc, vcc, s[60:61]
    s_cbranch_vccnz L_b2_full
L_b2_ok:
    ds_read_b64_tr_b16 v[128:129], v6 offset:0
    ds_read_b64_tr_b16 v[130:131], v6 offset:32
    ds_read_b64_tr_b16 v[132:133], v6 offset:512
    ds_read_b64_tr_b16 v[134:135], v6 offset:544
    ds_read_b64_tr_b16 v[136:137], v6 offset:1024
    ds_read_b64_tr_b16 v[138:139], v6 offset:1056
    ds_read_b64_tr_b16 v[140:141], v6 offset:1536
    ds_read_b64_tr_b16 v[142:143], v6 offset:1568
    s_waitcnt lgkmcnt(0)
    v_mfma_f32_16x16x32_bf16 v[156:159], v[128:131], v[16:19], 0
    v_mfma_f32_16x16x32_bf16 v[160:163], v[128:131], v[32:35], 0
    v_mfma_f32_16x16x32_bf16 v[156:159], v[132:135], v[20:23], v[156:159]
    v_mfma_f32_16x16x32_bf16 v[160:163], v[132:135], v[36:39], v[160:163]
    v_mfma_f32_16x16x32_bf16 v[156:159], v[136:139], v[24:27], v[156:159]
    v_mfma_f32_16x16x32_bf16 v[160:163], v[136:139], v[40:43], v[160:163]
    v_mfma_f32_16x16x32_bf16 v[156:159], v[140:143], v[28:31], v[156:159]
    v_mfma_f32_16x16x32_bf16 v[160:163], v[140:143], v[44:47], v[160:163]
    s_nop 3
    v_cndmask_b32 v156, v7, v156, s[56:57]
    v_cndmask_b32 v157, v7, v157, s[56:57]
    v_cndmask_b32 v158, v7, v158, s[56:57]
    v_cndmask_b32 v159, v7, v159, s[56:57]
    v_max_f32 v176, v156, v157
    v_max3_f32 v176, v158, v159, v176
    v_max3_f32 v176, v144, v145, v176
    v_max3_f32 v176, v146, v147, v176
    v_mov_b32 v178, v176
    s_nop 1
    v_permlane32_swap_b32 v176, v178
    v_max_f32 v176, v176, v178
    v_mov_b32 v178, v176
    s_nop 1
    v_permlane16_swap_b32 v176, v178
    v_max_f32 v176, v176, v178
    v_mul_f32 v176, s44, v176
    v_fma_f32 v156, v156, s44, -v176
    v_fma_f32 v157, v157, s44, -v176
    v_fma_f32 v158, v158, s44, -v176
    v_fma_f32 v159, v159, s44, -v176
    v_fma_f32 v144, v144, s44, -v176
    v_fma_f32 v145, v145, s44, -v176
    v_fma_f32 v146, v146, s44, -v176
    v_fma_f32 v147, v147, s44, -v176
    v_exp_f32 v156, v156
    v_exp_f32 v157, v157
    v_exp_f32 v158, v158
    v_exp_f32 v159, v159
    v_exp_f32 v144, v144
    v_exp_f32 v145, v145
    v_exp_f32 v146, v146
    v_exp_f32 v147, v147
    v_add_f32 v177, v156, v157
    v_add_f32 v177, v177, v158
    v_add_f32 v177, v177, v159
    v_add_f32 v177, v177, v144
    v_add_f32 v177, v177, v145
    v_add_f32 v177, v177, v146
    v_add_f32 v177, v177, v147
    v_mov_b32 v178, v177
    s_nop 1
    v_permlane32_swap_b32 v177, v178
    v_add_f32 v177, v177, v178
    v_mov_b32 v178, v177
    s_nop 1
    v_permlane16_swap_b32 v177, v178
    v_add_f32 v177, v177, v178
    v_rcp_f32 v177, v177
    s_nop 0
    v_mul_f32 v156, v156, v177
    v_mul_f32 v157, v157, v177
    v_mul_f32 v158, v158, v177
    v_mul_f32 v159, v159, v177
    v_mul_f32 v144, v144, v177
    v_mul_f32 v145, v145, v177
    v_mul_f32 v146, v146, v177
    v_mul_f32 v147, v147, v177
    v_cvt_pk_bf16_f32 v172, v156, v157
    v_cvt_pk_bf16_f32 v173, v158, v159
    v_cvt_pk_bf16_f32 v164, v144, v145
    v_cvt_pk_bf16_f32 v165, v146, v147
    v_mov_b64 v[166:167], 0
    v_cndmask_b32 v160, v7, v160, s[56:57]
    v_cndmask_b32 v161, v7, v161, s[56:57]
    v_cndmask_b32 v162, v7, v162, s[56:57]
    v_cndmask_b32 v163, v7, v163, s[56:57]
    v_max_f32 v176, v160, v161
    v_max3_f32 v176, v162, v163, v176
    v_max3_f32 v176, v148, v149, v176
    v_max3_f32 v176, v150, v151, v176
    v_max3_f32 v176, v152, v153, v176
    v_max3_f32 v176, v154, v155, v176
    v_mov_b32 v178, v176
    s_nop 1
    v_permlane32_swap_b32 v176, v178
    v_max_f32 v176, v176, v178
    v_mov_b32 v178, v176
    s_nop 1
    v_permlane16_swap_b32 v176, v178
    v_max_f32 v176, v176, v178
    v_mul_f32 v176, s44, v176
    v_fma_f32 v160, v160, s44, -v176
    v_fma_f32 v161, v161, s44, -v176
    v_fma_f32 v162, v162, s44, -v176
    v_fma_f32 v163, v163, s44, -v176
    v_fma_f32 v148, v148, s44, -v176
    v_fma_f32 v149, v149, s44, -v176
    v_fma_f32 v150, v150, s44, -v176
    v_fma_f32 v151, v151, s44, -v176
    v_fma_f32 v152, v152, s44, -v176
    v_fma_f32 v153, v153, s44, -v176
    v_fma_f32 v154, v154, s44, -v176
    v_fma_f32 v155, v155, s44, -v176
    v_exp_f32 v160, v160
    v_exp_f32 v161, v161
    v_exp_f32 v162, v162
    v_exp_f32 v163, v163
    v_exp_f32 v148, v148
    v_exp_f32 v149, v149
    v_exp_f32 v150, v150
    v_exp_f32 v151, v151
    v_exp_f32 v152, v152
    v_exp_f32 v153, v153
    v_exp_f32 v154, v154
    v_exp_f32 v155, v155
    v_add_f32 v177, v160, v161
    v_add_f32 v177, v177, v162
    v_add_f32 v177, v177, v163
    v_add_f32 v177, v177, v148
    v_add_f32 v177, v177, v149
    v_add_f32 v177, v177, v150
    v_add_f32 v177, v177, v151
    v_add_f32 v177, v177, v152
    v_add_f32 v177, v177, v153
    v_add_f32 v177, v177, v154
    v_add_f32 v177, v177, v155
    v_mov_b32 v178, v177
    s_nop 1
    v_permlane32_swap_b32 v177, v178
    v_add_f32 v177, v177, v178
    v_mov_b32 v178, v177
    s_nop 1
    v_permlane16_swap_b32 v177, v178
    v_add_f32 v177, v177, v178
    v_rcp_f32 v177, v177
    s_nop 0
    v_mul_f32 v160, v160, v177
    v_mul_f32 v161, v161, v177
    v_mul_f32 v162, v162, v177
    v_mul_f32 v163, v163, v177
    v_mul_f32 v148, v148, v177
    v_mul_f32 v149, v149, v177
    v_mul_f32 v150, v150, v177
    v_mul_f32 v151, v151, v177
    v_mul_f32 v152, v152, v177
    v_mul_f32 v153, v153, v177
    v_mul_f32 v154, v154, v177
    v_mul_f32 v155, v155, v177
    v_cvt_pk_bf16_f32 v174, v160, v161
    v_cvt_pk_bf16_f32 v175, v162, v163
    v_cvt_pk_bf16_f32 v168, v148, v149
    v_cvt_pk_bf16_f32 v169, v150, v151
    v_cvt_pk_bf16_f32 v170, v152, v153
    v_cvt_pk_bf16_f32 v171, v154, v155
    s_waitcnt vmcnt(0)
    v_mfma_f32_16x16x32_bf16 v[180:183], v[80:83], v[164:167], 0
    v_mfma_f32_16x16x32_bf16 v[184:187], v[84:87], v[164:167], 0
    v_mfma_f32_16x16x32_bf16 v[188:191], v[88:91], v[164:167], 0
    v_mfma_f32_16x16x32_bf16 v[192:195], v[92:95], v[164:167], 0
    v_mfma_f32_16x16x32_bf16 v[196:199], v[96:99], v[164:167], 0
    v_mfma_f32_16x16x32_bf16 v[200:203], v[100:103], v[164:167], 0
    v_mfma_f32_16x16x32_bf16 v[204:207], v[104:107], v[164:167], 0
    v_mfma_f32_16x16x32_bf16 v[208:211], v[108:111], v[164:167], 0
    v_mfma_f32_16x16x32_bf16 v[212:215], v[80:83], v[168:171], 0
    v_mfma_f32_16x16x32_bf16 v[216:219], v[84:87], v[168:171], 0
    v_mfma_f32_16x16x32_bf16 v[220:223], v[88:91], v[168:171], 0
    v_mfma_f32_16x16x32_bf16 v[224:227], v[92:95], v[168:171], 0
    v_mfma_f32_16x16x32_bf16 v[228:231], v[96:99], v[168:171], 0
    v_mfma_f32_16x16x32_bf16 v[232:235], v[100:103], v[168:171], 0
    v_mfma_f32_16x16x32_bf16 v[236:239], v[104:107], v[168:171], 0
    v_mfma_f32_16x16x32_bf16 v[240:243], v[108:111], v[168:171], 0
    v_mfma_f32_16x16x16_bf16 v[180:183], v[112:113], v[172:173], v[180:183]
    v_mfma_f32_16x16x16_bf16 v[184:187], v[114:115], v[172:173], v[184:187]
    v_mfma_f32_16x16x16_bf16 v[188:191], v[116:117], v[172:173], v[188:191]
    v_mfma_f32_16x16x16_bf16 v[192:195], v[118:119], v[172:173], v[192:195]
    v_mfma_f32_16x16x16_bf16 v[196:199], v[120:121], v[172:173], v[196:199]
    v_mfma_f32_16x16x16_bf16 v[200:203], v[122:123], v[172:173], v[200:203]
    v_mfma_f32_16x16x16_bf16 v[204:207], v[124:125], v[172:173], v[204:207]
    v_mfma_f32_16x16x16_bf16 v[208:211], v[126:127], v[172:173], v[208:211]
    v_mfma_f32_16x16x16_bf16 v[212:215], v[112:113], v[174:175], v[212:215]
    v_mfma_f32_16x16x16_bf16 v[216:219], v[114:115], v[174:175], v[216:219]
    v_mfma_f32_16x16x16_bf16 v[220:223], v[116:117], v[174:175], v[220:223]
    v_mfma_f32_16x16x16_bf16 v[224:227], v[118:119], v[174:175], v[224:227]
    v_mfma_f32_16x16x16_bf16 v[228:231], v[120:121], v[174:175], v[228:231]
    v_mfma_f32_16x16x16_bf16 v[232:235], v[122:123], v[174:175], v[232:235]
    v_mfma_f32_16x16x16_bf16 v[236:239], v[124:125], v[174:175], v[236:239]
    v_mfma_f32_16x16x16_bf16 v[240:243], v[126:127], v[174:175], v[240:243]
    s_lshl_b32 s33, s42, 6
    s_add_u32 s33, s33, s40
    s_lshl_b32 s33, s33, 12
    s_add_u32 s33, s33, 0x5000000
    s_add_u32 s34, s33, 0x20000
    v_cvt_pk_bf16_f32 v16, v180, v181
    v_cvt_pk_bf16_f32 v17, v182, v183
    v_cvt_pk_bf16_f32 v18, v184, v185
    v_cvt_pk_bf16_f32 v19, v186, v187
    buffer_store_dwordx4 v[16:19], v4, s[8:11], s33 offen offset:0 sc1
    v_cvt_pk_bf16_f32 v20, v188, v189
    v_cvt_pk_bf16_f32 v21, v190, v191
    v_cvt_pk_bf16_f32 v22, v192, v193
    v_cvt_pk_bf16_f32 v23, v194, v195
    buffer_store_dwordx4 v[20:23], v4, s[8:11], s33 offen offset:1024 sc1
    v_cvt_pk_bf16_f32 v24, v196, v197
    v_cvt_pk_bf16_f32 v25, v198, v199
    v_cvt_pk_bf16_f32 v26, v200, v201
    v_cvt_pk_bf16_f32 v27, v202, v203
    buffer_store_dwordx4 v[24:27], v4, s[8:11], s33 offen offset:2048 sc1
    v_cvt_pk_bf16_f32 v28, v204, v205
    v_cvt_pk_bf16_f32 v29, v206, v207
    v_cvt_pk_bf16_f32 v30, v208, v209
    v_cvt_pk_bf16_f32 v31, v210, v211
    buffer_store_dwordx4 v[28:31], v4, s[8:11], s33 offen offset:3072 sc1
    v_cvt_pk_bf16_f32 v32, v212, v213
    v_cvt_pk_bf16_f32 v33, v214, v215
    v_cvt_pk_bf16_f32 v34, v216, v217
    v_cvt_pk_bf16_f32 v35, v218, v219
    buffer_store_dwordx4 v[32:35], v4, s[8:11], s34 offen offset:0 sc1
    v_cvt_pk_bf16_f32 v36, v220, v221
    v_cvt_pk_bf16_f32 v37, v222, v223
    v_cvt_pk_bf16_f32 v38, v224, v225
    v_cvt_pk_bf16_f32 v39, v226, v227
    buffer_store_dwordx4 v[36:39], v4, s[8:11], s34 offen offset:1024 sc1
    v_cvt_pk_bf16_f32 v40, v228, v229
    v_cvt_pk_bf16_f32 v41, v230, v231
    v_cvt_pk_bf16_f32 v42, v232, v233
    v_cvt_pk_bf16_f32 v43, v234, v235
    buffer_store_dwordx4 v[40:43], v4, s[8:11], s34 offen offset:2048 sc1
    v_cvt_pk_bf16_f32 v44, v236, v237
    v_cvt_pk_bf16_f32 v45, v238, v239
    v_cvt_pk_bf16_f32 v46, v240, v241
    v_cvt_pk_bf16_f32 v47, v242, v243
    buffer_store_dwordx4 v[44:47], v4, s[8:11], s34 offen offset:3072 sc1
    s_waitcnt vmcnt(0)
    s_lshl_b32 s34, s42, 7
    s_add_u32 s34, s34, 0x182000
    v_mov_b32 v12, s34
    v_mov_b32 v13, 1
    s_mov_b64 exec, 1
    buffer_atomic_add v13, v12, s[8:11], 0 offen
    s_mov_b64 exec, -1
L_sig_12:
    s_add_u32 s42, s42, 8
    s_nop 0
    s_branch L_b2_loop
L_b2_done:
    s_branch L_end
L_b3role:
    s_mul_i32 s43, s40, 3
    s_add_u32 s43, s43, s41
    s_sub_u32 s43, s43, 4
    s_mul_i32 s41, s43, 5462
    s_lshr_b32 s41, s41, 16
    s_mul_i32 s40, s41, 12
    s_sub_u32 s40, s43, s40
    v_and_b32 v1, 63, v0
    v_lshrrev_b32 v2, 4, v1
    v_and_b32 v3, 15, v1
    s_barrier
    s_mov_b32 s20, s80
    s_and_b32 s21, s81, 0xffff
    s_mov_b32 s22, 0x480000
    s_mov_b32 s23, 0x20000
    s_mul_i32 s29, s28, 1179648
    s_mul_i32 s33, s40, 96
    s_add_u32 s29, s29, s33
    s_mov_b32 s30, s41
    v_lshrrev_b32 v4, 3, v1
    v_and_b32 v5, 7, v1
    v_and_b32 v6, 6, v4
    v_xor_b32 v5, v5, v6
    v_mov_b32 v6, v5
    v_min_u32 v5, 5, v5
    v_min_u32 v6, 5, v6
    v_mul_u32_u24 v4, 1152, v4
    v_lshl_add_u32 v5, v5, 4, v4
    v_lshl_add_u32 v6, v6, 4, v4
    v_lshrrev_b32 v7, 2, v3
    v_and_b32 v8, 3, v3
    v_lshlrev_b32 v9, 9, v2
    v_lshl_add_u32 v9, v7, 7, v9
    v_lshl_add_u32 v9, v8, 3, v9
    v_lshrrev_b32 v7, 1, v7
    v_and_b32 v8, 1, v2
    v_lshl_add_u32 v7, v8, 1, v7
    v_lshlrev_b32 v7, 5, v7
    s_mul_i32 s33, s28, 36864
    s_add_u32 s33, s33, 16384
    v_add_u32 v9, s33, v9
    v_xor_b32 v10, 0, v7
    v_add_u32 v10, v10, v9
    v_xor_b32 v11, 32, v7
    v_add_u32 v11, v11, v9
    v_xor_b32 v12, 64, v7
    v_add_u32 v12, v12, v9
    s_add_u32 m0, s33, 0
    s_add_u32 s34, s29, 0
    buffer_load_dwordx4 v5, s[20:23], s34 offen lds
    s_add_u32 m0, s33, 1024
    s_add_u32 s34, s29, 9216
    buffer_load_dwordx4 v6, s[20:23], s34 offen lds
    s_add_u32 m0, s33, 2048
    s_add_u32 s34, s29, 18432
    buffer_load_dwordx4 v5, s[20:23], s34 offen lds
    s_add_u32 m0, s33, 3072
    s_add_u32 s34, s29, 27648
    buffer_load_dwordx4 v6, s[20:23], s34 offen lds
    s_add_u32 m0, s33, 4096
    s_add_u32 s34, s29, 36864
    buffer_load_dwordx4 v5, s[20:23], s34 offen lds
    s_add_u32 m0, s33, 5120
    s_add_u32 s34, s29, 46080
    buffer_load_dwordx4 v6, s[20:23], s34 offen lds
    s_add_u32 m0, s33, 6144
    s_add_u32 s34, s29, 55296
    buffer_load_dwordx4 v5, s[20:23], s34 offen lds
    s_add_u32 m0, s33, 7168
    s_add_u32 s34, s29, 64512
    buffer_load_dwordx4 v6, s[20:23], s34 offen lds
    s_add_u32 m0, s33, 8192
    s_add_u32 s34, s29, 73728
    buffer_load_dwordx4 v5, s[20:23], s34 offen lds
    s_add_u32 m0, s33, 9216
    s_add_u32 s34, s29, 82944
    buffer_load_dwordx4 v6, s[20:23], s34 offen lds
    s_add_u32 m0, s33, 10240
    s_add_u32 s34, s29, 92160
    buffer_load_dwordx4 v5, s[20:23], s34 offen lds
    s_add_u32 m0, s33, 11264
    s_add_u32 s34, s29, 101376
    buffer_load_dwordx4 v6, s[20:23], s34 offen lds
    s_add_u32 m0, s33, 12288
    s_add_u32 s34, s29, 110592
    buffer_load_dwordx4 v5, s[20:23], s34 offen lds
    s_add_u32 m0, s33, 13312
    s_add_u32 s34, s29, 119808
    buffer_load_dwordx4 v6, s[20:23], s34 offen lds
    s_add_u32 m0, s33, 14336
    s_add_u32 s34, s29, 129024
    buffer_load_dwordx4 v5, s[20:23], s34 offen lds
    s_add_u32 m0, s33, 15360
    s_add_u32 s34, s29, 138240
    buffer_load_dwordx4 v6, s[20:23], s34 offen lds
    s_add_u32 m0, s33, 16384
    s_add_u32 s34, s29, 147456
    buffer_load_dwordx4 v5, s[20:23], s34 offen lds
    s_add_u32 m0, s33, 17408
    s_add_u32 s34, s29, 156672
    buffer_load_dwordx4 v6, s[20:23], s34 offen lds
    s_add_u32 m0, s33, 18432
    s_add_u32 s34, s29, 165888
    buffer_load_dwordx4 v5, s[20:23], s34 offen lds
    s_add_u32 m0, s33, 19456
    s_add_u32 s34, s29, 175104
    buffer_load_dwordx4 v6, s[20:23], s34 offen lds
    s_add_u32 m0, s33, 20480
    s_add_u32 s34, s29, 184320
    buffer_load_dwordx4 v5, s[20:23], s34 offen lds
    s_add_u32 m0, s33, 21504
    s_add_u32 s34, s29, 193536
    buffer_load_dwordx4 v6, s[20:23], s34 offen lds
    s_add_u32 m0, s33, 22528
    s_add_u32 s34, s29, 202752
    buffer_load_dwordx4 v5, s[20:23], s34 offen lds
    s_add_u32 m0, s33, 23552
    s_add_u32 s34, s29, 211968
    buffer_load_dwordx4 v6, s[20:23], s34 offen lds
    s_add_u32 m0, s33, 24576
    s_add_u32 s34, s29, 221184
    buffer_load_dwordx4 v5, s[20:23], s34 offen lds
    s_add_u32 m0, s33, 25600
    s_add_u32 s34, s29, 230400
    buffer_load_dwordx4 v6, s[20:23], s34 offen lds
    s_add_u32 m0, s33, 26624
    s_add_u32 s34, s29, 239616
    buffer_load_dwordx4 v5, s[20:23], s34 offen lds
    s_add_u32 m0, s33, 27648
    s_add_u32 s34, s29, 248832
    buffer_load_dwordx4 v6, s[20:23], s34 offen lds
    s_add_u32 m0, s33, 28672
    s_add_u32 s34, s29, 258048
    buffer_load_dwordx4 v5, s[20:23], s34 offen lds
    s_add_u32 m0, s33, 29696
    s_add_u32 s34, s29, 267264
    buffer_load_dwordx4 v6, s[20:23], s34 offen lds
    s_add_u32 m0, s33, 30720
    s_add_u32 s34, s29, 276480
    buffer_load_dwordx4 v5, s[20:23], s34 offen lds
    s_add_u32 m0, s33, 31744
    s_add_u32 s34, s29, 285696
    buffer_load_dwordx4 v6, s[20:23], s34 offen lds
    s_add_u32 m0, s33, 32768
    s_add_u32 s34, s29, 294912
    buffer_load_dwordx4 v5, s[20:23], s34 offen lds
    s_add_u32 m0, s33, 33792
    s_add_u32 s34, s29, 304128
    buffer_load_dwordx4 v6, s[20:23], s34 offen lds
    s_add_u32 m0, s33, 34816
    s_add_u32 s34, s29, 313344
    buffer_load_dwordx4 v5, s[20:23], s34 offen lds
    s_add_u32 m0, s33, 35840
    s_add_u32 s34, s29, 322560
    buffer_load_dwordx4 v6, s[20:23], s34 offen lds
    s_waitcnt vmcnt(32)
    ds_read_b64_tr_b16 v[128:129], v10 offset:0
    ds_read_b64_tr_b16 v[130:131], v10 offset:2048
    ds_read_b64_tr_b16 v[132:133], v11 offset:0
    ds_read_b64_tr_b16 v[134:135], v11 offset:2048
    ds_read_b64_tr_b16 v[136:137], v12 offset:0
    ds_read_b64_tr_b16 v[138:139], v12 offset:2048
    s_waitcnt lgkmcnt(0)
    s_add_u32 m0, s33, 0
    s_add_u32 s34, s29, 331776
    buffer_load_dwordx4 v5, s[20:23], s34 offen lds
    s_add_u32 m0, s33, 1024
    s_add_u32 s34, s29, 340992
    buffer_load_dwordx4 v6, s[20:23], s34 offen lds
    s_add_u32 m0, s33, 2048
    s_add_u32 s34, s29, 350208
    buffer_load_dwordx4 v5, s[20:23], s34 offen lds
    s_add_u32 m0, s33, 3072
    s_add_u32 s34, s29, 359424
    buffer_load_dwordx4 v6, s[20:23], s34 offen lds
    s_waitcnt vmcnt(32)
    ds_read_b64_tr_b16 v[140:141], v10 offset:4096
    ds_read_b64_tr_b16 v[142:143], v10 offset:6144
    ds_read_b64_tr_b16 v[144:145], v11 offset:4096
    ds_read_b64_tr_b16 v[146:147], v11 offset:6144
    ds_read_b64_tr_b16 v[148:149], v12 offset:4096
    ds_read_b64_tr_b16 v[150:151], v12 offset:6144
    s_waitcnt lgkmcnt(0)
    s_add_u32 m0, s33, 4096
    s_add_u32 s34, s29, 368640
    buffer_load_dwordx4 v5, s[20:23], s34 offen lds
    s_add_u32 m0, s33, 5120
    s_add_u32 s34, s29, 377856
    buffer_load_dwordx4 v6, s[20:23], s34 offen lds
    s_add_u32 m0, s33, 6144
    s_add_u32 s34, s29, 387072
    buffer_load_dwordx4 v5, s[20:23], s34 offen lds
    s_add_u32 m0, s33, 7168
    s_add_u32 s34, s29, 396288
    buffer_load_dwordx4 v6, s[20:23], s34 offen lds
    s_waitcnt vmcnt(32)
    ds_read_b64_tr_b16 v[152:153], v10 offset:8192
    ds_read_b64_tr_b16 v[154:155], v10 offset:10240
    ds_read_b64_tr_b16 v[156:157], v11 offset:8192
    ds_read_b64_tr_b16 v[158:159], v11 offset:10240
    ds_read_b64_tr_b16 v[160:161], v12 offset:8192
    ds_read_b64_tr_b16 v[162:163], v12 offset:10240
    s_waitcnt lgkmcnt(0)
    s_add_u32 m0, s33, 8192
    s_add_u32 s34, s29, 405504
    buffer_load_dwordx4 v5, s[20:23], s34 offen lds
    s_add_u32 m0, s33, 9216
    s_add_u32 s34, s29, 414720
    buffer_load_dwordx4 v6, s[20:23], s34 offen lds
    s_add_u32 m0, s33, 10240
    s_add_u32 s34, s29, 423936
    buffer_load_dwordx4 v5, s[20:23], s34 offen lds
    s_add_u32 m0, s33, 11264
    s_add_u32 s34, s29, 433152
    buffer_load_dwordx4 v6, s[20:23], s34 offen lds
    s_waitcnt vmcnt(32)
    ds_read_b64_tr_b16 v[164:165], v10 offset:12288
    ds_read_b64_tr_b16 v[166:167], v10 offset:14336
    ds_read_b64_tr_b16 v[168:169], v11 offset:12288
    ds_read_b64_tr_b16 v[170:171], v11 offset:14336
    ds_read_b64_tr_b16 v[172:173], v12 offset:12288
    ds_read_b64_tr_b16 v[174:175], v12 offset:14336
    s_waitcnt lgkmcnt(0)
    s_add_u32 m0, s33, 12288
    s_add_u32 s34, s29, 442368
    buffer_load_dwordx4 v5, s[20:23], s34 offen lds
    s_add_u32 m0, s33, 13312
    s_add_u32 s34, s29, 451584
    buffer_load_dwordx4 v6, s[20:23], s34 offen lds
    s_add_u32 m0, s33, 14336
    s_add_u32 s34, s29, 460800
    buffer_load_dwordx4 v5, s[20:23], s34 offen lds
    s_add_u32 m0, s33, 15360
    s_add_u32 s34, s29, 470016
    buffer_load_dwordx4 v6, s[20:23], s34 offen lds
    s_waitcnt vmcnt(32)
    ds_read_b64_tr_b16 v[176:177], v10 offset:16384
    ds_read_b64_tr_b16 v[178:179], v10 offset:18432
    ds_read_b64_tr_b16 v[180:181], v11 offset:16384
    ds_read_b64_tr_b16 v[182:183], v11 offset:18432
    ds_read_b64_tr_b16 v[184:185], v12 offset:16384
    ds_read_b64_tr_b16 v[186:187], v12 offset:18432
    s_waitcnt lgkmcnt(0)
    s_add_u32 m0, s33, 16384
    s_add_u32 s34, s29, 479232
    buffer_load_dwordx4 v5, s[20:23], s34 offen lds
    s_add_u32 m0, s33, 17408
    s_add_u32 s34, s29, 488448
    buffer_load_dwordx4 v6, s[20:23], s34 offen lds
    s_add_u32 m0, s33, 18432
    s_add_u32 s34, s29, 497664
    buffer_load_dwordx4 v5, s[20:23], s34 offen lds
    s_add_u32 m0, s33, 19456
    s_add_u32 s34, s29, 506880
    buffer_load_dwordx4 v6, s[20:23], s34 offen lds
    s_waitcnt vmcnt(32)
    ds_read_b64_tr_b16 v[188:189], v10 offset:20480
    ds_read_b64_tr_b16 v[190:191], v10 offset:22528
    ds_read_b64_tr_b16 v[192:193], v11 offset:20480
    ds_read_b64_tr_b16 v[194:195], v11 offset:22528
    ds_read_b64_tr_b16 v[196:197], v12 offset:20480
    ds_read_b64_tr_b16 v[198:199], v12 offset:22528
    s_waitcnt lgkmcnt(0)
    s_add_u32 m0, s33, 20480
    s_add_u32 s34, s29, 516096
    buffer_load_dwordx4 v5, s[20:23], s34 offen lds
    s_add_u32 m0, s33, 21504
    s_add_u32 s34, s29, 525312
    buffer_load_dwordx4 v6, s[20:23], s34 offen lds
    s_add_u32 m0, s33, 22528
    s_add_u32 s34, s29, 534528
    buffer_load_dwordx4 v5, s[20:23], s34 offen lds
    s_add_u32 m0, s33, 23552
    s_add_u32 s34, s29, 543744
    buffer_load_dwordx4 v6, s[20:23], s34 offen lds
    s_waitcnt vmcnt(32)
    ds_read_b64_tr_b16 v[200:201], v10 offset:24576
    ds_read_b64_tr_b16 v[202:203], v10 offset:26624
    ds_read_b64_tr_b16 v[204:205], v11 offset:24576
    ds_read_b64_tr_b16 v[206:207], v11 offset:26624
    ds_read_b64_tr_b16 v[208:209], v12 offset:24576
    ds_read_b64_tr_b16 v[210:211], v12 offset:26624
    s_waitcnt lgkmcnt(0)
    s_add_u32 m0, s33, 24576
    s_add_u32 s34, s29, 552960
    buffer_load_dwordx4 v5, s[20:23], s34 offen lds
    s_add_u32 m0, s33, 25600
    s_add_u32 s34, s29, 562176
    buffer_load_dwordx4 v6, s[20:23], s34 offen lds
    s_add_u32 m0, s33, 26624
    s_add_u32 s34, s29, 571392
    buffer_load_dwordx4 v5, s[20:23], s34 offen lds
    s_add_u32 m0, s33, 27648
    s_add_u32 s34, s29, 580608
    buffer_load_dwordx4 v6, s[20:23], s34 offen lds
    s_waitcnt vmcnt(32)
    ds_read_b64_tr_b16 v[212:213], v10 offset:28672
    ds_read_b64_tr_b16 v[214:215], v10 offset:30720
    ds_read_b64_tr_b16 v[216:217], v11 offset:28672
    ds_read_b64_tr_b16 v[218:219], v11 offset:30720
    ds_read_b64_tr_b16 v[220:221], v12 offset:28672
    ds_read_b64_tr_b16 v[222:223], v12 offset:30720
    s_waitcnt lgkmcnt(0)
    s_add_u32 m0, s33, 28672
    s_add_u32 s34, s29, 589824
    buffer_load_dwordx4 v5, s[20:23], s34 offen lds
    s_add_u32 m0, s33, 29696
    s_add_u32 s34, s29, 599040
    buffer_load_dwordx4 v6, s[20:23], s34 offen lds
    s_add_u32 m0, s33, 30720
    s_add_u32 s34, s29, 608256
    buffer_load_dwordx4 v5, s[20:23], s34 offen lds
    s_add_u32 m0, s33, 31744
    s_add_u32 s34, s29, 617472
    buffer_load_dwordx4 v6, s[20:23], s34 offen lds
    s_waitcnt vmcnt(32)
    ds_read_b64_tr_b16 v[224:225], v10 offset:32768
    ds_read_b64_tr_b16 v[226:227], v10 offset:34816
    ds_read_b64_tr_b16 v[228:229], v11 offset:32768
    ds_read_b64_tr_b16 v[230:231], v11 offset:34816
    ds_read_b64_tr_b16 v[232:233], v12 offset:32768
    ds_read_b64_tr_b16 v[234:235], v12 offset:34816
    s_waitcnt lgkmcnt(0)
    s_add_u32 m0, s33, 32768
    s_add_u32 s34, s29, 626688
    buffer_load_dwordx4 v5, s[20:23], s34 offen lds
    s_add_u32 m0, s33, 33792
    s_add_u32 s34, s29, 635904
    buffer_load_dwordx4 v6, s[20:23], s34 offen lds
    s_add_u32 m0, s33, 34816
    s_add_u32 s34, s29, 645120
    buffer_load_dwordx4 v5, s[20:23], s34 offen lds
    s_add_u32 m0, s33, 35840
    s_add_u32 s34, s29, 654336
    buffer_load_dwordx4 v6, s[20:23], s34 offen lds
    s_waitcnt vmcnt(32)
    ds_read_b64_tr_b16 v[236:237], v10 offset:0
    ds_read_b64_tr_b16 v[238:239], v10 offset:2048
    ds_read_b64_tr_b16 v[240:241], v11 offset:0
    ds_read_b64_tr_b16 v[242:243], v11 offset:2048
    ds_read_b64_tr_b16 v[244:245], v12 offset:0
    ds_read_b64_tr_b16 v[246:247], v12 offset:2048
    s_waitcnt lgkmcnt(0)
    s_add_u32 m0, s33, 0
    s_add_u32 s34, s29, 663552
    buffer_load_dwordx4 v5, s[20:23], s34 offen lds
    s_add_u32 m0, s33, 1024
    s_add_u32 s34, s29, 672768
    buffer_load_dwordx4 v6, s[20:23], s34 offen lds
    s_add_u32 m0, s33, 2048
    s_add_u32 s34, s29, 681984
    buffer_load_dwordx4 v5, s[20:23], s34 offen lds
    s_add_u32 m0, s33, 3072
    s_add_u32 s34, s29, 691200
    buffer_load_dwordx4 v6, s[20:23], s34 offen lds
    s_waitcnt vmcnt(32)
    ds_read_b64_tr_b16 v[248:249], v10 offset:4096
    ds_read_b64_tr_b16 v[250:251], v10 offset:6144
    ds_read_b64_tr_b16 v[252:253], v11 offset:4096
    ds_read_b64_tr_b16 v[254:255], v11 offset:6144
    ds_read_b64_tr_b16 a[0:1], v12 offset:4096
    ds_read_b64_tr_b16 a[2:3], v12 offset:6144
    s_waitcnt lgkmcnt(0)
    s_add_u32 m0, s33, 4096
    s_add_u32 s34, s29, 700416
    buffer_load_dwordx4 v5, s[20:23], s34 offen lds
    s_add_u32 m0, s33, 5120
    s_add_u32 s34, s29, 709632
    buffer_load_dwordx4 v6, s[20:23], s34 offen lds
    s_add_u32 m0, s33, 6144
    s_add_u32 s34, s29, 718848
    buffer_load_dwordx4 v5, s[20:23], s34 offen lds
    s_add_u32 m0, s33, 7168
    s_add_u32 s34, s29, 728064
    buffer_load_dwordx4 v6, s[20:23], s34 offen lds
    s_waitcnt vmcnt(32)
    ds_read_b64_tr_b16 a[4:5], v10 offset:8192
    ds_read_b64_tr_b16 a[6:7], v10 offset:10240
    ds_read_b64_tr_b16 a[8:9], v11 offset:8192
    ds_read_b64_tr_b16 a[10:11], v11 offset:10240
    ds_read_b64_tr_b16 a[12:13], v12 offset:8192
    ds_read_b64_tr_b16 a[14:15], v12 offset:10240
    s_waitcnt lgkmcnt(0)
    s_add_u32 m0, s33, 8192
    s_add_u32 s34, s29, 737280
    buffer_load_dwordx4 v5, s[20:23], s34 offen lds
    s_add_u32 m0, s33, 9216
    s_add_u32 s34, s29, 746496
    buffer_load_dwordx4 v6, s[20:23], s34 offen lds
    s_add_u32 m0, s33, 10240
    s_add_u32 s34, s29, 755712
    buffer_load_dwordx4 v5, s[20:23], s34 offen lds
    s_add_u32 m0, s33, 11264
    s_add_u32 s34, s29, 764928
    buffer_load_dwordx4 v6, s[20:23], s34 offen lds
    s_waitcnt vmcnt(32)
    ds_read_b64_tr_b16 a[16:17], v10 offset:12288
    ds_read_b64_tr_b16 a[18:19], v10 offset:14336
    ds_read_b64_tr_b16 a[20:21], v11 offset:12288
    ds_read_b64_tr_b16 a[22:23], v11 offset:14336
    ds_read_b64_tr_b16 a[24:25], v12 offset:12288
    ds_read_b64_tr_b16 a[26:27], v12 offset:14336
    s_waitcnt lgkmcnt(0)
    s_add_u32 m0, s33, 12288
    s_add_u32 s34, s29, 774144
    buffer_load_dwordx4 v5, s[20:23], s34 offen lds
    s_add_u32 m0, s33, 13312
    s_add_u32 s34, s29, 783360
    buffer_load_dwordx4 v6, s[20:23], s34 offen lds
    s_add_u32 m0, s33, 14336
    s_add_u32 s34, s29, 792576
    buffer_load_dwordx4 v5, s[20:23], s34 offen lds
    s_add_u32 m0, s33, 15360
    s_add_u32 s34, s29, 801792
    buffer_load_dwordx4 v6, s[20:23], s34 offen lds
    s_waitcnt vmcnt(32)
    ds_read_b64_tr_b16 a[28:29], v10 offset:16384
    ds_read_b64_tr_b16 a[30:31], v10 offset:18432
    ds_read_b64_tr_b16 a[32:33], v11 offset:16384
    ds_read_b64_tr_b16 a[34:35], v11 offset:18432
    ds_read_b64_tr_b16 a[36:37], v12 offset:16384
    ds_read_b64_tr_b16 a[38:39], v12 offset:18432
    s_waitcnt lgkmcnt(0)
    s_add_u32 m0, s33, 16384
    s_add_u32 s34, s29, 811008
    buffer_load_dwordx4 v5, s[20:23], s34 offen lds
    s_add_u32 m0, s33, 17408
    s_add_u32 s34, s29, 820224
    buffer_load_dwordx4 v6, s[20:23], s34 offen lds
    s_add_u32 m0, s33, 18432
    s_add_u32 s34, s29, 829440
    buffer_load_dwordx4 v5, s[20:23], s34 offen lds
    s_add_u32 m0, s33, 19456
    s_add_u32 s34, s29, 838656
    buffer_load_dwordx4 v6, s[20:23], s34 offen lds
    s_waitcnt vmcnt(32)
    ds_read_b64_tr_b16 a[40:41], v10 offset:20480
    ds_read_b64_tr_b16 a[42:43], v10 offset:22528
    ds_read_b64_tr_b16 a[44:45], v11 offset:20480
    ds_read_b64_tr_b16 a[46:47], v11 offset:22528
    ds_read_b64_tr_b16 a[48:49], v12 offset:20480
    ds_read_b64_tr_b16 a[50:51], v12 offset:22528
    s_waitcnt lgkmcnt(0)
    s_add_u32 m0, s33, 20480
    s_add_u32 s34, s29, 847872
    buffer_load_dwordx4 v5, s[20:23], s34 offen lds
    s_add_u32 m0, s33, 21504
    s_add_u32 s34, s29, 857088
    buffer_load_dwordx4 v6, s[20:23], s34 offen lds
    s_add_u32 m0, s33, 22528
    s_add_u32 s34, s29, 866304
    buffer_load_dwordx4 v5, s[20:23], s34 offen lds
    s_add_u32 m0, s33, 23552
    s_add_u32 s34, s29, 875520
    buffer_load_dwordx4 v6, s[20:23], s34 offen lds
    s_waitcnt vmcnt(32)
    ds_read_b64_tr_b16 a[52:53], v10 offset:24576
    ds_read_b64_tr_b16 a[54:55], v10 offset:26624
    ds_read_b64_tr_b16 a[56:57], v11 offset:24576
    ds_read_b64_tr_b16 a[58:59], v11 offset:26624
    ds_read_b64_tr_b16 a[60:61], v12 offset:24576
    ds_read_b64_tr_b16 a[62:63], v12 offset:26624
    s_waitcnt lgkmcnt(0)
    s_add_u32 m0, s33, 24576
    s_add_u32 s34, s29, 884736
    buffer_load_dwordx4 v5, s[20:23], s34 offen lds
    s_add_u32 m0, s33, 25600
    s_add_u32 s34, s29, 893952
    buffer_load_dwordx4 v6, s[20:23], s34 offen lds
    s_add_u32 m0, s33, 26624
    s_add_u32 s34, s29, 903168
    buffer_load_dwordx4 v5, s[20:23], s34 offen lds
    s_add_u32 m0, s33, 27648
    s_add_u32 s34, s29, 912384
    buffer_load_dwordx4 v6, s[20:23], s34 offen lds
    s_waitcnt vmcnt(32)
    ds_read_b64_tr_b16 a[64:65], v10 offset:28672
    ds_read_b64_tr_b16 a[66:67], v10 offset:30720
    ds_read_b64_tr_b16 a[68:69], v11 offset:28672
    ds_read_b64_tr_b16 a[70:71], v11 offset:30720
    ds_read_b64_tr_b16 a[72:73], v12 offset:28672
    ds_read_b64_tr_b16 a[74:75], v12 offset:30720
    s_waitcnt lgkmcnt(0)
    s_add_u32 m0, s33, 28672
    s_add_u32 s34, s29, 921600
    buffer_load_dwordx4 v5, s[20:23], s34 offen lds
    s_add_u32 m0, s33, 29696
    s_add_u32 s34, s29, 930816
    buffer_load_dwordx4 v6, s[20:23], s34 offen lds
    s_add_u32 m0, s33, 30720
    s_add_u32 s34, s29, 940032
    buffer_load_dwordx4 v5, s[20:23], s34 offen lds
    s_add_u32 m0, s33, 31744
    s_add_u32 s34, s29, 949248
    buffer_load_dwordx4 v6, s[20:23], s34 offen lds
    s_waitcnt vmcnt(32)
    ds_read_b64_tr_b16 a[76:77], v10 offset:32768
    ds_read_b64_tr_b16 a[78:79], v10 offset:34816
    ds_read_b64_tr_b16 a[80:81], v11 offset:32768
    ds_read_b64_tr_b16 a[82:83], v11 offset:34816
    ds_read_b64_tr_b16 a[84:85], v12 offset:32768
    ds_read_b64_tr_b16 a[86:87], v12 offset:34816
    s_waitcnt lgkmcnt(0)
    s_add_u32 m0, s33, 32768
    s_add_u32 s34, s29, 958464
    buffer_load_dwordx4 v5, s[20:23], s34 offen lds
    s_add_u32 m0, s33, 33792
    s_add_u32 s34, s29, 967680
    buffer_load_dwordx4 v6, s[20:23], s34 offen lds
    s_add_u32 m0, s33, 34816
    s_add_u32 s34, s29, 976896
    buffer_load_dwordx4 v5, s[20:23], s34 offen lds
    s_add_u32 m0, s33, 35840
    s_add_u32 s34, s29, 986112
    buffer_load_dwordx4 v6, s[20:23], s34 offen lds
    s_waitcnt vmcnt(32)
    ds_read_b64_tr_b16 a[88:89], v10 offset:0
    ds_read_b64_tr_b16 a[90:91], v10 offset:2048
    ds_read_b64_tr_b16 a[92:93], v11 offset:0
    ds_read_b64_tr_b16 a[94:95], v11 offset:2048
    ds_read_b64_tr_b16 a[96:97], v12 offset:0
    ds_read_b64_tr_b16 a[98:99], v12 offset:2048
    s_waitcnt lgkmcnt(0)
    s_add_u32 m0, s33, 0
    s_add_u32 s34, s29, 995328
    buffer_load_dwordx4 v5, s[20:23], s34 offen lds
    s_add_u32 m0, s33, 1024
    s_add_u32 s34, s29, 1004544
    buffer_load_dwordx4 v6, s[20:23], s34 offen lds
    s_add_u32 m0, s33, 2048
    s_add_u32 s34, s29, 1013760
    buffer_load_dwordx4 v5, s[20:23], s34 offen lds
    s_add_u32 m0, s33, 3072
    s_add_u32 s34, s29, 1022976
    buffer_load_dwordx4 v6, s[20:23], s34 offen lds
    s_waitcnt vmcnt(32)
    ds_read_b64_tr_b16 a[100:101], v10 offset:4096
    ds_read_b64_tr_b16 a[102:103], v10 offset:6144
    ds_read_b64_tr_b16 a[104:105], v11 offset:4096
    ds_read_b64_tr_b16 a[106:107], v11 offset:6144
    ds_read_b64_tr_b16 a[108:109], v12 offset:4096
    ds_read_b64_tr_b16 a[110:111], v12 offset:6144
    s_waitcnt lgkmcnt(0)
    s_add_u32 m0, s33, 4096
    s_add_u32 s34, s29, 1032192
    buffer_load_dwordx4 v5, s[20:23], s34 offen lds
    s_add_u32 m0, s33, 5120
    s_add_u32 s34, s29, 1041408
    buffer_load_dwordx4 v6, s[20:23], s34 offen lds
    s_add_u32 m0, s33, 6144
    s_add_u32 s34, s29, 1050624
    buffer_load_dwordx4 v5, s[20:23], s34 offen lds
    s_add_u32 m0, s33, 7168
    s_add_u32 s34, s29, 1059840
    buffer_load_dwordx4 v6, s[20:23], s34 offen lds
    s_waitcnt vmcnt(32)
    ds_read_b64_tr_b16 a[112:113], v10 offset:8192
    ds_read_b64_tr_b16 a[114:115], v10 offset:10240
    ds_read_b64_tr_b16 a[116:117], v11 offset:8192
    ds_read_b64_tr_b16 a[118:119], v11 offset:10240
    ds_read_b64_tr_b16 a[120:121], v12 offset:8192
    ds_read_b64_tr_b16 a[122:123], v12 offset:10240
    s_waitcnt lgkmcnt(0)
    s_add_u32 m0, s33, 8192
    s_add_u32 s34, s29, 1069056
    buffer_load_dwordx4 v5, s[20:23], s34 offen lds
    s_add_u32 m0, s33, 9216
    s_add_u32 s34, s29, 1078272
    buffer_load_dwordx4 v6, s[20:23], s34 offen lds
    s_add_u32 m0, s33, 10240
    s_add_u32 s34, s29, 1087488
    buffer_load_dwordx4 v5, s[20:23], s34 offen lds
    s_add_u32 m0, s33, 11264
    s_add_u32 s34, s29, 1096704
    buffer_load_dwordx4 v6, s[20:23], s34 offen lds
    s_waitcnt vmcnt(32)
    ds_read_b64_tr_b16 a[124:125], v10 offset:12288
    ds_read_b64_tr_b16 a[126:127], v10 offset:14336
    ds_read_b64_tr_b16 a[128:129], v11 offset:12288
    ds_read_b64_tr_b16 a[130:131], v11 offset:14336
    ds_read_b64_tr_b16 a[132:133], v12 offset:12288
    ds_read_b64_tr_b16 a[134:135], v12 offset:14336
    s_waitcnt lgkmcnt(0)
    s_add_u32 m0, s33, 12288
    s_add_u32 s34, s29, 1105920
    buffer_load_dwordx4 v5, s[20:23], s34 offen lds
    s_add_u32 m0, s33, 13312
    s_add_u32 s34, s29, 1115136
    buffer_load_dwordx4 v6, s[20:23], s34 offen lds
    s_add_u32 m0, s33, 14336
    s_add_u32 s34, s29, 1124352
    buffer_load_dwordx4 v5, s[20:23], s34 offen lds
    s_add_u32 m0, s33, 15360
    s_add_u32 s34, s29, 1133568
    buffer_load_dwordx4 v6, s[20:23], s34 offen lds
    s_waitcnt vmcnt(32)
    ds_read_b64_tr_b16 a[136:137], v10 offset:16384
    ds_read_b64_tr_b16 a[138:139], v10 offset:18432
    ds_read_b64_tr_b16 a[140:141], v11 offset:16384
    ds_read_b64_tr_b16 a[142:143], v11 offset:18432
    ds_read_b64_tr_b16 a[144:145], v12 offset:16384
    ds_read_b64_tr_b16 a[146:147], v12 offset:18432
    s_waitcnt lgkmcnt(0)
    s_add_u32 m0, s33, 16384
    s_add_u32 s34, s29, 1142784
    buffer_load_dwordx4 v5, s[20:23], s34 offen lds
    s_add_u32 m0, s33, 17408
    s_add_u32 s34, s29, 1152000
    buffer_load_dwordx4 v6, s[20:23], s34 offen lds
    s_add_u32 m0, s33, 18432
    s_add_u32 s34, s29, 1161216
    buffer_load_dwordx4 v5, s[20:23], s34 offen lds
    s_add_u32 m0, s33, 19456
    s_add_u32 s34, s29, 1170432
    buffer_load_dwordx4 v6, s[20:23], s34 offen lds
    s_waitcnt vmcnt(32)
    ds_read_b64_tr_b16 a[148:149], v10 offset:20480
    ds_read_b64_tr_b16 a[150:151], v10 offset:22528
    ds_read_b64_tr_b16 a[152:153], v11 offset:20480
    ds_read_b64_tr_b16 a[154:155], v11 offset:22528
    ds_read_b64_tr_b16 a[156:157], v12 offset:20480
    ds_read_b64_tr_b16 a[158:159], v12 offset:22528
    s_waitcnt lgkmcnt(0)
    s_waitcnt vmcnt(28)
    ds_read_b64_tr_b16 a[160:161], v10 offset:24576
    ds_read_b64_tr_b16 a[162:163], v10 offset:26624
    ds_read_b64_tr_b16 a[164:165], v11 offset:24576
    ds_read_b64_tr_b16 a[166:167], v11 offset:26624
    ds_read_b64_tr_b16 a[168:169], v12 offset:24576
    ds_read_b64_tr_b16 a[170:171], v12 offset:26624
    s_waitcnt lgkmcnt(0)
    s_waitcnt vmcnt(24)
    ds_read_b64_tr_b16 a[172:173], v10 offset:28672
    ds_read_b64_tr_b16 a[174:175], v10 offset:30720
    ds_read_b64_tr_b16 a[176:177], v11 offset:28672
    ds_read_b64_tr_b16 a[178:179], v11 offset:30720
    ds_read_b64_tr_b16 a[180:181], v12 offset:28672
    ds_read_b64_tr_b16 a[182:183], v12 offset:30720
    s_waitcnt lgkmcnt(0)
    s_waitcnt vmcnt(20)
    ds_read_b64_tr_b16 a[184:185], v10 offset:32768
    ds_read_b64_tr_b16 a[186:187], v10 offset:34816
    ds_read_b64_tr_b16 a[188:189], v11 offset:32768
    ds_read_b64_tr_b16 a[190:191], v11 offset:34816
    ds_read_b64_tr_b16 a[192:193], v12 offset:32768
    ds_read_b64_tr_b16 a[194:195], v12 offset:34816
    s_waitcnt lgkmcnt(0)
    s_waitcnt vmcnt(16)
    ds_read_b64_tr_b16 a[196:197], v10 offset:0
    ds_read_b64_tr_b16 a[198:199], v10 offset:2048
    ds_read_b64_tr_b16 a[200:201], v11 offset:0
    ds_read_b64_tr_b16 a[202:203], v11 offset:2048
    ds_read_b64_tr_b16 a[204:205], v12 offset:0
    ds_read_b64_tr_b16 a[206:207], v12 offset:2048
    s_waitcnt lgkmcnt(0)
    s_waitcnt vmcnt(12)
    ds_read_b64_tr_b16 a[208:209], v10 offset:4096
    ds_read_b64_tr_b16 a[210:211], v10 offset:6144
    ds_read_b64_tr_b16 a[212:213], v11 offset:4096
    ds_read_b64_tr_b16 a[214:215], v11 offset:6144
    ds_read_b64_tr_b16 a[216:217], v12 offset:4096
    ds_read_b64_tr_b16 a[218:219], v12 offset:6144
    s_waitcnt lgkmcnt(0)
    s_waitcnt vmcnt(8)
    ds_read_b64_tr_b16 a[220:221], v10 offset:8192
    ds_read_b64_tr_b16 a[222:223], v10 offset:10240
    ds_read_b64_tr_b16 a[224:225], v11 offset:8192
    ds_read_b64_tr_b16 a[226:227], v11 offset:10240
    ds_read_b64_tr_b16 a[228:229], v12 offset:8192
    ds_read_b64_tr_b16 a[230:231], v12 offset:10240
    s_waitcnt lgkmcnt(0)
    s_waitcnt vmcnt(4)
    ds_read_b64_tr_b16 a[232:233], v10 offset:12288
    ds_read_b64_tr_b16 a[234:235], v10 offset:14336
    ds_read_b64_tr_b16 a[236:237], v11 offset:12288
    ds_read_b64_tr_b16 a[238:239], v11 offset:14336
    ds_read_b64_tr_b16 a[240:241], v12 offset:12288
    ds_read_b64_tr_b16 a[242:243], v12 offset:14336
    s_waitcnt lgkmcnt(0)
    s_waitcnt vmcnt(0)
    ds_read_b64_tr_b16 a[244:245], v10 offset:16384
    ds_read_b64_tr_b16 a[246:247], v10 offset:18432
    ds_read_b64_tr_b16 a[248:249], v11 offset:16384
    ds_read_b64_tr_b16 a[250:251], v11 offset:18432
    ds_read_b64_tr_b16 a[252:253], v12 offset:16384
    ds_read_b64_tr_b16 a[254:255], v12 offset:18432
    s_waitcnt lgkmcnt(0)
    v_lshlrev_b32 v4, 4, v1
    s_mul_i32 s33, s28, 3072
    v_add_u32 v5, s33, v4
    s_lshl_b32 s33, s28, 10
    v_add_u32 v6, s33, v4
    v_mul_u32_u24 v7, 2304, v3
    v_lshl_add_u32 v7, v2, 3, v7
L_b3_loop:
    s_cmp_ge_u32 s30, 128
    s_cbranch_scc1 L_b3_done
    s_lshr_b32 s34, s30, 1
    s_lshl_b32 s34, s34, 7
    s_add_u32 s34, s34, 0x182000
    s_mov_b32 s39, 0
    v_mov_b32 v12, s34
L_poll_13:
    buffer_load_dword v13, v12, s[8:11], 0 offen sc1
    s_add_u32 s39, s39, 1
    s_cmp_gt_u32 s39, 4000000
    s_cbranch_scc1 L_fail
    s_waitcnt vmcnt(0)
    v_readfirstlane_b32 s33, v13
    s_nop 0
    s_cmp_ge_u32 s33, 32
    s_cbranch_scc1 L_poll_13_d
    s_sleep 1
    s_branch L_poll_13
L_poll_13_d:
    s_lshl_b32 s33, s30, 2
    s_add_u32 s33, s33, s28
    s_lshl_b32 s33, s33, 15
    s_add_u32 s33, s33, 0x5000000
    buffer_load_dwordx4 v[32:35], v4, s[8:11], s33 offen offset:0 sc1
    buffer_load_dwordx4 v[36:39], v4, s[8:11], s33 offen offset:1024 sc1
    buffer_load_dwordx4 v[40:43], v4, s[8:11], s33 offen offset:2048 sc1
    buffer_load_dwordx4 v[44:47], v4, s[8:11], s33 offen offset:3072 sc1
    s_add_u32 s33, s33, 4096
    buffer_load_dwordx4 v[48:51], v4, s[8:11], s33 offen offset:0 sc1
    buffer_load_dwordx4 v[52:55], v4, s[8:11], s33 offen offset:1024 sc1
    buffer_load_dwordx4 v[56:59], v4, s[8:11], s33 offen offset:2048 sc1
    buffer_load_dwordx4 v[60:63], v4, s[8:11], s33 offen offset:3072 sc1
    s_add_u32 s33, s33, 4096
    buffer_load_dwordx4 v[64:67], v4, s[8:11], s33 offen offset:0 sc1
    buffer_load_dwordx4 v[68:71], v4, s[8:11], s33 offen offset:1024 sc1
    buffer_load_dwordx4 v[72:75], v4, s[8:11], s33 offen offset:2048 sc1
    buffer_load_dwordx4 v[76:79], v4, s[8:11], s33 offen offset:3072 sc1
    s_add_u32 s33, s33, 4096
    buffer_load_dwordx4 v[80:83], v4, s[8:11], s33 offen offset:0 sc1
    buffer_load_dwordx4 v[84:87], v4, s[8:11], s33 offen offset:1024 sc1
    buffer_load_dwordx4 v[88:91], v4, s[8:11], s33 offen offset:2048 sc1
    buffer_load_dwordx4 v[92:95], v4, s[8:11], s33 offen offset:3072 sc1
    s_add_u32 s33, s33, 4096
    buffer_load_dwordx4 v[96:99], v4, s[8:11], s33 offen offset:0 sc1
    buffer_load_dwordx4 v[100:103], v4, s[8:11], s33 offen offset:1024 sc1
    buffer_load_dwordx4 v[104:107], v4, s[8:11], s33 offen offset:2048 sc1
    buffer_load_dwordx4 v[108:111], v4, s[8:11], s33 offen offset:3072 sc1
    s_waitcnt vmcnt(19)
    v_mfma_f32_16x16x32_bf16 v[16:19], v[128:131], v[32:35], 0
    v_mfma_f32_16x16x32_bf16 v[20:23], v[132:135], v[32:35], 0
    v_mfma_f32_16x16x32_bf16 v[24:27], v[136:139], v[32:35], 0
    s_add_u32 s33, s33, 4096
    buffer_load_dwordx4 v[32:35], v4, s[8:11], s33 offen offset:0 sc1
    s_waitcnt vmcnt(19)
    v_mfma_f32_16x16x32_bf16 v[16:19], v[140:143], v[36:39], v[16:19]
    v_mfma_f32_16x16x32_bf16 v[20:23], v[144:147], v[36:39], v[20:23]
    v_mfma_f32_16x16x32_bf16 v[24:27], v[148:151], v[36:39], v[24:27]
    buffer_load_dwordx4 v[36:39], v4, s[8:11], s33 offen offset:1024 sc1
    s_waitcnt vmcnt(19)
    v_mfma_f32_16x16x32_bf16 v[16:19], v[152:155], v[40:43], v[16:19]
    v_mfma_f32_16x16x32_bf16 v[20:23], v[156:159], v[40:43], v[20:23]
    v_mfma_f32_16x16x32_bf16 v[24:27], v[160:163], v[40:43], v[24:27]
    buffer_load_dwordx4 v[40:43], v4, s[8:11], s33 offen offset:2048 sc1
    s_waitcnt vmcnt(19)
    v_mfma_f32_16x16x32_bf16 v[16:19], v[164:167], v[44:47], v[16:19]
    v_mfma_f32_16x16x32_bf16 v[20:23], v[168:171], v[44:47], v[20:23]
    v_mfma_f32_16x16x32_bf16 v[24:27], v[172:175], v[44:47], v[24:27]
    buffer_load_dwordx4 v[44:47], v4, s[8:11], s33 offen offset:3072 sc1
    s_waitcnt vmcnt(19)
    v_mfma_f32_16x16x32_bf16 v[16:19], v[176:179], v[48:51], v[16:19]
    v_mfma_f32_16x16x32_bf16 v[20:23], v[180:183], v[48:51], v[20:23]
    v_mfma_f32_16x16x32_bf16 v[24:27], v[184:187], v[48:51], v[24:27]
    s_add_u32 s33, s33, 4096
    buffer_load_dwordx4 v[48:51], v4, s[8:11], s33 offen offset:0 sc1
    s_waitcnt vmcnt(19)
    v_mfma_f32_16x16x32_bf16 v[16:19], v[188:191], v[52:55], v[16:19]
    v_mfma_f32_16x16x32_bf16 v[20:23], v[192:195], v[52:55], v[20:23]
    v_mfma_f32_16x16x32_bf16 v[24:27], v[196:199], v[52:55], v[24:27]
    buffer_load_dwordx4 v[52:55], v4, s[8:11], s33 offen offset:1024 sc1
    s_waitcnt vmcnt(19)
    v_mfma_f32_16x16x32_bf16 v[16:19], v[200:203], v[56:59], v[16:19]
    v_mfma_f32_16x16x32_bf16 v[20:23], v[204:207], v[56:59], v[20:23]
    v_mfma_f32_16x16x32_bf16 v[24:27], v[208:211], v[56:59], v[24:27]
    buffer_load_dwordx4 v[56:59], v4, s[8:11], s33 offen offset:2048 sc1
    s_waitcnt vmcnt(19)
    v_mfma_f32_16x16x32_bf16 v[16:19], v[212:215], v[60:63], v[16:19]
    v_mfma_f32_16x16x32_bf16 v[20:23], v[216:219], v[60:63], v[20:23]
    v_mfma_f32_16x16x32_bf16 v[24:27], v[220:223], v[60:63], v[24:27]
    buffer_load_dwordx4 v[60:63], v4, s[8:11], s33 offen offset:3072 sc1
    s_waitcnt vmcnt(19)
    v_mfma_f32_16x16x32_bf16 v[16:19], v[224:227], v[64:67], v[16:19]
    v_mfma_f32_16x16x32_bf16 v[20:23], v[228:231], v[64:67], v[20:23]
    v_mfma_f32_16x16x32_bf16 v[24:27], v[232:235], v[64:67], v[24:27]
    s_add_u32 s33, s33, 4096
    buffer_load_dwordx4 v[64:67], v4, s[8:11], s33 offen offset:0 sc1
    s_waitcnt vmcnt(19)
    v_mfma_f32_16x16x32_bf16 v[16:19], v[236:239], v[68:71], v[16:19]
    v_mfma_f32_16x16x32_bf16 v[20:23], v[240:243], v[68:71], v[20:23]
    v_mfma_f32_16x16x32_bf16 v[24:27], v[244:247], v[68:71], v[24:27]
    buffer_load_dwordx4 v[68:71], v4, s[8:11], s33 offen offset:1024 sc1
    s_waitcnt vmcnt(19)
    v_mfma_f32_16x16x32_bf16 v[16:19], v[248:251], v[72:75], v[16:19]
    v_mfma_f32_16x16x32_bf16 v[20:23], v[252:255], v[72:75], v[20:23]
    v_mfma_f32_16x16x32_bf16 v[24:27], a[0:3], v[72:75], v[24:27]
    buffer_load_dwordx4 v[72:75], v4, s[8:11], s33 offen offset:2048 sc1
    s_waitcnt vmcnt(19)
    v_mfma_f32_16x16x32_bf16 v[16:19], a[4:7], v[76:79], v[16:19]
    v_mfma_f32_16x16x32_bf16 v[20:23], a[8:11], v[76:79], v[20:23]
    v_mfma_f32_16x16x32_bf16 v[24:27], a[12:15], v[76:79], v[24:27]
    buffer_load_dwordx4 v[76:79], v4, s[8:11], s33 offen offset:3072 sc1
    s_waitcnt vmcnt(19)
    v_mfma_f32_16x16x32_bf16 v[16:19], a[16:19], v[80:83], v[16:19]
    v_mfma_f32_16x16x32_bf16 v[20:23], a[20:23], v[80:83], v[20:23]
    v_mfma_f32_16x16x32_bf16 v[24:27], a[24:27], v[80:83], v[24:27]
    s_waitcnt vmcnt(18)
    v_mfma_f32_16x16x32_bf16 v[16:19], a[28:31], v[84:87], v[16:19]
    v_mfma_f32_16x16x32_bf16 v[20:23], a[32:35], v[84:87], v[20:23]
    v_mfma_f32_16x16x32_bf16 v[24:27], a[36:39], v[84:87], v[24:27]
    s_waitcnt vmcnt(17)
    v_mfma_f32_16x16x32_bf16 v[16:19], a[40:43], v[88:91], v[16:19]
    v_mfma_f32_16x16x32_bf16 v[20:23], a[44:47], v[88:91], v[20:23]
    v_mfma_f32_16x16x32_bf16 v[24:27], a[48:51], v[88:91], v[24:27]
    s_waitcnt vmcnt(16)
    v_mfma_f32_16x16x32_bf16 v[16:19], a[52:55], v[92:95], v[16:19]
    v_mfma_f32_16x16x32_bf16 v[20:23], a[56:59], v[92:95], v[20:23]
    v_mfma_f32_16x16x32_bf16 v[24:27], a[60:63], v[92:95], v[24:27]
    s_waitcnt vmcnt(15)
    v_mfma_f32_16x16x32_bf16 v[16:19], a[64:67], v[96:99], v[16:19]
    v_mfma_f32_16x16x32_bf16 v[20:23], a[68:71], v[96:99], v[20:23]
    v_mfma_f32_16x16x32_bf16 v[24:27], a[72:75], v[96:99], v[24:27]
    s_waitcnt vmcnt(14)
    v_mfma_f32_16x16x32_bf16 v[16:19], a[76:79], v[100:103], v[16:19]
    v_mfma_f32_16x16x32_bf16 v[20:23], a[80:83], v[100:103], v[20:23]
    v_mfma_f32_16x16x32_bf16 v[24:27], a[84:87], v[100:103], v[24:27]
    s_waitcnt vmcnt(13)
    v_mfma_f32_16x16x32_bf16 v[16:19], a[88:91], v[104:107], v[16:19]
    v_mfma_f32_16x16x32_bf16 v[20:23], a[92:95], v[104:107], v[20:23]
    v_mfma_f32_16x16x32_bf16 v[24:27], a[96:99], v[104:107], v[24:27]
    s_waitcnt vmcnt(12)
    v_mfma_f32_16x16x32_bf16 v[16:19], a[100:103], v[108:111], v[16:19]
    v_mfma_f32_16x16x32_bf16 v[20:23], a[104:107], v[108:111], v[20:23]
    v_mfma_f32_16x16x32_bf16 v[24:27], a[108:111], v[108:111], v[24:27]
    s_waitcnt vmcnt(11)
    v_mfma_f32_16x16x32_bf16 v[16:19], a[112:115], v[32:35], v[16:19]
    v_mfma_f32_16x16x32_bf16 v[20:23], a[116:119], v[32:35], v[20:23]
    v_mfma_f32_16x16x32_bf16 v[24:27], a[120:123], v[32:35], v[24:27]
    s_waitcnt vmcnt(10)
    v_mfma_f32_16x16x32_bf16 v[16:19], a[124:127], v[36:39], v[16:19]
    v_mfma_f32_16x16x32_bf16 v[20:23], a[128:131], v[36:39], v[20:23]
    v_mfma_f32_16x16x32_bf16 v[24:27], a[132:135], v[36:39], v[24:27]
    s_waitcnt vmcnt(9)
    v_mfma_f32_16x16x32_bf16 v[16:19], a[136:139], v[40:43], v[16:19]
    v_mfma_f32_16x16x32_bf16 v[20:23], a[140:143], v[40:43], v[20:23]
    v_mfma_f32_16x16x32_bf16 v[24:27], a[144:147], v[40:43], v[24:27]
    s_waitcnt vmcnt(8)
    v_mfma_f32_16x16x32_bf16 v[16:19], a[148:151], v[44:47], v[16:19]
    v_mfma_f32_16x16x32_bf16 v[20:23], a[152:155], v[44:47], v[20:23]
    v_mfma_f32_16x16x32_bf16 v[24:27], a[156:159], v[44:47], v[24:27]
    s_waitcnt vmcnt(7)
    v_mfma_f32_16x16x32_bf16 v[16:19], a[160:163], v[48:51], v[16:19]
    v_mfma_f32_16x16x32_bf16 v[20:23], a[164:167], v[48:51], v[20:23]
    v_mfma_f32_16x16x32_bf16 v[24:27], a[168:171], v[48:51], v[24:27]
    s_waitcnt vmcnt(6)
    v_mfma_f32_16x16x32_bf16 v[16:19], a[172:175], v[52:55], v[16:19]
    v_mfma_f32_16x16x32_bf16 v[20:23], a[176:179], v[52:55], v[20:23]
    v_mfma_f32_16x16x32_bf16 v[24:27], a[180:183], v[52:55], v[24:27]
    s_waitcnt vmcnt(5)
    v_mfma_f32_16x16x32_bf16 v[16:19], a[184:187], v[56:59], v[16:19]
    v_mfma_f32_16x16x32_bf16 v[20:23], a[188:191], v[56:59], v[20:23]
    v_mfma_f32_16x16x32_bf16 v[24:27], a[192:195], v[56:59], v[24:27]
    s_waitcnt vmcnt(4)
    v_mfma_f32_16x16x32_bf16 v[16:19], a[196:199], v[60:63], v[16:19]
    v_mfma_f32_16x16x32_bf16 v[20:23], a[200:203], v[60:63], v[20:23]
    v_mfma_f32_16x16x32_bf16 v[24:27], a[204:207], v[60:63], v[24:27]
    s_waitcnt vmcnt(3)
    v_mfma_f32_16x16x32_bf16 v[16:19], a[208:211], v[64:67], v[16:19]
    v_mfma_f32_16x16x32_bf16 v[20:23], a[212:215], v[64:67], v[20:23]
    v_mfma_f32_16x16x32_bf16 v[24:27], a[216:219], v[64:67], v[24:27]
    s_waitcnt vmcnt(2)
    v_mfma_f32_16x16x32_bf16 v[16:19], a[220:223], v[68:71], v[16:19]
    v_mfma_f32_16x16x32_bf16 v[20:23], a[224:227], v[68:71], v[20:23]
    v_mfma_f32_16x16x32_bf16 v[24:27], a[228:231], v[68:71], v[24:27]
    s_waitcnt vmcnt(1)
    v_mfma_f32_16x16x32_bf16 v[16:19], a[232:235], v[72:75], v[16:19]
    v_mfma_f32_16x16x32_bf16 v[20:23], a[236:239], v[72:75], v[20:23]
    v_mfma_f32_16x16x32_bf16 v[24:27], a[240:243], v[72:75], v[24:27]
    s_waitcnt vmcnt(0)
    v_mfma_f32_16x16x32_bf16 v[16:19], a[244:247], v[76:79], v[16:19]
    v_mfma_f32_16x16x32_bf16 v[20:23], a[248:251], v[76:79], v[20:23]
    v_mfma_f32_16x16x32_bf16 v[24:27], a[252:255], v[76:79], v[24:27]
    s_barrier
    ds_write_b128 v5, v[16:19] offset:0
    s_nop 1
    ds_write_b128 v5, v[20:23] offset:1024
    s_nop 2
    ds_write_b128 v5, v[24:27] offset:2048
    s_waitcnt lgkmcnt(0)
    s_barrier
    s_cmp_eq_u32 s28, 3
    s_cbranch_scc1 L_b3_next
    ds_read_b128 v[32:35], v6 offset:0
    ds_read_b128 v[36:39], v6 offset:3072
    ds_read_b128 v[40:43], v6 offset:6144
    ds_read_b128 v[44:47], v6 offset:9216
    s_mul_i32 s33, s30, 36864
    s_mul_i32 s34, s40, 96
    s_add_u32 s33, s33, s34
    s_lshl_b32 s34, s28, 5
    s_add_u32 s33, s33, s34
    s_waitcnt lgkmcnt(0)
    v_add_f32 v32, v32, v36
    v_add_f32 v40, v40, v44
    v_add_f32 v32, v32, v40
    v_add_f32 v33, v33, v37
    v_add_f32 v41, v41, v45
    v_add_f32 v33, v33, v41
    v_add_f32 v34, v34, v38
    v_add_f32 v42, v42, v46
    v_add_f32 v34, v34, v42
    v_add_f32 v35, v35, v39
    v_add_f32 v43, v43, v47
    v_add_f32 v35, v35, v43
    v_cvt_pk_bf16_f32 v28, v32, v33
    v_cvt_pk_bf16_f32 v29, v34, v35
    buffer_store_dwordx2 v[28:29], v7, s[16:19], s33 offen offset:1152
L_b3_next:
    s_add_u32 s30, s30, 8
    s_nop 0
    s_branch L_b3_loop
L_b3_done:
    s_branch L_end
L_chain:
    s_lshr_b32 s36, s2, 3
    s_load_dwordx4 s[92:95], s[0:1], 32
    s_load_dwordx4 s[96:99], s[0:1], 48
    s_load_dwordx2 s[100:101], s[0:1], 64
    s_load_dwordx4 s[4:7], s[0:1], 88
    v_lshrrev_b32 v16, 6, v0
    v_and_b32 v17, 63, v0
    v_readfirstlane_b32 s37, v16
    s_waitcnt lgkmcnt(0)
    s_mov_b32 s16, s94
    s_and_b32 s17, s95, 0xffff
    s_mov_b32 s18, 0x480000
    s_mov_b32 s19, 0x20000
    v_lshrrev_b32 v18, 4, v17
    v_and_b32 v19, 15, v17
    v_and_b32 v24, 1, v18
    v_lshlrev_b32 v24, 1, v24
    v_xor_b32 v24, v24, v19
    s_and_b32 s43, s37, 1
    s_lshl_b32 s43, s43, 3
    v_xor_b32 v24, s43, v24
    v_lshlrev_b32 v25, 13, v18
    v_lshl_add_u32 v48, v24, 4, v25
    v_xor_b32 v24, 4, v24
    v_lshl_add_u32 v49, v24, 4, v25
    s_lshl_b32 s44, s37, 15
    s_add_u32 s44, s44, 32768
    s_lshl_b32 s45, s36, 8
    s_lshl_b32 s43, s37, 17
    s_add_u32 s45, s45, s43
    s_add_u32 m0, s44, 16384
    s_add_u32 s43, s45, 0x0
    buffer_load_dwordx4 v48, s[16:19], s43 offen lds
    s_add_u32 m0, s44, 17408
    s_add_u32 s43, s45, 0x8000
    buffer_load_dwordx4 v49, s[16:19], s43 offen lds
    s_add_u32 m0, s44, 18432
    s_add_u32 s43, s45, 0x10000
    buffer_load_dwordx4 v48, s[16:19], s43 offen lds
    s_add_u32 m0, s44, 19456
    s_add_u32 s43, s45, 0x18000
    buffer_load_dwordx4 v49, s[16:19], s43 offen lds
    s_add_u32 m0, s44, 20480
    s_add_u32 s43, s45, 0x80000
    buffer_load_dwordx4 v48, s[16:19], s43 offen lds
    s_add_u32 m0, s44, 21504
    s_add_u32 s43, s45, 0x88000
    buffer_load_dwordx4 v49, s[16:19], s43 offen lds
    s_add_u32 m0, s44, 22528
    s_add_u32 s43, s45, 0x90000
    buffer_load_dwordx4 v48, s[16:19], s43 offen lds
    s_add_u32 m0, s44, 23552
    s_add_u32 s43, s45, 0x98000
    buffer_load_dwordx4 v49, s[16:19], s43 offen lds
    s_add_u32 m0, s44, 24576
    s_add_u32 s43, s45, 0x100000
    buffer_load_dwordx4 v48, s[16:19], s43 offen lds
    s_add_u32 m0, s44, 25600
    s_add_u32 s43, s45, 0x108000
    buffer_load_dwordx4 v49, s[16:19], s43 offen lds
    s_add_u32 m0, s44, 26624
    s_add_u32 s43, s45, 0x110000
    buffer_load_dwordx4 v48, s[16:19], s43 offen lds
    s_add_u32 m0, s44, 27648
    s_add_u32 s43, s45, 0x118000
    buffer_load_dwordx4 v49, s[16:19], s43 offen lds
    s_add_u32 m0, s44, 28672
    s_add_u32 s43, s45, 0x180000
    buffer_load_dwordx4 v48, s[16:19], s43 offen lds
    s_add_u32 m0, s44, 29696
    s_add_u32 s43, s45, 0x188000
    buffer_load_dwordx4 v49, s[16:19], s43 offen lds
    s_add_u32 m0, s44, 30720
    s_add_u32 s43, s45, 0x190000
    buffer_load_dwordx4 v48, s[16:19], s43 offen lds
    s_add_u32 m0, s44, 31744
    s_add_u32 s43, s45, 0x198000
    buffer_load_dwordx4 v49, s[16:19], s43 offen lds
    s_add_u32 m0, s44, 0
    s_add_u32 s43, s45, 0x200000
    buffer_load_dwordx4 v48, s[16:19], s43 offen lds
    s_add_u32 m0, s44, 1024
    s_add_u32 s43, s45, 0x208000
    buffer_load_dwordx4 v49, s[16:19], s43 offen lds
    s_add_u32 m0, s44, 2048
    s_add_u32 s43, s45, 0x210000
    buffer_load_dwordx4 v48, s[16:19], s43 offen lds
    s_add_u32 m0, s44, 3072
    s_add_u32 s43, s45, 0x218000
    buffer_load_dwordx4 v49, s[16:19], s43 offen lds
    s_add_u32 m0, s44, 4096
    s_add_u32 s43, s45, 0x280000
    buffer_load_dwordx4 v48, s[16:19], s43 offen lds
    s_add_u32 m0, s44, 5120
    s_add_u32 s43, s45, 0x288000
    buffer_load_dwordx4 v49, s[16:19], s43 offen lds
    s_add_u32 m0, s44, 6144
    s_add_u32 s43, s45, 0x290000
    buffer_load_dwordx4 v48, s[16:19], s43 offen lds
    s_add_u32 m0, s44, 7168
    s_add_u32 s43, s45, 0x298000
    buffer_load_dwordx4 v49, s[16:19], s43 offen lds
    s_add_u32 m0, s44, 8192
    s_add_u32 s43, s45, 0x300000
    buffer_load_dwordx4 v48, s[16:19], s43 offen lds
    s_add_u32 m0, s44, 9216
    s_add_u32 s43, s45, 0x308000
    buffer_load_dwordx4 v49, s[16:19], s43 offen lds
    s_add_u32 m0, s44, 10240
    s_add_u32 s43, s45, 0x310000
    buffer_load_dwordx4 v48, s[16:19], s43 offen lds
    s_add_u32 m0, s44, 11264
    s_add_u32 s43, s45, 0x318000
    buffer_load_dwordx4 v49, s[16:19], s43 offen lds
    s_add_u32 m0, s44, 12288
    s_add_u32 s43, s45, 0x380000
    buffer_load_dwordx4 v48, s[16:19], s43 offen lds
    s_add_u32 m0, s44, 13312
    s_add_u32 s43, s45, 0x388000
    buffer_load_dwordx4 v49, s[16:19], s43 offen lds
    s_add_u32 m0, s44, 14336
    s_add_u32 s43, s45, 0x390000
    buffer_load_dwordx4 v48, s[16:19], s43 offen lds
    s_add_u32 m0, s44, 15360
    s_add_u32 s43, s45, 0x398000
    buffer_load_dwordx4 v49, s[16:19], s43 offen lds
    s_mov_b32 s32, s92
    s_and_b32 s33, s93, 0xffff
    s_mov_b32 s34, 0x2400
    s_mov_b32 s35, 0x20000
    s_mov_b32 s20, s96
    s_and_b32 s21, s97, 0xffff
    s_mov_b32 s22, 0x480000
    s_mov_b32 s23, 0x20000
    s_mov_b32 s24, s98
    s_and_b32 s25, s99, 0xffff
    s_mov_b32 s26, 0x480000
    s_mov_b32 s27, 0x20000
    s_mov_b32 s28, s100
    s_and_b32 s29, s101, 0xffff
    s_mov_b32 s30, 0x480000
    s_mov_b32 s31, 0x20000
    s_mov_b32 s12, s4
    s_and_b32 s13, s5, 0xffff
    s_mov_b32 s14, 0x100
    s_mov_b32 s15, 0x20000
    s_mov_b32 s8, s6
    s_and_b32 s9, s7, 0xffff
    s_mov_b32 s10, 0x10000000
    s_mov_b32 s11, 0x20000
    s_mov_b32 s50, 0x3e0293ee
    s_mov_b32 s51, 0xffbfffbf
    s_mov_b32 s52, 0x00ff00ff
    s_mov_b32 s53, 0
    s_mov_b32 s56, 0x00ff00ff
    s_mov_b32 s57, 0x00ff00ff
    s_mov_b32 s66, 0xaaaaaaaa
    s_mov_b32 s67, 0xaaaaaaaa
    s_mov_b32 s68, 0x2b800000
    s_mov_b32 s69, 0x53800000
    s_mov_b32 s88, 0x3ffff
    s_mov_b32 s89, 0
    s_mov_b32 s70, 0xcccccccc
    s_mov_b32 s71, 0xcccccccc
    s_mov_b32 s58, 0x30003
    s_mov_b32 s59, 0x30003
    s_mov_b32 s60, 0xc000c
    s_mov_b32 s61, 0xc000c
    s_mov_b32 s62, 0x300030
    s_mov_b32 s63, 0x300030
    s_mov_b32 s64, 0xc000c0
    s_mov_b32 s65, 0xc000c0
    v_lshrrev_b32 v18, 4, v17
    v_and_b32 v19, 15, v17
    v_lshrrev_b32 v20, 5, v17
    v_and_b32 v21, 1, v18
    v_lshrrev_b32 v22, 2, v19
    v_and_b32 v23, 3, v17
    v_lshlrev_b32 v0, 4, v17
    s_lshl_b32 s43, s37, 15
    s_add_u32 s43, s43, 32768
    v_add_u32 v1, s43, v0
    v_lshlrev_b32 v24, 9, v20
    v_lshlrev_b32 v25, 7, v23
    v_lshlrev_b32 v26, 6, v21
    v_add3_u32 v24, v24, v25, v26
    v_lshlrev_b32 v25, 3, v22
    v_add_u32 v24, v24, v25
    v_lshrrev_b32 v25, 3, v24
    v_and_b32 v25, 0x20, v25
    v_xor_b32 v2, v24, v25
    v_xor_b32 v3, 0x20, v2
    v_lshlrev_b32 v24, 3, v17
    v_lshrrev_b32 v25, 3, v24
    v_and_b32 v25, 0x20, v25
    v_xor_b32 v4, v24, v25
    v_lshlrev_b32 v24, 4, v19
    v_lshlrev_b32 v25, 2, v18
    v_add_u32 v11, v24, v25
    v_lshlrev_b32 v24, 6, v18
    v_lshlrev_b32 v26, 4, v22
    v_and_b32 v27, 1, v17
    v_lshlrev_b32 v27, 3, v27
    v_add3_u32 v5, v24, v26, v27
    v_lshlrev_b32 v24, 5, v18
    v_and_b32 v26, 1, v22
    v_lshlrev_b32 v26, 4, v26
    v_add3_u32 v8, v24, v26, v27
    s_lshl_b32 s43, s37, 9
    s_add_u32 s43, s43, 13312
    v_lshlrev_b32 v24, 7, v18
    v_and_b32 v26, 7, v17
    v_lshl_add_u32 v24, v26, 4, v24
    v_bfe_u32 v26, v17, 3, 1
    v_lshlrev_b32 v26, 2, v26
    v_add3_u32 v6, v24, v26, s43
    v_mov_b32 v24, 0xeeeeeeee
    v_mov_b32 v25, 0x44444444
    v_cndmask_b32 v10, v25, v24, s[70:71]
    v_lshlrev_b32 v24, 12, v18
    v_lshlrev_b32 v25, 3, v19
    v_add_u32 v24, v24, v25
    s_lshl_b32 s44, s36, 7
    v_add_u32 v7, s44, v24
    s_lshl_b32 s43, s37, 5
    s_add_u32 s43, s43, s36
    s_lshl_b32 s47, s43, 12
    s_lshl_b32 s44, s43, 7
    v_and_b32 v24, 7, v17
    v_lshlrev_b32 v24, 4, v24
    v_lshlrev_b32 v25, 3, v21
    v_add3_u32 v24, v24, v25, s44
    v_lshrrev_b32 v25, 3, v24
    v_and_b32 v25, 0x20, v25
    v_xor_b32 v24, v24, v25
    v_mov_b32 v25, 0x7ff00000
    v_cndmask_b32 v9, v25, v24, s[52:53]
    s_cmp_eq_u32 s37, 1
    s_cbranch_scc1 L_cw1
    s_cmp_eq_u32 s37, 2
    s_cbranch_scc1 L_cw2
    s_cmp_eq_u32 s37, 3
    s_cbranch_scc1 L_cw3
L_cw0:
    v_and_b32 v24, 1, v18
    v_lshlrev_b32 v24, 1, v24
    v_xor_b32 v24, v24, v19
    v_xor_b32 v24, 0, v24
    v_lshlrev_b32 v25, 13, v18
    v_lshl_add_u32 v48, v24, 4, v25
    v_xor_b32 v24, 4, v24
    v_lshl_add_u32 v49, v24, 4, v25
    v_mul_u32_u24 v25, 1152, v18
    v_lshl_add_u32 v51, v24, 4, v25
    v_xor_b32 v24, 4, v24
    v_lshl_add_u32 v50, v24, 4, v25
    v_lshrrev_b32 v24, 3, v17
    v_mul_u32_u24 v24, 1152, v24
    v_and_b32 v25, 7, v17
    v_lshl_add_u32 v52, v25, 4, v24
    v_lshrrev_b32 v24, 1, v22
    v_and_b32 v25, 1, v22
    v_lshlrev_b32 v26, 15, v24
    v_lshl_add_u32 v26, v18, 10, v26
    v_lshl_add_u32 v26, v25, 8, v26
    v_lshl_add_u32 v26, v23, 3, v26
    v_add_u32 v26, 32768, v26
    v_lshl_add_u32 v27, v21, 1, v25
    v_lshl_add_u32 v27, v24, 2, v27
    v_xor_b32 v28, 0, v27
    v_lshl_add_u32 v53, v28, 5, v26
    v_add_u32 v55, 65536, v53
    v_xor_b32 v28, 1, v27
    v_lshl_add_u32 v54, v28, 5, v26
    v_add_u32 v56, 65536, v54
    v_lshlrev_b32 v26, 15, v21
    v_lshl_add_u32 v26, v20, 10, v26
    v_lshl_add_u32 v26, v25, 8, v26
    v_lshl_add_u32 v26, v23, 3, v26
    v_add_u32 v26, 32768, v26
    v_lshl_add_u32 v27, v20, 1, v25
    v_lshl_add_u32 v27, v21, 2, v27
    v_add_u32 v28, 0, v24
    v_xor_b32 v28, v28, v27
    v_lshl_add_u32 v57, v28, 5, v26
    v_add_u32 v58, 65536, v57
    v_lshlrev_b32 v26, 15, v24
    v_lshl_add_u32 v26, v21, 11, v26
    v_lshl_add_u32 v26, v20, 9, v26
    v_lshl_add_u32 v26, v25, 7, v26
    v_lshl_add_u32 v26, v23, 3, v26
    v_add_u32 v61, 32768, v26
    v_add_u32 v62, 65536, v61
    s_lshl_b32 s45, s36, 8
    s_mul_i32 s46, s36, 147456
    v_lshlrev_b32 v28, 1, v17
    v_lshlrev_b32 v29, 9, v20
    v_lshlrev_b32 v30, 3, v19
    v_add_u32 v29, v29, v30
    v_lshlrev_b32 v30, 2, v21
    v_add_u32 v29, v29, v30
    v_xor_b32 v29, 0, v29
    s_mov_b32 s43, 0
    buffer_load_ushort v32, v28, s[32:35], s43 offen offset:0
    buffer_load_ushort v33, v28, s[32:35], s43 offen offset:128
    buffer_load_ushort v34, v28, s[32:35], s43 offen offset:256
    buffer_load_ushort v35, v28, s[32:35], s43 offen offset:384
    buffer_load_ushort v36, v28, s[32:35], s43 offen offset:512
    buffer_load_ushort v37, v28, s[32:35], s43 offen offset:640
    buffer_load_ushort v38, v28, s[32:35], s43 offen offset:768
    buffer_load_ushort v39, v28, s[32:35], s43 offen offset:896
    buffer_load_ushort v40, v28, s[32:35], s43 offen offset:1024
    s_mov_b32 s43, 1152
    buffer_load_ushort v41, v28, s[32:35], s43 offen offset:0
    buffer_load_ushort v42, v28, s[32:35], s43 offen offset:128
    buffer_load_ushort v43, v28, s[32:35], s43 offen offset:256
    buffer_load_ushort v44, v28, s[32:35], s43 offen offset:384
    buffer_load_ushort v45, v28, s[32:35], s43 offen offset:512
    buffer_load_ushort v46, v28, s[32:35], s43 offen offset:640
    buffer_load_ushort v47, v28, s[32:35], s43 offen offset:768
    buffer_load_ushort v12, v28, s[32:35], s43 offen offset:896
    buffer_load_ushort v13, v28, s[32:35], s43 offen offset:1024
    v_mov_b32 v63, v29
    s_waitcnt lgkmcnt(0)
    s_mov_b32 s38, 0
    s_mov_b32 s39, 0
    s_mov_b32 s40, 1048576
    s_mov_b32 s41, 1064960
    s_mov_b32 s42, 1081344
    s_lshl_b32 s48, s36, 13
    s_mov_b32 s94, 0xffbfffbf
    s_mov_b32 s96, 0x3f803f80
    s_mov_b32 s100, 0xcccccccc
    s_mov_b32 s101, 0xcccccccc
    s_mov_b32 s97, 0x3f803f80
    s_mov_b32 s98, 0x3f803f80
    s_mov_b32 s99, 0
    s_mov_b32 s95, 0xffbfffbf
    s_mov_b32 s54, 294912
    s_mov_b32 s92, 0
    s_mov_b32 s93, 1097728
    s_waitcnt vmcnt(46)
    s_barrier
    ds_read_b64_tr_b16 a[144:145], v53 offset:16384
    ds_read_b64_tr_b16 a[146:147], v53 offset:16896
    ds_read_b64_tr_b16 a[148:149], v55 offset:16384
    ds_read_b64_tr_b16 a[150:151], v55 offset:16896
    ds_read_b64_tr_b16 a[152:153], v54 offset:16384
    ds_read_b64_tr_b16 a[154:155], v54 offset:16896
    ds_read_b64_tr_b16 a[156:157], v56 offset:16384
    ds_read_b64_tr_b16 a[158:159], v56 offset:16896
    s_waitcnt lgkmcnt(0)
    s_waitcnt vmcnt(42)
    s_barrier
    s_mov_b32 m0, 0xc000
    s_add_u32 s43, s45, 0x400000
    buffer_load_dwordx4 v48, s[16:19], s43 offen lds
    s_mov_b32 m0, 0xc400
    s_add_u32 s43, s45, 0x408000
    buffer_load_dwordx4 v49, s[16:19], s43 offen lds
    s_mov_b32 m0, 0xc800
    s_add_u32 s43, s45, 0x410000
    buffer_load_dwordx4 v48, s[16:19], s43 offen lds
    s_mov_b32 m0, 0xcc00
    s_add_u32 s43, s45, 0x418000
    buffer_load_dwordx4 v49, s[16:19], s43 offen lds
    ds_read_b64_tr_b16 v[64:65], v53 offset:20480
    ds_read_b64_tr_b16 v[66:67], v53 offset:20992
    ds_read_b64_tr_b16 v[68:69], v55 offset:20480
    ds_read_b64_tr_b16 v[70:71], v55 offset:20992
    ds_read_b64_tr_b16 v[72:73], v54 offset:20480
    ds_read_b64_tr_b16 v[74:75], v54 offset:20992
    ds_read_b64_tr_b16 v[76:77], v56 offset:20480
    ds_read_b64_tr_b16 v[78:79], v56 offset:20992
    s_waitcnt lgkmcnt(0)
    s_waitcnt vmcnt(42)
    s_barrier
    s_mov_b32 m0, 0xd000
    s_add_u32 s43, s45, 0x0
    buffer_load_dwordx4 v48, s[20:23], s43 offen lds
    s_mov_b32 m0, 0xd400
    s_add_u32 s43, s45, 0x8000
    buffer_load_dwordx4 v49, s[20:23], s43 offen lds
    s_mov_b32 m0, 0xd800
    s_add_u32 s43, s45, 0x10000
    buffer_load_dwordx4 v48, s[20:23], s43 offen lds
    s_mov_b32 m0, 0xdc00
    s_add_u32 s43, s45, 0x18000
    buffer_load_dwordx4 v49, s[20:23], s43 offen lds
    ds_read_b64_tr_b16 v[80:81], v53 offset:24576
    ds_read_b64_tr_b16 v[82:83], v53 offset:25088
    ds_read_b64_tr_b16 v[84:85], v55 offset:24576
    ds_read_b64_tr_b16 v[86:87], v55 offset:25088
    ds_read_b64_tr_b16 v[88:89], v54 offset:24576
    ds_read_b64_tr_b16 v[90:91], v54 offset:25088
    ds_read_b64_tr_b16 v[92:93], v56 offset:24576
    ds_read_b64_tr_b16 v[94:95], v56 offset:25088
    s_waitcnt lgkmcnt(0)
    s_waitcnt vmcnt(42)
    s_barrier
    s_mov_b32 m0, 0xe000
    s_add_u32 s43, s45, 0x80000
    buffer_load_dwordx4 v48, s[20:23], s43 offen lds
    s_mov_b32 m0, 0xe400
    s_add_u32 s43, s45, 0x88000
    buffer_load_dwordx4 v49, s[20:23], s43 offen lds
    s_mov_b32 m0, 0xe800
    s_add_u32 s43, s45, 0x90000
    buffer_load_dwordx4 v48, s[20:23], s43 offen lds
    s_mov_b32 m0, 0xec00
    s_add_u32 s43, s45, 0x98000
    buffer_load_dwordx4 v49, s[20:23], s43 offen lds
    ds_read_b64_tr_b16 v[96:97], v53 offset:28672
    ds_read_b64_tr_b16 v[98:99], v53 offset:29184
    ds_read_b64_tr_b16 v[100:101], v55 offset:28672
    ds_read_b64_tr_b16 v[102:103], v55 offset:29184
    ds_read_b64_tr_b16 v[104:105], v54 offset:28672
    ds_read_b64_tr_b16 v[106:107], v54 offset:29184
    ds_read_b64_tr_b16 v[108:109], v56 offset:28672
    ds_read_b64_tr_b16 v[110:111], v56 offset:29184
    s_waitcnt lgkmcnt(0)
    s_waitcnt vmcnt(42)
    s_barrier
    s_mov_b32 m0, 0xf000
    s_add_u32 s43, s45, 0x100000
    buffer_load_dwordx4 v48, s[20:23], s43 offen lds
    s_mov_b32 m0, 0xf400
    s_add_u32 s43, s45, 0x108000
    buffer_load_dwordx4 v49, s[20:23], s43 offen lds
    s_mov_b32 m0, 0xf800
    s_add_u32 s43, s45, 0x110000
    buffer_load_dwordx4 v48, s[20:23], s43 offen lds
    s_mov_b32 m0, 0xfc00
    s_add_u32 s43, s45, 0x118000
    buffer_load_dwordx4 v49, s[20:23], s43 offen lds
    ds_read_b64_tr_b16 v[112:113], v53 offset:0
    ds_read_b64_tr_b16 v[114:115], v53 offset:512
    ds_read_b64_tr_b16 v[116:117], v55 offset:0
    ds_read_b64_tr_b16 v[118:119], v55 offset:512
    ds_read_b64_tr_b16 v[120:121], v54 offset:0
    ds_read_b64_tr_b16 v[122:123], v54 offset:512
    ds_read_b64_tr_b16 v[124:125], v56 offset:0
    ds_read_b64_tr_b16 v[126:127], v56 offset:512
    s_waitcnt lgkmcnt(0)
    s_waitcnt vmcnt(42)
    s_barrier
    s_mov_b32 m0, 0x8000
    s_add_u32 s43, s45, 0x180000
    buffer_load_dwordx4 v48, s[20:23], s43 offen lds
    s_mov_b32 m0, 0x8400
    s_add_u32 s43, s45, 0x188000
    buffer_load_dwordx4 v49, s[20:23], s43 offen lds
    s_mov_b32 m0, 0x8800
    s_add_u32 s43, s45, 0x190000
    buffer_load_dwordx4 v48, s[20:23], s43 offen lds
    s_mov_b32 m0, 0x8c00
    s_add_u32 s43, s45, 0x198000
    buffer_load_dwordx4 v49, s[20:23], s43 offen lds
    ds_read_b64_tr_b16 a[160:161], v53 offset:4096
    ds_read_b64_tr_b16 a[162:163], v53 offset:4608
    ds_read_b64_tr_b16 a[164:165], v55 offset:4096
    ds_read_b64_tr_b16 a[166:167], v55 offset:4608
    ds_read_b64_tr_b16 a[168:169], v54 offset:4096
    ds_read_b64_tr_b16 a[170:171], v54 offset:4608
    ds_read_b64_tr_b16 a[172:173], v56 offset:4096
    ds_read_b64_tr_b16 a[174:175], v56 offset:4608
    s_waitcnt lgkmcnt(0)
    s_waitcnt vmcnt(42)
    s_barrier
    s_mov_b32 m0, 0x9000
    s_add_u32 s43, s45, 0x200000
    buffer_load_dwordx4 v48, s[20:23], s43 offen lds
    s_mov_b32 m0, 0x9400
    s_add_u32 s43, s45, 0x208000
    buffer_load_dwordx4 v49, s[20:23], s43 offen lds
    s_mov_b32 m0, 0x9800
    s_add_u32 s43, s45, 0x210000
    buffer_load_dwordx4 v48, s[20:23], s43 offen lds
    s_mov_b32 m0, 0x9c00
    s_add_u32 s43, s45, 0x218000
    buffer_load_dwordx4 v49, s[20:23], s43 offen lds
    ds_read_b64_tr_b16 v[128:129], v53 offset:8192
    ds_read_b64_tr_b16 v[130:131], v53 offset:8704
    ds_read_b64_tr_b16 v[132:133], v55 offset:8192
    ds_read_b64_tr_b16 v[134:135], v55 offset:8704
    ds_read_b64_tr_b16 v[136:137], v54 offset:8192
    ds_read_b64_tr_b16 v[138:139], v54 offset:8704
    ds_read_b64_tr_b16 v[140:141], v56 offset:8192
    ds_read_b64_tr_b16 v[142:143], v56 offset:8704
    s_waitcnt lgkmcnt(0)
    s_waitcnt vmcnt(42)
    s_barrier
    s_mov_b32 m0, 0xa000
    s_add_u32 s43, s45, 0x280000
    buffer_load_dwordx4 v48, s[20:23], s43 offen lds
    s_mov_b32 m0, 0xa400
    s_add_u32 s43, s45, 0x288000
    buffer_load_dwordx4 v49, s[20:23], s43 offen lds
    s_mov_b32 m0, 0xa800
    s_add_u32 s43, s45, 0x290000
    buffer_load_dwordx4 v48, s[20:23], s43 offen lds
    s_mov_b32 m0, 0xac00
    s_add_u32 s43, s45, 0x298000
    buffer_load_dwordx4 v49, s[20:23], s43 offen lds
    ds_read_b64_tr_b16 v[144:145], v53 offset:12288
    ds_read_b64_tr_b16 v[146:147], v53 offset:12800
    ds_read_b64_tr_b16 v[148:149], v55 offset:12288
    ds_read_b64_tr_b16 v[150:151], v55 offset:12800
    ds_read_b64_tr_b16 v[152:153], v54 offset:12288
    ds_read_b64_tr_b16 v[154:155], v54 offset:12800
    ds_read_b64_tr_b16 v[156:157], v56 offset:12288
    ds_read_b64_tr_b16 v[158:159], v56 offset:12800
    s_waitcnt lgkmcnt(0)
    s_waitcnt vmcnt(24)
    s_barrier
    s_mov_b32 m0, 0xb000
    s_add_u32 s43, s45, 0x300000
    buffer_load_dwordx4 v48, s[20:23], s43 offen lds
    s_mov_b32 m0, 0xb400
    s_add_u32 s43, s45, 0x308000
    buffer_load_dwordx4 v49, s[20:23], s43 offen lds
    s_mov_b32 m0, 0xb800
    s_add_u32 s43, s45, 0x310000
    buffer_load_dwordx4 v48, s[20:23], s43 offen lds
    s_mov_b32 m0, 0xbc00
    s_add_u32 s43, s45, 0x318000
    buffer_load_dwordx4 v49, s[20:23], s43 offen lds
    ds_read_b64_tr_b16 v[160:161], v53 offset:16384
    ds_read_b64_tr_b16 v[162:163], v53 offset:16896
    ds_read_b64_tr_b16 v[164:165], v55 offset:16384
    ds_read_b64_tr_b16 v[166:167], v55 offset:16896
    ds_read_b64_tr_b16 v[168:169], v54 offset:16384
    ds_read_b64_tr_b16 v[170:171], v54 offset:16896
    ds_read_b64_tr_b16 v[172:173], v56 offset:16384
    ds_read_b64_tr_b16 v[174:175], v56 offset:16896
    s_waitcnt lgkmcnt(0)
    s_waitcnt vmcnt(24)
    s_barrier
    s_mov_b32 m0, 0xc000
    s_add_u32 s43, s45, 0x380000
    buffer_load_dwordx4 v48, s[20:23], s43 offen lds
    s_mov_b32 m0, 0xc400
    s_add_u32 s43, s45, 0x388000
    buffer_load_dwordx4 v49, s[20:23], s43 offen lds
    s_mov_b32 m0, 0xc800
    s_add_u32 s43, s45, 0x390000
    buffer_load_dwordx4 v48, s[20:23], s43 offen lds
    s_mov_b32 m0, 0xcc00
    s_add_u32 s43, s45, 0x398000
    buffer_load_dwordx4 v49, s[20:23], s43 offen lds
    ds_read_b64_tr_b16 v[176:177], v53 offset:20480
    ds_read_b64_tr_b16 v[178:179], v53 offset:20992
    ds_read_b64_tr_b16 v[180:181], v55 offset:20480
    ds_read_b64_tr_b16 v[182:183], v55 offset:20992
    ds_read_b64_tr_b16 v[184:185], v54 offset:20480
    ds_read_b64_tr_b16 v[186:187], v54 offset:20992
    ds_read_b64_tr_b16 v[188:189], v56 offset:20480
    ds_read_b64_tr_b16 v[190:191], v56 offset:20992
    s_waitcnt lgkmcnt(0)
    ds_write_b16 v63, v32 offset:0
    ds_write_b16 v63, v33 offset:1024
    ds_write_b16 v63, v34 offset:2048
    ds_write_b16 v63, v35 offset:3072
    ds_write_b16 v63, v36 offset:4096
    ds_write_b16 v63, v37 offset:5120
    ds_write_b16 v63, v38 offset:6144
    ds_write_b16 v63, v39 offset:7168
    ds_write_b16 v63, v40 offset:8192
    ds_write_b16 v63, v41 offset:2
    ds_write_b16 v63, v42 offset:1026
    ds_write_b16 v63, v43 offset:2050
    ds_write_b16 v63, v44 offset:3074
    ds_write_b16 v63, v45 offset:4098
    ds_write_b16 v63, v46 offset:5122
    ds_write_b16 v63, v47 offset:6146
    ds_write_b16 v63, v12 offset:7170
    ds_write_b16 v63, v13 offset:8194
    s_waitcnt vmcnt(24)
    s_barrier
    s_mov_b32 m0, 0xd000
    s_add_u32 s43, s45, 0x400000
    buffer_load_dwordx4 v48, s[20:23], s43 offen lds
    s_mov_b32 m0, 0xd400
    s_add_u32 s43, s45, 0x408000
    buffer_load_dwordx4 v49, s[20:23], s43 offen lds
    s_mov_b32 m0, 0xd800
    s_add_u32 s43, s45, 0x410000
    buffer_load_dwordx4 v48, s[20:23], s43 offen lds
    s_mov_b32 m0, 0xdc00
    s_add_u32 s43, s45, 0x418000
    buffer_load_dwordx4 v49, s[20:23], s43 offen lds
    ds_read_b64_tr_b16 v[192:193], v53 offset:24576
    ds_read_b64_tr_b16 v[194:195], v53 offset:25088
    ds_read_b64_tr_b16 v[196:197], v55 offset:24576
    ds_read_b64_tr_b16 v[198:199], v55 offset:25088
    ds_read_b64_tr_b16 v[200:201], v54 offset:24576
    ds_read_b64_tr_b16 v[202:203], v54 offset:25088
    ds_read_b64_tr_b16 v[204:205], v56 offset:24576
    ds_read_b64_tr_b16 v[206:207], v56 offset:25088
    s_waitcnt lgkmcnt(0)
    s_waitcnt vmcnt(24)
    s_barrier
    s_mov_b32 m0, 0xe000
    s_add_u32 s43, s45, 0x0
    buffer_load_dwordx4 v48, s[24:27], s43 offen lds
    s_mov_b32 m0, 0xe400
    s_add_u32 s43, s45, 0x8000
    buffer_load_dwordx4 v49, s[24:27], s43 offen lds
    s_mov_b32 m0, 0xe800
    s_add_u32 s43, s45, 0x10000
    buffer_load_dwordx4 v48, s[24:27], s43 offen lds
    s_mov_b32 m0, 0xec00
    s_add_u32 s43, s45, 0x18000
    buffer_load_dwordx4 v49, s[24:27], s43 offen lds
    ds_read_b64_tr_b16 v[208:209], v53 offset:28672
    ds_read_b64_tr_b16 v[210:211], v53 offset:29184
    ds_read_b64_tr_b16 v[212:213], v55 offset:28672
    ds_read_b64_tr_b16 v[214:215], v55 offset:29184
    ds_read_b64_tr_b16 v[216:217], v54 offset:28672
    ds_read_b64_tr_b16 v[218:219], v54 offset:29184
    ds_read_b64_tr_b16 v[220:221], v56 offset:28672
    ds_read_b64_tr_b16 v[222:223], v56 offset:29184
    s_waitcnt lgkmcnt(0)
    s_waitcnt vmcnt(24)
    s_barrier
    s_mov_b32 m0, 0xf000
    s_add_u32 s43, s45, 0x80000
    buffer_load_dwordx4 v48, s[24:27], s43 offen lds
    s_mov_b32 m0, 0xf400
    s_add_u32 s43, s45, 0x88000
    buffer_load_dwordx4 v49, s[24:27], s43 offen lds
    s_mov_b32 m0, 0xf800
    s_add_u32 s43, s45, 0x90000
    buffer_load_dwordx4 v48, s[24:27], s43 offen lds
    s_mov_b32 m0, 0xfc00
    s_add_u32 s43, s45, 0x98000
    buffer_load_dwordx4 v49, s[24:27], s43 offen lds
    ds_read_b64_tr_b16 a[176:177], v53 offset:0
    ds_read_b64_tr_b16 a[178:179], v53 offset:512
    ds_read_b64_tr_b16 a[180:181], v55 offset:0
    ds_read_b64_tr_b16 a[182:183], v55 offset:512
    ds_read_b64_tr_b16 a[184:185], v54 offset:0
    ds_read_b64_tr_b16 a[186:187], v54 offset:512
    ds_read_b64_tr_b16 a[188:189], v56 offset:0
    ds_read_b64_tr_b16 a[190:191], v56 offset:512
    s_waitcnt lgkmcnt(0)
    s_waitcnt vmcnt(24)
    s_barrier
    s_mov_b32 m0, 0x8000
    s_add_u32 s43, s45, 0x100000
    buffer_load_dwordx4 v48, s[24:27], s43 offen lds
    s_mov_b32 m0, 0x8400
    s_add_u32 s43, s45, 0x108000
    buffer_load_dwordx4 v49, s[24:27], s43 offen lds
    s_mov_b32 m0, 0x8800
    s_add_u32 s43, s45, 0x110000
    buffer_load_dwordx4 v48, s[24:27], s43 offen lds
    s_mov_b32 m0, 0x8c00
    s_add_u32 s43, s45, 0x118000
    buffer_load_dwordx4 v49, s[24:27], s43 offen lds
    ds_read_b64_tr_b16 v[224:225], v53 offset:4096
    ds_read_b64_tr_b16 v[226:227], v53 offset:4608
    ds_read_b64_tr_b16 v[228:229], v55 offset:4096
    ds_read_b64_tr_b16 v[230:231], v55 offset:4608
    ds_read_b64_tr_b16 v[232:233], v54 offset:4096
    ds_read_b64_tr_b16 v[234:235], v54 offset:4608
    ds_read_b64_tr_b16 v[236:237], v56 offset:4096
    ds_read_b64_tr_b16 v[238:239], v56 offset:4608
    s_waitcnt lgkmcnt(0)
    s_waitcnt vmcnt(24)
    s_barrier
    s_mov_b32 m0, 0x9000
    s_add_u32 s43, s45, 0x180000
    buffer_load_dwordx4 v48, s[24:27], s43 offen lds
    s_mov_b32 m0, 0x9400
    s_add_u32 s43, s45, 0x188000
    buffer_load_dwordx4 v49, s[24:27], s43 offen lds
    s_mov_b32 m0, 0x9800
    s_add_u32 s43, s45, 0x190000
    buffer_load_dwordx4 v48, s[24:27], s43 offen lds
    s_mov_b32 m0, 0x9c00
    s_add_u32 s43, s45, 0x198000
    buffer_load_dwordx4 v49, s[24:27], s43 offen lds
    ds_read_b64_tr_b16 v[240:241], v53 offset:8192
    ds_read_b64_tr_b16 v[242:243], v53 offset:8704
    ds_read_b64_tr_b16 v[244:245], v55 offset:8192
    ds_read_b64_tr_b16 v[246:247], v55 offset:8704
    ds_read_b64_tr_b16 v[248:249], v54 offset:8192
    ds_read_b64_tr_b16 v[250:251], v54 offset:8704
    ds_read_b64_tr_b16 v[252:253], v56 offset:8192
    ds_read_b64_tr_b16 v[254:255], v56 offset:8704
    s_waitcnt lgkmcnt(0)
    s_waitcnt vmcnt(24)
    s_barrier
    s_mov_b32 m0, 0xa000
    s_add_u32 s43, s45, 0x200000
    buffer_load_dwordx4 v48, s[24:27], s43 offen lds
    s_mov_b32 m0, 0xa400
    s_add_u32 s43, s45, 0x208000
    buffer_load_dwordx4 v49, s[24:27], s43 offen lds
    s_mov_b32 m0, 0xa800
    s_add_u32 s43, s45, 0x210000
    buffer_load_dwordx4 v48, s[24:27], s43 offen lds
    s_mov_b32 m0, 0xac00
    s_add_u32 s43, s45, 0x218000
    buffer_load_dwordx4 v49, s[24:27], s43 offen lds
    ds_read_b64_tr_b16 a[192:193], v53 offset:12288
    ds_read_b64_tr_b16 a[194:195], v53 offset:12800
    ds_read_b64_tr_b16 a[196:197], v55 offset:12288
    ds_read_b64_tr_b16 a[198:199], v55 offset:12800
    ds_read_b64_tr_b16 a[200:201], v54 offset:12288
    ds_read_b64_tr_b16 a[202:203], v54 offset:12800
    ds_read_b64_tr_b16 a[204:205], v56 offset:12288
    ds_read_b64_tr_b16 a[206:207], v56 offset:12800
    s_waitcnt lgkmcnt(0)
    s_waitcnt vmcnt(24)
    s_barrier
    s_mov_b32 m0, 0xb000
    s_add_u32 s43, s45, 0x280000
    buffer_load_dwordx4 v48, s[24:27], s43 offen lds
    s_mov_b32 m0, 0xb400
    s_add_u32 s43, s45, 0x288000
    buffer_load_dwordx4 v49, s[24:27], s43 offen lds
    s_mov_b32 m0, 0xb800
    s_add_u32 s43, s45, 0x290000
    buffer_load_dwordx4 v48, s[24:27], s43 offen lds
    s_mov_b32 m0, 0xbc00
    s_add_u32 s43, s45, 0x298000
    buffer_load_dwordx4 v49, s[24:27], s43 offen lds
    ds_read_b64_tr_b16 a[0:1], v53 offset:16384
    ds_read_b64_tr_b16 a[2:3], v53 offset:16896
    ds_read_b64_tr_b16 a[4:5], v55 offset:16384
    ds_read_b64_tr_b16 a[6:7], v55 offset:16896
    ds_read_b64_tr_b16 a[8:9], v54 offset:16384
    ds_read_b64_tr_b16 a[10:11], v54 offset:16896
    ds_read_b64_tr_b16 a[12:13], v56 offset:16384
    ds_read_b64_tr_b16 a[14:15], v56 offset:16896
    s_waitcnt lgkmcnt(0)
    s_waitcnt vmcnt(24)
    s_barrier
    s_mov_b32 m0, 0xc000
    s_add_u32 s43, s45, 0x300000
    buffer_load_dwordx4 v48, s[24:27], s43 offen lds
    s_mov_b32 m0, 0xc400
    s_add_u32 s43, s45, 0x308000
    buffer_load_dwordx4 v49, s[24:27], s43 offen lds
    s_mov_b32 m0, 0xc800
    s_add_u32 s43, s45, 0x310000
    buffer_load_dwordx4 v48, s[24:27], s43 offen lds
    s_mov_b32 m0, 0xcc00
    s_add_u32 s43, s45, 0x318000
    buffer_load_dwordx4 v49, s[24:27], s43 offen lds
    ds_read_b64_tr_b16 a[16:17], v53 offset:20480
    ds_read_b64_tr_b16 a[18:19], v53 offset:20992
    ds_read_b64_tr_b16 a[20:21], v55 offset:20480
    ds_read_b64_tr_b16 a[22:23], v55 offset:20992
    ds_read_b64_tr_b16 a[24:25], v54 offset:20480
    ds_read_b64_tr_b16 a[26:27], v54 offset:20992
    ds_read_b64_tr_b16 a[28:29], v56 offset:20480
    ds_read_b64_tr_b16 a[30:31], v56 offset:20992
    s_waitcnt lgkmcnt(0)
    s_waitcnt vmcnt(24)
    s_barrier
    s_mov_b32 m0, 0xd000
    s_add_u32 s43, s45, 0x380000
    buffer_load_dwordx4 v48, s[24:27], s43 offen lds
    s_mov_b32 m0, 0xd400
    s_add_u32 s43, s45, 0x388000
    buffer_load_dwordx4 v49, s[24:27], s43 offen lds
    s_mov_b32 m0, 0xd800
    s_add_u32 s43, s45, 0x390000
    buffer_load_dwordx4 v48, s[24:27], s43 offen lds
    s_mov_b32 m0, 0xdc00
    s_add_u32 s43, s45, 0x398000
    buffer_load_dwordx4 v49, s[24:27], s43 offen lds
    ds_read_b64_tr_b16 a[32:33], v53 offset:24576
    ds_read_b64_tr_b16 a[34:35], v53 offset:25088
    ds_read_b64_tr_b16 a[36:37], v55 offset:24576
    ds_read_b64_tr_b16 a[38:39], v55 offset:25088
    ds_read_b64_tr_b16 a[40:41], v54 offset:24576
    ds_read_b64_tr_b16 a[42:43], v54 offset:25088
    ds_read_b64_tr_b16 a[44:45], v56 offset:24576
    ds_read_b64_tr_b16 a[46:47], v56 offset:25088
    s_waitcnt lgkmcnt(0)
    s_waitcnt vmcnt(24)
    s_barrier
    s_mov_b32 m0, 0xe000
    s_add_u32 s43, s46, 0x0
    buffer_load_dwordx4 v50, s[28:31], s43 offen lds
    s_mov_b32 m0, 0xe400
    s_add_u32 s43, s46, 0x1200
    buffer_load_dwordx4 v51, s[28:31], s43 offen lds
    s_mov_b32 m0, 0xe800
    s_add_u32 s43, s46, 0x2400
    buffer_load_dwordx4 v50, s[28:31], s43 offen lds
    s_mov_b32 m0, 0xec00
    s_add_u32 s43, s46, 0x3600
    buffer_load_dwordx4 v51, s[28:31], s43 offen lds
    ds_read_b64_tr_b16 a[48:49], v53 offset:28672
    ds_read_b64_tr_b16 a[50:51], v53 offset:29184
    ds_read_b64_tr_b16 a[52:53], v55 offset:28672
    ds_read_b64_tr_b16 a[54:55], v55 offset:29184
    ds_read_b64_tr_b16 a[56:57], v54 offset:28672
    ds_read_b64_tr_b16 a[58:59], v54 offset:29184
    ds_read_b64_tr_b16 a[60:61], v56 offset:28672
    ds_read_b64_tr_b16 a[62:63], v56 offset:29184
    s_waitcnt lgkmcnt(0)
    s_waitcnt vmcnt(24)
    s_barrier
    s_mov_b32 m0, 0xf000
    s_add_u32 s43, s46, 0x200
    buffer_load_dwordx4 v50, s[28:31], s43 offen lds
    s_mov_b32 m0, 0xf400
    s_add_u32 s43, s46, 0x1400
    buffer_load_dwordx4 v51, s[28:31], s43 offen lds
    s_mov_b32 m0, 0xf800
    s_add_u32 s43, s46, 0x2600
    buffer_load_dwordx4 v50, s[28:31], s43 offen lds
    s_mov_b32 m0, 0xfc00
    s_add_u32 s43, s46, 0x3800
    buffer_load_dwordx4 v51, s[28:31], s43 offen lds
    ds_read_b64_tr_b16 a[208:209], v53 offset:0
    ds_read_b64_tr_b16 a[210:211], v53 offset:512
    ds_read_b64_tr_b16 a[212:213], v55 offset:0
    ds_read_b64_tr_b16 a[214:215], v55 offset:512
    ds_read_b64_tr_b16 a[216:217], v54 offset:0
    ds_read_b64_tr_b16 a[218:219], v54 offset:512
    ds_read_b64_tr_b16 a[220:221], v56 offset:0
    ds_read_b64_tr_b16 a[222:223], v56 offset:512
    s_waitcnt lgkmcnt(0)
    s_waitcnt vmcnt(24)
    s_barrier
    s_mov_b32 m0, 0x8000
    s_add_u32 s43, s46, 0x100
    buffer_load_dwordx4 v50, s[28:31], s43 offen lds
    s_mov_b32 m0, 0x8400
    s_add_u32 s43, s46, 0x1300
    buffer_load_dwordx4 v51, s[28:31], s43 offen lds
    s_mov_b32 m0, 0x8800
    s_add_u32 s43, s46, 0x2500
    buffer_load_dwordx4 v50, s[28:31], s43 offen lds
    s_mov_b32 m0, 0x8c00
    s_add_u32 s43, s46, 0x3700
    buffer_load_dwordx4 v51, s[28:31], s43 offen lds
    ds_read_b64_tr_b16 a[64:65], v53 offset:4096
    ds_read_b64_tr_b16 a[66:67], v53 offset:4608
    ds_read_b64_tr_b16 a[68:69], v55 offset:4096
    ds_read_b64_tr_b16 a[70:71], v55 offset:4608
    ds_read_b64_tr_b16 a[72:73], v54 offset:4096
    ds_read_b64_tr_b16 a[74:75], v54 offset:4608
    ds_read_b64_tr_b16 a[76:77], v56 offset:4096
    ds_read_b64_tr_b16 a[78:79], v56 offset:4608
    s_waitcnt lgkmcnt(0)
    s_waitcnt vmcnt(24)
    s_barrier
    s_mov_b32 m0, 0x9000
    s_add_u32 s43, s46, 0x300
    buffer_load_dwordx4 v50, s[28:31], s43 offen lds
    s_mov_b32 m0, 0x9400
    s_add_u32 s43, s46, 0x1500
    buffer_load_dwordx4 v51, s[28:31], s43 offen lds
    s_mov_b32 m0, 0x9800
    s_add_u32 s43, s46, 0x2700
    buffer_load_dwordx4 v50, s[28:31], s43 offen lds
    s_mov_b32 m0, 0x9c00
    s_add_u32 s43, s46, 0x3900
    buffer_load_dwordx4 v51, s[28:31], s43 offen lds
    ds_read_b64_tr_b16 a[80:81], v53 offset:8192
    ds_read_b64_tr_b16 a[82:83], v53 offset:8704
    ds_read_b64_tr_b16 a[84:85], v55 offset:8192
    ds_read_b64_tr_b16 a[86:87], v55 offset:8704
    ds_read_b64_tr_b16 a[88:89], v54 offset:8192
    ds_read_b64_tr_b16 a[90:91], v54 offset:8704
    ds_read_b64_tr_b16 a[92:93], v56 offset:8192
    ds_read_b64_tr_b16 a[94:95], v56 offset:8704
    s_waitcnt lgkmcnt(0)
    s_waitcnt vmcnt(24)
    s_barrier
    s_mov_b32 m0, 0xa000
    s_add_u32 s43, s46, 0x12000
    buffer_load_dwordx4 v50, s[28:31], s43 offen lds
    s_mov_b32 m0, 0xa400
    s_add_u32 s43, s46, 0x13200
    buffer_load_dwordx4 v51, s[28:31], s43 offen lds
    s_mov_b32 m0, 0xa800
    s_add_u32 s43, s46, 0x14400
    buffer_load_dwordx4 v50, s[28:31], s43 offen lds
    s_mov_b32 m0, 0xac00
    s_add_u32 s43, s46, 0x15600
    buffer_load_dwordx4 v51, s[28:31], s43 offen lds
    ds_read_b64_tr_b16 a[96:97], v53 offset:12288
    ds_read_b64_tr_b16 a[98:99], v53 offset:12800
    ds_read_b64_tr_b16 a[100:101], v55 offset:12288
    ds_read_b64_tr_b16 a[102:103], v55 offset:12800
    ds_read_b64_tr_b16 a[104:105], v54 offset:12288
    ds_read_b64_tr_b16 a[106:107], v54 offset:12800
    ds_read_b64_tr_b16 a[108:109], v56 offset:12288
    ds_read_b64_tr_b16 a[110:111], v56 offset:12800
    s_waitcnt lgkmcnt(0)
    s_waitcnt vmcnt(24)
    s_barrier
    s_mov_b32 m0, 0xb000
    s_add_u32 s43, s46, 0x12100
    buffer_load_dwordx4 v50, s[28:31], s43 offen lds
    s_mov_b32 m0, 0xb400
    s_add_u32 s43, s46, 0x13300
    buffer_load_dwordx4 v51, s[28:31], s43 offen lds
    s_mov_b32 m0, 0xb800
    s_add_u32 s43, s46, 0x14500
    buffer_load_dwordx4 v50, s[28:31], s43 offen lds
    s_mov_b32 m0, 0xbc00
    s_add_u32 s43, s46, 0x15700
    buffer_load_dwordx4 v51, s[28:31], s43 offen lds
    ds_read_b64_tr_b16 a[224:225], v53 offset:16384
    ds_read_b64_tr_b16 a[226:227], v53 offset:16896
    ds_read_b64_tr_b16 a[228:229], v55 offset:16384
    ds_read_b64_tr_b16 a[230:231], v55 offset:16896
    ds_read_b64_tr_b16 a[232:233], v54 offset:16384
    ds_read_b64_tr_b16 a[234:235], v54 offset:16896
    ds_read_b64_tr_b16 a[236:237], v56 offset:16384
    ds_read_b64_tr_b16 a[238:239], v56 offset:16896
    s_waitcnt lgkmcnt(0)
    s_waitcnt vmcnt(24)
    s_barrier
    s_mov_b32 m0, 0xc000
    s_add_u32 s43, s46, 0x12200
    buffer_load_dwordx4 v50, s[28:31], s43 offen lds
    s_mov_b32 m0, 0xc400
    s_add_u32 s43, s46, 0x13400
    buffer_load_dwordx4 v51, s[28:31], s43 offen lds
    s_mov_b32 m0, 0xc800
    s_add_u32 s43, s46, 0x14600
    buffer_load_dwordx4 v50, s[28:31], s43 offen lds
    s_mov_b32 m0, 0xcc00
    s_add_u32 s43, s46, 0x15800
    buffer_load_dwordx4 v51, s[28:31], s43 offen lds
    ds_read_b64_tr_b16 a[112:113], v53 offset:20480
    ds_read_b64_tr_b16 a[114:115], v53 offset:20992
    ds_read_b64_tr_b16 a[116:117], v55 offset:20480
    ds_read_b64_tr_b16 a[118:119], v55 offset:20992
    ds_read_b64_tr_b16 a[120:121], v54 offset:20480
    ds_read_b64_tr_b16 a[122:123], v54 offset:20992
    ds_read_b64_tr_b16 a[124:125], v56 offset:20480
    ds_read_b64_tr_b16 a[126:127], v56 offset:20992
    s_waitcnt lgkmcnt(0)
    s_waitcnt vmcnt(24)
    s_barrier
    s_mov_b32 m0, 0xd000
    s_add_u32 s43, s46, 0x12300
    buffer_load_dwordx4 v50, s[28:31], s43 offen lds
    s_mov_b32 m0, 0xd400
    s_add_u32 s43, s46, 0x13500
    buffer_load_dwordx4 v51, s[28:31], s43 offen lds
    s_mov_b32 m0, 0xd800
    s_add_u32 s43, s46, 0x14700
    buffer_load_dwordx4 v50, s[28:31], s43 offen lds
    s_mov_b32 m0, 0xdc00
    s_add_u32 s43, s46, 0x15900
    buffer_load_dwordx4 v51, s[28:31], s43 offen lds
    ds_read_b64_tr_b16 a[240:241], v57 offset:24576
    ds_read_b64_tr_b16 a[242:243], v57 offset:25088
    ds_read_b64_tr_b16 a[244:245], v57 offset:26624
    ds_read_b64_tr_b16 a[246:247], v57 offset:27136
    ds_read_b64_tr_b16 a[248:249], v58 offset:24576
    ds_read_b64_tr_b16 a[250:251], v58 offset:25088
    ds_read_b64_tr_b16 a[252:253], v58 offset:26624
    ds_read_b64_tr_b16 a[254:255], v58 offset:27136
    s_waitcnt lgkmcnt(0)
    s_waitcnt vmcnt(24)
    s_barrier
    s_mov_b32 m0, 0xe000
    s_add_u32 s43, s46, 0x400
    buffer_load_dwordx4 v52, s[28:31], s43 offen lds
    s_mov_b32 m0, 0xe400
    s_add_u32 s43, s46, 0x2800
    buffer_load_dwordx4 v52, s[28:31], s43 offen lds
    s_mov_b32 m0, 0xe800
    s_add_u32 s43, s46, 0x4c00
    buffer_load_dwordx4 v52, s[28:31], s43 offen lds
    s_mov_b32 m0, 0xec00
    s_add_u32 s43, s46, 0x7000
    buffer_load_dwordx4 v52, s[28:31], s43 offen lds
    ds_read_b64_tr_b16 a[128:129], v57 offset:28672
    ds_read_b64_tr_b16 a[130:131], v57 offset:29184
    ds_read_b64_tr_b16 a[132:133], v57 offset:30720
    ds_read_b64_tr_b16 a[134:135], v57 offset:31232
    ds_read_b64_tr_b16 a[136:137], v58 offset:28672
    ds_read_b64_tr_b16 a[138:139], v58 offset:29184
    ds_read_b64_tr_b16 a[140:141], v58 offset:30720
    ds_read_b64_tr_b16 a[142:143], v58 offset:31232
    s_waitcnt lgkmcnt(0)
    v_mov_b32 v30, 0
    buffer_load_dwordx2 v[24:25], v30, s[12:15], 0 offen sc1
    s_waitcnt vmcnt(25)
    s_barrier
    s_mov_b32 m0, 0xf000
    s_add_u32 s43, s45, 0x400000
    buffer_load_dwordx4 v48, s[24:27], s43 offen lds
    s_mov_b32 m0, 0xf400
    s_add_u32 s43, s45, 0x408000
    buffer_load_dwordx4 v49, s[24:27], s43 offen lds
    s_mov_b32 m0, 0xf800
    s_add_u32 s43, s45, 0x410000
    buffer_load_dwordx4 v48, s[24:27], s43 offen lds
    s_mov_b32 m0, 0xfc00
    s_add_u32 s43, s45, 0x418000
    buffer_load_dwordx4 v49, s[24:27], s43 offen lds
    ds_read_b64_tr_b16 v[32:33], v57 offset:0
    ds_read_b64_tr_b16 v[34:35], v57 offset:512
    ds_read_b64_tr_b16 v[36:37], v57 offset:2048
    ds_read_b64_tr_b16 v[38:39], v57 offset:2560
    ds_read_b64_tr_b16 v[40:41], v58 offset:0
    ds_read_b64_tr_b16 v[42:43], v58 offset:512
    ds_read_b64_tr_b16 v[44:45], v58 offset:2048
    ds_read_b64_tr_b16 v[46:47], v58 offset:2560
    s_waitcnt lgkmcnt(0)
    s_waitcnt vmcnt(25)
    s_barrier
    ds_write_b128 v1, a[144:147] offset:0
    ds_write_b128 v1, a[148:151] offset:1024
    ds_write_b128 v1, a[152:155] offset:2048
    ds_write_b128 v1, a[156:159] offset:3072
    s_waitcnt lgkmcnt(0)
    v_accvgpr_write_b32 a144, v32
    v_accvgpr_write_b32 a145, v33
    v_accvgpr_write_b32 a146, v34
    v_accvgpr_write_b32 a147, v35
    v_accvgpr_write_b32 a148, v36
    v_accvgpr_write_b32 a149, v37
    v_accvgpr_write_b32 a150, v38
    v_accvgpr_write_b32 a151, v39
    v_accvgpr_write_b32 a152, v40
    v_accvgpr_write_b32 a153, v41
    v_accvgpr_write_b32 a154, v42
    v_accvgpr_write_b32 a155, v43
    v_accvgpr_write_b32 a156, v44
    v_accvgpr_write_b32 a157, v45
    v_accvgpr_write_b32 a158, v46
    v_accvgpr_write_b32 a159, v47
    ds_read_b64_tr_b16 v[32:33], v57 offset:4096
    ds_read_b64_tr_b16 v[34:35], v57 offset:4608
    ds_read_b64_tr_b16 v[36:37], v57 offset:6144
    ds_read_b64_tr_b16 v[38:39], v57 offset:6656
    ds_read_b64_tr_b16 v[40:41], v58 offset:4096
    ds_read_b64_tr_b16 v[42:43], v58 offset:4608
    ds_read_b64_tr_b16 v[44:45], v58 offset:6144
    ds_read_b64_tr_b16 v[46:47], v58 offset:6656
    s_waitcnt lgkmcnt(0)
    s_waitcnt vmcnt(21)
    s_barrier
    ds_write_b128 v1, a[160:163] offset:4096
    ds_write_b128 v1, a[164:167] offset:5120
    ds_write_b128 v1, a[168:171] offset:6144
    ds_write_b128 v1, a[172:175] offset:7168
    s_waitcnt lgkmcnt(0)
    v_accvgpr_write_b32 a160, v32
    v_accvgpr_write_b32 a161, v33
    v_accvgpr_write_b32 a162, v34
    v_accvgpr_write_b32 a163, v35
    v_accvgpr_write_b32 a164, v36
    v_accvgpr_write_b32 a165, v37
    v_accvgpr_write_b32 a166, v38
    v_accvgpr_write_b32 a167, v39
    v_accvgpr_write_b32 a168, v40
    v_accvgpr_write_b32 a169, v41
    v_accvgpr_write_b32 a170, v42
    v_accvgpr_write_b32 a171, v43
    v_accvgpr_write_b32 a172, v44
    v_accvgpr_write_b32 a173, v45
    v_accvgpr_write_b32 a174, v46
    v_accvgpr_write_b32 a175, v47
    ds_read_b64_tr_b16 v[32:33], v57 offset:8192
    ds_read_b64_tr_b16 v[34:35], v57 offset:8704
    ds_read_b64_tr_b16 v[36:37], v57 offset:10240
    ds_read_b64_tr_b16 v[38:39], v57 offset:10752
    ds_read_b64_tr_b16 v[40:41], v58 offset:8192
    ds_read_b64_tr_b16 v[42:43], v58 offset:8704
    ds_read_b64_tr_b16 v[44:45], v58 offset:10240
    ds_read_b64_tr_b16 v[46:47], v58 offset:10752
    s_waitcnt lgkmcnt(0)
    s_waitcnt vmcnt(17)
    s_barrier
    ds_write_b128 v1, a[176:179] offset:8192
    ds_write_b128 v1, a[180:183] offset:9216
    ds_write_b128 v1, a[184:187] offset:10240
    ds_write_b128 v1, a[188:191] offset:11264
    s_waitcnt lgkmcnt(0)
    v_accvgpr_write_b32 a176, v32
    v_accvgpr_write_b32 a177, v33
    v_accvgpr_write_b32 a178, v34
    v_accvgpr_write_b32 a179, v35
    v_accvgpr_write_b32 a180, v36
    v_accvgpr_write_b32 a181, v37
    v_accvgpr_write_b32 a182, v38
    v_accvgpr_write_b32 a183, v39
    v_accvgpr_write_b32 a184, v40
    v_accvgpr_write_b32 a185, v41
    v_accvgpr_write_b32 a186, v42
    v_accvgpr_write_b32 a187, v43
    v_accvgpr_write_b32 a188, v44
    v_accvgpr_write_b32 a189, v45
    v_accvgpr_write_b32 a190, v46
    v_accvgpr_write_b32 a191, v47
    ds_read_b64_tr_b16 v[32:33], v57 offset:12288
    ds_read_b64_tr_b16 v[34:35], v57 offset:12800
    ds_read_b64_tr_b16 v[36:37], v57 offset:14336
    ds_read_b64_tr_b16 v[38:39], v57 offset:14848
    ds_read_b64_tr_b16 v[40:41], v58 offset:12288
    ds_read_b64_tr_b16 v[42:43], v58 offset:12800
    ds_read_b64_tr_b16 v[44:45], v58 offset:14336
    ds_read_b64_tr_b16 v[46:47], v58 offset:14848
    s_waitcnt lgkmcnt(0)
    s_waitcnt vmcnt(13)
    s_barrier
    ds_write_b128 v1, a[192:195] offset:12288
    ds_write_b128 v1, a[196:199] offset:13312
    ds_write_b128 v1, a[200:203] offset:14336
    ds_write_b128 v1, a[204:207] offset:15360
    s_waitcnt lgkmcnt(0)
    v_accvgpr_write_b32 a192, v32
    v_accvgpr_write_b32 a193, v33
    v_accvgpr_write_b32 a194, v34
    v_accvgpr_write_b32 a195, v35
    v_accvgpr_write_b32 a196, v36
    v_accvgpr_write_b32 a197, v37
    v_accvgpr_write_b32 a198, v38
    v_accvgpr_write_b32 a199, v39
    v_accvgpr_write_b32 a200, v40
    v_accvgpr_write_b32 a201, v41
    v_accvgpr_write_b32 a202, v42
    v_accvgpr_write_b32 a203, v43
    v_accvgpr_write_b32 a204, v44
    v_accvgpr_write_b32 a205, v45
    v_accvgpr_write_b32 a206, v46
    v_accvgpr_write_b32 a207, v47
    ds_read_b64_tr_b16 v[32:33], v57 offset:16384
    ds_read_b64_tr_b16 v[34:35], v57 offset:16896
    ds_read_b64_tr_b16 v[36:37], v57 offset:18432
    ds_read_b64_tr_b16 v[38:39], v57 offset:18944
    ds_read_b64_tr_b16 v[40:41], v58 offset:16384
    ds_read_b64_tr_b16 v[42:43], v58 offset:16896
    ds_read_b64_tr_b16 v[44:45], v58 offset:18432
    ds_read_b64_tr_b16 v[46:47], v58 offset:18944
    s_waitcnt lgkmcnt(0)
    s_waitcnt vmcnt(9)
    s_barrier
    ds_write_b128 v1, a[208:211] offset:16384
    ds_write_b128 v1, a[212:215] offset:17408
    ds_write_b128 v1, a[216:219] offset:18432
    ds_write_b128 v1, a[220:223] offset:19456
    s_waitcnt lgkmcnt(0)
    v_accvgpr_write_b32 a208, v32
    v_accvgpr_write_b32 a209, v33
    v_accvgpr_write_b32 a210, v34
    v_accvgpr_write_b32 a211, v35
    v_accvgpr_write_b32 a212, v36
    v_accvgpr_write_b32 a213, v37
    v_accvgpr_write_b32 a214, v38
    v_accvgpr_write_b32 a215, v39
    v_accvgpr_write_b32 a216, v40
    v_accvgpr_write_b32 a217, v41
    v_accvgpr_write_b32 a218, v42
    v_accvgpr_write_b32 a219, v43
    v_accvgpr_write_b32 a220, v44
    v_accvgpr_write_b32 a221, v45
    v_accvgpr_write_b32 a222, v46
    v_accvgpr_write_b32 a223, v47
    ds_read_b64_tr_b16 v[32:33], v57 offset:20480
    ds_read_b64_tr_b16 v[34:35], v57 offset:20992
    ds_read_b64_tr_b16 v[36:37], v57 offset:22528
    ds_read_b64_tr_b16 v[38:39], v57 offset:23040
    ds_read_b64_tr_b16 v[40:41], v58 offset:20480
    ds_read_b64_tr_b16 v[42:43], v58 offset:20992
    ds_read_b64_tr_b16 v[44:45], v58 offset:22528
    ds_read_b64_tr_b16 v[46:47], v58 offset:23040
    s_waitcnt lgkmcnt(0)
    s_waitcnt vmcnt(5)
    s_barrier
    ds_write_b128 v1, a[224:227] offset:20480
    ds_write_b128 v1, a[228:231] offset:21504
    ds_write_b128 v1, a[232:235] offset:22528
    ds_write_b128 v1, a[236:239] offset:23552
    s_waitcnt lgkmcnt(0)
    v_accvgpr_write_b32 a224, v32
    v_accvgpr_write_b32 a225, v33
    v_accvgpr_write_b32 a226, v34
    v_accvgpr_write_b32 a227, v35
    v_accvgpr_write_b32 a228, v36
    v_accvgpr_write_b32 a229, v37
    v_accvgpr_write_b32 a230, v38
    v_accvgpr_write_b32 a231, v39
    v_accvgpr_write_b32 a232, v40
    v_accvgpr_write_b32 a233, v41
    v_accvgpr_write_b32 a234, v42
    v_accvgpr_write_b32 a235, v43
    v_accvgpr_write_b32 a236, v44
    v_accvgpr_write_b32 a237, v45
    v_accvgpr_write_b32 a238, v46
    v_accvgpr_write_b32 a239, v47
    ds_read_b64_tr_b16 v[32:33], v61 offset:24576
    ds_read_b64_tr_b16 v[34:35], v61 offset:24832
    ds_read_b64_tr_b16 v[36:37], v61 offset:25600
    ds_read_b64_tr_b16 v[38:39], v61 offset:25856
    ds_read_b64_tr_b16 v[40:41], v62 offset:24576
    ds_read_b64_tr_b16 v[42:43], v62 offset:24832
    ds_read_b64_tr_b16 v[44:45], v62 offset:25600
    ds_read_b64_tr_b16 v[46:47], v62 offset:25856
    s_waitcnt lgkmcnt(0)
    s_waitcnt vmcnt(0)
    s_barrier
    ds_write_b128 v1, a[240:243] offset:24576
    ds_write_b128 v1, a[244:247] offset:25600
    ds_write_b128 v1, a[248:251] offset:26624
    ds_write_b128 v1, a[252:255] offset:27648
    s_waitcnt lgkmcnt(0)
    v_accvgpr_write_b32 a240, v32
    v_accvgpr_write_b32 a241, v33
    v_accvgpr_write_b32 a242, v34
    v_accvgpr_write_b32 a243, v35
    v_accvgpr_write_b32 a244, v36
    v_accvgpr_write_b32 a245, v37
    v_accvgpr_write_b32 a246, v38
    v_accvgpr_write_b32 a247, v39
    v_accvgpr_write_b32 a248, v40
    v_accvgpr_write_b32 a249, v41
    v_accvgpr_write_b32 a250, v42
    v_accvgpr_write_b32 a251, v43
    v_accvgpr_write_b32 a252, v44
    v_accvgpr_write_b32 a253, v45
    v_accvgpr_write_b32 a254, v46
    v_accvgpr_write_b32 a255, v47
    ds_read_b64_tr_b16 v[32:33], v53 offset:28672
    ds_read_b64_tr_b16 v[34:35], v53 offset:29184
    ds_read_b64_tr_b16 v[36:37], v55 offset:28672
    ds_read_b64_tr_b16 v[38:39], v55 offset:29184
    ds_read_b64_tr_b16 v[40:41], v54 offset:28672
    ds_read_b64_tr_b16 v[42:43], v54 offset:29184
    ds_read_b64_tr_b16 v[44:45], v56 offset:28672
    ds_read_b64_tr_b16 v[46:47], v56 offset:29184
    s_waitcnt lgkmcnt(0)
    s_barrier
    ds_write_b128 v1, a[128:131] offset:28672
    ds_write_b128 v1, a[132:135] offset:29696
    ds_write_b128 v1, a[136:139] offset:30720
    ds_write_b128 v1, a[140:143] offset:31744
    s_waitcnt lgkmcnt(0)
    v_accvgpr_write_b32 a128, v32
    v_accvgpr_write_b32 a129, v33
    v_accvgpr_write_b32 a130, v34
    v_accvgpr_write_b32 a131, v35
    v_accvgpr_write_b32 a132, v36
    v_accvgpr_write_b32 a133, v37
    v_accvgpr_write_b32 a134, v38
    v_accvgpr_write_b32 a135, v39
    v_accvgpr_write_b32 a136, v40
    v_accvgpr_write_b32 a137, v41
    v_accvgpr_write_b32 a138, v42
    v_accvgpr_write_b32 a139, v43
    v_accvgpr_write_b32 a140, v44
    v_accvgpr_write_b32 a141, v45
    v_accvgpr_write_b32 a142, v46
    v_accvgpr_write_b32 a143, v47
    v_mov_b32 v28, v24
    v_mov_b32 v29, v25
    v_mov_b32 v30, 0
    s_mov_b32 s49, 0
    s_branch L_sbe_0
    s_mov_b32 s49, 0
    v_mov_b32 v30, 0
L_sb_14:
    buffer_load_dwordx2 v[28:29], v30, s[12:15], 0 offen sc1
    s_add_u32 s49, s49, 1
    s_cmp_gt_u32 s49, 4000000
    s_cbranch_scc1 L_fail
    s_waitcnt vmcnt(0)
L_sbe_0:
    v_sad_u8 v31, v28, 0, 0
    v_sad_u8 v31, v29, 0, v31
    v_or_b32 v32, v28, v29
    v_readfirstlane_b32 s43, v31
    v_readfirstlane_b32 s44, v32
    s_cmp_lt_u32 s43, 32
    s_cbranch_scc1 L_sb_14
    s_and_b32 s90, s44, 0x20202020
    s_barrier
    s_mov_b32 s46, 0
    s_cmp_eq_u32 s90, 0
    s_cbranch_scc1 L_slowmode_0
    ds_read_b128 v[32:35], v0 offset:4096
    ds_read_b32 v12, v11 offset:8192
    ds_read_b128 v[40:43], v1 offset:0
    ds_read_b128 v[44:47], v1 offset:1024
    v_mov_b64 v[16:17], 0
    v_mov_b64 v[18:19], 0
    v_mov_b64 v[20:21], 0
    v_mov_b64 v[22:23], 0
    v_mov_b64 v[24:25], 0
    v_mov_b64 v[26:27], 0
    v_mov_b64 v[28:29], 0
    v_mov_b64 v[30:31], 0
    s_waitcnt vmcnt(0) lgkmcnt(0)
    s_nop 0
    s_branch L_gar_f0
L_loop_f0:
    s_barrier
    s_add_u32 s43, s40, 0
    buffer_load_dwordx4 v[60:63], v0, s[8:11], s43 offen sc1
    v_mov_b64 v[16:17], 0
    v_mov_b64 v[18:19], 0
    v_mov_b64 v[20:21], 0
    v_mov_b64 v[22:23], 0
    v_mov_b64 v[24:25], 0
    v_mov_b64 v[26:27], 0
    v_mov_b64 v[28:29], 0
    v_mov_b64 v[30:31], 0
    s_nop 15
    s_nop 7
    s_add_u32 s43, s40, 0
    buffer_load_dwordx4 v[56:59], v0, s[8:11], s43 offen sc1
    s_waitcnt vmcnt(1)
    ds_write_b128 v0, v[60:63] offset:0
    v_max3_u32 v14, v60, v61, v62
    v_max_u32 v14, v14, v63
    v_cmp_le_u32 vcc, s51, v14
    s_add_u32 s43, s40, 4096
    buffer_load_dwordx4 v[32:35], v0, s[8:11], s43 offen sc1
    s_add_u32 s43, s40, 8192
    buffer_load_dword v12, v11, s[8:11], s43 offen sc1
    s_cbranch_vccnz L_ga_f0
L_gar_f0:
    ds_read_b64_tr_b16 v[48:49], v2 offset:0
    ds_read_b64_tr_b16 v[50:51], v3 offset:0
    ds_read_b128 v[40:43], v1 offset:0
    ds_read_b128 v[44:47], v1 offset:1024
    s_waitcnt lgkmcnt(4)
    s_barrier
    ds_read_b64_tr_b16 v[52:53], v2 offset:1024
    ds_read_b64_tr_b16 v[54:55], v3 offset:1024
    s_waitcnt lgkmcnt(4)
    s_waitcnt lgkmcnt(2)
    v_smfmac_f32_16x16x64_bf16 v[16:19], v[48:51], v[40:47], v10
    s_waitcnt vmcnt(2)
    ds_read_b64_tr_b16 v[56:57], v2 offset:2048
    ds_read_b64_tr_b16 v[58:59], v3 offset:2048
    v_smfmac_f32_16x16x64_bf16 v[24:27], v[48:51], v[176:183], v10
    ds_read_b64_tr_b16 v[60:61], v2 offset:3072
    ds_read_b64_tr_b16 v[62:63], v3 offset:3072
    v_smfmac_f32_16x16x64_bf16 v[28:31], v[48:51], v[184:191], v10
    ds_read_b128 v[40:43], v1 offset:2048
    ds_read_b128 v[44:47], v1 offset:3072
    s_waitcnt lgkmcnt(6)
    v_smfmac_f32_16x16x64_bf16 v[16:19], v[52:55], v[64:71], v10
    s_add_u32 s43, s40, 4096
    buffer_load_dwordx4 v[36:39], v0, s[8:11], s43 offen sc1
    s_add_u32 s43, s40, 8192
    buffer_load_dword v13, v11, s[8:11], s43 offen sc1
    v_smfmac_f32_16x16x64_bf16 v[20:23], v[52:55], v[72:79], v10
    v_smfmac_f32_16x16x64_bf16 v[24:27], v[52:55], v[192:199], v10
    s_waitcnt lgkmcnt(0)
    v_smfmac_f32_16x16x64_bf16 v[20:23], v[48:51], v[40:47], v10
    ds_read_b128 v[40:43], v1 offset:8192
    v_smfmac_f32_16x16x64_bf16 v[28:31], v[52:55], v[200:207], v10
    ds_read_b128 v[44:47], v1 offset:9216
    v_smfmac_f32_16x16x64_bf16 v[16:19], v[56:59], v[80:87], v10
    s_waitcnt vmcnt(2)
    ds_write_b128 v0, v[32:35] offset:4096
    v_max3_u32 v14, v32, v33, v34
    v_smfmac_f32_16x16x64_bf16 v[20:23], v[56:59], v[88:95], v10
    ds_write_b32 v11, v12 offset:8192
    v_max3_u32 v14, v14, v35, v12
    v_smfmac_f32_16x16x64_bf16 v[24:27], v[56:59], v[208:215], v10
    v_cmp_le_u32 vcc, s51, v14
    v_smfmac_f32_16x16x64_bf16 v[28:31], v[56:59], v[216:223], v10
    s_cbranch_vccnz L_gb_f0
L_gbr_f0:
    ds_read_b64_tr_b16 v[48:49], v2 offset:4096
    v_smfmac_f32_16x16x64_bf16 v[16:19], v[60:63], v[96:103], v10
    ds_read_b64_tr_b16 v[50:51], v3 offset:4096
    v_smfmac_f32_16x16x64_bf16 v[20:23], v[60:63], v[104:111], v10
    s_waitcnt lgkmcnt(2)
    s_barrier
    ds_read_b64_tr_b16 v[52:53], v2 offset:5120
    ds_read_b64_tr_b16 v[54:55], v3 offset:5120
    v_smfmac_f32_16x16x64_bf16 v[24:27], v[60:63], v[40:47], v10
    ds_read_b64_tr_b16 v[56:57], v2 offset:6144
    ds_read_b64_tr_b16 v[58:59], v3 offset:6144
    s_waitcnt lgkmcnt(4)
    v_smfmac_f32_16x16x64_bf16 v[16:19], v[48:51], v[112:119], v10
    s_waitcnt vmcnt(0)
    ds_read_b128 v[32:35], v1 offset:10240
    ds_read_b128 v[36:39], v1 offset:11264
    v_smfmac_f32_16x16x64_bf16 v[20:23], v[48:51], v[120:127], v10
    ds_read_b128 v[40:43], v1 offset:4096
    ds_read_b128 v[44:47], v1 offset:5120
    v_smfmac_f32_16x16x64_bf16 v[24:27], v[48:51], v[224:231], v10
    v_smfmac_f32_16x16x64_bf16 v[28:31], v[48:51], v[232:239], v10
    ds_read_b64_tr_b16 v[48:49], v2 offset:8192
    ds_read_b64_tr_b16 v[50:51], v3 offset:8192
    s_waitcnt lgkmcnt(8)
    v_smfmac_f32_16x16x64_bf16 v[24:27], v[52:55], v[240:247], v10
    s_waitcnt lgkmcnt(4)
    v_smfmac_f32_16x16x64_bf16 v[28:31], v[60:63], v[32:39], v10
    ds_read_b64_tr_b16 v[60:61], v2 offset:7168
    s_waitcnt lgkmcnt(3)
    v_smfmac_f32_16x16x64_bf16 v[16:19], v[52:55], v[40:47], v10
    ds_read_b64_tr_b16 v[62:63], v3 offset:7168
    v_smfmac_f32_16x16x64_bf16 v[28:31], v[52:55], v[248:255], v10
    ds_read_b128 v[32:35], v1 offset:6144
    v_smfmac_f32_16x16x64_bf16 v[16:19], v[56:59], v[128:135], v10
    ds_read_b128 v[36:39], v1 offset:7168
    v_and_b32 v12, 0x200, v0
    v_smfmac_f32_16x16x64_bf16 v[20:23], v[56:59], v[136:143], v10
    ds_read_b128 v[40:43], v1 offset:12288
    v_mul_u32_u24 v12, 3, v12
    s_waitcnt lgkmcnt(3)
    v_smfmac_f32_16x16x64_bf16 v[16:19], v[60:63], v[144:151], v10
    ds_read_b128 v[44:47], v1 offset:13312
    v_add_u32 v12, v12, v0
    s_waitcnt lgkmcnt(2)
    v_smfmac_f32_16x16x64_bf16 v[20:23], v[52:55], v[32:39], v10
    ds_read_b128 v[12:15], v12 offset:9216
    v_smfmac_f32_16x16x64_bf16 v[20:23], v[60:63], v[152:159], v10
    ds_read_b128 v[32:35], v1 offset:14336
    v_smfmac_f32_16x16x64_bf16 v[16:19], v[48:51], v[160:167], v10
    ds_read_b128 v[36:39], v1 offset:15360
    v_smfmac_f32_16x16x64_bf16 v[20:23], v[48:51], v[168:175], v10
    s_waitcnt lgkmcnt(3)
    v_smfmac_f32_16x16x64_bf16 v[24:27], v[56:59], v[40:47], v10
    s_waitcnt lgkmcnt(2)
    s_lshr_b32 s44, s48, 1
    s_add_u32 s44, s44, 0x40e0000
    buffer_store_dwordx4 v[12:15], v0, s[8:11], s44 offen sc1
    v_add_f32 v16, v16, v18
    v_add_f32 v17, v17, v19
    s_waitcnt lgkmcnt(0)
    v_smfmac_f32_16x16x64_bf16 v[28:31], v[56:59], v[32:39], v10
    ds_read_b128 v[32:35], v1 offset:22528
    v_cvt_pk_bf16_f32 v16, v16, v17
    v_add_f32 v20, v20, v22
    v_smfmac_f32_16x16x64_bf16 v[24:27], v[60:63], a[0:7], v10
    ds_read_b128 v[36:39], v1 offset:23552
    v_add_f32 v21, v21, v23
    v_cvt_pk_bf16_f32 v17, v20, v21
    v_smfmac_f32_16x16x64_bf16 v[24:27], v[48:51], a[16:23], v10
    ds_write_b64 v4, v[16:17] offset:9216
    v_mov_b64 v[40:41], 0
    v_mov_b64 v[42:43], 0
    v_smfmac_f32_16x16x64_bf16 v[28:31], v[60:63], a[8:15], v10
    ds_read_b128 v[16:19], v1 offset:20480
    v_mov_b64 v[44:45], 0
    v_mov_b64 v[46:47], 0
    v_smfmac_f32_16x16x64_bf16 v[28:31], v[48:51], a[24:31], v10
    ds_read_b128 v[20:23], v1 offset:21504
    v_add_f32 v24, v24, v26
    v_add_f32 v25, v25, v27
    v_cvt_pk_bf16_f32 v24, v24, v25
    v_smfmac_f32_16x16x64_bf16 v[40:43], v[52:55], a[96:103], v10
    v_smfmac_f32_16x16x64_bf16 v[44:47], v[52:55], a[104:111], v10
    v_add_f32 v28, v28, v30
    v_add_f32 v29, v29, v31
    v_cvt_pk_bf16_f32 v25, v28, v29
    ds_write2st64_b32 v11, v24, v25 offset0:44 offset1:45
    s_waitcnt lgkmcnt(4)
    v_smfmac_f32_16x16x64_bf16 v[44:47], v[56:59], v[32:39], v10
    ds_read_b128 v[24:27], v0 offset:18432
    v_mov_b64 v[52:53], 0
    v_mov_b64 v[54:55], 0
    v_smfmac_f32_16x16x64_bf16 v[40:43], v[60:63], a[112:119], v10
    ds_read_b128 v[28:31], v0 offset:19456
    s_waitcnt lgkmcnt(3)
    v_smfmac_f32_16x16x64_bf16 v[40:43], v[56:59], v[16:23], v10
    ds_read_b64_tr_b16 v[56:57], v2 offset:0
    ds_read_b128 v[16:19], v0 offset:16384
    ds_read_b128 v[20:23], v0 offset:17408
    ds_read_b64_tr_b16 v[58:59], v3 offset:0
    s_waitcnt lgkmcnt(6)
    s_barrier
    s_cmp_eq_u32 s38, 63
    s_cbranch_scc1 L_tail_f0
    ds_read_b64_tr_b16 v[32:33], v2 offset:9216
    ds_read_b64_tr_b16 v[34:35], v3 offset:9216
    ds_read_b64_tr_b16 v[36:37], v2 offset:10240
    ds_read_b64_tr_b16 v[38:39], v3 offset:10240
    s_waitcnt lgkmcnt(5)
    v_smfmac_f32_16x16x64_bf16 v[44:47], v[60:63], a[120:127], v10
    s_mov_b32 m0, 0x4000
    s_add_u32 s55, s48, 0x1040000
    buffer_load_dwordx4 v0, s[8:11], s55 offen sc1 lds
    buffer_load_dwordx4 v0, s[8:11], s55 offen offset:1024 sc1 lds
    v_smfmac_f32_16x16x64_bf16 v[40:43], v[48:51], a[128:135], v10
    buffer_load_dwordx4 v0, s[8:11], s55 offen offset:2048 sc1 lds
    buffer_load_dwordx4 v0, s[8:11], s55 offen offset:3072 sc1 lds
    v_smfmac_f32_16x16x64_bf16 v[44:47], v[48:51], a[136:143], v10
    ds_read_b64_tr_b16 v[60:61], v2 offset:1024
    ds_read_b64_tr_b16 v[62:63], v3 offset:1024
    s_waitcnt lgkmcnt(6)
    v_smfmac_f32_16x16x64_bf16 v[40:43], v[56:59], a[32:39], v10
    ds_read_b64_tr_b16 v[48:49], v2 offset:2048
    ds_read_b64_tr_b16 v[50:51], v3 offset:2048
    s_waitcnt lgkmcnt(4)
    v_smfmac_f32_16x16x64_bf16 v[52:55], v[32:35], v[16:23], v10
    v_smfmac_f32_16x16x64_bf16 v[52:55], v[36:39], v[24:31], v10
    ds_read_b128 v[16:19], v1 offset:16384
    ds_read_b128 v[20:23], v1 offset:17408
    v_smfmac_f32_16x16x64_bf16 v[44:47], v[56:59], a[40:47], v10
    ds_read_b128 v[24:27], v1 offset:18432
    ds_read_b128 v[28:31], v1 offset:19456
    s_waitcnt lgkmcnt(6)
    v_smfmac_f32_16x16x64_bf16 v[40:43], v[60:63], a[48:55], v10
    ds_read_b64_tr_b16 v[56:57], v2 offset:3072
    ds_read_b64_tr_b16 v[58:59], v3 offset:3072
    v_add_f32 v52, v52, v54
    v_add_f32 v53, v53, v55
    v_mul_f32 v52, s50, v52
    v_mul_f32 v53, s50, v53
    v_exp_f32 v54, v52
    v_exp_f32 v55, v53
    s_nop 0
    v_cvt_pk_bf16_f32 v54, v54, v55
    ds_write_b32 v11, v54 offset:15360
    v_smfmac_f32_16x16x64_bf16 v[44:47], v[60:63], a[56:63], v10
    ds_read_b64_tr_b16 v[60:61], v2 offset:4096
    ds_read_b64_tr_b16 v[62:63], v3 offset:4096
    s_waitcnt lgkmcnt(9)
    s_waitcnt lgkmcnt(7)
    v_smfmac_f32_16x16x64_bf16 v[40:43], v[48:51], v[16:23], v10
    s_waitcnt lgkmcnt(5)
    v_smfmac_f32_16x16x64_bf16 v[44:47], v[48:51], v[24:31], v10
    s_waitcnt lgkmcnt(2)
    s_barrier
L_pv_f0:
    ds_read_b64_tr_b16 v[48:49], v5 offset:15360
    ds_read_b64_tr_b16 v[50:51], v5 offset:15616
    ds_read_b64_tr_b16 v[54:55], v8 offset:15872
    s_cmp_eq_u32 s46, 0x5105
    s_cbranch_scc1 L_pv2_f0
    ds_read_b128 v[24:27], v0 offset:24576
    ds_read_b128 v[28:31], v0 offset:25600
    v_smfmac_f32_16x16x64_bf16 v[40:43], v[56:59], a[64:71], v10
    v_mov_b64 v[32:33], s[98:99]
    v_smfmac_f32_16x16x64_bf16 v[44:47], v[56:59], a[72:79], v10
    s_waitcnt lgkmcnt(5)
    v_smfmac_f32_16x16x64_bf16 v[40:43], v[60:63], a[80:87], v10
    v_mov_b64 v[56:57], s[96:97]
    v_smfmac_f32_16x16x64_bf16 v[44:47], v[60:63], a[88:95], v10
    v_mov_b64 v[58:59], s[96:97]
    s_waitcnt lgkmcnt(0)
    s_nop 0
    v_mfma_f32_16x16x32_bf16 v[36:39], v[56:59], v[48:51], 0
    v_mfma_f32_16x16x32_bf16 v[16:19], v[24:27], v[48:51], 0
    v_add_f32 v40, v40, v42
    v_add_f32 v41, v41, v43
    v_mfma_f32_16x16x32_bf16 v[20:23], v[28:31], v[48:51], 0
    v_cvt_pk_bf16_f32 v40, v40, v41
    v_mov_b32 v41, 0
    v_mfma_f32_16x16x16_bf16 v[36:39], v[32:33], v[54:55], v[36:39]
    v_add_f32 v44, v44, v46
    v_add_f32 v45, v45, v47
    v_mfma_f32_16x16x16_bf16 v[16:19], v[40:41], v[54:55], v[16:19]
    v_cvt_pk_bf16_f32 v44, v44, v45
    v_mov_b32 v45, 0
    s_nop 1
    v_mfma_f32_16x16x16_bf16 v[20:23], v[44:45], v[54:55], v[20:23]
L_pv4_f0:
    ds_read_b128 v[56:59], v1 offset:24576
    ds_read_b128 v[60:63], v1 offset:25600
    ds_read_b128 v[24:27], v1 offset:26624
    ds_read_b128 v[28:31], v1 offset:27648
    v_rcp_f32 v34, v36
    v_cmp_ngt_f32 vcc, s69, v36
    v_cmp_nlt_f32 s[44:45], s68, v36
    v_cndmask_b32 v16, v18, v16, s[56:57]
    v_cndmask_b32 v17, v19, v17, s[56:57]
    s_or_b64 vcc, vcc, s[44:45]
    v_mul_f32 v16, v16, v34
    v_mul_f32 v17, v17, v34
    v_cndmask_b32 v20, v22, v20, s[56:57]
    v_cndmask_b32 v21, v23, v21, s[56:57]
    v_cvt_pk_bf16_f32 v16, v16, v17
    v_mul_f32 v20, v20, v34
    v_mul_f32 v21, v21, v34
    s_cbranch_vccnz L_slow_f0
L_pv3_f0:
    v_cvt_pk_bf16_f32 v20, v20, v21
    ds_write2_b32 v6, v16, v20 offset0:0 offset1:2
    s_mov_b32 s46, 0
    v_lshrrev_b32 v12, 1, v0
    v_and_b32 v12, 0x1e0, v12
    v_and_or_b32 v12, v0, 16, v12
    v_mov_b64 v[48:49], 0
    v_mov_b64 v[50:51], 0
    v_mov_b64 v[52:53], 0
    v_mov_b64 v[54:55], 0
    v_mov_b64 v[16:17], 0
    v_mov_b64 v[18:19], 0
    v_mov_b64 v[20:21], 0
    v_mov_b64 v[22:23], 0
    s_waitcnt lgkmcnt(0)
    s_barrier
    ds_read_b128 v[32:35], v12 offset:13312
    ds_read_b128 v[36:39], v12 offset:13824
    ds_write2st64_b32 v11, v40, v44 offset0:36 offset1:37
    ds_read_b128 v[40:43], v12 offset:14336
    ds_read_b128 v[44:47], v12 offset:14848
    s_waitcnt lgkmcnt(4)
    v_smfmac_f32_16x16x64_bf16 v[16:19], v[32:35], v[56:63], v10
    ds_read_b128 v[56:59], v1 offset:28672
    v_smfmac_f32_16x16x64_bf16 v[20:23], v[32:35], a[144:151], v10
    ds_read_b128 v[60:63], v1 offset:29696
    s_waitcnt lgkmcnt(5)
    v_smfmac_f32_16x16x64_bf16 v[16:19], v[36:39], v[24:31], v10
    ds_read_b128 v[24:27], v1 offset:30720
    v_smfmac_f32_16x16x64_bf16 v[20:23], v[36:39], a[152:159], v10
    ds_read_b128 v[28:31], v1 offset:31744
    s_waitcnt lgkmcnt(5)
    v_smfmac_f32_16x16x64_bf16 v[16:19], v[40:43], a[176:183], v10
    v_smfmac_f32_16x16x64_bf16 v[20:23], v[40:43], a[192:199], v10
    s_waitcnt lgkmcnt(4)
    v_smfmac_f32_16x16x64_bf16 v[16:19], v[44:47], a[184:191], v10
    v_smfmac_f32_16x16x64_bf16 v[20:23], v[44:47], a[200:207], v10
    s_waitcnt lgkmcnt(2)
    v_smfmac_f32_16x16x64_bf16 v[48:51], v[32:35], v[56:63], v10
    v_cvt_pk_bf16_f32 v16, v16, v17
    v_cvt_pk_bf16_f32 v17, v18, v19
    v_and_or_b32 v16, v16, -2, s92
    s_waitcnt lgkmcnt(0)
    v_smfmac_f32_16x16x64_bf16 v[48:51], v[36:39], v[24:31], v10
    s_add_u32 s43, s39, 0
    buffer_store_dwordx2 v[16:17], v7, s[8:11], s43 offen
    v_cvt_pk_bf16_f32 v20, v20, v21
    v_cvt_pk_bf16_f32 v21, v22, v23
    v_and_or_b32 v20, v20, -2, s92
    v_smfmac_f32_16x16x64_bf16 v[48:51], v[40:43], a[208:215], v10
    s_add_u32 s43, s39, 65536
    buffer_store_dwordx2 v[20:21], v7, s[8:11], s43 offen
    v_cndmask_b32 v56, v32, v36, s[100:101]
    v_cndmask_b32 v57, v33, v37, s[100:101]
    v_cndmask_b32 v58, v34, v38, s[100:101]
    v_smfmac_f32_16x16x64_bf16 v[48:51], v[44:47], a[216:223], v10
    v_cndmask_b32 v59, v35, v39, s[100:101]
    v_cndmask_b32 v60, v40, v44, s[100:101]
    v_cndmask_b32 v61, v41, v45, s[100:101]
    v_smfmac_f32_16x16x64_bf16 v[52:55], v[32:35], a[160:167], v10
    v_cndmask_b32 v62, v42, v46, s[100:101]
    v_cndmask_b32 v63, v43, v47, s[100:101]
    v_mov_b64 v[24:25], 0
    v_smfmac_f32_16x16x64_bf16 v[52:55], v[36:39], a[168:175], v10
    v_mov_b64 v[26:27], 0
    s_nop 1
    v_smfmac_f32_16x16x64_bf16 v[24:27], v[56:59], a[240:247], v10
    v_cvt_pk_bf16_f32 v48, v48, v49
    v_cvt_pk_bf16_f32 v49, v50, v51
    v_smfmac_f32_16x16x64_bf16 v[24:27], v[60:63], a[248:255], v10
    v_and_or_b32 v48, v48, -2, s92
    v_smfmac_f32_16x16x64_bf16 v[52:55], v[40:43], a[224:231], v10
    s_add_u32 s43, s39, 131072
    buffer_store_dwordx2 v[48:49], v7, s[8:11], s43 offen
    v_smfmac_f32_16x16x64_bf16 v[52:55], v[44:47], a[232:239], v10
    v_add_f32 v24, v24, v26
    v_add_f32 v25, v25, v27
    v_cvt_pk_bf16_f32 v24, v24, v25
    v_and_or_b32 v24, v24, -2, s92
    s_add_u32 s43, s39, 262144
    buffer_store_dword v24, v7, s[8:11], s43 offen offset:0
    s_nop 1
    v_cvt_pk_bf16_f32 v52, v52, v53
    v_cvt_pk_bf16_f32 v53, v54, v55
    v_and_or_b32 v52, v52, -2, s92
    s_add_u32 s43, s39, 196608
    buffer_store_dwordx2 v[52:53], v7, s[8:11], s43 offen
    s_add_u32 s43, s39, s47
    s_mov_b32 s49, 0
    s_nop 15
    s_nop 11
    buffer_load_dwordx4 v[32:35], v0, s[8:11], s43 offen offset:0 sc1
    buffer_load_dwordx4 v[36:39], v0, s[8:11], s43 offen offset:1024 sc1
    buffer_load_dwordx4 v[40:43], v0, s[8:11], s43 offen offset:2048 sc1
    buffer_load_dwordx4 v[44:47], v0, s[8:11], s43 offen offset:3072 sc1
    v_mov_b32 v16, 0x3f80
    v_mov_b32 v17, 0x3f800000
    v_cndmask_b32 v16, v16, v17, s[66:67]
    v_cndmask_b32 v20, 0, v16, s[58:59]
    v_cndmask_b32 v21, 0, v16, s[60:61]
    v_cndmask_b32 v22, 0, v16, s[62:63]
    v_cndmask_b32 v23, 0, v16, s[64:65]
    v_mov_b32 v19, s92
    s_xor_b32 s92, s92, 1
    s_mov_b32 s45, s40
    s_mov_b32 s40, s41
    s_mov_b32 s41, s42
    s_mov_b32 s42, s93
    s_mov_b32 s93, s45
    s_add_u32 s38, s38, 1
    s_add_u32 s48, s48, 262144
    s_nop 15
    s_nop 15
    buffer_load_dwordx4 v[48:51], v0, s[8:11], s43 offen offset:0 sc1
    buffer_load_dwordx4 v[52:55], v0, s[8:11], s43 offen offset:1024 sc1
    buffer_load_dwordx4 v[56:59], v0, s[8:11], s43 offen offset:2048 sc1
    buffer_load_dwordx4 v[60:63], v0, s[8:11], s43 offen offset:3072 sc1
    s_waitcnt vmcnt(7)
    v_mfma_f32_16x16x32_bf16 v[24:27], v[20:23], v[32:35], 0
    v_bitop3_b32 v18, v32, v34, v19 bitop3:0x7e
    s_waitcnt vmcnt(6)
    v_mfma_f32_16x16x32_bf16 v[24:27], v[20:23], v[36:39], v[24:27]
    v_bitop3_b32 v16, v36, v38, v19 bitop3:0x7e
    v_or_b32 v18, v18, v16
    s_waitcnt vmcnt(5)
    v_mfma_f32_16x16x32_bf16 v[24:27], v[20:23], v[40:43], v[24:27]
    v_bitop3_b32 v16, v40, v42, v19 bitop3:0x7e
    v_or_b32 v18, v18, v16
    s_waitcnt vmcnt(4)
    v_mfma_f32_16x16x32_bf16 v[24:27], v[20:23], v[44:47], v[24:27]
    v_bitop3_b32 v16, v44, v46, v19 bitop3:0x7e
    v_or_b32 v18, v18, v16
    v_and_b32 v18, 1, v18
    v_cmp_ne_u32 vcc, 0, v18
    s_nop 3
    v_add_f32_dpp v28, v24, v24 row_ror:8 row_mask:0xf bank_mask:0xf
    v_add_f32_dpp v29, v25, v25 row_ror:8 row_mask:0xf bank_mask:0xf
    v_add_f32_dpp v30, v26, v26 row_ror:8 row_mask:0xf bank_mask:0xf
    v_add_f32_dpp v31, v27, v27 row_ror:8 row_mask:0xf bank_mask:0xf
    v_cvt_pk_bf16_f32 v28, v28, v29
    v_cvt_pk_bf16_f32 v29, v30, v31
    s_cbranch_vccnz L_rn0_f0
L_rp_f0:
    buffer_store_dwordx2 v[28:29], v9, s[8:11], s40 offen
    s_waitcnt vmcnt(0)
L_rd_f0:
    s_branch L_loop_f0
L_ga_f0:
    s_mov_b32 s49, 0
    s_add_u32 s43, s40, 0
    buffer_load_dwordx4 v[60:63], v0, s[8:11], s43 offen sc1
    s_waitcnt vmcnt(3)
    s_branch L_gac1_f0
L_gaw0_f0:
    s_waitcnt vmcnt(1)
L_gac0_f0:
    ds_write_b128 v0, v[60:63] offset:0
    v_max3_u32 v14, v60, v61, v62
    v_max_u32 v14, v14, v63
    v_cmp_le_u32 vcc, s51, v14
    s_cbranch_vccz L_ga3_f0
    s_and_b32 s43, s49, 15
    s_cmp_lg_u32 s43, 15
    s_cbranch_scc1 L_gan0_f0
    v_cmp_eq_u32 vcc, s51, v60
    v_cmp_eq_u32 s[44:45], s51, v61
    s_nop 0
    s_or_b64 vcc, vcc, s[44:45]
    v_cmp_eq_u32 s[44:45], s51, v62
    s_nop 0
    s_or_b64 vcc, vcc, s[44:45]
    v_cmp_eq_u32 s[44:45], s51, v63
    s_nop 0
    s_or_b64 vcc, vcc, s[44:45]
    s_cbranch_vccz L_ga3_f0
L_gan0_f0:
    s_add_u32 s43, s40, 0
    buffer_load_dwordx4 v[60:63], v0, s[8:11], s43 offen sc1
    s_add_u32 s49, s49, 1
    s_cmp_gt_u32 s49, 4000000
    s_cbranch_scc1 L_fail
L_gaw1_f0:
    s_waitcnt vmcnt(1)
L_gac1_f0:
    ds_write_b128 v0, v[56:59] offset:0
    v_max3_u32 v14, v56, v57, v58
    v_max_u32 v14, v14, v59
    v_cmp_le_u32 vcc, s51, v14
    s_cbranch_vccz L_ga3_f0
    s_and_b32 s43, s49, 15
    s_cmp_lg_u32 s43, 15
    s_cbranch_scc1 L_gan1_f0
    v_cmp_eq_u32 vcc, s51, v56
    v_cmp_eq_u32 s[44:45], s51, v57
    s_nop 0
    s_or_b64 vcc, vcc, s[44:45]
    v_cmp_eq_u32 s[44:45], s51, v58
    s_nop 0
    s_or_b64 vcc, vcc, s[44:45]
    v_cmp_eq_u32 s[44:45], s51, v59
    s_nop 0
    s_or_b64 vcc, vcc, s[44:45]
    s_cbranch_vccz L_ga3_f0
L_gan1_f0:
    s_add_u32 s43, s40, 0
    buffer_load_dwordx4 v[56:59], v0, s[8:11], s43 offen sc1
    s_add_u32 s49, s49, 1
    s_cmp_gt_u32 s49, 4000000
    s_cbranch_scc1 L_fail
    s_branch L_gaw0_f0
L_ga3_f0:
    s_waitcnt lgkmcnt(0)
    s_waitcnt vmcnt(0)
    s_branch L_gar_f0
L_gb_f0:
    s_mov_b32 s49, 0
    s_add_u32 s43, s40, 4096
    buffer_load_dwordx4 v[32:35], v0, s[8:11], s43 offen sc1
    s_add_u32 s43, s40, 8192
    buffer_load_dword v12, v11, s[8:11], s43 offen sc1
    s_waitcnt vmcnt(2)
    s_branch L_gbc1_f0
L_gbw0_f0:
    s_waitcnt vmcnt(2)
L_gbc0_f0:
    ds_write_b128 v0, v[32:35] offset:4096
    ds_write_b32 v11, v12 offset:8192
    v_max3_u32 v14, v32, v33, v34
    v_max3_u32 v14, v14, v35, v12
    v_cmp_le_u32 vcc, s51, v14
    s_cbranch_vccz L_gb3_f0
    s_and_b32 s43, s49, 15
    s_cmp_lg_u32 s43, 15
    s_cbranch_scc1 L_gbn0_f0
    v_cmp_eq_u32 vcc, s51, v32
    v_cmp_eq_u32 s[44:45], s51, v33
    s_nop 0
    s_or_b64 vcc, vcc, s[44:45]
    v_cmp_eq_u32 s[44:45], s51, v34
    s_nop 0
    s_or_b64 vcc, vcc, s[44:45]
    v_cmp_eq_u32 s[44:45], s51, v35
    s_nop 0
    s_or_b64 vcc, vcc, s[44:45]
    v_cmp_eq_u32 s[44:45], s51, v12
    s_nop 0
    s_or_b64 vcc, vcc, s[44:45]
    s_cbranch_vccz L_gb3_f0
L_gbn0_f0:
    s_add_u32 s43, s40, 4096
    buffer_load_dwordx4 v[32:35], v0, s[8:11], s43 offen sc1
    s_add_u32 s43, s40, 8192
    buffer_load_dword v12, v11, s[8:11], s43 offen sc1
    s_add_u32 s49, s49, 1
    s_cmp_gt_u32 s49, 4000000
    s_cbranch_scc1 L_fail
L_gbw1_f0:
    s_waitcnt vmcnt(2)
L_gbc1_f0:
    ds_write_b128 v0, v[36:39] offset:4096
    ds_write_b32 v11, v13 offset:8192
    v_max3_u32 v14, v36, v37, v38
    v_max3_u32 v14, v14, v39, v13
    v_cmp_le_u32 vcc, s51, v14
    s_cbranch_vccz L_gb3_f0
    s_and_b32 s43, s49, 15
    s_cmp_lg_u32 s43, 15
    s_cbranch_scc1 L_gbn1_f0
    v_cmp_eq_u32 vcc, s51, v36
    v_cmp_eq_u32 s[44:45], s51, v37
    s_nop 0
    s_or_b64 vcc, vcc, s[44:45]
    v_cmp_eq_u32 s[44:45], s51, v38
    s_nop 0
    s_or_b64 vcc, vcc, s[44:45]
    v_cmp_eq_u32 s[44:45], s51, v39
    s_nop 0
    s_or_b64 vcc, vcc, s[44:45]
    v_cmp_eq_u32 s[44:45], s51, v13
    s_nop 0
    s_or_b64 vcc, vcc, s[44:45]
    s_cbranch_vccz L_gb3_f0
L_gbn1_f0:
    s_add_u32 s43, s40, 4096
    buffer_load_dwordx4 v[36:39], v0, s[8:11], s43 offen sc1
    s_add_u32 s43, s40, 8192
    buffer_load_dword v13, v11, s[8:11], s43 offen sc1
    s_add_u32 s49, s49, 1
    s_cmp_gt_u32 s49, 4000000
    s_cbranch_scc1 L_fail
    s_branch L_gbw0_f0
L_gb3_f0:
    s_waitcnt lgkmcnt(0)
    s_waitcnt vmcnt(0)
    s_branch L_gbr_f0
L_rw1_f0:
    s_waitcnt vmcnt(7)
    v_mfma_f32_16x16x32_bf16 v[24:27], v[20:23], v[48:51], 0
    v_bitop3_b32 v18, v48, v50, v19 bitop3:0x7e
    s_waitcnt vmcnt(6)
    v_mfma_f32_16x16x32_bf16 v[24:27], v[20:23], v[52:55], v[24:27]
    v_bitop3_b32 v16, v52, v54, v19 bitop3:0x7e
    v_or_b32 v18, v18, v16
    s_waitcnt vmcnt(5)
    v_mfma_f32_16x16x32_bf16 v[24:27], v[20:23], v[56:59], v[24:27]
    v_bitop3_b32 v16, v56, v58, v19 bitop3:0x7e
    v_or_b32 v18, v18, v16
    s_waitcnt vmcnt(4)
    v_mfma_f32_16x16x32_bf16 v[24:27], v[20:23], v[60:63], v[24:27]
    v_bitop3_b32 v16, v60, v62, v19 bitop3:0x7e
    v_or_b32 v18, v18, v16
    v_and_b32 v18, 1, v18
    v_cmp_ne_u32 vcc, 0, v18
    s_nop 3
    v_add_f32_dpp v28, v24, v24 row_ror:8 row_mask:0xf bank_mask:0xf
    v_add_f32_dpp v29, v25, v25 row_ror:8 row_mask:0xf bank_mask:0xf
    v_add_f32_dpp v30, v26, v26 row_ror:8 row_mask:0xf bank_mask:0xf
    v_add_f32_dpp v31, v27, v27 row_ror:8 row_mask:0xf bank_mask:0xf
    v_cvt_pk_bf16_f32 v28, v28, v29
    v_cvt_pk_bf16_f32 v29, v30, v31
    s_cbranch_vccz L_rp_f0
L_rn1_f0:
    buffer_load_dwordx4 v[48:51], v0, s[8:11], s43 offen offset:0 sc1
    buffer_load_dwordx4 v[52:55], v0, s[8:11], s43 offen offset:1024 sc1
    buffer_load_dwordx4 v[56:59], v0, s[8:11], s43 offen offset:2048 sc1
    buffer_load_dwordx4 v[60:63], v0, s[8:11], s43 offen offset:3072 sc1
    s_add_u32 s49, s49, 1
    s_cmp_gt_u32 s49, 4000000
    s_cbranch_scc1 L_fail
L_rw0_f0:
    s_waitcnt vmcnt(7)
    v_mfma_f32_16x16x32_bf16 v[24:27], v[20:23], v[32:35], 0
    v_bitop3_b32 v18, v32, v34, v19 bitop3:0x7e
    s_waitcnt vmcnt(6)
    v_mfma_f32_16x16x32_bf16 v[24:27], v[20:23], v[36:39], v[24:27]
    v_bitop3_b32 v16, v36, v38, v19 bitop3:0x7e
    v_or_b32 v18, v18, v16
    s_waitcnt vmcnt(5)
    v_mfma_f32_16x16x32_bf16 v[24:27], v[20:23], v[40:43], v[24:27]
    v_bitop3_b32 v16, v40, v42, v19 bitop3:0x7e
    v_or_b32 v18, v18, v16
    s_waitcnt vmcnt(4)
    v_mfma_f32_16x16x32_bf16 v[24:27], v[20:23], v[44:47], v[24:27]
    v_bitop3_b32 v16, v44, v46, v19 bitop3:0x7e
    v_or_b32 v18, v18, v16
    v_and_b32 v18, 1, v18
    v_cmp_ne_u32 vcc, 0, v18
    s_nop 3
    v_add_f32_dpp v28, v24, v24 row_ror:8 row_mask:0xf bank_mask:0xf
    v_add_f32_dpp v29, v25, v25 row_ror:8 row_mask:0xf bank_mask:0xf
    v_add_f32_dpp v30, v26, v26 row_ror:8 row_mask:0xf bank_mask:0xf
    v_add_f32_dpp v31, v27, v27 row_ror:8 row_mask:0xf bank_mask:0xf
    v_cvt_pk_bf16_f32 v28, v28, v29
    v_cvt_pk_bf16_f32 v29, v30, v31
    s_cbranch_vccz L_rp_f0
L_rn0_f0:
    buffer_load_dwordx4 v[32:35], v0, s[8:11], s43 offen offset:0 sc1
    buffer_load_dwordx4 v[36:39], v0, s[8:11], s43 offen offset:1024 sc1
    buffer_load_dwordx4 v[40:43], v0, s[8:11], s43 offen offset:2048 sc1
    buffer_load_dwordx4 v[44:47], v0, s[8:11], s43 offen offset:3072 sc1
    s_add_u32 s49, s49, 1
    s_cmp_gt_u32 s49, 4000000
    s_cbranch_scc1 L_fail
    s_branch L_rw1_f0
L_slow_f0:
    s_cmp_eq_u32 s46, 0x5105
    s_cbranch_scc1 L_pv3_f0
    s_mov_b32 s46, 0x5105
    s_nop 0
    v_mov_b32 v54, v52
    v_mov_b32 v55, v53
    s_nop 0
    v_max_f32_dpp v54, v54, v54 row_ror:1 row_mask:0xf bank_mask:0xf
    v_max_f32_dpp v55, v55, v55 row_ror:1 row_mask:0xf bank_mask:0xf
    s_nop 0
    v_max_f32_dpp v54, v54, v54 row_ror:2 row_mask:0xf bank_mask:0xf
    v_max_f32_dpp v55, v55, v55 row_ror:2 row_mask:0xf bank_mask:0xf
    s_nop 0
    v_max_f32_dpp v54, v54, v54 row_ror:4 row_mask:0xf bank_mask:0xf
    v_max_f32_dpp v55, v55, v55 row_ror:4 row_mask:0xf bank_mask:0xf
    s_nop 0
    v_max_f32_dpp v54, v54, v54 row_ror:8 row_mask:0xf bank_mask:0xf
    v_max_f32_dpp v55, v55, v55 row_ror:8 row_mask:0xf bank_mask:0xf
    v_and_b32 v35, 15, v11
    v_lshlrev_b32 v35, 1, v35
    ds_write_b64 v35, v[54:55] offset:16256
    s_waitcnt lgkmcnt(0)
    s_barrier
    ds_read_b64 v[16:17], v35 offset:16256
    ds_read_b64 v[18:19], v35 offset:16288
    ds_read_b64 v[20:21], v35 offset:16320
    s_waitcnt lgkmcnt(0)
    v_max3_f32 v54, v16, v18, v20
    v_max3_f32 v55, v17, v19, v21
    v_sub_f32 v54, v52, v54
    v_sub_f32 v55, v53, v55
    v_exp_f32 v54, v54
    v_exp_f32 v55, v55
    s_nop 0
    v_cvt_pk_bf16_f32 v54, v54, v55
    ds_write_b32 v11, v54 offset:15360
    s_waitcnt lgkmcnt(0)
    s_barrier
    s_branch L_pv_f0
L_pv2_f0:
    ds_read_b128 v[24:27], v0 offset:24576
    ds_read_b128 v[28:31], v0 offset:25600
    s_waitcnt lgkmcnt(0)
    v_mov_b32 v56, 0x3f803f80
    v_mov_b32 v57, 0x3f803f80
    v_mov_b32 v58, 0x3f803f80
    v_mov_b32 v59, 0x3f803f80
    s_nop 1
    v_mfma_f32_16x16x32_bf16 v[36:39], v[56:59], v[48:51], 0
    v_mfma_f32_16x16x32_bf16 v[16:19], v[24:27], v[48:51], 0
    v_mfma_f32_16x16x32_bf16 v[20:23], v[28:31], v[48:51], 0
    v_mfma_f32_16x16x16_bf16 v[36:39], v[32:33], v[54:55], v[36:39]
    v_mfma_f32_16x16x16_bf16 v[16:19], v[40:41], v[54:55], v[16:19]
    v_mfma_f32_16x16x16_bf16 v[20:23], v[44:45], v[54:55], v[20:23]
    s_nop 7
    s_branch L_pv4_f0
L_tail_f0:
    s_waitcnt lgkmcnt(0)
    v_smfmac_f32_16x16x64_bf16 v[44:47], v[60:63], a[120:127], v10
    ds_read_b128 v[16:19], v1 offset:16384
    ds_read_b128 v[20:23], v1 offset:17408
    v_smfmac_f32_16x16x64_bf16 v[40:43], v[48:51], a[128:135], v10
    ds_read_b128 v[24:27], v1 offset:18432
    ds_read_b128 v[28:31], v1 offset:19456
    v_smfmac_f32_16x16x64_bf16 v[44:47], v[48:51], a[136:143], v10
    ds_read_b64_tr_b16 v[60:61], v2 offset:1024
    ds_read_b64_tr_b16 v[62:63], v3 offset:1024
    v_smfmac_f32_16x16x64_bf16 v[40:43], v[56:59], a[32:39], v10
    ds_read_b64_tr_b16 v[48:49], v2 offset:2048
    ds_read_b64_tr_b16 v[50:51], v3 offset:2048
    v_smfmac_f32_16x16x64_bf16 v[44:47], v[56:59], a[40:47], v10
    ds_read_b64_tr_b16 v[56:57], v2 offset:3072
    ds_read_b64_tr_b16 v[58:59], v3 offset:3072
    s_waitcnt lgkmcnt(4)
    v_smfmac_f32_16x16x64_bf16 v[40:43], v[60:63], a[48:55], v10
    v_smfmac_f32_16x16x64_bf16 v[44:47], v[60:63], a[56:63], v10
    ds_read_b64_tr_b16 v[60:61], v2 offset:4096
    ds_read_b64_tr_b16 v[62:63], v3 offset:4096
    s_waitcnt lgkmcnt(4)
    v_smfmac_f32_16x16x64_bf16 v[40:43], v[48:51], v[16:23], v10
    v_smfmac_f32_16x16x64_bf16 v[44:47], v[48:51], v[24:31], v10
    s_waitcnt lgkmcnt(2)
    v_smfmac_f32_16x16x64_bf16 v[40:43], v[56:59], a[64:71], v10
    v_smfmac_f32_16x16x64_bf16 v[44:47], v[56:59], a[72:79], v10
    s_waitcnt lgkmcnt(0)
    v_smfmac_f32_16x16x64_bf16 v[40:43], v[60:63], a[80:87], v10
    v_smfmac_f32_16x16x64_bf16 v[44:47], v[60:63], a[88:95], v10
    s_nop 3
    v_add_f32 v40, v40, v42
    v_add_f32 v41, v41, v43
    v_cvt_pk_bf16_f32 v40, v40, v41
    s_nop 0
    v_add_f32 v44, v44, v46
    v_add_f32 v45, v45, v47
    v_cvt_pk_bf16_f32 v44, v44, v45
    ds_write_b32 v11, v40 offset:9216
    ds_write_b32 v11, v44 offset:9472
    s_waitcnt vmcnt(0)
    v_and_b32 v12, 0x200, v0
    v_mul_u32_u24 v12, 3, v12
    v_add_u32 v12, v12, v0
    ds_read_b128 v[12:15], v12 offset:9216
    s_waitcnt lgkmcnt(0)
    s_lshr_b32 s44, s48, 1
    s_add_u32 s44, s44, 0x4100000
    buffer_store_dwordx4 v[12:15], v0, s[8:11], s44 offen sc1
    s_waitcnt vmcnt(0)
    s_barrier
    s_branch L_end
L_slowmode_0:
    ds_read_b128 v[32:35], v0 offset:4096
    ds_read_b32 v12, v11 offset:8192
    ds_read_b128 v[40:43], v1 offset:0
    ds_read_b128 v[44:47], v1 offset:1024
    v_mov_b64 v[16:17], 0
    v_mov_b64 v[18:19], 0
    v_mov_b64 v[20:21], 0
    v_mov_b64 v[22:23], 0
    v_mov_b64 v[24:25], 0
    v_mov_b64 v[26:27], 0
    v_mov_b64 v[28:29], 0
    v_mov_b64 v[30:31], 0
    s_waitcnt vmcnt(0) lgkmcnt(0)
    s_nop 0
    s_branch L_gar_s0
L_loop_s0:
    s_barrier
    s_add_u32 s43, s40, 0
    buffer_load_dwordx4 v[60:63], v0, s[8:11], s43 offen sc1
    v_mov_b64 v[16:17], 0
    v_mov_b64 v[18:19], 0
    v_mov_b64 v[20:21], 0
    v_mov_b64 v[22:23], 0
    v_mov_b64 v[24:25], 0
    v_mov_b64 v[26:27], 0
    v_mov_b64 v[28:29], 0
    v_mov_b64 v[30:31], 0
    s_nop 15
    s_nop 7
    s_add_u32 s43, s40, 0
    buffer_load_dwordx4 v[56:59], v0, s[8:11], s43 offen sc1
    s_waitcnt vmcnt(1)
    ds_write_b128 v0, v[60:63] offset:0
    v_max3_u32 v14, v60, v61, v62
    v_max_u32 v14, v14, v63
    v_cmp_le_u32 vcc, s51, v14
    s_add_u32 s43, s40, 4096
    buffer_load_dwordx4 v[32:35], v0, s[8:11], s43 offen sc1
    s_add_u32 s43, s40, 8192
    buffer_load_dword v12, v11, s[8:11], s43 offen sc1
    s_cbranch_vccnz L_ga_s0
L_gar_s0:
    ds_read_b64_tr_b16 v[48:49], v2 offset:0
    ds_read_b64_tr_b16 v[50:51], v3 offset:0
    ds_read_b128 v[40:43], v1 offset:0
    ds_read_b128 v[44:47], v1 offset:1024
    s_waitcnt lgkmcnt(4)
    s_barrier
    ds_read_b64_tr_b16 v[52:53], v2 offset:1024
    ds_read_b64_tr_b16 v[54:55], v3 offset:1024
    s_waitcnt lgkmcnt(4)
    s_waitcnt lgkmcnt(2)
    v_smfmac_f32_16x16x64_bf16 v[16:19], v[48:51], v[40:47], v10
    s_waitcnt vmcnt(2)
    ds_read_b64_tr_b16 v[56:57], v2 offset:2048
    ds_read_b64_tr_b16 v[58:59], v3 offset:2048
    v_smfmac_f32_16x16x64_bf16 v[24:27], v[48:51], v[176:183], v10
    ds_read_b64_tr_b16 v[60:61], v2 offset:3072
    ds_read_b64_tr_b16 v[62:63], v3 offset:3072
    v_smfmac_f32_16x16x64_bf16 v[28:31], v[48:51], v[184:191], v10
    ds_read_b128 v[40:43], v1 offset:2048
    ds_read_b128 v[44:47], v1 offset:3072
    s_waitcnt lgkmcnt(6)
    v_smfmac_f32_16x16x64_bf16 v[16:19], v[52:55], v[64:71], v10
    s_add_u32 s43, s40, 4096
    buffer_load_dwordx4 v[36:39], v0, s[8:11], s43 offen sc1
    s_add_u32 s43, s40, 8192
    buffer_load_dword v13, v11, s[8:11], s43 offen sc1
    v_smfmac_f32_16x16x64_bf16 v[20:23], v[52:55], v[72:79], v10
    v_smfmac_f32_16x16x64_bf16 v[24:27], v[52:55], v[192:199], v10
    s_waitcnt lgkmcnt(0)
    v_smfmac_f32_16x16x64_bf16 v[20:23], v[48:51], v[40:47], v10
    ds_read_b128 v[40:43], v1 offset:8192
    v_smfmac_f32_16x16x64_bf16 v[28:31], v[52:55], v[200:207], v10
    ds_read_b128 v[44:47], v1 offset:9216
    v_smfmac_f32_16x16x64_bf16 v[16:19], v[56:59], v[80:87], v10
    s_waitcnt vmcnt(2)
    ds_write_b128 v0, v[32:35] offset:4096
    v_max3_u32 v14, v32, v33, v34
    v_smfmac_f32_16x16x64_bf16 v[20:23], v[56:59], v[88:95], v10
    ds_write_b32 v11, v12 offset:8192
    v_max3_u32 v14, v14, v35, v12
    v_smfmac_f32_16x16x64_bf16 v[24:27], v[56:59], v[208:215], v10
    v_cmp_le_u32 vcc, s51, v14
    v_smfmac_f32_16x16x64_bf16 v[28:31], v[56:59], v[216:223], v10
    s_cbranch_vccnz L_gb_s0
L_gbr_s0:
    ds_read_b64_tr_b16 v[48:49], v2 offset:4096
    v_smfmac_f32_16x16x64_bf16 v[16:19], v[60:63], v[96:103], v10
    ds_read_b64_tr_b16 v[50:51], v3 offset:4096
    v_smfmac_f32_16x16x64_bf16 v[20:23], v[60:63], v[104:111], v10
    s_waitcnt lgkmcnt(2)
    s_barrier
    ds_read_b64_tr_b16 v[52:53], v2 offset:5120
    ds_read_b64_tr_b16 v[54:55], v3 offset:5120
    v_smfmac_f32_16x16x64_bf16 v[24:27], v[60:63], v[40:47], v10
    ds_read_b64_tr_b16 v[56:57], v2 offset:6144
    ds_read_b64_tr_b16 v[58:59], v3 offset:6144
    s_waitcnt lgkmcnt(4)
    v_smfmac_f32_16x16x64_bf16 v[16:19], v[48:51], v[112:119], v10
    s_waitcnt vmcnt(0)
    ds_read_b128 v[32:35], v1 offset:10240
    ds_read_b128 v[36:39], v1 offset:11264
    v_smfmac_f32_16x16x64_bf16 v[20:23], v[48:51], v[120:127], v10
    ds_read_b128 v[40:43], v1 offset:4096
    ds_read_b128 v[44:47], v1 offset:5120
    v_smfmac_f32_16x16x64_bf16 v[24:27], v[48:51], v[224:231], v10
    v_smfmac_f32_16x16x64_bf16 v[28:31], v[48:51], v[232:239], v10
    ds_read_b64_tr_b16 v[48:49], v2 offset:8192
    ds_read_b64_tr_b16 v[50:51], v3 offset:8192
    s_waitcnt lgkmcnt(8)
    v_smfmac_f32_16x16x64_bf16 v[24:27], v[52:55], v[240:247], v10
    s_waitcnt lgkmcnt(4)
    v_smfmac_f32_16x16x64_bf16 v[28:31], v[60:63], v[32:39], v10
    ds_read_b64_tr_b16 v[60:61], v2 offset:7168
    s_waitcnt lgkmcnt(3)
    v_smfmac_f32_16x16x64_bf16 v[16:19], v[52:55], v[40:47], v10
    ds_read_b64_tr_b16 v[62:63], v3 offset:7168
    v_smfmac_f32_16x16x64_bf16 v[28:31], v[52:55], v[248:255], v10
    ds_read_b128 v[32:35], v1 offset:6144
    v_smfmac_f32_16x16x64_bf16 v[16:19], v[56:59], v[128:135], v10
    ds_read_b128 v[36:39], v1 offset:7168
    v_and_b32 v12, 0x200, v0
    v_smfmac_f32_16x16x64_bf16 v[20:23], v[56:59], v[136:143], v10
    ds_read_b128 v[40:43], v1 offset:12288
    v_mul_u32_u24 v12, 3, v12
    s_waitcnt lgkmcnt(3)
    v_smfmac_f32_16x16x64_bf16 v[16:19], v[60:63], v[144:151], v10
    ds_read_b128 v[44:47], v1 offset:13312
    v_add_u32 v12, v12, v0
    s_waitcnt lgkmcnt(2)
    v_smfmac_f32_16x16x64_bf16 v[20:23], v[52:55], v[32:39], v10
    ds_read_b128 v[12:15], v12 offset:9216
    v_smfmac_f32_16x16x64_bf16 v[20:23], v[60:63], v[152:159], v10
    ds_read_b128 v[32:35], v1 offset:14336
    v_smfmac_f32_16x16x64_bf16 v[16:19], v[48:51], v[160:167], v10
    ds_read_b128 v[36:39], v1 offset:15360
    v_smfmac_f32_16x16x64_bf16 v[20:23], v[48:51], v[168:175], v10
    s_waitcnt lgkmcnt(3)
    v_smfmac_f32_16x16x64_bf16 v[24:27], v[56:59], v[40:47], v10
    s_waitcnt lgkmcnt(2)
    s_lshr_b32 s44, s48, 1
    s_add_u32 s44, s44, 0x40e0000
    buffer_store_dwordx4 v[12:15], v0, s[8:11], s44 offen sc1
    v_add_f32 v16, v16, v18
    v_add_f32 v17, v17, v19
    s_waitcnt lgkmcnt(0)
    v_smfmac_f32_16x16x64_bf16 v[28:31], v[56:59], v[32:39], v10
    ds_read_b128 v[32:35], v1 offset:22528
    v_cvt_pk_bf16_f32 v16, v16, v17
    v_add_f32 v20, v20, v22
    v_smfmac_f32_16x16x64_bf16 v[24:27], v[60:63], a[0:7], v10
    ds_read_b128 v[36:39], v1 offset:23552
    v_add_f32 v21, v21, v23
    v_cvt_pk_bf16_f32 v17, v20, v21
    v_smfmac_f32_16x16x64_bf16 v[24:27], v[48:51], a[16:23], v10
    ds_write_b64 v4, v[16:17] offset:9216
    v_mov_b64 v[40:41], 0
    v_mov_b64 v[42:43], 0
    v_smfmac_f32_16x16x64_bf16 v[28:31], v[60:63], a[8:15], v10
    ds_read_b128 v[16:19], v1 offset:20480
    v_mov_b64 v[44:45], 0
    v_mov_b64 v[46:47], 0
    v_smfmac_f32_16x16x64_bf16 v[28:31], v[48:51], a[24:31], v10
    ds_read_b128 v[20:23], v1 offset:21504
    v_add_f32 v24, v24, v26
    v_add_f32 v25, v25, v27
    v_cvt_pk_bf16_f32 v24, v24, v25
    v_smfmac_f32_16x16x64_bf16 v[40:43], v[52:55], a[96:103], v10
    v_smfmac_f32_16x16x64_bf16 v[44:47], v[52:55], a[104:111], v10
    v_add_f32 v28, v28, v30
    v_add_f32 v29, v29, v31
    v_cvt_pk_bf16_f32 v25, v28, v29
    ds_write2st64_b32 v11, v24, v25 offset0:44 offset1:45
    s_waitcnt lgkmcnt(4)
    v_smfmac_f32_16x16x64_bf16 v[44:47], v[56:59], v[32:39], v10
    ds_read_b128 v[24:27], v0 offset:18432
    v_mov_b64 v[52:53], 0
    v_mov_b64 v[54:55], 0
    v_smfmac_f32_16x16x64_bf16 v[40:43], v[60:63], a[112:119], v10
    ds_read_b128 v[28:31], v0 offset:19456
    s_waitcnt lgkmcnt(3)
    v_smfmac_f32_16x16x64_bf16 v[40:43], v[56:59], v[16:23], v10
    ds_read_b64_tr_b16 v[56:57], v2 offset:0
    ds_read_b128 v[16:19], v0 offset:16384
    ds_read_b128 v[20:23], v0 offset:17408
    ds_read_b64_tr_b16 v[58:59], v3 offset:0
    s_waitcnt lgkmcnt(6)
    s_barrier
    s_cmp_eq_u32 s38, 63
    s_cbranch_scc1 L_tail_s0
    ds_read_b64_tr_b16 v[32:33], v2 offset:9216
    ds_read_b64_tr_b16 v[34:35], v3 offset:9216
    ds_read_b64_tr_b16 v[36:37], v2 offset:10240
    ds_read_b64_tr_b16 v[38:39], v3 offset:10240
    s_waitcnt lgkmcnt(5)
    v_smfmac_f32_16x16x64_bf16 v[44:47], v[60:63], a[120:127], v10
    s_mov_b32 m0, 0x4000
    s_add_u32 s55, s48, 0x1040000
    buffer_load_dwordx4 v0, s[8:11], s55 offen sc1 lds
    buffer_load_dwordx4 v0, s[8:11], s55 offen offset:1024 sc1 lds
    v_smfmac_f32_16x16x64_bf16 v[40:43], v[48:51], a[128:135], v10
    buffer_load_dwordx4 v0, s[8:11], s55 offen offset:2048 sc1 lds
    buffer_load_dwordx4 v0, s[8:11], s55 offen offset:3072 sc1 lds
    v_smfmac_f32_16x16x64_bf16 v[44:47], v[48:51], a[136:143], v10
    ds_read_b64_tr_b16 v[60:61], v2 offset:1024
    ds_read_b64_tr_b16 v[62:63], v3 offset:1024
    s_waitcnt lgkmcnt(6)
    v_smfmac_f32_16x16x64_bf16 v[40:43], v[56:59], a[32:39], v10
    ds_read_b64_tr_b16 v[48:49], v2 offset:2048
    ds_read_b64_tr_b16 v[50:51], v3 offset:2048
    s_waitcnt lgkmcnt(4)
    v_smfmac_f32_16x16x64_bf16 v[52:55], v[32:35], v[16:23], v10
    v_smfmac_f32_16x16x64_bf16 v[52:55], v[36:39], v[24:31], v10
    ds_read_b128 v[16:19], v1 offset:16384
    ds_read_b128 v[20:23], v1 offset:17408
    v_smfmac_f32_16x16x64_bf16 v[44:47], v[56:59], a[40:47], v10
    ds_read_b128 v[24:27], v1 offset:18432
    ds_read_b128 v[28:31], v1 offset:19456
    s_waitcnt lgkmcnt(6)
    v_smfmac_f32_16x16x64_bf16 v[40:43], v[60:63], a[48:55], v10
    ds_read_b64_tr_b16 v[56:57], v2 offset:3072
    ds_read_b64_tr_b16 v[58:59], v3 offset:3072
    v_add_f32 v52, v52, v54
    v_add_f32 v53, v53, v55
    v_mul_f32 v52, s50, v52
    v_mul_f32 v53, s50, v53
    v_exp_f32 v54, v52
    v_exp_f32 v55, v53
    s_nop 0
    v_cvt_pk_bf16_f32 v54, v54, v55
    ds_write_b32 v11, v54 offset:15360
    v_smfmac_f32_16x16x64_bf16 v[44:47], v[60:63], a[56:63], v10
    ds_read_b64_tr_b16 v[60:61], v2 offset:4096
    ds_read_b64_tr_b16 v[62:63], v3 offset:4096
    s_waitcnt lgkmcnt(9)
    s_waitcnt lgkmcnt(7)
    v_smfmac_f32_16x16x64_bf16 v[40:43], v[48:51], v[16:23], v10
    s_waitcnt lgkmcnt(5)
    v_smfmac_f32_16x16x64_bf16 v[44:47], v[48:51], v[24:31], v10
    s_waitcnt lgkmcnt(2)
    s_barrier
L_pv_s0:
    ds_read_b64_tr_b16 v[48:49], v5 offset:15360
    ds_read_b64_tr_b16 v[50:51], v5 offset:15616
    ds_read_b64_tr_b16 v[54:55], v8 offset:15872
    s_cmp_eq_u32 s46, 0x5105
    s_cbranch_scc1 L_pv2_s0
    ds_read_b128 v[24:27], v0 offset:24576
    ds_read_b128 v[28:31], v0 offset:25600
    v_smfmac_f32_16x16x64_bf16 v[40:43], v[56:59], a[64:71], v10
    v_mov_b64 v[32:33], s[98:99]
    v_smfmac_f32_16x16x64_bf16 v[44:47], v[56:59], a[72:79], v10
    s_waitcnt lgkmcnt(5)
    v_smfmac_f32_16x16x64_bf16 v[40:43], v[60:63], a[80:87], v10
    v_mov_b64 v[56:57], s[96:97]
    v_smfmac_f32_16x16x64_bf16 v[44:47], v[60:63], a[88:95], v10
    v_mov_b64 v[58:59], s[96:97]
    s_waitcnt lgkmcnt(0)
    s_nop 0
    v_mfma_f32_16x16x32_bf16 v[36:39], v[56:59], v[48:51], 0
    v_mfma_f32_16x16x32_bf16 v[16:19], v[24:27], v[48:51], 0
    v_add_f32 v40, v40, v42
    v_add_f32 v41, v41, v43
    v_mfma_f32_16x16x32_bf16 v[20:23], v[28:31], v[48:51], 0
    v_cvt_pk_bf16_f32 v40, v40, v41
    v_mov_b32 v41, 0
    v_mfma_f32_16x16x16_bf16 v[36:39], v[32:33], v[54:55], v[36:39]
    v_add_f32 v44, v44, v46
    v_add_f32 v45, v45, v47
    v_mfma_f32_16x16x16_bf16 v[16:19], v[40:41], v[54:55], v[16:19]
    v_cvt_pk_bf16_f32 v44, v44, v45
    v_mov_b32 v45, 0
    s_nop 1
    v_mfma_f32_16x16x16_bf16 v[20:23], v[44:45], v[54:55], v[20:23]
L_pv4_s0:
    ds_read_b128 v[56:59], v1 offset:24576
    ds_read_b128 v[60:63], v1 offset:25600
    ds_read_b128 v[24:27], v1 offset:26624
    ds_read_b128 v[28:31], v1 offset:27648
    v_rcp_f32 v34, v36
    v_cmp_ngt_f32 vcc, s69, v36
    v_cmp_nlt_f32 s[44:45], s68, v36
    v_cndmask_b32 v16, v18, v16, s[56:57]
    v_cndmask_b32 v17, v19, v17, s[56:57]
    s_or_b64 vcc, vcc, s[44:45]
    v_mul_f32 v16, v16, v34
    v_mul_f32 v17, v17, v34
    v_cndmask_b32 v20, v22, v20, s[56:57]
    v_cndmask_b32 v21, v23, v21, s[56:57]
    v_cvt_pk_bf16_f32 v16, v16, v17
    v_mul_f32 v20, v20, v34
    v_mul_f32 v21, v21, v34
    s_cbranch_vccnz L_slow_s0
L_pv3_s0:
    v_cvt_pk_bf16_f32 v20, v20, v21
    ds_write2_b32 v6, v16, v20 offset0:0 offset1:2
    s_mov_b32 s46, 0
    v_lshrrev_b32 v12, 1, v0
    v_and_b32 v12, 0x1e0, v12
    v_and_or_b32 v12, v0, 16, v12
    v_mov_b64 v[48:49], 0
    v_mov_b64 v[50:51], 0
    v_mov_b64 v[52:53], 0
    v_mov_b64 v[54:55], 0
    v_mov_b64 v[16:17], 0
    v_mov_b64 v[18:19], 0
    v_mov_b64 v[20:21], 0
    v_mov_b64 v[22:23], 0
    s_waitcnt lgkmcnt(0)
    s_barrier
    ds_read_b128 v[32:35], v12 offset:13312
    ds_read_b128 v[36:39], v12 offset:13824
    ds_write2st64_b32 v11, v40, v44 offset0:36 offset1:37
    ds_read_b128 v[40:43], v12 offset:14336
    ds_read_b128 v[44:47], v12 offset:14848
    s_waitcnt lgkmcnt(4)
    v_smfmac_f32_16x16x64_bf16 v[16:19], v[32:35], v[56:63], v10
    ds_read_b128 v[56:59], v1 offset:28672
    v_smfmac_f32_16x16x64_bf16 v[20:23], v[32:35], a[144:151], v10
    ds_read_b128 v[60:63], v1 offset:29696
    s_waitcnt lgkmcnt(5)
    v_smfmac_f32_16x16x64_bf16 v[16:19], v[36:39], v[24:31], v10
    ds_read_b128 v[24:27], v1 offset:30720
    v_smfmac_f32_16x16x64_bf16 v[20:23], v[36:39], a[152:159], v10
    ds_read_b128 v[28:31], v1 offset:31744
    s_waitcnt lgkmcnt(5)
    v_smfmac_f32_16x16x64_bf16 v[16:19], v[40:43], a[176:183], v10
    v_smfmac_f32_16x16x64_bf16 v[20:23], v[40:43], a[192:199], v10
    s_waitcnt lgkmcnt(4)
    v_smfmac_f32_16x16x64_bf16 v[16:19], v[44:47], a[184:191], v10
    v_smfmac_f32_16x16x64_bf16 v[20:23], v[44:47], a[200:207], v10
    s_waitcnt lgkmcnt(2)
    v_smfmac_f32_16x16x64_bf16 v[48:51], v[32:35], v[56:63], v10
    v_cvt_pk_bf16_f32 v16, v16, v17
    v_cvt_pk_bf16_f32 v17, v18, v19
    v_and_or_b32 v16, v16, -2, s92
    s_waitcnt lgkmcnt(0)
    v_smfmac_f32_16x16x64_bf16 v[48:51], v[36:39], v[24:31], v10
    s_add_u32 s43, s39, 0
    buffer_store_dwordx2 v[16:17], v7, s[8:11], s43 offen sc1
    v_cvt_pk_bf16_f32 v20, v20, v21
    v_cvt_pk_bf16_f32 v21, v22, v23
    v_and_or_b32 v20, v20, -2, s92
    v_smfmac_f32_16x16x64_bf16 v[48:51], v[40:43], a[208:215], v10
    s_add_u32 s43, s39, 65536
    buffer_store_dwordx2 v[20:21], v7, s[8:11], s43 offen sc1
    v_cndmask_b32 v56, v32, v36, s[100:101]
    v_cndmask_b32 v57, v33, v37, s[100:101]
    v_cndmask_b32 v58, v34, v38, s[100:101]
    v_smfmac_f32_16x16x64_bf16 v[48:51], v[44:47], a[216:223], v10
    v_cndmask_b32 v59, v35, v39, s[100:101]
    v_cndmask_b32 v60, v40, v44, s[100:101]
    v_cndmask_b32 v61, v41, v45, s[100:101]
    v_smfmac_f32_16x16x64_bf16 v[52:55], v[32:35], a[160:167], v10
    v_cndmask_b32 v62, v42, v46, s[100:101]
    v_cndmask_b32 v63, v43, v47, s[100:101]
    v_mov_b64 v[24:25], 0
    v_smfmac_f32_16x16x64_bf16 v[52:55], v[36:39], a[168:175], v10
    v_mov_b64 v[26:27], 0
    s_nop 1
    v_smfmac_f32_16x16x64_bf16 v[24:27], v[56:59], a[240:247], v10
    v_cvt_pk_bf16_f32 v48, v48, v49
    v_cvt_pk_bf16_f32 v49, v50, v51
    v_smfmac_f32_16x16x64_bf16 v[24:27], v[60:63], a[248:255], v10
    v_and_or_b32 v48, v48, -2, s92
    v_smfmac_f32_16x16x64_bf16 v[52:55], v[40:43], a[224:231], v10
    s_add_u32 s43, s39, 131072
    buffer_store_dwordx2 v[48:49], v7, s[8:11], s43 offen sc1
    v_smfmac_f32_16x16x64_bf16 v[52:55], v[44:47], a[232:239], v10
    v_add_f32 v24, v24, v26
    v_add_f32 v25, v25, v27
    v_cvt_pk_bf16_f32 v24, v24, v25
    v_and_or_b32 v24, v24, -2, s92
    s_add_u32 s43, s39, 262144
    buffer_store_dword v24, v7, s[8:11], s43 offen offset:0 sc1
    s_nop 1
    v_cvt_pk_bf16_f32 v52, v52, v53
    v_cvt_pk_bf16_f32 v53, v54, v55
    v_and_or_b32 v52, v52, -2, s92
    s_add_u32 s43, s39, 196608
    buffer_store_dwordx2 v[52:53], v7, s[8:11], s43 offen sc1
    s_add_u32 s43, s39, s47
    s_mov_b32 s49, 0
    s_nop 15
    s_nop 11
    buffer_load_dwordx4 v[32:35], v0, s[8:11], s43 offen offset:0 sc1
    buffer_load_dwordx4 v[36:39], v0, s[8:11], s43 offen offset:1024 sc1
    buffer_load_dwordx4 v[40:43], v0, s[8:11], s43 offen offset:2048 sc1
    buffer_load_dwordx4 v[44:47], v0, s[8:11], s43 offen offset:3072 sc1
    v_mov_b32 v16, 0x3f80
    v_mov_b32 v17, 0x3f800000
    v_cndmask_b32 v16, v16, v17, s[66:67]
    v_cndmask_b32 v20, 0, v16, s[58:59]
    v_cndmask_b32 v21, 0, v16, s[60:61]
    v_cndmask_b32 v22, 0, v16, s[62:63]
    v_cndmask_b32 v23, 0, v16, s[64:65]
    v_mov_b32 v19, s92
    s_xor_b32 s92, s92, 1
    s_mov_b32 s45, s40
    s_mov_b32 s40, s41
    s_mov_b32 s41, s42
    s_mov_b32 s42, s93
    s_mov_b32 s93, s45
    s_add_u32 s38, s38, 1
    s_add_u32 s48, s48, 262144
    s_nop 15
    s_nop 15
    buffer_load_dwordx4 v[48:51], v0, s[8:11], s43 offen offset:0 sc1
    buffer_load_dwordx4 v[52:55], v0, s[8:11], s43 offen offset:1024 sc1
    buffer_load_dwordx4 v[56:59], v0, s[8:11], s43 offen offset:2048 sc1
    buffer_load_dwordx4 v[60:63], v0, s[8:11], s43 offen offset:3072 sc1
    s_waitcnt vmcnt(7)
    v_mfma_f32_16x16x32_bf16 v[24:27], v[20:23], v[32:35], 0
    v_bitop3_b32 v18, v32, v34, v19 bitop3:0x7e
    s_waitcnt vmcnt(6)
    v_mfma_f32_16x16x32_bf16 v[24:27], v[20:23], v[36:39], v[24:27]
    v_bitop3_b32 v16, v36, v38, v19 bitop3:0x7e
    v_or_b32 v18, v18, v16
    s_waitcnt vmcnt(5)
    v_mfma_f32_16x16x32_bf16 v[24:27], v[20:23], v[40:43], v[24:27]
    v_bitop3_b32 v16, v40, v42, v19 bitop3:0x7e
    v_or_b32 v18, v18, v16
    s_waitcnt vmcnt(4)
    v_mfma_f32_16x16x32_bf16 v[24:27], v[20:23], v[44:47], v[24:27]
    v_bitop3_b32 v16, v44, v46, v19 bitop3:0x7e
    v_or_b32 v18, v18, v16
    v_and_b32 v18, 1, v18
    v_cmp_ne_u32 vcc, 0, v18
    s_nop 3
    v_add_f32_dpp v28, v24, v24 row_ror:8 row_mask:0xf bank_mask:0xf
    v_add_f32_dpp v29, v25, v25 row_ror:8 row_mask:0xf bank_mask:0xf
    v_add_f32_dpp v30, v26, v26 row_ror:8 row_mask:0xf bank_mask:0xf
    v_add_f32_dpp v31, v27, v27 row_ror:8 row_mask:0xf bank_mask:0xf
    v_cvt_pk_bf16_f32 v28, v28, v29
    v_cvt_pk_bf16_f32 v29, v30, v31
    s_cbranch_vccnz L_rn0_s0
L_rp_s0:
    buffer_store_dwordx2 v[28:29], v9, s[8:11], s40 offen sc1
    s_waitcnt vmcnt(0)
L_rd_s0:
    s_branch L_loop_s0
L_ga_s0:
    s_mov_b32 s49, 0
    s_add_u32 s43, s40, 0
    buffer_load_dwordx4 v[60:63], v0, s[8:11], s43 offen sc1
    s_waitcnt vmcnt(3)
    s_branch L_gac1_s0
L_gaw0_s0:
    s_waitcnt vmcnt(1)
L_gac0_s0:
    ds_write_b128 v0, v[60:63] offset:0
    v_max3_u32 v14, v60, v61, v62
    v_max_u32 v14, v14, v63
    v_cmp_le_u32 vcc, s51, v14
    s_cbranch_vccz L_ga3_s0
    s_and_b32 s43, s49, 15
    s_cmp_lg_u32 s43, 15
    s_cbranch_scc1 L_gan0_s0
    v_cmp_eq_u32 vcc, s51, v60
    v_cmp_eq_u32 s[44:45], s51, v61
    s_nop 0
    s_or_b64 vcc, vcc, s[44:45]
    v_cmp_eq_u32 s[44:45], s51, v62
    s_nop 0
    s_or_b64 vcc, vcc, s[44:45]
    v_cmp_eq_u32 s[44:45], s51, v63
    s_nop 0
    s_or_b64 vcc, vcc, s[44:45]
    s_cbranch_vccz L_ga3_s0
L_gan0_s0:
    s_add_u32 s43, s40, 0
    buffer_load_dwordx4 v[60:63], v0, s[8:11], s43 offen sc1
    s_add_u32 s49, s49, 1
    s_cmp_gt_u32 s49, 4000000
    s_cbranch_scc1 L_fail
L_gaw1_s0:
    s_waitcnt vmcnt(1)
L_gac1_s0:
    ds_write_b128 v0, v[56:59] offset:0
    v_max3_u32 v14, v56, v57, v58
    v_max_u32 v14, v14, v59
    v_cmp_le_u32 vcc, s51, v14
    s_cbranch_vccz L_ga3_s0
    s_and_b32 s43, s49, 15
    s_cmp_lg_u32 s43, 15
    s_cbranch_scc1 L_gan1_s0
    v_cmp_eq_u32 vcc, s51, v56
    v_cmp_eq_u32 s[44:45], s51, v57
    s_nop 0
    s_or_b64 vcc, vcc, s[44:45]
    v_cmp_eq_u32 s[44:45], s51, v58
    s_nop 0
    s_or_b64 vcc, vcc, s[44:45]
    v_cmp_eq_u32 s[44:45], s51, v59
    s_nop 0
    s_or_b64 vcc, vcc, s[44:45]
    s_cbranch_vccz L_ga3_s0
L_gan1_s0:
    s_add_u32 s43, s40, 0
    buffer_load_dwordx4 v[56:59], v0, s[8:11], s43 offen sc1
    s_add_u32 s49, s49, 1
    s_cmp_gt_u32 s49, 4000000
    s_cbranch_scc1 L_fail
    s_branch L_gaw0_s0
L_ga3_s0:
    s_waitcnt lgkmcnt(0)
    s_waitcnt vmcnt(0)
    s_branch L_gar_s0
L_gb_s0:
    s_mov_b32 s49, 0
    s_add_u32 s43, s40, 4096
    buffer_load_dwordx4 v[32:35], v0, s[8:11], s43 offen sc1
    s_add_u32 s43, s40, 8192
    buffer_load_dword v12, v11, s[8:11], s43 offen sc1
    s_waitcnt vmcnt(2)
    s_branch L_gbc1_s0
L_gbw0_s0:
    s_waitcnt vmcnt(2)
L_gbc0_s0:
    ds_write_b128 v0, v[32:35] offset:4096
    ds_write_b32 v11, v12 offset:8192
    v_max3_u32 v14, v32, v33, v34
    v_max3_u32 v14, v14, v35, v12
    v_cmp_le_u32 vcc, s51, v14
    s_cbranch_vccz L_gb3_s0
    s_and_b32 s43, s49, 15
    s_cmp_lg_u32 s43, 15
    s_cbranch_scc1 L_gbn0_s0
    v_cmp_eq_u32 vcc, s51, v32
    v_cmp_eq_u32 s[44:45], s51, v33
    s_nop 0
    s_or_b64 vcc, vcc, s[44:45]
    v_cmp_eq_u32 s[44:45], s51, v34
    s_nop 0
    s_or_b64 vcc, vcc, s[44:45]
    v_cmp_eq_u32 s[44:45], s51, v35
    s_nop 0
    s_or_b64 vcc, vcc, s[44:45]
    v_cmp_eq_u32 s[44:45], s51, v12
    s_nop 0
    s_or_b64 vcc, vcc, s[44:45]
    s_cbranch_vccz L_gb3_s0
L_gbn0_s0:
    s_add_u32 s43, s40, 4096
    buffer_load_dwordx4 v[32:35], v0, s[8:11], s43 offen sc1
    s_add_u32 s43, s40, 8192
    buffer_load_dword v12, v11, s[8:11], s43 offen sc1
    s_add_u32 s49, s49, 1
    s_cmp_gt_u32 s49, 4000000
    s_cbranch_scc1 L_fail
L_gbw1_s0:
    s_waitcnt vmcnt(2)
L_gbc1_s0:
    ds_write_b128 v0, v[36:39] offset:4096
    ds_write_b32 v11, v13 offset:8192
    v_max3_u32 v14, v36, v37, v38
    v_max3_u32 v14, v14, v39, v13
    v_cmp_le_u32 vcc, s51, v14
    s_cbranch_vccz L_gb3_s0
    s_and_b32 s43, s49, 15
    s_cmp_lg_u32 s43, 15
    s_cbranch_scc1 L_gbn1_s0
    v_cmp_eq_u32 vcc, s51, v36
    v_cmp_eq_u32 s[44:45], s51, v37
    s_nop 0
    s_or_b64 vcc, vcc, s[44:45]
    v_cmp_eq_u32 s[44:45], s51, v38
    s_nop 0
    s_or_b64 vcc, vcc, s[44:45]
    v_cmp_eq_u32 s[44:45], s51, v39
    s_nop 0
    s_or_b64 vcc, vcc, s[44:45]
    v_cmp_eq_u32 s[44:45], s51, v13
    s_nop 0
    s_or_b64 vcc, vcc, s[44:45]
    s_cbranch_vccz L_gb3_s0
L_gbn1_s0:
    s_add_u32 s43, s40, 4096
    buffer_load_dwordx4 v[36:39], v0, s[8:11], s43 offen sc1
    s_add_u32 s43, s40, 8192
    buffer_load_dword v13, v11, s[8:11], s43 offen sc1
    s_add_u32 s49, s49, 1
    s_cmp_gt_u32 s49, 4000000
    s_cbranch_scc1 L_fail
    s_branch L_gbw0_s0
L_gb3_s0:
    s_waitcnt lgkmcnt(0)
    s_waitcnt vmcnt(0)
    s_branch L_gbr_s0
L_rw1_s0:
    s_waitcnt vmcnt(7)
    v_mfma_f32_16x16x32_bf16 v[24:27], v[20:23], v[48:51], 0
    v_bitop3_b32 v18, v48, v50, v19 bitop3:0x7e
    s_waitcnt vmcnt(6)
    v_mfma_f32_16x16x32_bf16 v[24:27], v[20:23], v[52:55], v[24:27]
    v_bitop3_b32 v16, v52, v54, v19 bitop3:0x7e
    v_or_b32 v18, v18, v16
    s_waitcnt vmcnt(5)
    v_mfma_f32_16x16x32_bf16 v[24:27], v[20:23], v[56:59], v[24:27]
    v_bitop3_b32 v16, v56, v58, v19 bitop3:0x7e
    v_or_b32 v18, v18, v16
    s_waitcnt vmcnt(4)
    v_mfma_f32_16x16x32_bf16 v[24:27], v[20:23], v[60:63], v[24:27]
    v_bitop3_b32 v16, v60, v62, v19 bitop3:0x7e
    v_or_b32 v18, v18, v16
    v_and_b32 v18, 1, v18
    v_cmp_ne_u32 vcc, 0, v18
    s_nop 3
    v_add_f32_dpp v28, v24, v24 row_ror:8 row_mask:0xf bank_mask:0xf
    v_add_f32_dpp v29, v25, v25 row_ror:8 row_mask:0xf bank_mask:0xf
    v_add_f32_dpp v30, v26, v26 row_ror:8 row_mask:0xf bank_mask:0xf
    v_add_f32_dpp v31, v27, v27 row_ror:8 row_mask:0xf bank_mask:0xf
    v_cvt_pk_bf16_f32 v28, v28, v29
    v_cvt_pk_bf16_f32 v29, v30, v31
    s_cbranch_vccz L_rp_s0
L_rn1_s0:
    buffer_load_dwordx4 v[48:51], v0, s[8:11], s43 offen offset:0 sc1
    buffer_load_dwordx4 v[52:55], v0, s[8:11], s43 offen offset:1024 sc1
    buffer_load_dwordx4 v[56:59], v0, s[8:11], s43 offen offset:2048 sc1
    buffer_load_dwordx4 v[60:63], v0, s[8:11], s43 offen offset:3072 sc1
    s_add_u32 s49, s49, 1
    s_cmp_gt_u32 s49, 4000000
    s_cbranch_scc1 L_fail
L_rw0_s0:
    s_waitcnt vmcnt(7)
    v_mfma_f32_16x16x32_bf16 v[24:27], v[20:23], v[32:35], 0
    v_bitop3_b32 v18, v32, v34, v19 bitop3:0x7e
    s_waitcnt vmcnt(6)
    v_mfma_f32_16x16x32_bf16 v[24:27], v[20:23], v[36:39], v[24:27]
    v_bitop3_b32 v16, v36, v38, v19 bitop3:0x7e
    v_or_b32 v18, v18, v16
    s_waitcnt vmcnt(5)
    v_mfma_f32_16x16x32_bf16 v[24:27], v[20:23], v[40:43], v[24:27]
    v_bitop3_b32 v16, v40, v42, v19 bitop3:0x7e
    v_or_b32 v18, v18, v16
    s_waitcnt vmcnt(4)
    v_mfma_f32_16x16x32_bf16 v[24:27], v[20:23], v[44:47], v[24:27]
    v_bitop3_b32 v16, v44, v46, v19 bitop3:0x7e
    v_or_b32 v18, v18, v16
    v_and_b32 v18, 1, v18
    v_cmp_ne_u32 vcc, 0, v18
    s_nop 3
    v_add_f32_dpp v28, v24, v24 row_ror:8 row_mask:0xf bank_mask:0xf
    v_add_f32_dpp v29, v25, v25 row_ror:8 row_mask:0xf bank_mask:0xf
    v_add_f32_dpp v30, v26, v26 row_ror:8 row_mask:0xf bank_mask:0xf
    v_add_f32_dpp v31, v27, v27 row_ror:8 row_mask:0xf bank_mask:0xf
    v_cvt_pk_bf16_f32 v28, v28, v29
    v_cvt_pk_bf16_f32 v29, v30, v31
    s_cbranch_vccz L_rp_s0
L_rn0_s0:
    buffer_load_dwordx4 v[32:35], v0, s[8:11], s43 offen offset:0 sc1
    buffer_load_dwordx4 v[36:39], v0, s[8:11], s43 offen offset:1024 sc1
    buffer_load_dwordx4 v[40:43], v0, s[8:11], s43 offen offset:2048 sc1
    buffer_load_dwordx4 v[44:47], v0, s[8:11], s43 offen offset:3072 sc1
    s_add_u32 s49, s49, 1
    s_cmp_gt_u32 s49, 4000000
    s_cbranch_scc1 L_fail
    s_branch L_rw1_s0
L_slow_s0:
    s_cmp_eq_u32 s46, 0x5105
    s_cbranch_scc1 L_pv3_s0
    s_mov_b32 s46, 0x5105
    s_nop 0
    v_mov_b32 v54, v52
    v_mov_b32 v55, v53
    s_nop 0
    v_max_f32_dpp v54, v54, v54 row_ror:1 row_mask:0xf bank_mask:0xf
    v_max_f32_dpp v55, v55, v55 row_ror:1 row_mask:0xf bank_mask:0xf
    s_nop 0
    v_max_f32_dpp v54, v54, v54 row_ror:2 row_mask:0xf bank_mask:0xf
    v_max_f32_dpp v55, v55, v55 row_ror:2 row_mask:0xf bank_mask:0xf
    s_nop 0
    v_max_f32_dpp v54, v54, v54 row_ror:4 row_mask:0xf bank_mask:0xf
    v_max_f32_dpp v55, v55, v55 row_ror:4 row_mask:0xf bank_mask:0xf
    s_nop 0
    v_max_f32_dpp v54, v54, v54 row_ror:8 row_mask:0xf bank_mask:0xf
    v_max_f32_dpp v55, v55, v55 row_ror:8 row_mask:0xf bank_mask:0xf
    v_and_b32 v35, 15, v11
    v_lshlrev_b32 v35, 1, v35
    ds_write_b64 v35, v[54:55] offset:16256
    s_waitcnt lgkmcnt(0)
    s_barrier
    ds_read_b64 v[16:17], v35 offset:16256
    ds_read_b64 v[18:19], v35 offset:16288
    ds_read_b64 v[20:21], v35 offset:16320
    s_waitcnt lgkmcnt(0)
    v_max3_f32 v54, v16, v18, v20
    v_max3_f32 v55, v17, v19, v21
    v_sub_f32 v54, v52, v54
    v_sub_f32 v55, v53, v55
    v_exp_f32 v54, v54
    v_exp_f32 v55, v55
    s_nop 0
    v_cvt_pk_bf16_f32 v54, v54, v55
    ds_write_b32 v11, v54 offset:15360
    s_waitcnt lgkmcnt(0)
    s_barrier
    s_branch L_pv_s0
L_pv2_s0:
    ds_read_b128 v[24:27], v0 offset:24576
    ds_read_b128 v[28:31], v0 offset:25600
    s_waitcnt lgkmcnt(0)
    v_mov_b32 v56, 0x3f803f80
    v_mov_b32 v57, 0x3f803f80
    v_mov_b32 v58, 0x3f803f80
    v_mov_b32 v59, 0x3f803f80
    s_nop 1
    v_mfma_f32_16x16x32_bf16 v[36:39], v[56:59], v[48:51], 0
    v_mfma_f32_16x16x32_bf16 v[16:19], v[24:27], v[48:51], 0
    v_mfma_f32_16x16x32_bf16 v[20:23], v[28:31], v[48:51], 0
    v_mfma_f32_16x16x16_bf16 v[36:39], v[32:33], v[54:55], v[36:39]
    v_mfma_f32_16x16x16_bf16 v[16:19], v[40:41], v[54:55], v[16:19]
    v_mfma_f32_16x16x16_bf16 v[20:23], v[44:45], v[54:55], v[20:23]
    s_nop 7
    s_branch L_pv4_s0
L_tail_s0:
    s_waitcnt lgkmcnt(0)
    v_smfmac_f32_16x16x64_bf16 v[44:47], v[60:63], a[120:127], v10
    ds_read_b128 v[16:19], v1 offset:16384
    ds_read_b128 v[20:23], v1 offset:17408
    v_smfmac_f32_16x16x64_bf16 v[40:43], v[48:51], a[128:135], v10
    ds_read_b128 v[24:27], v1 offset:18432
    ds_read_b128 v[28:31], v1 offset:19456
    v_smfmac_f32_16x16x64_bf16 v[44:47], v[48:51], a[136:143], v10
    ds_read_b64_tr_b16 v[60:61], v2 offset:1024
    ds_read_b64_tr_b16 v[62:63], v3 offset:1024
    v_smfmac_f32_16x16x64_bf16 v[40:43], v[56:59], a[32:39], v10
    ds_read_b64_tr_b16 v[48:49], v2 offset:2048
    ds_read_b64_tr_b16 v[50:51], v3 offset:2048
    v_smfmac_f32_16x16x64_bf16 v[44:47], v[56:59], a[40:47], v10
    ds_read_b64_tr_b16 v[56:57], v2 offset:3072
    ds_read_b64_tr_b16 v[58:59], v3 offset:3072
    s_waitcnt lgkmcnt(4)
    v_smfmac_f32_16x16x64_bf16 v[40:43], v[60:63], a[48:55], v10
    v_smfmac_f32_16x16x64_bf16 v[44:47], v[60:63], a[56:63], v10
    ds_read_b64_tr_b16 v[60:61], v2 offset:4096
    ds_read_b64_tr_b16 v[62:63], v3 offset:4096
    s_waitcnt lgkmcnt(4)
    v_smfmac_f32_16x16x64_bf16 v[40:43], v[48:51], v[16:23], v10
    v_smfmac_f32_16x16x64_bf16 v[44:47], v[48:51], v[24:31], v10
    s_waitcnt lgkmcnt(2)
    v_smfmac_f32_16x16x64_bf16 v[40:43], v[56:59], a[64:71], v10
    v_smfmac_f32_16x16x64_bf16 v[44:47], v[56:59], a[72:79], v10
    s_waitcnt lgkmcnt(0)
    v_smfmac_f32_16x16x64_bf16 v[40:43], v[60:63], a[80:87], v10
    v_smfmac_f32_16x16x64_bf16 v[44:47], v[60:63], a[88:95], v10
    s_nop 3
    v_add_f32 v40, v40, v42
    v_add_f32 v41, v41, v43
    v_cvt_pk_bf16_f32 v40, v40, v41
    s_nop 0
    v_add_f32 v44, v44, v46
    v_add_f32 v45, v45, v47
    v_cvt_pk_bf16_f32 v44, v44, v45
    ds_write_b32 v11, v40 offset:9216
    ds_write_b32 v11, v44 offset:9472
    s_waitcnt vmcnt(0)
    v_and_b32 v12, 0x200, v0
    v_mul_u32_u24 v12, 3, v12
    v_add_u32 v12, v12, v0
    ds_read_b128 v[12:15], v12 offset:9216
    s_waitcnt lgkmcnt(0)
    s_lshr_b32 s44, s48, 1
    s_add_u32 s44, s44, 0x4100000
    buffer_store_dwordx4 v[12:15], v0, s[8:11], s44 offen sc1
    s_waitcnt vmcnt(0)
    s_barrier
    s_branch L_end
L_cw1:
    v_and_b32 v24, 1, v18
    v_lshlrev_b32 v24, 1, v24
    v_xor_b32 v24, v24, v19
    v_xor_b32 v24, 8, v24
    v_lshlrev_b32 v25, 13, v18
    v_lshl_add_u32 v48, v24, 4, v25
    v_xor_b32 v24, 4, v24
    v_lshl_add_u32 v49, v24, 4, v25
    v_mul_u32_u24 v25, 1152, v18
    v_lshl_add_u32 v51, v24, 4, v25
    v_xor_b32 v24, 4, v24
    v_lshl_add_u32 v50, v24, 4, v25
    v_lshrrev_b32 v24, 3, v17
    v_mul_u32_u24 v24, 1152, v24
    v_and_b32 v25, 7, v17
    v_lshl_add_u32 v52, v25, 4, v24
    v_lshrrev_b32 v24, 1, v22
    v_and_b32 v25, 1, v22
    v_lshlrev_b32 v26, 15, v24
    v_lshl_add_u32 v26, v18, 10, v26
    v_lshl_add_u32 v26, v25, 8, v26
    v_lshl_add_u32 v26, v23, 3, v26
    v_add_u32 v26, 32768, v26
    v_lshl_add_u32 v27, v21, 1, v25
    v_lshl_add_u32 v27, v24, 2, v27
    v_xor_b32 v28, 2, v27
    v_lshl_add_u32 v53, v28, 5, v26
    v_add_u32 v55, 65536, v53
    v_xor_b32 v28, 3, v27
    v_lshl_add_u32 v54, v28, 5, v26
    v_add_u32 v56, 65536, v54
    v_lshlrev_b32 v26, 15, v21
    v_lshl_add_u32 v26, v20, 10, v26
    v_lshl_add_u32 v26, v25, 8, v26
    v_lshl_add_u32 v26, v23, 3, v26
    v_add_u32 v26, 32768, v26
    v_lshl_add_u32 v27, v20, 1, v25
    v_lshl_add_u32 v27, v21, 2, v27
    v_add_u32 v28, 2, v24
    v_xor_b32 v28, v28, v27
    v_lshl_add_u32 v57, v28, 5, v26
    v_add_u32 v58, 65536, v57
    v_lshlrev_b32 v26, 15, v24
    v_lshl_add_u32 v26, v21, 11, v26
    v_lshl_add_u32 v26, v20, 9, v26
    v_lshl_add_u32 v26, v25, 7, v26
    v_lshl_add_u32 v26, v23, 3, v26
    v_add_u32 v61, 32800, v26
    v_add_u32 v62, 65536, v61
    s_lshl_b32 s45, s36, 8
    s_mul_i32 s46, s36, 147456
    v_lshlrev_b32 v28, 1, v17
    v_lshlrev_b32 v29, 9, v20
    v_lshlrev_b32 v30, 3, v19
    v_add_u32 v29, v29, v30
    v_lshlrev_b32 v30, 2, v21
    v_add_u32 v29, v29, v30
    v_xor_b32 v29, 0, v29
    s_mov_b32 s43, 2304
    buffer_load_ushort v32, v28, s[32:35], s43 offen offset:0
    buffer_load_ushort v33, v28, s[32:35], s43 offen offset:128
    buffer_load_ushort v34, v28, s[32:35], s43 offen offset:256
    buffer_load_ushort v35, v28, s[32:35], s43 offen offset:384
    buffer_load_ushort v36, v28, s[32:35], s43 offen offset:512
    buffer_load_ushort v37, v28, s[32:35], s43 offen offset:640
    buffer_load_ushort v38, v28, s[32:35], s43 offen offset:768
    buffer_load_ushort v39, v28, s[32:35], s43 offen offset:896
    buffer_load_ushort v40, v28, s[32:35], s43 offen offset:1024
    s_mov_b32 s43, 3456
    buffer_load_ushort v41, v28, s[32:35], s43 offen offset:0
    buffer_load_ushort v42, v28, s[32:35], s43 offen offset:128
    buffer_load_ushort v43, v28, s[32:35], s43 offen offset:256
    buffer_load_ushort v44, v28, s[32:35], s43 offen offset:384
    buffer_load_ushort v45, v28, s[32:35], s43 offen offset:512
    buffer_load_ushort v46, v28, s[32:35], s43 offen offset:640
    buffer_load_ushort v47, v28, s[32:35], s43 offen offset:768
    buffer_load_ushort v12, v28, s[32:35], s43 offen offset:896
    buffer_load_ushort v13, v28, s[32:35], s43 offen offset:1024
    v_mov_b32 v63, v29
    s_waitcnt lgkmcnt(0)
    s_mov_b32 s38, 0
    s_mov_b32 s39, 0
    s_mov_b32 s40, 1048576
    s_mov_b32 s41, 1064960
    s_mov_b32 s42, 1081344
    s_lshl_b32 s48, s36, 13
    s_mov_b32 s94, 0xffbfffbf
    s_mov_b32 s96, 0x3f803f80
    s_mov_b32 s100, 0xcccccccc
    s_mov_b32 s101, 0xcccccccc
    s_mov_b32 s97, 0x3f803f80
    s_mov_b32 s98, 0x3f803f80
    s_mov_b32 s99, 0
    s_mov_b32 s95, 0xffbfffbf
    s_mov_b32 s54, 294912
    s_mov_b32 s92, 0
    s_mov_b32 s93, 1097728
    s_waitcnt vmcnt(46)
    s_barrier
    ds_read_b64_tr_b16 v[64:65], v53 offset:16384
    ds_read_b64_tr_b16 v[66:67], v53 offset:16896
    ds_read_b64_tr_b16 v[68:69], v55 offset:16384
    ds_read_b64_tr_b16 v[70:71], v55 offset:16896
    ds_read_b64_tr_b16 v[72:73], v54 offset:16384
    ds_read_b64_tr_b16 v[74:75], v54 offset:16896
    ds_read_b64_tr_b16 v[76:77], v56 offset:16384
    ds_read_b64_tr_b16 v[78:79], v56 offset:16896
    s_waitcnt lgkmcnt(0)
    s_waitcnt vmcnt(42)
    s_barrier
    s_mov_b32 m0, 0x14000
    s_add_u32 s43, s45, 0x420000
    buffer_load_dwordx4 v48, s[16:19], s43 offen lds
    s_mov_b32 m0, 0x14400
    s_add_u32 s43, s45, 0x428000
    buffer_load_dwordx4 v49, s[16:19], s43 offen lds
    s_mov_b32 m0, 0x14800
    s_add_u32 s43, s45, 0x430000
    buffer_load_dwordx4 v48, s[16:19], s43 offen lds
    s_mov_b32 m0, 0x14c00
    s_add_u32 s43, s45, 0x438000
    buffer_load_dwordx4 v49, s[16:19], s43 offen lds
    ds_read_b64_tr_b16 a[144:145], v53 offset:20480
    ds_read_b64_tr_b16 a[146:147], v53 offset:20992
    ds_read_b64_tr_b16 a[148:149], v55 offset:20480
    ds_read_b64_tr_b16 a[150:151], v55 offset:20992
    ds_read_b64_tr_b16 a[152:153], v54 offset:20480
    ds_read_b64_tr_b16 a[154:155], v54 offset:20992
    ds_read_b64_tr_b16 a[156:157], v56 offset:20480
    ds_read_b64_tr_b16 a[158:159], v56 offset:20992
    s_waitcnt lgkmcnt(0)
    s_waitcnt vmcnt(42)
    s_barrier
    s_mov_b32 m0, 0x15000
    s_add_u32 s43, s45, 0x20000
    buffer_load_dwordx4 v48, s[20:23], s43 offen lds
    s_mov_b32 m0, 0x15400
    s_add_u32 s43, s45, 0x28000
    buffer_load_dwordx4 v49, s[20:23], s43 offen lds
    s_mov_b32 m0, 0x15800
    s_add_u32 s43, s45, 0x30000
    buffer_load_dwordx4 v48, s[20:23], s43 offen lds
    s_mov_b32 m0, 0x15c00
    s_add_u32 s43, s45, 0x38000
    buffer_load_dwordx4 v49, s[20:23], s43 offen lds
    ds_read_b64_tr_b16 v[80:81], v53 offset:24576
    ds_read_b64_tr_b16 v[82:83], v53 offset:25088
    ds_read_b64_tr_b16 v[84:85], v55 offset:24576
    ds_read_b64_tr_b16 v[86:87], v55 offset:25088
    ds_read_b64_tr_b16 v[88:89], v54 offset:24576
    ds_read_b64_tr_b16 v[90:91], v54 offset:25088
    ds_read_b64_tr_b16 v[92:93], v56 offset:24576
    ds_read_b64_tr_b16 v[94:95], v56 offset:25088
    s_waitcnt lgkmcnt(0)
    s_waitcnt vmcnt(42)
    s_barrier
    s_mov_b32 m0, 0x16000
    s_add_u32 s43, s45, 0xa0000
    buffer_load_dwordx4 v48, s[20:23], s43 offen lds
    s_mov_b32 m0, 0x16400
    s_add_u32 s43, s45, 0xa8000
    buffer_load_dwordx4 v49, s[20:23], s43 offen lds
    s_mov_b32 m0, 0x16800
    s_add_u32 s43, s45, 0xb0000
    buffer_load_dwordx4 v48, s[20:23], s43 offen lds
    s_mov_b32 m0, 0x16c00
    s_add_u32 s43, s45, 0xb8000
    buffer_load_dwordx4 v49, s[20:23], s43 offen lds
    ds_read_b64_tr_b16 v[96:97], v53 offset:28672
    ds_read_b64_tr_b16 v[98:99], v53 offset:29184
    ds_read_b64_tr_b16 v[100:101], v55 offset:28672
    ds_read_b64_tr_b16 v[102:103], v55 offset:29184
    ds_read_b64_tr_b16 v[104:105], v54 offset:28672
    ds_read_b64_tr_b16 v[106:107], v54 offset:29184
    ds_read_b64_tr_b16 v[108:109], v56 offset:28672
    ds_read_b64_tr_b16 v[110:111], v56 offset:29184
    s_waitcnt lgkmcnt(0)
    s_waitcnt vmcnt(42)
    s_barrier
    s_mov_b32 m0, 0x17000
    s_add_u32 s43, s45, 0x120000
    buffer_load_dwordx4 v48, s[20:23], s43 offen lds
    s_mov_b32 m0, 0x17400
    s_add_u32 s43, s45, 0x128000
    buffer_load_dwordx4 v49, s[20:23], s43 offen lds
    s_mov_b32 m0, 0x17800
    s_add_u32 s43, s45, 0x130000
    buffer_load_dwordx4 v48, s[20:23], s43 offen lds
    s_mov_b32 m0, 0x17c00
    s_add_u32 s43, s45, 0x138000
    buffer_load_dwordx4 v49, s[20:23], s43 offen lds
    ds_read_b64_tr_b16 a[160:161], v53 offset:0
    ds_read_b64_tr_b16 a[162:163], v53 offset:512
    ds_read_b64_tr_b16 a[164:165], v55 offset:0
    ds_read_b64_tr_b16 a[166:167], v55 offset:512
    ds_read_b64_tr_b16 a[168:169], v54 offset:0
    ds_read_b64_tr_b16 a[170:171], v54 offset:512
    ds_read_b64_tr_b16 a[172:173], v56 offset:0
    ds_read_b64_tr_b16 a[174:175], v56 offset:512
    s_waitcnt lgkmcnt(0)
    s_waitcnt vmcnt(42)
    s_barrier
    s_mov_b32 m0, 0x10000
    s_add_u32 s43, s45, 0x1a0000
    buffer_load_dwordx4 v48, s[20:23], s43 offen lds
    s_mov_b32 m0, 0x10400
    s_add_u32 s43, s45, 0x1a8000
    buffer_load_dwordx4 v49, s[20:23], s43 offen lds
    s_mov_b32 m0, 0x10800
    s_add_u32 s43, s45, 0x1b0000
    buffer_load_dwordx4 v48, s[20:23], s43 offen lds
    s_mov_b32 m0, 0x10c00
    s_add_u32 s43, s45, 0x1b8000
    buffer_load_dwordx4 v49, s[20:23], s43 offen lds
    ds_read_b64_tr_b16 v[112:113], v53 offset:4096
    ds_read_b64_tr_b16 v[114:115], v53 offset:4608
    ds_read_b64_tr_b16 v[116:117], v55 offset:4096
    ds_read_b64_tr_b16 v[118:119], v55 offset:4608
    ds_read_b64_tr_b16 v[120:121], v54 offset:4096
    ds_read_b64_tr_b16 v[122:123], v54 offset:4608
    ds_read_b64_tr_b16 v[124:125], v56 offset:4096
    ds_read_b64_tr_b16 v[126:127], v56 offset:4608
    s_waitcnt lgkmcnt(0)
    s_waitcnt vmcnt(42)
    s_barrier
    s_mov_b32 m0, 0x11000
    s_add_u32 s43, s45, 0x220000
    buffer_load_dwordx4 v48, s[20:23], s43 offen lds
    s_mov_b32 m0, 0x11400
    s_add_u32 s43, s45, 0x228000
    buffer_load_dwordx4 v49, s[20:23], s43 offen lds
    s_mov_b32 m0, 0x11800
    s_add_u32 s43, s45, 0x230000
    buffer_load_dwordx4 v48, s[20:23], s43 offen lds
    s_mov_b32 m0, 0x11c00
    s_add_u32 s43, s45, 0x238000
    buffer_load_dwordx4 v49, s[20:23], s43 offen lds
    ds_read_b64_tr_b16 v[128:129], v53 offset:8192
    ds_read_b64_tr_b16 v[130:131], v53 offset:8704
    ds_read_b64_tr_b16 v[132:133], v55 offset:8192
    ds_read_b64_tr_b16 v[134:135], v55 offset:8704
    ds_read_b64_tr_b16 v[136:137], v54 offset:8192
    ds_read_b64_tr_b16 v[138:139], v54 offset:8704
    ds_read_b64_tr_b16 v[140:141], v56 offset:8192
    ds_read_b64_tr_b16 v[142:143], v56 offset:8704
    s_waitcnt lgkmcnt(0)
    s_waitcnt vmcnt(42)
    s_barrier
    s_mov_b32 m0, 0x12000
    s_add_u32 s43, s45, 0x2a0000
    buffer_load_dwordx4 v48, s[20:23], s43 offen lds
    s_mov_b32 m0, 0x12400
    s_add_u32 s43, s45, 0x2a8000
    buffer_load_dwordx4 v49, s[20:23], s43 offen lds
    s_mov_b32 m0, 0x12800
    s_add_u32 s43, s45, 0x2b0000
    buffer_load_dwordx4 v48, s[20:23], s43 offen lds
    s_mov_b32 m0, 0x12c00
    s_add_u32 s43, s45, 0x2b8000
    buffer_load_dwordx4 v49, s[20:23], s43 offen lds
    ds_read_b64_tr_b16 v[144:145], v53 offset:12288
    ds_read_b64_tr_b16 v[146:147], v53 offset:12800
    ds_read_b64_tr_b16 v[148:149], v55 offset:12288
    ds_read_b64_tr_b16 v[150:151], v55 offset:12800
    ds_read_b64_tr_b16 v[152:153], v54 offset:12288
    ds_read_b64_tr_b16 v[154:155], v54 offset:12800
    ds_read_b64_tr_b16 v[156:157], v56 offset:12288
    ds_read_b64_tr_b16 v[158:159], v56 offset:12800
    s_waitcnt lgkmcnt(0)
    s_waitcnt vmcnt(24)
    s_barrier
    s_mov_b32 m0, 0x13000
    s_add_u32 s43, s45, 0x320000
    buffer_load_dwordx4 v48, s[20:23], s43 offen lds
    s_mov_b32 m0, 0x13400
    s_add_u32 s43, s45, 0x328000
    buffer_load_dwordx4 v49, s[20:23], s43 offen lds
    s_mov_b32 m0, 0x13800
    s_add_u32 s43, s45, 0x330000
    buffer_load_dwordx4 v48, s[20:23], s43 offen lds
    s_mov_b32 m0, 0x13c00
    s_add_u32 s43, s45, 0x338000
    buffer_load_dwordx4 v49, s[20:23], s43 offen lds
    ds_read_b64_tr_b16 v[160:161], v53 offset:16384
    ds_read_b64_tr_b16 v[162:163], v53 offset:16896
    ds_read_b64_tr_b16 v[164:165], v55 offset:16384
    ds_read_b64_tr_b16 v[166:167], v55 offset:16896
    ds_read_b64_tr_b16 v[168:169], v54 offset:16384
    ds_read_b64_tr_b16 v[170:171], v54 offset:16896
    ds_read_b64_tr_b16 v[172:173], v56 offset:16384
    ds_read_b64_tr_b16 v[174:175], v56 offset:16896
    s_waitcnt lgkmcnt(0)
    s_waitcnt vmcnt(24)
    s_barrier
    s_mov_b32 m0, 0x14000
    s_add_u32 s43, s45, 0x3a0000
    buffer_load_dwordx4 v48, s[20:23], s43 offen lds
    s_mov_b32 m0, 0x14400
    s_add_u32 s43, s45, 0x3a8000
    buffer_load_dwordx4 v49, s[20:23], s43 offen lds
    s_mov_b32 m0, 0x14800
    s_add_u32 s43, s45, 0x3b0000
    buffer_load_dwordx4 v48, s[20:23], s43 offen lds
    s_mov_b32 m0, 0x14c00
    s_add_u32 s43, s45, 0x3b8000
    buffer_load_dwordx4 v49, s[20:23], s43 offen lds
    ds_read_b64_tr_b16 v[192:193], v53 offset:20480
    ds_read_b64_tr_b16 v[194:195], v53 offset:20992
    ds_read_b64_tr_b16 v[196:197], v55 offset:20480
    ds_read_b64_tr_b16 v[198:199], v55 offset:20992
    ds_read_b64_tr_b16 v[200:201], v54 offset:20480
    ds_read_b64_tr_b16 v[202:203], v54 offset:20992
    ds_read_b64_tr_b16 v[204:205], v56 offset:20480
    ds_read_b64_tr_b16 v[206:207], v56 offset:20992
    s_waitcnt lgkmcnt(0)
    ds_write_b16 v63, v32 offset:128
    ds_write_b16 v63, v33 offset:1152
    ds_write_b16 v63, v34 offset:2176
    ds_write_b16 v63, v35 offset:3200
    ds_write_b16 v63, v36 offset:4224
    ds_write_b16 v63, v37 offset:5248
    ds_write_b16 v63, v38 offset:6272
    ds_write_b16 v63, v39 offset:7296
    ds_write_b16 v63, v40 offset:8320
    ds_write_b16 v63, v41 offset:130
    ds_write_b16 v63, v42 offset:1154
    ds_write_b16 v63, v43 offset:2178
    ds_write_b16 v63, v44 offset:3202
    ds_write_b16 v63, v45 offset:4226
    ds_write_b16 v63, v46 offset:5250
    ds_write_b16 v63, v47 offset:6274
    ds_write_b16 v63, v12 offset:7298
    ds_write_b16 v63, v13 offset:8322
    s_waitcnt vmcnt(24)
    s_barrier
    s_mov_b32 m0, 0x15000
    s_add_u32 s43, s45, 0x420000
    buffer_load_dwordx4 v48, s[20:23], s43 offen lds
    s_mov_b32 m0, 0x15400
    s_add_u32 s43, s45, 0x428000
    buffer_load_dwordx4 v49, s[20:23], s43 offen lds
    s_mov_b32 m0, 0x15800
    s_add_u32 s43, s45, 0x430000
    buffer_load_dwordx4 v48, s[20:23], s43 offen lds
    s_mov_b32 m0, 0x15c00
    s_add_u32 s43, s45, 0x438000
    buffer_load_dwordx4 v49, s[20:23], s43 offen lds
    ds_read_b64_tr_b16 v[176:177], v53 offset:24576
    ds_read_b64_tr_b16 v[178:179], v53 offset:25088
    ds_read_b64_tr_b16 v[180:181], v55 offset:24576
    ds_read_b64_tr_b16 v[182:183], v55 offset:25088
    ds_read_b64_tr_b16 v[184:185], v54 offset:24576
    ds_read_b64_tr_b16 v[186:187], v54 offset:25088
    ds_read_b64_tr_b16 v[188:189], v56 offset:24576
    ds_read_b64_tr_b16 v[190:191], v56 offset:25088
    s_waitcnt lgkmcnt(0)
    s_waitcnt vmcnt(24)
    s_barrier
    s_mov_b32 m0, 0x16000
    s_add_u32 s43, s45, 0x20000
    buffer_load_dwordx4 v48, s[24:27], s43 offen lds
    s_mov_b32 m0, 0x16400
    s_add_u32 s43, s45, 0x28000
    buffer_load_dwordx4 v49, s[24:27], s43 offen lds
    s_mov_b32 m0, 0x16800
    s_add_u32 s43, s45, 0x30000
    buffer_load_dwordx4 v48, s[24:27], s43 offen lds
    s_mov_b32 m0, 0x16c00
    s_add_u32 s43, s45, 0x38000
    buffer_load_dwordx4 v49, s[24:27], s43 offen lds
    ds_read_b64_tr_b16 v[208:209], v53 offset:28672
    ds_read_b64_tr_b16 v[210:211], v53 offset:29184
    ds_read_b64_tr_b16 v[212:213], v55 offset:28672
    ds_read_b64_tr_b16 v[214:215], v55 offset:29184
    ds_read_b64_tr_b16 v[216:217], v54 offset:28672
    ds_read_b64_tr_b16 v[218:219], v54 offset:29184
    ds_read_b64_tr_b16 v[220:221], v56 offset:28672
    ds_read_b64_tr_b16 v[222:223], v56 offset:29184
    s_waitcnt lgkmcnt(0)
    s_waitcnt vmcnt(24)
    s_barrier
    s_mov_b32 m0, 0x17000
    s_add_u32 s43, s45, 0xa0000
    buffer_load_dwordx4 v48, s[24:27], s43 offen lds
    s_mov_b32 m0, 0x17400
    s_add_u32 s43, s45, 0xa8000
    buffer_load_dwordx4 v49, s[24:27], s43 offen lds
    s_mov_b32 m0, 0x17800
    s_add_u32 s43, s45, 0xb0000
    buffer_load_dwordx4 v48, s[24:27], s43 offen lds
    s_mov_b32 m0, 0x17c00
    s_add_u32 s43, s45, 0xb8000
    buffer_load_dwordx4 v49, s[24:27], s43 offen lds
    ds_read_b64_tr_b16 a[176:177], v53 offset:0
    ds_read_b64_tr_b16 a[178:179], v53 offset:512
    ds_read_b64_tr_b16 a[180:181], v55 offset:0
    ds_read_b64_tr_b16 a[182:183], v55 offset:512
    ds_read_b64_tr_b16 a[184:185], v54 offset:0
    ds_read_b64_tr_b16 a[186:187], v54 offset:512
    ds_read_b64_tr_b16 a[188:189], v56 offset:0
    ds_read_b64_tr_b16 a[190:191], v56 offset:512
    s_waitcnt lgkmcnt(0)
    s_waitcnt vmcnt(24)
    s_barrier
    s_mov_b32 m0, 0x10000
    s_add_u32 s43, s45, 0x120000
    buffer_load_dwordx4 v48, s[24:27], s43 offen lds
    s_mov_b32 m0, 0x10400
    s_add_u32 s43, s45, 0x128000
    buffer_load_dwordx4 v49, s[24:27], s43 offen lds
    s_mov_b32 m0, 0x10800
    s_add_u32 s43, s45, 0x130000
    buffer_load_dwordx4 v48, s[24:27], s43 offen lds
    s_mov_b32 m0, 0x10c00
    s_add_u32 s43, s45, 0x138000
    buffer_load_dwordx4 v49, s[24:27], s43 offen lds
    ds_read_b64_tr_b16 v[240:241], v53 offset:4096
    ds_read_b64_tr_b16 v[242:243], v53 offset:4608
    ds_read_b64_tr_b16 v[244:245], v55 offset:4096
    ds_read_b64_tr_b16 v[246:247], v55 offset:4608
    ds_read_b64_tr_b16 v[248:249], v54 offset:4096
    ds_read_b64_tr_b16 v[250:251], v54 offset:4608
    ds_read_b64_tr_b16 v[252:253], v56 offset:4096
    ds_read_b64_tr_b16 v[254:255], v56 offset:4608
    s_waitcnt lgkmcnt(0)
    s_waitcnt vmcnt(24)
    s_barrier
    s_mov_b32 m0, 0x11000
    s_add_u32 s43, s45, 0x1a0000
    buffer_load_dwordx4 v48, s[24:27], s43 offen lds
    s_mov_b32 m0, 0x11400
    s_add_u32 s43, s45, 0x1a8000
    buffer_load_dwordx4 v49, s[24:27], s43 offen lds
    s_mov_b32 m0, 0x11800
    s_add_u32 s43, s45, 0x1b0000
    buffer_load_dwordx4 v48, s[24:27], s43 offen lds
    s_mov_b32 m0, 0x11c00
    s_add_u32 s43, s45, 0x1b8000
    buffer_load_dwordx4 v49, s[24:27], s43 offen lds
    ds_read_b64_tr_b16 v[224:225], v53 offset:8192
    ds_read_b64_tr_b16 v[226:227], v53 offset:8704
    ds_read_b64_tr_b16 v[228:229], v55 offset:8192
    ds_read_b64_tr_b16 v[230:231], v55 offset:8704
    ds_read_b64_tr_b16 v[232:233], v54 offset:8192
    ds_read_b64_tr_b16 v[234:235], v54 offset:8704
    ds_read_b64_tr_b16 v[236:237], v56 offset:8192
    ds_read_b64_tr_b16 v[238:239], v56 offset:8704
    s_waitcnt lgkmcnt(0)
    s_waitcnt vmcnt(24)
    s_barrier
    s_mov_b32 m0, 0x12000
    s_add_u32 s43, s45, 0x220000
    buffer_load_dwordx4 v48, s[24:27], s43 offen lds
    s_mov_b32 m0, 0x12400
    s_add_u32 s43, s45, 0x228000
    buffer_load_dwordx4 v49, s[24:27], s43 offen lds
    s_mov_b32 m0, 0x12800
    s_add_u32 s43, s45, 0x230000
    buffer_load_dwordx4 v48, s[24:27], s43 offen lds
    s_mov_b32 m0, 0x12c00
    s_add_u32 s43, s45, 0x238000
    buffer_load_dwordx4 v49, s[24:27], s43 offen lds
    ds_read_b64_tr_b16 a[192:193], v53 offset:12288
    ds_read_b64_tr_b16 a[194:195], v53 offset:12800
    ds_read_b64_tr_b16 a[196:197], v55 offset:12288
    ds_read_b64_tr_b16 a[198:199], v55 offset:12800
    ds_read_b64_tr_b16 a[200:201], v54 offset:12288
    ds_read_b64_tr_b16 a[202:203], v54 offset:12800
    ds_read_b64_tr_b16 a[204:205], v56 offset:12288
    ds_read_b64_tr_b16 a[206:207], v56 offset:12800
    s_waitcnt lgkmcnt(0)
    s_waitcnt vmcnt(24)
    s_barrier
    s_mov_b32 m0, 0x13000
    s_add_u32 s43, s45, 0x2a0000
    buffer_load_dwordx4 v48, s[24:27], s43 offen lds
    s_mov_b32 m0, 0x13400
    s_add_u32 s43, s45, 0x2a8000
    buffer_load_dwordx4 v49, s[24:27], s43 offen lds
    s_mov_b32 m0, 0x13800
    s_add_u32 s43, s45, 0x2b0000
    buffer_load_dwordx4 v48, s[24:27], s43 offen lds
    s_mov_b32 m0, 0x13c00
    s_add_u32 s43, s45, 0x2b8000
    buffer_load_dwordx4 v49, s[24:27], s43 offen lds
    ds_read_b64_tr_b16 a[0:1], v53 offset:16384
    ds_read_b64_tr_b16 a[2:3], v53 offset:16896
    ds_read_b64_tr_b16 a[4:5], v55 offset:16384
    ds_read_b64_tr_b16 a[6:7], v55 offset:16896
    ds_read_b64_tr_b16 a[8:9], v54 offset:16384
    ds_read_b64_tr_b16 a[10:11], v54 offset:16896
    ds_read_b64_tr_b16 a[12:13], v56 offset:16384
    ds_read_b64_tr_b16 a[14:15], v56 offset:16896
    s_waitcnt lgkmcnt(0)
    s_waitcnt vmcnt(24)
    s_barrier
    s_mov_b32 m0, 0x14000
    s_add_u32 s43, s45, 0x320000
    buffer_load_dwordx4 v48, s[24:27], s43 offen lds
    s_mov_b32 m0, 0x14400
    s_add_u32 s43, s45, 0x328000
    buffer_load_dwordx4 v49, s[24:27], s43 offen lds
    s_mov_b32 m0, 0x14800
    s_add_u32 s43, s45, 0x330000
    buffer_load_dwordx4 v48, s[24:27], s43 offen lds
    s_mov_b32 m0, 0x14c00
    s_add_u32 s43, s45, 0x338000
    buffer_load_dwordx4 v49, s[24:27], s43 offen lds
    ds_read_b64_tr_b16 a[16:17], v53 offset:20480
    ds_read_b64_tr_b16 a[18:19], v53 offset:20992
    ds_read_b64_tr_b16 a[20:21], v55 offset:20480
    ds_read_b64_tr_b16 a[22:23], v55 offset:20992
    ds_read_b64_tr_b16 a[24:25], v54 offset:20480
    ds_read_b64_tr_b16 a[26:27], v54 offset:20992
    ds_read_b64_tr_b16 a[28:29], v56 offset:20480
    ds_read_b64_tr_b16 a[30:31], v56 offset:20992
    s_waitcnt lgkmcnt(0)
    s_waitcnt vmcnt(24)
    s_barrier
    s_mov_b32 m0, 0x15000
    s_add_u32 s43, s45, 0x3a0000
    buffer_load_dwordx4 v48, s[24:27], s43 offen lds
    s_mov_b32 m0, 0x15400
    s_add_u32 s43, s45, 0x3a8000
    buffer_load_dwordx4 v49, s[24:27], s43 offen lds
    s_mov_b32 m0, 0x15800
    s_add_u32 s43, s45, 0x3b0000
    buffer_load_dwordx4 v48, s[24:27], s43 offen lds
    s_mov_b32 m0, 0x15c00
    s_add_u32 s43, s45, 0x3b8000
    buffer_load_dwordx4 v49, s[24:27], s43 offen lds
    ds_read_b64_tr_b16 a[48:49], v53 offset:24576
    ds_read_b64_tr_b16 a[50:51], v53 offset:25088
    ds_read_b64_tr_b16 a[52:53], v55 offset:24576
    ds_read_b64_tr_b16 a[54:55], v55 offset:25088
    ds_read_b64_tr_b16 a[56:57], v54 offset:24576
    ds_read_b64_tr_b16 a[58:59], v54 offset:25088
    ds_read_b64_tr_b16 a[60:61], v56 offset:24576
    ds_read_b64_tr_b16 a[62:63], v56 offset:25088
    s_waitcnt lgkmcnt(0)
    s_waitcnt vmcnt(24)
    s_barrier
    s_mov_b32 m0, 0x16000
    s_add_u32 s43, s46, 0x4800
    buffer_load_dwordx4 v50, s[28:31], s43 offen lds
    s_mov_b32 m0, 0x16400
    s_add_u32 s43, s46, 0x5a00
    buffer_load_dwordx4 v51, s[28:31], s43 offen lds
    s_mov_b32 m0, 0x16800
    s_add_u32 s43, s46, 0x6c00
    buffer_load_dwordx4 v50, s[28:31], s43 offen lds
    s_mov_b32 m0, 0x16c00
    s_add_u32 s43, s46, 0x7e00
    buffer_load_dwordx4 v51, s[28:31], s43 offen lds
    ds_read_b64_tr_b16 a[32:33], v53 offset:28672
    ds_read_b64_tr_b16 a[34:35], v53 offset:29184
    ds_read_b64_tr_b16 a[36:37], v55 offset:28672
    ds_read_b64_tr_b16 a[38:39], v55 offset:29184
    ds_read_b64_tr_b16 a[40:41], v54 offset:28672
    ds_read_b64_tr_b16 a[42:43], v54 offset:29184
    ds_read_b64_tr_b16 a[44:45], v56 offset:28672
    ds_read_b64_tr_b16 a[46:47], v56 offset:29184
    s_waitcnt lgkmcnt(0)
    s_waitcnt vmcnt(24)
    s_barrier
    s_mov_b32 m0, 0x17000
    s_add_u32 s43, s46, 0x4a00
    buffer_load_dwordx4 v50, s[28:31], s43 offen lds
    s_mov_b32 m0, 0x17400
    s_add_u32 s43, s46, 0x5c00
    buffer_load_dwordx4 v51, s[28:31], s43 offen lds
    s_mov_b32 m0, 0x17800
    s_add_u32 s43, s46, 0x6e00
    buffer_load_dwordx4 v50, s[28:31], s43 offen lds
    s_mov_b32 m0, 0x17c00
    s_add_u32 s43, s46, 0x8000
    buffer_load_dwordx4 v51, s[28:31], s43 offen lds
    ds_read_b64_tr_b16 a[208:209], v53 offset:0
    ds_read_b64_tr_b16 a[210:211], v53 offset:512
    ds_read_b64_tr_b16 a[212:213], v55 offset:0
    ds_read_b64_tr_b16 a[214:215], v55 offset:512
    ds_read_b64_tr_b16 a[216:217], v54 offset:0
    ds_read_b64_tr_b16 a[218:219], v54 offset:512
    ds_read_b64_tr_b16 a[220:221], v56 offset:0
    ds_read_b64_tr_b16 a[222:223], v56 offset:512
    s_waitcnt lgkmcnt(0)
    s_waitcnt vmcnt(24)
    s_barrier
    s_mov_b32 m0, 0x10000
    s_add_u32 s43, s46, 0x4900
    buffer_load_dwordx4 v50, s[28:31], s43 offen lds
    s_mov_b32 m0, 0x10400
    s_add_u32 s43, s46, 0x5b00
    buffer_load_dwordx4 v51, s[28:31], s43 offen lds
    s_mov_b32 m0, 0x10800
    s_add_u32 s43, s46, 0x6d00
    buffer_load_dwordx4 v50, s[28:31], s43 offen lds
    s_mov_b32 m0, 0x10c00
    s_add_u32 s43, s46, 0x7f00
    buffer_load_dwordx4 v51, s[28:31], s43 offen lds
    ds_read_b64_tr_b16 a[64:65], v53 offset:4096
    ds_read_b64_tr_b16 a[66:67], v53 offset:4608
    ds_read_b64_tr_b16 a[68:69], v55 offset:4096
    ds_read_b64_tr_b16 a[70:71], v55 offset:4608
    ds_read_b64_tr_b16 a[72:73], v54 offset:4096
    ds_read_b64_tr_b16 a[74:75], v54 offset:4608
    ds_read_b64_tr_b16 a[76:77], v56 offset:4096
    ds_read_b64_tr_b16 a[78:79], v56 offset:4608
    s_waitcnt lgkmcnt(0)
    s_waitcnt vmcnt(24)
    s_barrier
    s_mov_b32 m0, 0x11000
    s_add_u32 s43, s46, 0x4b00
    buffer_load_dwordx4 v50, s[28:31], s43 offen lds
    s_mov_b32 m0, 0x11400
    s_add_u32 s43, s46, 0x5d00
    buffer_load_dwordx4 v51, s[28:31], s43 offen lds
    s_mov_b32 m0, 0x11800
    s_add_u32 s43, s46, 0x6f00
    buffer_load_dwordx4 v50, s[28:31], s43 offen lds
    s_mov_b32 m0, 0x11c00
    s_add_u32 s43, s46, 0x8100
    buffer_load_dwordx4 v51, s[28:31], s43 offen lds
    ds_read_b64_tr_b16 a[96:97], v53 offset:8192
    ds_read_b64_tr_b16 a[98:99], v53 offset:8704
    ds_read_b64_tr_b16 a[100:101], v55 offset:8192
    ds_read_b64_tr_b16 a[102:103], v55 offset:8704
    ds_read_b64_tr_b16 a[104:105], v54 offset:8192
    ds_read_b64_tr_b16 a[106:107], v54 offset:8704
    ds_read_b64_tr_b16 a[108:109], v56 offset:8192
    ds_read_b64_tr_b16 a[110:111], v56 offset:8704
    s_waitcnt lgkmcnt(0)
    s_waitcnt vmcnt(24)
    s_barrier
    s_mov_b32 m0, 0x12000
    s_add_u32 s43, s46, 0x16800
    buffer_load_dwordx4 v50, s[28:31], s43 offen lds
    s_mov_b32 m0, 0x12400
    s_add_u32 s43, s46, 0x17a00
    buffer_load_dwordx4 v51, s[28:31], s43 offen lds
    s_mov_b32 m0, 0x12800
    s_add_u32 s43, s46, 0x18c00
    buffer_load_dwordx4 v50, s[28:31], s43 offen lds
    s_mov_b32 m0, 0x12c00
    s_add_u32 s43, s46, 0x19e00
    buffer_load_dwordx4 v51, s[28:31], s43 offen lds
    ds_read_b64_tr_b16 a[80:81], v53 offset:12288
    ds_read_b64_tr_b16 a[82:83], v53 offset:12800
    ds_read_b64_tr_b16 a[84:85], v55 offset:12288
    ds_read_b64_tr_b16 a[86:87], v55 offset:12800
    ds_read_b64_tr_b16 a[88:89], v54 offset:12288
    ds_read_b64_tr_b16 a[90:91], v54 offset:12800
    ds_read_b64_tr_b16 a[92:93], v56 offset:12288
    ds_read_b64_tr_b16 a[94:95], v56 offset:12800
    s_waitcnt lgkmcnt(0)
    s_waitcnt vmcnt(24)
    s_barrier
    s_mov_b32 m0, 0x13000
    s_add_u32 s43, s46, 0x16900
    buffer_load_dwordx4 v50, s[28:31], s43 offen lds
    s_mov_b32 m0, 0x13400
    s_add_u32 s43, s46, 0x17b00
    buffer_load_dwordx4 v51, s[28:31], s43 offen lds
    s_mov_b32 m0, 0x13800
    s_add_u32 s43, s46, 0x18d00
    buffer_load_dwordx4 v50, s[28:31], s43 offen lds
    s_mov_b32 m0, 0x13c00
    s_add_u32 s43, s46, 0x19f00
    buffer_load_dwordx4 v51, s[28:31], s43 offen lds
    ds_read_b64_tr_b16 a[224:225], v53 offset:16384
    ds_read_b64_tr_b16 a[226:227], v53 offset:16896
    ds_read_b64_tr_b16 a[228:229], v55 offset:16384
    ds_read_b64_tr_b16 a[230:231], v55 offset:16896
    ds_read_b64_tr_b16 a[232:233], v54 offset:16384
    ds_read_b64_tr_b16 a[234:235], v54 offset:16896
    ds_read_b64_tr_b16 a[236:237], v56 offset:16384
    ds_read_b64_tr_b16 a[238:239], v56 offset:16896
    s_waitcnt lgkmcnt(0)
    s_waitcnt vmcnt(24)
    s_barrier
    s_mov_b32 m0, 0x14000
    s_add_u32 s43, s46, 0x16a00
    buffer_load_dwordx4 v50, s[28:31], s43 offen lds
    s_mov_b32 m0, 0x14400
    s_add_u32 s43, s46, 0x17c00
    buffer_load_dwordx4 v51, s[28:31], s43 offen lds
    s_mov_b32 m0, 0x14800
    s_add_u32 s43, s46, 0x18e00
    buffer_load_dwordx4 v50, s[28:31], s43 offen lds
    s_mov_b32 m0, 0x14c00
    s_add_u32 s43, s46, 0x1a000
    buffer_load_dwordx4 v51, s[28:31], s43 offen lds
    ds_read_b64_tr_b16 a[112:113], v53 offset:20480
    ds_read_b64_tr_b16 a[114:115], v53 offset:20992
    ds_read_b64_tr_b16 a[116:117], v55 offset:20480
    ds_read_b64_tr_b16 a[118:119], v55 offset:20992
    ds_read_b64_tr_b16 a[120:121], v54 offset:20480
    ds_read_b64_tr_b16 a[122:123], v54 offset:20992
    ds_read_b64_tr_b16 a[124:125], v56 offset:20480
    ds_read_b64_tr_b16 a[126:127], v56 offset:20992
    s_waitcnt lgkmcnt(0)
    s_waitcnt vmcnt(24)
    s_barrier
    s_mov_b32 m0, 0x15000
    s_add_u32 s43, s46, 0x16b00
    buffer_load_dwordx4 v50, s[28:31], s43 offen lds
    s_mov_b32 m0, 0x15400
    s_add_u32 s43, s46, 0x17d00
    buffer_load_dwordx4 v51, s[28:31], s43 offen lds
    s_mov_b32 m0, 0x15800
    s_add_u32 s43, s46, 0x18f00
    buffer_load_dwordx4 v50, s[28:31], s43 offen lds
    s_mov_b32 m0, 0x15c00
    s_add_u32 s43, s46, 0x1a100
    buffer_load_dwordx4 v51, s[28:31], s43 offen lds
    ds_read_b64_tr_b16 a[240:241], v57 offset:24576
    ds_read_b64_tr_b16 a[242:243], v57 offset:25088
    ds_read_b64_tr_b16 a[244:245], v57 offset:26624
    ds_read_b64_tr_b16 a[246:247], v57 offset:27136
    ds_read_b64_tr_b16 a[248:249], v58 offset:24576
    ds_read_b64_tr_b16 a[250:251], v58 offset:25088
    ds_read_b64_tr_b16 a[252:253], v58 offset:26624
    ds_read_b64_tr_b16 a[254:255], v58 offset:27136
    s_waitcnt lgkmcnt(0)
    s_waitcnt vmcnt(24)
    s_barrier
    s_mov_b32 m0, 0x16000
    s_add_u32 s43, s46, 0x9400
    buffer_load_dwordx4 v52, s[28:31], s43 offen lds
    s_mov_b32 m0, 0x16400
    s_add_u32 s43, s46, 0xb800
    buffer_load_dwordx4 v52, s[28:31], s43 offen lds
    s_mov_b32 m0, 0x16800
    s_add_u32 s43, s46, 0xdc00
    buffer_load_dwordx4 v52, s[28:31], s43 offen lds
    s_mov_b32 m0, 0x16c00
    s_add_u32 s43, s46, 0x10000
    buffer_load_dwordx4 v52, s[28:31], s43 offen lds
    ds_read_b64_tr_b16 a[128:129], v57 offset:28672
    ds_read_b64_tr_b16 a[130:131], v57 offset:29184
    ds_read_b64_tr_b16 a[132:133], v57 offset:30720
    ds_read_b64_tr_b16 a[134:135], v57 offset:31232
    ds_read_b64_tr_b16 a[136:137], v58 offset:28672
    ds_read_b64_tr_b16 a[138:139], v58 offset:29184
    ds_read_b64_tr_b16 a[140:141], v58 offset:30720
    ds_read_b64_tr_b16 a[142:143], v58 offset:31232
    s_waitcnt lgkmcnt(0)
    v_mov_b32 v30, 0
    buffer_load_dwordx2 v[24:25], v30, s[12:15], 0 offen sc1
    s_waitcnt vmcnt(25)
    s_barrier
    s_mov_b32 m0, 0x17000
    s_add_u32 s43, s45, 0x420000
    buffer_load_dwordx4 v48, s[24:27], s43 offen lds
    s_mov_b32 m0, 0x17400
    s_add_u32 s43, s45, 0x428000
    buffer_load_dwordx4 v49, s[24:27], s43 offen lds
    s_mov_b32 m0, 0x17800
    s_add_u32 s43, s45, 0x430000
    buffer_load_dwordx4 v48, s[24:27], s43 offen lds
    s_mov_b32 m0, 0x17c00
    s_add_u32 s43, s45, 0x438000
    buffer_load_dwordx4 v49, s[24:27], s43 offen lds
    ds_read_b64_tr_b16 v[32:33], v57 offset:0
    ds_read_b64_tr_b16 v[34:35], v57 offset:512
    ds_read_b64_tr_b16 v[36:37], v57 offset:2048
    ds_read_b64_tr_b16 v[38:39], v57 offset:2560
    ds_read_b64_tr_b16 v[40:41], v58 offset:0
    ds_read_b64_tr_b16 v[42:43], v58 offset:512
    ds_read_b64_tr_b16 v[44:45], v58 offset:2048
    ds_read_b64_tr_b16 v[46:47], v58 offset:2560
    s_waitcnt lgkmcnt(0)
    s_waitcnt vmcnt(25)
    s_barrier
    ds_write_b128 v1, a[144:147] offset:0
    ds_write_b128 v1, a[148:151] offset:1024
    ds_write_b128 v1, a[152:155] offset:2048
    ds_write_b128 v1, a[156:159] offset:3072
    s_waitcnt lgkmcnt(0)
    v_accvgpr_write_b32 a144, v32
    v_accvgpr_write_b32 a145, v33
    v_accvgpr_write_b32 a146, v34
    v_accvgpr_write_b32 a147, v35
    v_accvgpr_write_b32 a148, v36
    v_accvgpr_write_b32 a149, v37
    v_accvgpr_write_b32 a150, v38
    v_accvgpr_write_b32 a151, v39
    v_accvgpr_write_b32 a152, v40
    v_accvgpr_write_b32 a153, v41
    v_accvgpr_write_b32 a154, v42
    v_accvgpr_write_b32 a155, v43
    v_accvgpr_write_b32 a156, v44
    v_accvgpr_write_b32 a157, v45
    v_accvgpr_write_b32 a158, v46
    v_accvgpr_write_b32 a159, v47
    ds_read_b64_tr_b16 v[32:33], v57 offset:4096
    ds_read_b64_tr_b16 v[34:35], v57 offset:4608
    ds_read_b64_tr_b16 v[36:37], v57 offset:6144
    ds_read_b64_tr_b16 v[38:39], v57 offset:6656
    ds_read_b64_tr_b16 v[40:41], v58 offset:4096
    ds_read_b64_tr_b16 v[42:43], v58 offset:4608
    ds_read_b64_tr_b16 v[44:45], v58 offset:6144
    ds_read_b64_tr_b16 v[46:47], v58 offset:6656
    s_waitcnt lgkmcnt(0)
    s_waitcnt vmcnt(21)
    s_barrier
    ds_write_b128 v1, a[160:163] offset:4096
    ds_write_b128 v1, a[164:167] offset:5120
    ds_write_b128 v1, a[168:171] offset:6144
    ds_write_b128 v1, a[172:175] offset:7168
    s_waitcnt lgkmcnt(0)
    v_accvgpr_write_b32 a160, v32
    v_accvgpr_write_b32 a161, v33
    v_accvgpr_write_b32 a162, v34
    v_accvgpr_write_b32 a163, v35
    v_accvgpr_write_b32 a164, v36
    v_accvgpr_write_b32 a165, v37
    v_accvgpr_write_b32 a166, v38
    v_accvgpr_write_b32 a167, v39
    v_accvgpr_write_b32 a168, v40
    v_accvgpr_write_b32 a169, v41
    v_accvgpr_write_b32 a170, v42
    v_accvgpr_write_b32 a171, v43
    v_accvgpr_write_b32 a172, v44
    v_accvgpr_write_b32 a173, v45
    v_accvgpr_write_b32 a174, v46
    v_accvgpr_write_b32 a175, v47
    ds_read_b64_tr_b16 v[32:33], v57 offset:8192
    ds_read_b64_tr_b16 v[34:35], v57 offset:8704
    ds_read_b64_tr_b16 v[36:37], v57 offset:10240
    ds_read_b64_tr_b16 v[38:39], v57 offset:10752
    ds_read_b64_tr_b16 v[40:41], v58 offset:8192
    ds_read_b64_tr_b16 v[42:43], v58 offset:8704
    ds_read_b64_tr_b16 v[44:45], v58 offset:10240
    ds_read_b64_tr_b16 v[46:47], v58 offset:10752
    s_waitcnt lgkmcnt(0)
    s_waitcnt vmcnt(17)
    s_barrier
    ds_write_b128 v1, a[176:179] offset:8192
    ds_write_b128 v1, a[180:183] offset:9216
    ds_write_b128 v1, a[184:187] offset:10240
    ds_write_b128 v1, a[188:191] offset:11264
    s_waitcnt lgkmcnt(0)
    v_accvgpr_write_b32 a176, v32
    v_accvgpr_write_b32 a177, v33
    v_accvgpr_write_b32 a178, v34
    v_accvgpr_write_b32 a179, v35
    v_accvgpr_write_b32 a180, v36
    v_accvgpr_write_b32 a181, v37
    v_accvgpr_write_b32 a182, v38
    v_accvgpr_write_b32 a183, v39
    v_accvgpr_write_b32 a184, v40
    v_accvgpr_write_b32 a185, v41
    v_accvgpr_write_b32 a186, v42
    v_accvgpr_write_b32 a187, v43
    v_accvgpr_write_b32 a188, v44
    v_accvgpr_write_b32 a189, v45
    v_accvgpr_write_b32 a190, v46
    v_accvgpr_write_b32 a191, v47
    ds_read_b64_tr_b16 v[32:33], v57 offset:12288
    ds_read_b64_tr_b16 v[34:35], v57 offset:12800
    ds_read_b64_tr_b16 v[36:37], v57 offset:14336
    ds_read_b64_tr_b16 v[38:39], v57 offset:14848
    ds_read_b64_tr_b16 v[40:41], v58 offset:12288
    ds_read_b64_tr_b16 v[42:43], v58 offset:12800
    ds_read_b64_tr_b16 v[44:45], v58 offset:14336
    ds_read_b64_tr_b16 v[46:47], v58 offset:14848
    s_waitcnt lgkmcnt(0)
    s_waitcnt vmcnt(13)
    s_barrier
    ds_write_b128 v1, a[192:195] offset:12288
    ds_write_b128 v1, a[196:199] offset:13312
    ds_write_b128 v1, a[200:203] offset:14336
    ds_write_b128 v1, a[204:207] offset:15360
    s_waitcnt lgkmcnt(0)
    v_accvgpr_write_b32 a192, v32
    v_accvgpr_write_b32 a193, v33
    v_accvgpr_write_b32 a194, v34
    v_accvgpr_write_b32 a195, v35
    v_accvgpr_write_b32 a196, v36
    v_accvgpr_write_b32 a197, v37
    v_accvgpr_write_b32 a198, v38
    v_accvgpr_write_b32 a199, v39
    v_accvgpr_write_b32 a200, v40
    v_accvgpr_write_b32 a201, v41
    v_accvgpr_write_b32 a202, v42
    v_accvgpr_write_b32 a203, v43
    v_accvgpr_write_b32 a204, v44
    v_accvgpr_write_b32 a205, v45
    v_accvgpr_write_b32 a206, v46
    v_accvgpr_write_b32 a207, v47
    ds_read_b64_tr_b16 v[32:33], v57 offset:16384
    ds_read_b64_tr_b16 v[34:35], v57 offset:16896
    ds_read_b64_tr_b16 v[36:37], v57 offset:18432
    ds_read_b64_tr_b16 v[38:39], v57 offset:18944
    ds_read_b64_tr_b16 v[40:41], v58 offset:16384
    ds_read_b64_tr_b16 v[42:43], v58 offset:16896
    ds_read_b64_tr_b16 v[44:45], v58 offset:18432
    ds_read_b64_tr_b16 v[46:47], v58 offset:18944
    s_waitcnt lgkmcnt(0)
    s_waitcnt vmcnt(9)
    s_barrier
    ds_write_b128 v1, a[208:211] offset:16384
    ds_write_b128 v1, a[212:215] offset:17408
    ds_write_b128 v1, a[216:219] offset:18432
    ds_write_b128 v1, a[220:223] offset:19456
    s_waitcnt lgkmcnt(0)
    v_accvgpr_write_b32 a208, v32
    v_accvgpr_write_b32 a209, v33
    v_accvgpr_write_b32 a210, v34
    v_accvgpr_write_b32 a211, v35
    v_accvgpr_write_b32 a212, v36
    v_accvgpr_write_b32 a213, v37
    v_accvgpr_write_b32 a214, v38
    v_accvgpr_write_b32 a215, v39
    v_accvgpr_write_b32 a216, v40
    v_accvgpr_write_b32 a217, v41
    v_accvgpr_write_b32 a218, v42
    v_accvgpr_write_b32 a219, v43
    v_accvgpr_write_b32 a220, v44
    v_accvgpr_write_b32 a221, v45
    v_accvgpr_write_b32 a222, v46
    v_accvgpr_write_b32 a223, v47
    ds_read_b64_tr_b16 v[32:33], v57 offset:20480
    ds_read_b64_tr_b16 v[34:35], v57 offset:20992
    ds_read_b64_tr_b16 v[36:37], v57 offset:22528
    ds_read_b64_tr_b16 v[38:39], v57 offset:23040
    ds_read_b64_tr_b16 v[40:41], v58 offset:20480
    ds_read_b64_tr_b16 v[42:43], v58 offset:20992
    ds_read_b64_tr_b16 v[44:45], v58 offset:22528
    ds_read_b64_tr_b16 v[46:47], v58 offset:23040
    s_waitcnt lgkmcnt(0)
    s_waitcnt vmcnt(5)
    s_barrier
    ds_write_b128 v1, a[224:227] offset:20480
    ds_write_b128 v1, a[228:231] offset:21504
    ds_write_b128 v1, a[232:235] offset:22528
    ds_write_b128 v1, a[236:239] offset:23552
    s_waitcnt lgkmcnt(0)
    v_accvgpr_write_b32 a224, v32
    v_accvgpr_write_b32 a225, v33
    v_accvgpr_write_b32 a226, v34
    v_accvgpr_write_b32 a227, v35
    v_accvgpr_write_b32 a228, v36
    v_accvgpr_write_b32 a229, v37
    v_accvgpr_write_b32 a230, v38
    v_accvgpr_write_b32 a231, v39
    v_accvgpr_write_b32 a232, v40
    v_accvgpr_write_b32 a233, v41
    v_accvgpr_write_b32 a234, v42
    v_accvgpr_write_b32 a235, v43
    v_accvgpr_write_b32 a236, v44
    v_accvgpr_write_b32 a237, v45
    v_accvgpr_write_b32 a238, v46
    v_accvgpr_write_b32 a239, v47
    ds_read_b64_tr_b16 v[32:33], v61 offset:24576
    ds_read_b64_tr_b16 v[34:35], v61 offset:24832
    ds_read_b64_tr_b16 v[36:37], v61 offset:25600
    ds_read_b64_tr_b16 v[38:39], v61 offset:25856
    ds_read_b64_tr_b16 v[40:41], v62 offset:24576
    ds_read_b64_tr_b16 v[42:43], v62 offset:24832
    ds_read_b64_tr_b16 v[44:45], v62 offset:25600
    ds_read_b64_tr_b16 v[46:47], v62 offset:25856
    s_waitcnt lgkmcnt(0)
    s_waitcnt vmcnt(0)
    s_barrier
    ds_write_b128 v1, a[240:243] offset:24576
    ds_write_b128 v1, a[244:247] offset:25600
    ds_write_b128 v1, a[248:251] offset:26624
    ds_write_b128 v1, a[252:255] offset:27648
    s_waitcnt lgkmcnt(0)
    v_accvgpr_write_b32 a240, v32
    v_accvgpr_write_b32 a241, v33
    v_accvgpr_write_b32 a242, v34
    v_accvgpr_write_b32 a243, v35
    v_accvgpr_write_b32 a244, v36
    v_accvgpr_write_b32 a245, v37
    v_accvgpr_write_b32 a246, v38
    v_accvgpr_write_b32 a247, v39
    v_accvgpr_write_b32 a248, v40
    v_accvgpr_write_b32 a249, v41
    v_accvgpr_write_b32 a250, v42
    v_accvgpr_write_b32 a251, v43
    v_accvgpr_write_b32 a252, v44
    v_accvgpr_write_b32 a253, v45
    v_accvgpr_write_b32 a254, v46
    v_accvgpr_write_b32 a255, v47
    ds_read_b64_tr_b16 v[32:33], v53 offset:28672
    ds_read_b64_tr_b16 v[34:35], v53 offset:29184
    ds_read_b64_tr_b16 v[36:37], v55 offset:28672
    ds_read_b64_tr_b16 v[38:39], v55 offset:29184
    ds_read_b64_tr_b16 v[40:41], v54 offset:28672
    ds_read_b64_tr_b16 v[42:43], v54 offset:29184
    ds_read_b64_tr_b16 v[44:45], v56 offset:28672
    ds_read_b64_tr_b16 v[46:47], v56 offset:29184
    s_waitcnt lgkmcnt(0)
    s_barrier
    ds_write_b128 v1, a[128:131] offset:28672
    ds_write_b128 v1, a[132:135] offset:29696
    ds_write_b128 v1, a[136:139] offset:30720
    ds_write_b128 v1, a[140:143] offset:31744
    s_waitcnt lgkmcnt(0)
    v_accvgpr_write_b32 a128, v32
    v_accvgpr_write_b32 a129, v33
    v_accvgpr_write_b32 a130, v34
    v_accvgpr_write_b32 a131, v35
    v_accvgpr_write_b32 a132, v36
    v_accvgpr_write_b32 a133, v37
    v_accvgpr_write_b32 a134, v38
    v_accvgpr_write_b32 a135, v39
    v_accvgpr_write_b32 a136, v40
    v_accvgpr_write_b32 a137, v41
    v_accvgpr_write_b32 a138, v42
    v_accvgpr_write_b32 a139, v43
    v_accvgpr_write_b32 a140, v44
    v_accvgpr_write_b32 a141, v45
    v_accvgpr_write_b32 a142, v46
    v_accvgpr_write_b32 a143, v47
    v_mov_b32 v28, v24
    v_mov_b32 v29, v25
    v_mov_b32 v30, 0
    s_mov_b32 s49, 0
    s_branch L_sbe_1
    s_mov_b32 s49, 0
    v_mov_b32 v30, 0
L_sb_15:
    buffer_load_dwordx2 v[28:29], v30, s[12:15], 0 offen sc1
    s_add_u32 s49, s49, 1
    s_cmp_gt_u32 s49, 4000000
    s_cbranch_scc1 L_fail
    s_waitcnt vmcnt(0)
L_sbe_1:
    v_sad_u8 v31, v28, 0, 0
    v_sad_u8 v31, v29, 0, v31
    v_or_b32 v32, v28, v29
    v_readfirstlane_b32 s43, v31
    v_readfirstlane_b32 s44, v32
    s_cmp_lt_u32 s43, 32
    s_cbranch_scc1 L_sb_15
    s_and_b32 s90, s44, 0x20202020
    s_barrier
    s_mov_b32 s46, 0
    s_cmp_eq_u32 s90, 0
    s_cbranch_scc1 L_slowmode_1
    ds_read_b128 v[32:35], v0 offset:5120
    ds_read_b32 v12, v11 offset:8448
    ds_read_b128 v[40:43], v1 offset:0
    ds_read_b128 v[44:47], v1 offset:1024
    v_mov_b64 v[16:17], 0
    v_mov_b64 v[18:19], 0
    v_mov_b64 v[20:21], 0
    v_mov_b64 v[22:23], 0
    v_mov_b64 v[24:25], 0
    v_mov_b64 v[26:27], 0
    v_mov_b64 v[28:29], 0
    v_mov_b64 v[30:31], 0
    s_waitcnt vmcnt(0) lgkmcnt(0)
    s_nop 0
    s_branch L_gar_f1
L_loop_f1:
    s_barrier
    s_add_u32 s43, s40, 1024
    buffer_load_dwordx4 v[60:63], v0, s[8:11], s43 offen sc1
    v_mov_b64 v[16:17], 0
    v_mov_b64 v[18:19], 0
    v_mov_b64 v[20:21], 0
    v_mov_b64 v[22:23], 0
    v_mov_b64 v[24:25], 0
    v_mov_b64 v[26:27], 0
    v_mov_b64 v[28:29], 0
    v_mov_b64 v[30:31], 0
    s_nop 15
    s_nop 7
    s_add_u32 s43, s40, 1024
    buffer_load_dwordx4 v[56:59], v0, s[8:11], s43 offen sc1
    s_waitcnt vmcnt(1)
    ds_write_b128 v0, v[60:63] offset:1024
    v_max3_u32 v14, v60, v61, v62
    v_max_u32 v14, v14, v63
    v_cmp_le_u32 vcc, s51, v14
    s_add_u32 s43, s40, 5120
    buffer_load_dwordx4 v[32:35], v0, s[8:11], s43 offen sc1
    s_add_u32 s43, s40, 8448
    buffer_load_dword v12, v11, s[8:11], s43 offen sc1
    s_cbranch_vccnz L_ga_f1
L_gar_f1:
    ds_read_b64_tr_b16 v[48:49], v2 offset:1024
    ds_read_b64_tr_b16 v[50:51], v3 offset:1024
    ds_read_b128 v[40:43], v1 offset:0
    ds_read_b128 v[44:47], v1 offset:1024
    s_waitcnt lgkmcnt(4)
    s_barrier
    ds_read_b64_tr_b16 v[52:53], v2 offset:0
    ds_read_b64_tr_b16 v[54:55], v3 offset:0
    s_waitcnt lgkmcnt(4)
    s_waitcnt lgkmcnt(2)
    v_smfmac_f32_16x16x64_bf16 v[16:19], v[48:51], v[40:47], v10
    s_waitcnt vmcnt(2)
    ds_read_b64_tr_b16 v[56:57], v2 offset:2048
    ds_read_b64_tr_b16 v[58:59], v3 offset:2048
    v_smfmac_f32_16x16x64_bf16 v[24:27], v[48:51], v[176:183], v10
    ds_read_b64_tr_b16 v[60:61], v2 offset:3072
    ds_read_b64_tr_b16 v[62:63], v3 offset:3072
    v_smfmac_f32_16x16x64_bf16 v[28:31], v[48:51], v[184:191], v10
    ds_read_b128 v[40:43], v1 offset:2048
    ds_read_b128 v[44:47], v1 offset:3072
    s_waitcnt lgkmcnt(6)
    v_smfmac_f32_16x16x64_bf16 v[16:19], v[52:55], v[64:71], v10
    s_add_u32 s43, s40, 5120
    buffer_load_dwordx4 v[36:39], v0, s[8:11], s43 offen sc1
    s_add_u32 s43, s40, 8448
    buffer_load_dword v13, v11, s[8:11], s43 offen sc1
    v_smfmac_f32_16x16x64_bf16 v[20:23], v[52:55], v[72:79], v10
    v_smfmac_f32_16x16x64_bf16 v[24:27], v[52:55], v[192:199], v10
    s_waitcnt lgkmcnt(0)
    v_smfmac_f32_16x16x64_bf16 v[20:23], v[48:51], v[40:47], v10
    ds_read_b128 v[40:43], v1 offset:8192
    v_smfmac_f32_16x16x64_bf16 v[28:31], v[52:55], v[200:207], v10
    ds_read_b128 v[44:47], v1 offset:9216
    v_smfmac_f32_16x16x64_bf16 v[16:19], v[56:59], v[80:87], v10
    s_waitcnt vmcnt(2)
    ds_write_b128 v0, v[32:35] offset:5120
    v_max3_u32 v14, v32, v33, v34
    v_smfmac_f32_16x16x64_bf16 v[20:23], v[56:59], v[88:95], v10
    ds_write_b32 v11, v12 offset:8448
    v_max3_u32 v14, v14, v35, v12
    v_smfmac_f32_16x16x64_bf16 v[24:27], v[56:59], v[208:215], v10
    v_cmp_le_u32 vcc, s51, v14
    v_smfmac_f32_16x16x64_bf16 v[28:31], v[56:59], v[216:223], v10
    s_cbranch_vccnz L_gb_f1
L_gbr_f1:
    ds_read_b64_tr_b16 v[48:49], v2 offset:5120
    v_smfmac_f32_16x16x64_bf16 v[16:19], v[60:63], v[96:103], v10
    ds_read_b64_tr_b16 v[50:51], v3 offset:5120
    v_smfmac_f32_16x16x64_bf16 v[20:23], v[60:63], v[104:111], v10
    s_waitcnt lgkmcnt(2)
    s_barrier
    ds_read_b64_tr_b16 v[52:53], v2 offset:4096
    ds_read_b64_tr_b16 v[54:55], v3 offset:4096
    v_smfmac_f32_16x16x64_bf16 v[24:27], v[60:63], v[40:47], v10
    ds_read_b64_tr_b16 v[56:57], v2 offset:6144
    ds_read_b64_tr_b16 v[58:59], v3 offset:6144
    s_waitcnt lgkmcnt(4)
    v_smfmac_f32_16x16x64_bf16 v[16:19], v[48:51], v[112:119], v10
    s_waitcnt vmcnt(0)
    ds_read_b128 v[32:35], v1 offset:10240
    ds_read_b128 v[36:39], v1 offset:11264
    v_smfmac_f32_16x16x64_bf16 v[20:23], v[48:51], v[120:127], v10
    ds_read_b128 v[40:43], v1 offset:4096
    ds_read_b128 v[44:47], v1 offset:5120
    v_smfmac_f32_16x16x64_bf16 v[24:27], v[48:51], v[224:231], v10
    v_smfmac_f32_16x16x64_bf16 v[28:31], v[48:51], v[232:239], v10
    ds_read_b64_tr_b16 v[48:49], v2 offset:8192
    ds_read_b64_tr_b16 v[50:51], v3 offset:8192
    s_waitcnt lgkmcnt(8)
    v_smfmac_f32_16x16x64_bf16 v[24:27], v[52:55], v[240:247], v10
    s_waitcnt lgkmcnt(4)
    v_smfmac_f32_16x16x64_bf16 v[28:31], v[60:63], v[32:39], v10
    ds_read_b64_tr_b16 v[60:61], v2 offset:7168
    s_waitcnt lgkmcnt(3)
    v_smfmac_f32_16x16x64_bf16 v[16:19], v[52:55], v[40:47], v10
    ds_read_b64_tr_b16 v[62:63], v3 offset:7168
    v_smfmac_f32_16x16x64_bf16 v[28:31], v[52:55], v[248:255], v10
    ds_read_b128 v[32:35], v1 offset:6144
    v_smfmac_f32_16x16x64_bf16 v[16:19], v[56:59], v[128:135], v10
    ds_read_b128 v[36:39], v1 offset:7168
    v_and_b32 v12, 0x200, v0
    v_smfmac_f32_16x16x64_bf16 v[20:23], v[56:59], v[136:143], v10
    ds_read_b128 v[40:43], v1 offset:12288
    v_mul_u32_u24 v12, 3, v12
    s_waitcnt lgkmcnt(3)
    v_smfmac_f32_16x16x64_bf16 v[16:19], v[60:63], v[144:151], v10
    ds_read_b128 v[44:47], v1 offset:13312
    v_add_u32 v12, v12, v0
    s_waitcnt lgkmcnt(2)
    v_smfmac_f32_16x16x64_bf16 v[20:23], v[52:55], v[32:39], v10
    ds_read_b128 v[12:15], v12 offset:9728
    v_smfmac_f32_16x16x64_bf16 v[20:23], v[60:63], v[152:159], v10
    ds_read_b128 v[32:35], v1 offset:14336
    v_smfmac_f32_16x16x64_bf16 v[16:19], v[48:51], v[160:167], v10
    ds_read_b128 v[36:39], v1 offset:15360
    v_smfmac_f32_16x16x64_bf16 v[20:23], v[48:51], v[168:175], v10
    s_waitcnt lgkmcnt(3)
    v_smfmac_f32_16x16x64_bf16 v[24:27], v[56:59], v[40:47], v10
    s_waitcnt lgkmcnt(2)
    s_lshr_b32 s44, s48, 1
    s_add_u32 s44, s44, 0x40e0400
    buffer_store_dwordx4 v[12:15], v0, s[8:11], s44 offen sc1
    v_add_f32 v16, v16, v18
    v_add_f32 v17, v17, v19
    s_waitcnt lgkmcnt(0)
    v_smfmac_f32_16x16x64_bf16 v[28:31], v[56:59], v[32:39], v10
    ds_read_b128 v[32:35], v1 offset:22528
    v_cvt_pk_bf16_f32 v16, v16, v17
    v_add_f32 v20, v20, v22
    v_smfmac_f32_16x16x64_bf16 v[24:27], v[60:63], a[0:7], v10
    ds_read_b128 v[36:39], v1 offset:23552
    v_add_f32 v21, v21, v23
    v_cvt_pk_bf16_f32 v17, v20, v21
    v_smfmac_f32_16x16x64_bf16 v[24:27], v[48:51], a[16:23], v10
    ds_write_b64 v4, v[16:17] offset:9728
    v_mov_b64 v[40:41], 0
    v_mov_b64 v[42:43], 0
    v_smfmac_f32_16x16x64_bf16 v[28:31], v[60:63], a[8:15], v10
    ds_read_b128 v[16:19], v1 offset:20480
    v_mov_b64 v[44:45], 0
    v_mov_b64 v[46:47], 0
    v_smfmac_f32_16x16x64_bf16 v[28:31], v[48:51], a[24:31], v10
    ds_read_b128 v[20:23], v1 offset:21504
    v_add_f32 v24, v24, v26
    v_add_f32 v25, v25, v27
    v_cvt_pk_bf16_f32 v24, v24, v25
    v_smfmac_f32_16x16x64_bf16 v[40:43], v[52:55], a[96:103], v10
    v_smfmac_f32_16x16x64_bf16 v[44:47], v[52:55], a[104:111], v10
    v_add_f32 v28, v28, v30
    v_add_f32 v29, v29, v31
    v_cvt_pk_bf16_f32 v25, v28, v29
    ds_write2st64_b32 v11, v24, v25 offset0:46 offset1:47
    s_waitcnt lgkmcnt(4)
    v_smfmac_f32_16x16x64_bf16 v[44:47], v[56:59], v[32:39], v10
    ds_read_b128 v[24:27], v0 offset:22528
    v_mov_b64 v[52:53], 0
    v_mov_b64 v[54:55], 0
    v_smfmac_f32_16x16x64_bf16 v[40:43], v[60:63], a[112:119], v10
    ds_read_b128 v[28:31], v0 offset:23552
    s_waitcnt lgkmcnt(3)
    v_smfmac_f32_16x16x64_bf16 v[40:43], v[56:59], v[16:23], v10
    ds_read_b64_tr_b16 v[56:57], v2 offset:1024
    ds_read_b128 v[16:19], v0 offset:20480
    ds_read_b128 v[20:23], v0 offset:21504
    ds_read_b64_tr_b16 v[58:59], v3 offset:1024
    s_waitcnt lgkmcnt(6)
    s_barrier
    s_cmp_eq_u32 s38, 63
    s_cbranch_scc1 L_tail_f1
    ds_read_b64_tr_b16 v[32:33], v2 offset:9216
    ds_read_b64_tr_b16 v[34:35], v3 offset:9216
    ds_read_b64_tr_b16 v[36:37], v2 offset:10240
    ds_read_b64_tr_b16 v[38:39], v3 offset:10240
    s_waitcnt lgkmcnt(5)
    v_smfmac_f32_16x16x64_bf16 v[44:47], v[60:63], a[120:127], v10
    s_mov_b32 m0, 0x5000
    s_add_u32 s55, s48, 0x1041000
    buffer_load_dwordx4 v0, s[8:11], s55 offen sc1 lds
    buffer_load_dwordx4 v0, s[8:11], s55 offen offset:1024 sc1 lds
    v_smfmac_f32_16x16x64_bf16 v[40:43], v[48:51], a[128:135], v10
    buffer_load_dwordx4 v0, s[8:11], s55 offen offset:2048 sc1 lds
    buffer_load_dwordx4 v0, s[8:11], s55 offen offset:3072 sc1 lds
    v_smfmac_f32_16x16x64_bf16 v[44:47], v[48:51], a[136:143], v10
    ds_read_b64_tr_b16 v[60:61], v2 offset:0
    ds_read_b64_tr_b16 v[62:63], v3 offset:0
    s_waitcnt lgkmcnt(6)
    v_smfmac_f32_16x16x64_bf16 v[40:43], v[56:59], a[32:39], v10
    ds_read_b64_tr_b16 v[48:49], v2 offset:2048
    ds_read_b64_tr_b16 v[50:51], v3 offset:2048
    s_waitcnt lgkmcnt(4)
    v_smfmac_f32_16x16x64_bf16 v[52:55], v[32:35], v[16:23], v10
    v_smfmac_f32_16x16x64_bf16 v[52:55], v[36:39], v[24:31], v10
    ds_read_b128 v[16:19], v1 offset:16384
    ds_read_b128 v[20:23], v1 offset:17408
    v_smfmac_f32_16x16x64_bf16 v[44:47], v[56:59], a[40:47], v10
    ds_read_b128 v[24:27], v1 offset:18432
    ds_read_b128 v[28:31], v1 offset:19456
    s_waitcnt lgkmcnt(6)
    v_smfmac_f32_16x16x64_bf16 v[40:43], v[60:63], a[48:55], v10
    ds_read_b64_tr_b16 v[56:57], v2 offset:3072
    ds_read_b64_tr_b16 v[58:59], v3 offset:3072
    v_add_f32 v52, v52, v54
    v_add_f32 v53, v53, v55
    v_mul_f32 v52, s50, v52
    v_mul_f32 v53, s50, v53
    v_exp_f32 v54, v52
    v_exp_f32 v55, v53
    s_nop 0
    v_cvt_pk_bf16_f32 v54, v54, v55
    ds_write_b32 v11, v54 offset:15616
    v_smfmac_f32_16x16x64_bf16 v[44:47], v[60:63], a[56:63], v10
    ds_read_b64_tr_b16 v[60:61], v2 offset:5120
    ds_read_b64_tr_b16 v[62:63], v3 offset:5120
    s_waitcnt lgkmcnt(9)
    s_waitcnt lgkmcnt(7)
    v_smfmac_f32_16x16x64_bf16 v[40:43], v[48:51], v[16:23], v10
    s_waitcnt lgkmcnt(5)
    v_smfmac_f32_16x16x64_bf16 v[44:47], v[48:51], v[24:31], v10
    s_waitcnt lgkmcnt(2)
    s_barrier
L_pv_f1:
    ds_read_b64_tr_b16 v[48:49], v5 offset:15360
    ds_read_b64_tr_b16 v[50:51], v5 offset:15616
    ds_read_b64_tr_b16 v[54:55], v8 offset:15872
    s_cmp_eq_u32 s46, 0x5105
    s_cbranch_scc1 L_pv2_f1
    ds_read_b128 v[24:27], v0 offset:26624
    ds_read_b128 v[28:31], v0 offset:27648
    v_smfmac_f32_16x16x64_bf16 v[40:43], v[56:59], a[64:71], v10
    v_mov_b64 v[32:33], s[98:99]
    v_smfmac_f32_16x16x64_bf16 v[44:47], v[56:59], a[72:79], v10
    s_waitcnt lgkmcnt(5)
    v_smfmac_f32_16x16x64_bf16 v[40:43], v[60:63], a[80:87], v10
    v_mov_b64 v[56:57], s[96:97]
    v_smfmac_f32_16x16x64_bf16 v[44:47], v[60:63], a[88:95], v10
    v_mov_b64 v[58:59], s[96:97]
    s_waitcnt lgkmcnt(0)
    s_nop 0
    v_mfma_f32_16x16x32_bf16 v[36:39], v[56:59], v[48:51], 0
    v_mfma_f32_16x16x32_bf16 v[16:19], v[24:27], v[48:51], 0
    v_add_f32 v40, v40, v42
    v_add_f32 v41, v41, v43
    v_mfma_f32_16x16x32_bf16 v[20:23], v[28:31], v[48:51], 0
    v_cvt_pk_bf16_f32 v40, v40, v41
    v_mov_b32 v41, 0
    v_mfma_f32_16x16x16_bf16 v[36:39], v[32:33], v[54:55], v[36:39]
    v_add_f32 v44, v44, v46
    v_add_f32 v45, v45, v47
    v_mfma_f32_16x16x16_bf16 v[16:19], v[40:41], v[54:55], v[16:19]
    v_cvt_pk_bf16_f32 v44, v44, v45
    v_mov_b32 v45, 0
    s_nop 1
    v_mfma_f32_16x16x16_bf16 v[20:23], v[44:45], v[54:55], v[20:23]
L_pv4_f1:
    ds_read_b128 v[56:59], v1 offset:24576
    ds_read_b128 v[60:63], v1 offset:25600
    ds_read_b128 v[24:27], v1 offset:26624
    ds_read_b128 v[28:31], v1 offset:27648
    v_rcp_f32 v34, v36
    v_cmp_ngt_f32 vcc, s69, v36
    v_cmp_nlt_f32 s[44:45], s68, v36
    v_cndmask_b32 v16, v18, v16, s[56:57]
    v_cndmask_b32 v17, v19, v17, s[56:57]
    s_or_b64 vcc, vcc, s[44:45]
    v_mul_f32 v16, v16, v34
    v_mul_f32 v17, v17, v34
    v_cndmask_b32 v20, v22, v20, s[56:57]
    v_cndmask_b32 v21, v23, v21, s[56:57]
    v_cvt_pk_bf16_f32 v16, v16, v17
    v_mul_f32 v20, v20, v34
    v_mul_f32 v21, v21, v34
    s_cbranch_vccnz L_slow_f1
L_pv3_f1:
    v_cvt_pk_bf16_f32 v20, v20, v21
    ds_write2_b32 v6, v16, v20 offset0:0 offset1:2
    s_mov_b32 s46, 0
    v_lshrrev_b32 v12, 1, v0
    v_and_b32 v12, 0x1e0, v12
    v_and_or_b32 v12, v0, 16, v12
    v_mov_b64 v[48:49], 0
    v_mov_b64 v[50:51], 0
    v_mov_b64 v[52:53], 0
    v_mov_b64 v[54:55], 0
    v_mov_b64 v[16:17], 0
    v_mov_b64 v[18:19], 0
    v_mov_b64 v[20:21], 0
    v_mov_b64 v[22:23], 0
    s_waitcnt lgkmcnt(0)
    s_barrier
    ds_read_b128 v[32:35], v12 offset:13312
    ds_read_b128 v[36:39], v12 offset:13824
    ds_write2st64_b32 v11, v40, v44 offset0:38 offset1:39
    ds_read_b128 v[40:43], v12 offset:14336
    ds_read_b128 v[44:47], v12 offset:14848
    s_waitcnt lgkmcnt(4)
    v_smfmac_f32_16x16x64_bf16 v[16:19], v[32:35], v[56:63], v10
    ds_read_b128 v[56:59], v1 offset:28672
    v_smfmac_f32_16x16x64_bf16 v[20:23], v[32:35], a[144:151], v10
    ds_read_b128 v[60:63], v1 offset:29696
    s_waitcnt lgkmcnt(5)
    v_smfmac_f32_16x16x64_bf16 v[16:19], v[36:39], v[24:31], v10
    ds_read_b128 v[24:27], v1 offset:30720
    v_smfmac_f32_16x16x64_bf16 v[20:23], v[36:39], a[152:159], v10
    ds_read_b128 v[28:31], v1 offset:31744
    s_waitcnt lgkmcnt(5)
    v_smfmac_f32_16x16x64_bf16 v[16:19], v[40:43], a[176:183], v10
    v_smfmac_f32_16x16x64_bf16 v[20:23], v[40:43], a[192:199], v10
    s_waitcnt lgkmcnt(4)
    v_smfmac_f32_16x16x64_bf16 v[16:19], v[44:47], a[184:191], v10
    v_smfmac_f32_16x16x64_bf16 v[20:23], v[44:47], a[200:207], v10
    s_waitcnt lgkmcnt(2)
    v_smfmac_f32_16x16x64_bf16 v[48:51], v[32:35], v[56:63], v10
    v_cvt_pk_bf16_f32 v16, v16, v17
    v_cvt_pk_bf16_f32 v17, v18, v19
    v_and_or_b32 v16, v16, -2, s92
    s_waitcnt lgkmcnt(0)
    v_smfmac_f32_16x16x64_bf16 v[48:51], v[36:39], v[24:31], v10
    s_add_u32 s43, s39, 16384
    buffer_store_dwordx2 v[16:17], v7, s[8:11], s43 offen
    v_cvt_pk_bf16_f32 v20, v20, v21
    v_cvt_pk_bf16_f32 v21, v22, v23
    v_and_or_b32 v20, v20, -2, s92
    v_smfmac_f32_16x16x64_bf16 v[48:51], v[40:43], a[208:215], v10
    s_add_u32 s43, s39, 81920
    buffer_store_dwordx2 v[20:21], v7, s[8:11], s43 offen
    v_cndmask_b32 v56, v32, v36, s[100:101]
    v_cndmask_b32 v57, v33, v37, s[100:101]
    v_cndmask_b32 v58, v34, v38, s[100:101]
    v_smfmac_f32_16x16x64_bf16 v[48:51], v[44:47], a[216:223], v10
    v_cndmask_b32 v59, v35, v39, s[100:101]
    v_cndmask_b32 v60, v40, v44, s[100:101]
    v_cndmask_b32 v61, v41, v45, s[100:101]
    v_smfmac_f32_16x16x64_bf16 v[52:55], v[32:35], a[160:167], v10
    v_cndmask_b32 v62, v42, v46, s[100:101]
    v_cndmask_b32 v63, v43, v47, s[100:101]
    v_mov_b64 v[24:25], 0
    v_smfmac_f32_16x16x64_bf16 v[52:55], v[36:39], a[168:175], v10
    v_mov_b64 v[26:27], 0
    s_nop 1
    v_smfmac_f32_16x16x64_bf16 v[24:27], v[56:59], a[240:247], v10
    v_cvt_pk_bf16_f32 v48, v48, v49
    v_cvt_pk_bf16_f32 v49, v50, v51
    v_smfmac_f32_16x16x64_bf16 v[24:27], v[60:63], a[248:255], v10
    v_and_or_b32 v48, v48, -2, s92
    v_smfmac_f32_16x16x64_bf16 v[52:55], v[40:43], a[224:231], v10
    s_add_u32 s43, s39, 147456
    buffer_store_dwordx2 v[48:49], v7, s[8:11], s43 offen
    v_smfmac_f32_16x16x64_bf16 v[52:55], v[44:47], a[232:239], v10
    v_add_f32 v24, v24, v26
    v_add_f32 v25, v25, v27
    v_cvt_pk_bf16_f32 v24, v24, v25
    v_and_or_b32 v24, v24, -2, s92
    s_add_u32 s43, s39, 262144
    buffer_store_dword v24, v7, s[8:11], s43 offen offset:4
    s_nop 1
    v_cvt_pk_bf16_f32 v52, v52, v53
    v_cvt_pk_bf16_f32 v53, v54, v55
    v_and_or_b32 v52, v52, -2, s92
    s_add_u32 s43, s39, 212992
    buffer_store_dwordx2 v[52:53], v7, s[8:11], s43 offen
    s_add_u32 s43, s39, s47
    s_mov_b32 s49, 0
    s_nop 15
    s_nop 15
    s_nop 15
    s_nop 11
    buffer_load_dwordx4 v[32:35], v0, s[8:11], s43 offen offset:0 sc1
    buffer_load_dwordx4 v[36:39], v0, s[8:11], s43 offen offset:1024 sc1
    buffer_load_dwordx4 v[40:43], v0, s[8:11], s43 offen offset:2048 sc1
    buffer_load_dwordx4 v[44:47], v0, s[8:11], s43 offen offset:3072 sc1
    v_mov_b32 v16, 0x3f80
    v_mov_b32 v17, 0x3f800000
    v_cndmask_b32 v16, v16, v17, s[66:67]
    v_cndmask_b32 v20, 0, v16, s[58:59]
    v_cndmask_b32 v21, 0, v16, s[60:61]
    v_cndmask_b32 v22, 0, v16, s[62:63]
    v_cndmask_b32 v23, 0, v16, s[64:65]
    v_mov_b32 v19, s92
    s_xor_b32 s92, s92, 1
    s_mov_b32 s45, s40
    s_mov_b32 s40, s41
    s_mov_b32 s41, s42
    s_mov_b32 s42, s93
    s_mov_b32 s93, s45
    s_add_u32 s38, s38, 1
    s_add_u32 s48, s48, 262144
    s_nop 15
    s_nop 15
    buffer_load_dwordx4 v[48:51], v0, s[8:11], s43 offen offset:0 sc1
    buffer_load_dwordx4 v[52:55], v0, s[8:11], s43 offen offset:1024 sc1
    buffer_load_dwordx4 v[56:59], v0, s[8:11], s43 offen offset:2048 sc1
    buffer_load_dwordx4 v[60:63], v0, s[8:11], s43 offen offset:3072 sc1
    s_waitcnt vmcnt(7)
    v_mfma_f32_16x16x32_bf16 v[24:27], v[20:23], v[32:35], 0
    v_bitop3_b32 v18, v32, v34, v19 bitop3:0x7e
    s_waitcnt vmcnt(6)
    v_mfma_f32_16x16x32_bf16 v[24:27], v[20:23], v[36:39], v[24:27]
    v_bitop3_b32 v16, v36, v38, v19 bitop3:0x7e
    v_or_b32 v18, v18, v16
    s_waitcnt vmcnt(5)
    v_mfma_f32_16x16x32_bf16 v[24:27], v[20:23], v[40:43], v[24:27]
    v_bitop3_b32 v16, v40, v42, v19 bitop3:0x7e
    v_or_b32 v18, v18, v16
    s_waitcnt vmcnt(4)
    v_mfma_f32_16x16x32_bf16 v[24:27], v[20:23], v[44:47], v[24:27]
    v_bitop3_b32 v16, v44, v46, v19 bitop3:0x7e
    v_or_b32 v18, v18, v16
    v_and_b32 v18, 1, v18
    v_cmp_ne_u32 vcc, 0, v18
    s_nop 3
    v_add_f32_dpp v28, v24, v24 row_ror:8 row_mask:0xf bank_mask:0xf
    v_add_f32_dpp v29, v25, v25 row_ror:8 row_mask:0xf bank_mask:0xf
    v_add_f32_dpp v30, v26, v26 row_ror:8 row_mask:0xf bank_mask:0xf
    v_add_f32_dpp v31, v27, v27 row_ror:8 row_mask:0xf bank_mask:0xf
    v_cvt_pk_bf16_f32 v28, v28, v29
    v_cvt_pk_bf16_f32 v29, v30, v31
    s_cbranch_vccnz L_rn0_f1
L_rp_f1:
    buffer_store_dwordx2 v[28:29], v9, s[8:11], s40 offen
L_rd_f1:
    s_branch L_loop_f1
L_ga_f1:
    s_mov_b32 s49, 0
    s_add_u32 s43, s40, 1024
    buffer_load_dwordx4 v[60:63], v0, s[8:11], s43 offen sc1
    s_waitcnt vmcnt(3)
    s_branch L_gac1_f1
L_gaw0_f1:
    s_waitcnt vmcnt(1)
L_gac0_f1:
    ds_write_b128 v0, v[60:63] offset:1024
    v_max3_u32 v14, v60, v61, v62
    v_max_u32 v14, v14, v63
    v_cmp_le_u32 vcc, s51, v14
    s_cbranch_vccz L_ga3_f1
    s_and_b32 s43, s49, 15
    s_cmp_lg_u32 s43, 15
    s_cbranch_scc1 L_gan0_f1
    v_cmp_eq_u32 vcc, s51, v60
    v_cmp_eq_u32 s[44:45], s51, v61
    s_nop 0
    s_or_b64 vcc, vcc, s[44:45]
    v_cmp_eq_u32 s[44:45], s51, v62
    s_nop 0
    s_or_b64 vcc, vcc, s[44:45]
    v_cmp_eq_u32 s[44:45], s51, v63
    s_nop 0
    s_or_b64 vcc, vcc, s[44:45]
    s_cbranch_vccz L_ga3_f1
L_gan0_f1:
    s_add_u32 s43, s40, 1024
    buffer_load_dwordx4 v[60:63], v0, s[8:11], s43 offen sc1
    s_add_u32 s49, s49, 1
    s_cmp_gt_u32 s49, 4000000
    s_cbranch_scc1 L_fail
L_gaw1_f1:
    s_waitcnt vmcnt(1)
L_gac1_f1:
    ds_write_b128 v0, v[56:59] offset:1024
    v_max3_u32 v14, v56, v57, v58
    v_max_u32 v14, v14, v59
    v_cmp_le_u32 vcc, s51, v14
    s_cbranch_vccz L_ga3_f1
    s_and_b32 s43, s49, 15
    s_cmp_lg_u32 s43, 15
    s_cbranch_scc1 L_gan1_f1
    v_cmp_eq_u32 vcc, s51, v56
    v_cmp_eq_u32 s[44:45], s51, v57
    s_nop 0
    s_or_b64 vcc, vcc, s[44:45]
    v_cmp_eq_u32 s[44:45], s51, v58
    s_nop 0
    s_or_b64 vcc, vcc, s[44:45]
    v_cmp_eq_u32 s[44:45], s51, v59
    s_nop 0
    s_or_b64 vcc, vcc, s[44:45]
    s_cbranch_vccz L_ga3_f1
L_gan1_f1:
    s_add_u32 s43, s40, 1024
    buffer_load_dwordx4 v[56:59], v0, s[8:11], s43 offen sc1
    s_add_u32 s49, s49, 1
    s_cmp_gt_u32 s49, 4000000
    s_cbranch_scc1 L_fail
    s_branch L_gaw0_f1
L_ga3_f1:
    s_waitcnt lgkmcnt(0)
    s_waitcnt vmcnt(0)
    s_branch L_gar_f1
L_gb_f1:
    s_mov_b32 s49, 0
    s_add_u32 s43, s40, 5120
    buffer_load_dwordx4 v[32:35], v0, s[8:11], s43 offen sc1
    s_add_u32 s43, s40, 8448
    buffer_load_dword v12, v11, s[8:11], s43 offen sc1
    s_waitcnt vmcnt(2)
    s_branch L_gbc1_f1
L_gbw0_f1:
    s_waitcnt vmcnt(2)
L_gbc0_f1:
    ds_write_b128 v0, v[32:35] offset:5120
    ds_write_b32 v11, v12 offset:8448
    v_max3_u32 v14, v32, v33, v34
    v_max3_u32 v14, v14, v35, v12
    v_cmp_le_u32 vcc, s51, v14
    s_cbranch_vccz L_gb3_f1
    s_and_b32 s43, s49, 15
    s_cmp_lg_u32 s43, 15
    s_cbranch_scc1 L_gbn0_f1
    v_cmp_eq_u32 vcc, s51, v32
    v_cmp_eq_u32 s[44:45], s51, v33
    s_nop 0
    s_or_b64 vcc, vcc, s[44:45]
    v_cmp_eq_u32 s[44:45], s51, v34
    s_nop 0
    s_or_b64 vcc, vcc, s[44:45]
    v_cmp_eq_u32 s[44:45], s51, v35
    s_nop 0
    s_or_b64 vcc, vcc, s[44:45]
    v_cmp_eq_u32 s[44:45], s51, v12
    s_nop 0
    s_or_b64 vcc, vcc, s[44:45]
    s_cbranch_vccz L_gb3_f1
L_gbn0_f1:
    s_add_u32 s43, s40, 5120
    buffer_load_dwordx4 v[32:35], v0, s[8:11], s43 offen sc1
    s_add_u32 s43, s40, 8448
    buffer_load_dword v12, v11, s[8:11], s43 offen sc1
    s_add_u32 s49, s49, 1
    s_cmp_gt_u32 s49, 4000000
    s_cbranch_scc1 L_fail
L_gbw1_f1:
    s_waitcnt vmcnt(2)
L_gbc1_f1:
    ds_write_b128 v0, v[36:39] offset:5120
    ds_write_b32 v11, v13 offset:8448
    v_max3_u32 v14, v36, v37, v38
    v_max3_u32 v14, v14, v39, v13
    v_cmp_le_u32 vcc, s51, v14
    s_cbranch_vccz L_gb3_f1
    s_and_b32 s43, s49, 15
    s_cmp_lg_u32 s43, 15
    s_cbranch_scc1 L_gbn1_f1
    v_cmp_eq_u32 vcc, s51, v36
    v_cmp_eq_u32 s[44:45], s51, v37
    s_nop 0
    s_or_b64 vcc, vcc, s[44:45]
    v_cmp_eq_u32 s[44:45], s51, v38
    s_nop 0
    s_or_b64 vcc, vcc, s[44:45]
    v_cmp_eq_u32 s[44:45], s51, v39
    s_nop 0
    s_or_b64 vcc, vcc, s[44:45]
    v_cmp_eq_u32 s[44:45], s51, v13
    s_nop 0
    s_or_b64 vcc, vcc, s[44:45]
    s_cbranch_vccz L_gb3_f1
L_gbn1_f1:
    s_add_u32 s43, s40, 5120
    buffer_load_dwordx4 v[36:39], v0, s[8:11], s43 offen sc1
    s_add_u32 s43, s40, 8448
    buffer_load_dword v13, v11, s[8:11], s43 offen sc1
    s_add_u32 s49, s49, 1
    s_cmp_gt_u32 s49, 4000000
    s_cbranch_scc1 L_fail
    s_branch L_gbw0_f1
L_gb3_f1:
    s_waitcnt lgkmcnt(0)
    s_waitcnt vmcnt(0)
    s_branch L_gbr_f1
L_rw1_f1:
    s_waitcnt vmcnt(7)
    v_mfma_f32_16x16x32_bf16 v[24:27], v[20:23], v[48:51], 0
    v_bitop3_b32 v18, v48, v50, v19 bitop3:0x7e
    s_waitcnt vmcnt(6)
    v_mfma_f32_16x16x32_bf16 v[24:27], v[20:23], v[52:55], v[24:27]
    v_bitop3_b32 v16, v52, v54, v19 bitop3:0x7e
    v_or_b32 v18, v18, v16
    s_waitcnt vmcnt(5)
    v_mfma_f32_16x16x32_bf16 v[24:27], v[20:23], v[56:59], v[24:27]
    v_bitop3_b32 v16, v56, v58, v19 bitop3:0x7e
    v_or_b32 v18, v18, v16
    s_waitcnt vmcnt(4)
    v_mfma_f32_16x16x32_bf16 v[24:27], v[20:23], v[60:63], v[24:27]
    v_bitop3_b32 v16, v60, v62, v19 bitop3:0x7e
    v_or_b32 v18, v18, v16
    v_and_b32 v18, 1, v18
    v_cmp_ne_u32 vcc, 0, v18
    s_nop 3
    v_add_f32_dpp v28, v24, v24 row_ror:8 row_mask:0xf bank_mask:0xf
    v_add_f32_dpp v29, v25, v25 row_ror:8 row_mask:0xf bank_mask:0xf
    v_add_f32_dpp v30, v26, v26 row_ror:8 row_mask:0xf bank_mask:0xf
    v_add_f32_dpp v31, v27, v27 row_ror:8 row_mask:0xf bank_mask:0xf
    v_cvt_pk_bf16_f32 v28, v28, v29
    v_cvt_pk_bf16_f32 v29, v30, v31
    s_cbranch_vccz L_rp_f1
L_rn1_f1:
    buffer_load_dwordx4 v[48:51], v0, s[8:11], s43 offen offset:0 sc1
    buffer_load_dwordx4 v[52:55], v0, s[8:11], s43 offen offset:1024 sc1
    buffer_load_dwordx4 v[56:59], v0, s[8:11], s43 offen offset:2048 sc1
    buffer_load_dwordx4 v[60:63], v0, s[8:11], s43 offen offset:3072 sc1
    s_add_u32 s49, s49, 1
    s_cmp_gt_u32 s49, 4000000
    s_cbranch_scc1 L_fail
L_rw0_f1:
    s_waitcnt vmcnt(7)
    v_mfma_f32_16x16x32_bf16 v[24:27], v[20:23], v[32:35], 0
    v_bitop3_b32 v18, v32, v34, v19 bitop3:0x7e
    s_waitcnt vmcnt(6)
    v_mfma_f32_16x16x32_bf16 v[24:27], v[20:23], v[36:39], v[24:27]
    v_bitop3_b32 v16, v36, v38, v19 bitop3:0x7e
    v_or_b32 v18, v18, v16
    s_waitcnt vmcnt(5)
    v_mfma_f32_16x16x32_bf16 v[24:27], v[20:23], v[40:43], v[24:27]
    v_bitop3_b32 v16, v40, v42, v19 bitop3:0x7e
    v_or_b32 v18, v18, v16
    s_waitcnt vmcnt(4)
    v_mfma_f32_16x16x32_bf16 v[24:27], v[20:23], v[44:47], v[24:27]
    v_bitop3_b32 v16, v44, v46, v19 bitop3:0x7e
    v_or_b32 v18, v18, v16
    v_and_b32 v18, 1, v18
    v_cmp_ne_u32 vcc, 0, v18
    s_nop 3
    v_add_f32_dpp v28, v24, v24 row_ror:8 row_mask:0xf bank_mask:0xf
    v_add_f32_dpp v29, v25, v25 row_ror:8 row_mask:0xf bank_mask:0xf
    v_add_f32_dpp v30, v26, v26 row_ror:8 row_mask:0xf bank_mask:0xf
    v_add_f32_dpp v31, v27, v27 row_ror:8 row_mask:0xf bank_mask:0xf
    v_cvt_pk_bf16_f32 v28, v28, v29
    v_cvt_pk_bf16_f32 v29, v30, v31
    s_cbranch_vccz L_rp_f1
L_rn0_f1:
    buffer_load_dwordx4 v[32:35], v0, s[8:11], s43 offen offset:0 sc1
    buffer_load_dwordx4 v[36:39], v0, s[8:11], s43 offen offset:1024 sc1
    buffer_load_dwordx4 v[40:43], v0, s[8:11], s43 offen offset:2048 sc1
    buffer_load_dwordx4 v[44:47], v0, s[8:11], s43 offen offset:3072 sc1
    s_add_u32 s49, s49, 1
    s_cmp_gt_u32 s49, 4000000
    s_cbranch_scc1 L_fail
    s_branch L_rw1_f1
L_slow_f1:
    s_cmp_eq_u32 s46, 0x5105
    s_cbranch_scc1 L_pv3_f1
    s_mov_b32 s46, 0x5105
    s_nop 0
    v_mov_b32 v54, v52
    v_mov_b32 v55, v53
    s_nop 0
    v_max_f32_dpp v54, v54, v54 row_ror:1 row_mask:0xf bank_mask:0xf
    v_max_f32_dpp v55, v55, v55 row_ror:1 row_mask:0xf bank_mask:0xf
    s_nop 0
    v_max_f32_dpp v54, v54, v54 row_ror:2 row_mask:0xf bank_mask:0xf
    v_max_f32_dpp v55, v55, v55 row_ror:2 row_mask:0xf bank_mask:0xf
    s_nop 0
    v_max_f32_dpp v54, v54, v54 row_ror:4 row_mask:0xf bank_mask:0xf
    v_max_f32_dpp v55, v55, v55 row_ror:4 row_mask:0xf bank_mask:0xf
    s_nop 0
    v_max_f32_dpp v54, v54, v54 row_ror:8 row_mask:0xf bank_mask:0xf
    v_max_f32_dpp v55, v55, v55 row_ror:8 row_mask:0xf bank_mask:0xf
    v_and_b32 v35, 15, v11
    v_lshlrev_b32 v35, 1, v35
    ds_write_b64 v35, v[54:55] offset:16288
    s_waitcnt lgkmcnt(0)
    s_barrier
    ds_read_b64 v[16:17], v35 offset:16256
    ds_read_b64 v[18:19], v35 offset:16288
    ds_read_b64 v[20:21], v35 offset:16320
    s_waitcnt lgkmcnt(0)
    v_max3_f32 v54, v16, v18, v20
    v_max3_f32 v55, v17, v19, v21
    v_sub_f32 v54, v52, v54
    v_sub_f32 v55, v53, v55
    v_exp_f32 v54, v54
    v_exp_f32 v55, v55
    s_nop 0
    v_cvt_pk_bf16_f32 v54, v54, v55
    ds_write_b32 v11, v54 offset:15616
    s_waitcnt lgkmcnt(0)
    s_barrier
    s_branch L_pv_f1
L_pv2_f1:
    ds_read_b128 v[24:27], v0 offset:26624
    ds_read_b128 v[28:31], v0 offset:27648
    s_waitcnt lgkmcnt(0)
    v_mov_b32 v56, 0x3f803f80
    v_mov_b32 v57, 0x3f803f80
    v_mov_b32 v58, 0x3f803f80
    v_mov_b32 v59, 0x3f803f80
    s_nop 1
    v_mfma_f32_16x16x32_bf16 v[36:39], v[56:59], v[48:51], 0
    v_mfma_f32_16x16x32_bf16 v[16:19], v[24:27], v[48:51], 0
    v_mfma_f32_16x16x32_bf16 v[20:23], v[28:31], v[48:51], 0
    v_mfma_f32_16x16x16_bf16 v[36:39], v[32:33], v[54:55], v[36:39]
    v_mfma_f32_16x16x16_bf16 v[16:19], v[40:41], v[54:55], v[16:19]
    v_mfma_f32_16x16x16_bf16 v[20:23], v[44:45], v[54:55], v[20:23]
    s_nop 7
    s_branch L_pv4_f1
L_tail_f1:
    s_waitcnt lgkmcnt(0)
    v_smfmac_f32_16x16x64_bf16 v[44:47], v[60:63], a[120:127], v10
    ds_read_b128 v[16:19], v1 offset:16384
    ds_read_b128 v[20:23], v1 offset:17408
    v_smfmac_f32_16x16x64_bf16 v[40:43], v[48:51], a[128:135], v10
    ds_read_b128 v[24:27], v1 offset:18432
    ds_read_b128 v[28:31], v1 offset:19456
    v_smfmac_f32_16x16x64_bf16 v[44:47], v[48:51], a[136:143], v10
    ds_read_b64_tr_b16 v[60:61], v2 offset:0
    ds_read_b64_tr_b16 v[62:63], v3 offset:0
    v_smfmac_f32_16x16x64_bf16 v[40:43], v[56:59], a[32:39], v10
    ds_read_b64_tr_b16 v[48:49], v2 offset:2048
    ds_read_b64_tr_b16 v[50:51], v3 offset:2048
    v_smfmac_f32_16x16x64_bf16 v[44:47], v[56:59], a[40:47], v10
    ds_read_b64_tr_b16 v[56:57], v2 offset:3072
    ds_read_b64_tr_b16 v[58:59], v3 offset:3072
    s_waitcnt lgkmcnt(4)
    v_smfmac_f32_16x16x64_bf16 v[40:43], v[60:63], a[48:55], v10
    v_smfmac_f32_16x16x64_bf16 v[44:47], v[60:63], a[56:63], v10
    ds_read_b64_tr_b16 v[60:61], v2 offset:5120
    ds_read_b64_tr_b16 v[62:63], v3 offset:5120
    s_waitcnt lgkmcnt(4)
    v_smfmac_f32_16x16x64_bf16 v[40:43], v[48:51], v[16:23], v10
    v_smfmac_f32_16x16x64_bf16 v[44:47], v[48:51], v[24:31], v10
    s_waitcnt lgkmcnt(2)
    v_smfmac_f32_16x16x64_bf16 v[40:43], v[56:59], a[64:71], v10
    v_smfmac_f32_16x16x64_bf16 v[44:47], v[56:59], a[72:79], v10
    s_waitcnt lgkmcnt(0)
    v_smfmac_f32_16x16x64_bf16 v[40:43], v[60:63], a[80:87], v10
    v_smfmac_f32_16x16x64_bf16 v[44:47], v[60:63], a[88:95], v10
    s_nop 3
    v_add_f32 v40, v40, v42
    v_add_f32 v41, v41, v43
    v_cvt_pk_bf16_f32 v40, v40, v41
    s_nop 0
    v_add_f32 v44, v44, v46
    v_add_f32 v45, v45, v47
    v_cvt_pk_bf16_f32 v44, v44, v45
    ds_write_b32 v11, v40 offset:9728
    ds_write_b32 v11, v44 offset:9984
    s_waitcnt vmcnt(0)
    v_and_b32 v12, 0x200, v0
    v_mul_u32_u24 v12, 3, v12
    v_add_u32 v12, v12, v0
    ds_read_b128 v[12:15], v12 offset:9728
    s_waitcnt lgkmcnt(0)
    s_lshr_b32 s44, s48, 1
    s_add_u32 s44, s44, 0x4100400
    buffer_store_dwordx4 v[12:15], v0, s[8:11], s44 offen sc1
    s_waitcnt vmcnt(0)
    s_barrier
    s_branch L_end
L_slowmode_1:
    ds_read_b128 v[32:35], v0 offset:5120
    ds_read_b32 v12, v11 offset:8448
    ds_read_b128 v[40:43], v1 offset:0
    ds_read_b128 v[44:47], v1 offset:1024
    v_mov_b64 v[16:17], 0
    v_mov_b64 v[18:19], 0
    v_mov_b64 v[20:21], 0
    v_mov_b64 v[22:23], 0
    v_mov_b64 v[24:25], 0
    v_mov_b64 v[26:27], 0
    v_mov_b64 v[28:29], 0
    v_mov_b64 v[30:31], 0
    s_waitcnt vmcnt(0) lgkmcnt(0)
    s_nop 0
    s_branch L_gar_s1
L_loop_s1:
    s_barrier
    s_add_u32 s43, s40, 1024
    buffer_load_dwordx4 v[60:63], v0, s[8:11], s43 offen sc1
    v_mov_b64 v[16:17], 0
    v_mov_b64 v[18:19], 0
    v_mov_b64 v[20:21], 0
    v_mov_b64 v[22:23], 0
    v_mov_b64 v[24:25], 0
    v_mov_b64 v[26:27], 0
    v_mov_b64 v[28:29], 0
    v_mov_b64 v[30:31], 0
    s_nop 15
    s_nop 7
    s_add_u32 s43, s40, 1024
    buffer_load_dwordx4 v[56:59], v0, s[8:11], s43 offen sc1
    s_waitcnt vmcnt(1)
    ds_write_b128 v0, v[60:63] offset:1024
    v_max3_u32 v14, v60, v61, v62
    v_max_u32 v14, v14, v63
    v_cmp_le_u32 vcc, s51, v14
    s_add_u32 s43, s40, 5120
    buffer_load_dwordx4 v[32:35], v0, s[8:11], s43 offen sc1
    s_add_u32 s43, s40, 8448
    buffer_load_dword v12, v11, s[8:11], s43 offen sc1
    s_cbranch_vccnz L_ga_s1
L_gar_s1:
    ds_read_b64_tr_b16 v[48:49], v2 offset:1024
    ds_read_b64_tr_b16 v[50:51], v3 offset:1024
    ds_read_b128 v[40:43], v1 offset:0
    ds_read_b128 v[44:47], v1 offset:1024
    s_waitcnt lgkmcnt(4)
    s_barrier
    ds_read_b64_tr_b16 v[52:53], v2 offset:0
    ds_read_b64_tr_b16 v[54:55], v3 offset:0
    s_waitcnt lgkmcnt(4)
    s_waitcnt lgkmcnt(2)
    v_smfmac_f32_16x16x64_bf16 v[16:19], v[48:51], v[40:47], v10
    s_waitcnt vmcnt(2)
    ds_read_b64_tr_b16 v[56:57], v2 offset:2048
    ds_read_b64_tr_b16 v[58:59], v3 offset:2048
    v_smfmac_f32_16x16x64_bf16 v[24:27], v[48:51], v[176:183], v10
    ds_read_b64_tr_b16 v[60:61], v2 offset:3072
    ds_read_b64_tr_b16 v[62:63], v3 offset:3072
    v_smfmac_f32_16x16x64_bf16 v[28:31], v[48:51], v[184:191], v10
    ds_read_b128 v[40:43], v1 offset:2048
    ds_read_b128 v[44:47], v1 offset:3072
    s_waitcnt lgkmcnt(6)
    v_smfmac_f32_16x16x64_bf16 v[16:19], v[52:55], v[64:71], v10
    s_add_u32 s43, s40, 5120
    buffer_load_dwordx4 v[36:39], v0, s[8:11], s43 offen sc1
    s_add_u32 s43, s40, 8448
    buffer_load_dword v13, v11, s[8:11], s43 offen sc1
    v_smfmac_f32_16x16x64_bf16 v[20:23], v[52:55], v[72:79], v10
    v_smfmac_f32_16x16x64_bf16 v[24:27], v[52:55], v[192:199], v10
    s_waitcnt lgkmcnt(0)
    v_smfmac_f32_16x16x64_bf16 v[20:23], v[48:51], v[40:47], v10
    ds_read_b128 v[40:43], v1 offset:8192
    v_smfmac_f32_16x16x64_bf16 v[28:31], v[52:55], v[200:207], v10
    ds_read_b128 v[44:47], v1 offset:9216
    v_smfmac_f32_16x16x64_bf16 v[16:19], v[56:59], v[80:87], v10
    s_waitcnt vmcnt(2)
    ds_write_b128 v0, v[32:35] offset:5120
    v_max3_u32 v14, v32, v33, v34
    v_smfmac_f32_16x16x64_bf16 v[20:23], v[56:59], v[88:95], v10
    ds_write_b32 v11, v12 offset:8448
    v_max3_u32 v14, v14, v35, v12
    v_smfmac_f32_16x16x64_bf16 v[24:27], v[56:59], v[208:215], v10
    v_cmp_le_u32 vcc, s51, v14
    v_smfmac_f32_16x16x64_bf16 v[28:31], v[56:59], v[216:223], v10
    s_cbranch_vccnz L_gb_s1
L_gbr_s1:
    ds_read_b64_tr_b16 v[48:49], v2 offset:5120
    v_smfmac_f32_16x16x64_bf16 v[16:19], v[60:63], v[96:103], v10
    ds_read_b64_tr_b16 v[50:51], v3 offset:5120
    v_smfmac_f32_16x16x64_bf16 v[20:23], v[60:63], v[104:111], v10
    s_waitcnt lgkmcnt(2)
    s_barrier
    ds_read_b64_tr_b16 v[52:53], v2 offset:4096
    ds_read_b64_tr_b16 v[54:55], v3 offset:4096
    v_smfmac_f32_16x16x64_bf16 v[24:27], v[60:63], v[40:47], v10
    ds_read_b64_tr_b16 v[56:57], v2 offset:6144
    ds_read_b64_tr_b16 v[58:59], v3 offset:6144
    s_waitcnt lgkmcnt(4)
    v_smfmac_f32_16x16x64_bf16 v[16:19], v[48:51], v[112:119], v10
    s_waitcnt vmcnt(0)
    ds_read_b128 v[32:35], v1 offset:10240
    ds_read_b128 v[36:39], v1 offset:11264
    v_smfmac_f32_16x16x64_bf16 v[20:23], v[48:51], v[120:127], v10
    ds_read_b128 v[40:43], v1 offset:4096
    ds_read_b128 v[44:47], v1 offset:5120
    v_smfmac_f32_16x16x64_bf16 v[24:27], v[48:51], v[224:231], v10
    v_smfmac_f32_16x16x64_bf16 v[28:31], v[48:51], v[232:239], v10
    ds_read_b64_tr_b16 v[48:49], v2 offset:8192
    ds_read_b64_tr_b16 v[50:51], v3 offset:8192
    s_waitcnt lgkmcnt(8)
    v_smfmac_f32_16x16x64_bf16 v[24:27], v[52:55], v[240:247], v10
    s_waitcnt lgkmcnt(4)
    v_smfmac_f32_16x16x64_bf16 v[28:31], v[60:63], v[32:39], v10
    ds_read_b64_tr_b16 v[60:61], v2 offset:7168
    s_waitcnt lgkmcnt(3)
    v_smfmac_f32_16x16x64_bf16 v[16:19], v[52:55], v[40:47], v10
    ds_read_b64_tr_b16 v[62:63], v3 offset:7168
    v_smfmac_f32_16x16x64_bf16 v[28:31], v[52:55], v[248:255], v10
    ds_read_b128 v[32:35], v1 offset:6144
    v_smfmac_f32_16x16x64_bf16 v[16:19], v[56:59], v[128:135], v10
    ds_read_b128 v[36:39], v1 offset:7168
    v_and_b32 v12, 0x200, v0
    v_smfmac_f32_16x16x64_bf16 v[20:23], v[56:59], v[136:143], v10
    ds_read_b128 v[40:43], v1 offset:12288
    v_mul_u32_u24 v12, 3, v12
    s_waitcnt lgkmcnt(3)
    v_smfmac_f32_16x16x64_bf16 v[16:19], v[60:63], v[144:151], v10
    ds_read_b128 v[44:47], v1 offset:13312
    v_add_u32 v12, v12, v0
    s_waitcnt lgkmcnt(2)
    v_smfmac_f32_16x16x64_bf16 v[20:23], v[52:55], v[32:39], v10
    ds_read_b128 v[12:15], v12 offset:9728
    v_smfmac_f32_16x16x64_bf16 v[20:23], v[60:63], v[152:159], v10
    ds_read_b128 v[32:35], v1 offset:14336
    v_smfmac_f32_16x16x64_bf16 v[16:19], v[48:51], v[160:167], v10
    ds_read_b128 v[36:39], v1 offset:15360
    v_smfmac_f32_16x16x64_bf16 v[20:23], v[48:51], v[168:175], v10
    s_waitcnt lgkmcnt(3)
    v_smfmac_f32_16x16x64_bf16 v[24:27], v[56:59], v[40:47], v10
    s_waitcnt lgkmcnt(2)
    s_lshr_b32 s44, s48, 1
    s_add_u32 s44, s44, 0x40e0400
    buffer_store_dwordx4 v[12:15], v0, s[8:11], s44 offen sc1
    v_add_f32 v16, v16, v18
    v_add_f32 v17, v17, v19
    s_waitcnt lgkmcnt(0)
    v_smfmac_f32_16x16x64_bf16 v[28:31], v[56:59], v[32:39], v10
    ds_read_b128 v[32:35], v1 offset:22528
    v_cvt_pk_bf16_f32 v16, v16, v17
    v_add_f32 v20, v20, v22
    v_smfmac_f32_16x16x64_bf16 v[24:27], v[60:63], a[0:7], v10
    ds_read_b128 v[36:39], v1 offset:23552
    v_add_f32 v21, v21, v23
    v_cvt_pk_bf16_f32 v17, v20, v21
    v_smfmac_f32_16x16x64_bf16 v[24:27], v[48:51], a[16:23], v10
    ds_write_b64 v4, v[16:17] offset:9728
    v_mov_b64 v[40:41], 0
    v_mov_b64 v[42:43], 0
    v_smfmac_f32_16x16x64_bf16 v[28:31], v[60:63], a[8:15], v10
    ds_read_b128 v[16:19], v1 offset:20480
    v_mov_b64 v[44:45], 0
    v_mov_b64 v[46:47], 0
    v_smfmac_f32_16x16x64_bf16 v[28:31], v[48:51], a[24:31], v10
    ds_read_b128 v[20:23], v1 offset:21504
    v_add_f32 v24, v24, v26
    v_add_f32 v25, v25, v27
    v_cvt_pk_bf16_f32 v24, v24, v25
    v_smfmac_f32_16x16x64_bf16 v[40:43], v[52:55], a[96:103], v10
    v_smfmac_f32_16x16x64_bf16 v[44:47], v[52:55], a[104:111], v10
    v_add_f32 v28, v28, v30
    v_add_f32 v29, v29, v31
    v_cvt_pk_bf16_f32 v25, v28, v29
    ds_write2st64_b32 v11, v24, v25 offset0:46 offset1:47
    s_waitcnt lgkmcnt(4)
    v_smfmac_f32_16x16x64_bf16 v[44:47], v[56:59], v[32:39], v10
    ds_read_b128 v[24:27], v0 offset:22528
    v_mov_b64 v[52:53], 0
    v_mov_b64 v[54:55], 0
    v_smfmac_f32_16x16x64_bf16 v[40:43], v[60:63], a[112:119], v10
    ds_read_b128 v[28:31], v0 offset:23552
    s_waitcnt lgkmcnt(3)
    v_smfmac_f32_16x16x64_bf16 v[40:43], v[56:59], v[16:23], v10
    ds_read_b64_tr_b16 v[56:57], v2 offset:1024
    ds_read_b128 v[16:19], v0 offset:20480
    ds_read_b128 v[20:23], v0 offset:21504
    ds_read_b64_tr_b16 v[58:59], v3 offset:1024
    s_waitcnt lgkmcnt(6)
    s_barrier
    s_cmp_eq_u32 s38, 63
    s_cbranch_scc1 L_tail_s1
    ds_read_b64_tr_b16 v[32:33], v2 offset:9216
    ds_read_b64_tr_b16 v[34:35], v3 offset:9216
    ds_read_b64_tr_b16 v[36:37], v2 offset:10240
    ds_read_b64_tr_b16 v[38:39], v3 offset:10240
    s_waitcnt lgkmcnt(5)
    v_smfmac_f32_16x16x64_bf16 v[44:47], v[60:63], a[120:127], v10
    s_mov_b32 m0, 0x5000
    s_add_u32 s55, s48, 0x1041000
    buffer_load_dwordx4 v0, s[8:11], s55 offen sc1 lds
    buffer_load_dwordx4 v0, s[8:11], s55 offen offset:1024 sc1 lds
    v_smfmac_f32_16x16x64_bf16 v[40:43], v[48:51], a[128:135], v10
    buffer_load_dwordx4 v0, s[8:11], s55 offen offset:2048 sc1 lds
    buffer_load_dwordx4 v0, s[8:11], s55 offen offset:3072 sc1 lds
    v_smfmac_f32_16x16x64_bf16 v[44:47], v[48:51], a[136:143], v10
    ds_read_b64_tr_b16 v[60:61], v2 offset:0
    ds_read_b64_tr_b16 v[62:63], v3 offset:0
    s_waitcnt lgkmcnt(6)
    v_smfmac_f32_16x16x64_bf16 v[40:43], v[56:59], a[32:39], v10
    ds_read_b64_tr_b16 v[48:49], v2 offset:2048
    ds_read_b64_tr_b16 v[50:51], v3 offset:2048
    s_waitcnt lgkmcnt(4)
    v_smfmac_f32_16x16x64_bf16 v[52:55], v[32:35], v[16:23], v10
    v_smfmac_f32_16x16x64_bf16 v[52:55], v[36:39], v[24:31], v10
    ds_read_b128 v[16:19], v1 offset:16384
    ds_read_b128 v[20:23], v1 offset:17408
    v_smfmac_f32_16x16x64_bf16 v[44:47], v[56:59], a[40:47], v10
    ds_read_b128 v[24:27], v1 offset:18432
    ds_read_b128 v[28:31], v1 offset:19456
    s_waitcnt lgkmcnt(6)
    v_smfmac_f32_16x16x64_bf16 v[40:43], v[60:63], a[48:55], v10
    ds_read_b64_tr_b16 v[56:57], v2 offset:3072
    ds_read_b64_tr_b16 v[58:59], v3 offset:3072
    v_add_f32 v52, v52, v54
    v_add_f32 v53, v53, v55
    v_mul_f32 v52, s50, v52
    v_mul_f32 v53, s50, v53
    v_exp_f32 v54, v52
    v_exp_f32 v55, v53
    s_nop 0
    v_cvt_pk_bf16_f32 v54, v54, v55
    ds_write_b32 v11, v54 offset:15616
    v_smfmac_f32_16x16x64_bf16 v[44:47], v[60:63], a[56:63], v10
    ds_read_b64_tr_b16 v[60:61], v2 offset:5120
    ds_read_b64_tr_b16 v[62:63], v3 offset:5120
    s_waitcnt lgkmcnt(9)
    s_waitcnt lgkmcnt(7)
    v_smfmac_f32_16x16x64_bf16 v[40:43], v[48:51], v[16:23], v10
    s_waitcnt lgkmcnt(5)
    v_smfmac_f32_16x16x64_bf16 v[44:47], v[48:51], v[24:31], v10
    s_waitcnt lgkmcnt(2)
    s_barrier
L_pv_s1:
    ds_read_b64_tr_b16 v[48:49], v5 offset:15360
    ds_read_b64_tr_b16 v[50:51], v5 offset:15616
    ds_read_b64_tr_b16 v[54:55], v8 offset:15872
    s_cmp_eq_u32 s46, 0x5105
    s_cbranch_scc1 L_pv2_s1
    ds_read_b128 v[24:27], v0 offset:26624
    ds_read_b128 v[28:31], v0 offset:27648
    v_smfmac_f32_16x16x64_bf16 v[40:43], v[56:59], a[64:71], v10
    v_mov_b64 v[32:33], s[98:99]
    v_smfmac_f32_16x16x64_bf16 v[44:47], v[56:59], a[72:79], v10
    s_waitcnt lgkmcnt(5)
    v_smfmac_f32_16x16x64_bf16 v[40:43], v[60:63], a[80:87], v10
    v_mov_b64 v[56:57], s[96:97]
    v_smfmac_f32_16x16x64_bf16 v[44:47], v[60:63], a[88:95], v10
    v_mov_b64 v[58:59], s[96:97]
    s_waitcnt lgkmcnt(0)
    s_nop 0
    v_mfma_f32_16x16x32_bf16 v[36:39], v[56:59], v[48:51], 0
    v_mfma_f32_16x16x32_bf16 v[16:19], v[24:27], v[48:51], 0
    v_add_f32 v40, v40, v42
    v_add_f32 v41, v41, v43
    v_mfma_f32_16x16x32_bf16 v[20:23], v[28:31], v[48:51], 0
    v_cvt_pk_bf16_f32 v40, v40, v41
    v_mov_b32 v41, 0
    v_mfma_f32_16x16x16_bf16 v[36:39], v[32:33], v[54:55], v[36:39]
    v_add_f32 v44, v44, v46
    v_add_f32 v45, v45, v47
    v_mfma_f32_16x16x16_bf16 v[16:19], v[40:41], v[54:55], v[16:19]
    v_cvt_pk_bf16_f32 v44, v44, v45
    v_mov_b32 v45, 0
    s_nop 1
    v_mfma_f32_16x16x16_bf16 v[20:23], v[44:45], v[54:55], v[20:23]
L_pv4_s1:
    ds_read_b128 v[56:59], v1 offset:24576
    ds_read_b128 v[60:63], v1 offset:25600
    ds_read_b128 v[24:27], v1 offset:26624
    ds_read_b128 v[28:31], v1 offset:27648
    v_rcp_f32 v34, v36
    v_cmp_ngt_f32 vcc, s69, v36
    v_cmp_nlt_f32 s[44:45], s68, v36
    v_cndmask_b32 v16, v18, v16, s[56:57]
    v_cndmask_b32 v17, v19, v17, s[56:57]
    s_or_b64 vcc, vcc, s[44:45]
    v_mul_f32 v16, v16, v34
    v_mul_f32 v17, v17, v34
    v_cndmask_b32 v20, v22, v20, s[56:57]
    v_cndmask_b32 v21, v23, v21, s[56:57]
    v_cvt_pk_bf16_f32 v16, v16, v17
    v_mul_f32 v20, v20, v34
    v_mul_f32 v21, v21, v34
    s_cbranch_vccnz L_slow_s1
L_pv3_s1:
    v_cvt_pk_bf16_f32 v20, v20, v21
    ds_write2_b32 v6, v16, v20 offset0:0 offset1:2
    s_mov_b32 s46, 0
    v_lshrrev_b32 v12, 1, v0
    v_and_b32 v12, 0x1e0, v12
    v_and_or_b32 v12, v0, 16, v12
    v_mov_b64 v[48:49], 0
    v_mov_b64 v[50:51], 0
    v_mov_b64 v[52:53], 0
    v_mov_b64 v[54:55], 0
    v_mov_b64 v[16:17], 0
    v_mov_b64 v[18:19], 0
    v_mov_b64 v[20:21], 0
    v_mov_b64 v[22:23], 0
    s_waitcnt lgkmcnt(0)
    s_barrier
    ds_read_b128 v[32:35], v12 offset:13312
    ds_read_b128 v[36:39], v12 offset:13824
    ds_write2st64_b32 v11, v40, v44 offset0:38 offset1:39
    ds_read_b128 v[40:43], v12 offset:14336
    ds_read_b128 v[44:47], v12 offset:14848
    s_waitcnt lgkmcnt(4)
    v_smfmac_f32_16x16x64_bf16 v[16:19], v[32:35], v[56:63], v10
    ds_read_b128 v[56:59], v1 offset:28672
    v_smfmac_f32_16x16x64_bf16 v[20:23], v[32:35], a[144:151], v10
    ds_read_b128 v[60:63], v1 offset:29696
    s_waitcnt lgkmcnt(5)
    v_smfmac_f32_16x16x64_bf16 v[16:19], v[36:39], v[24:31], v10
    ds_read_b128 v[24:27], v1 offset:30720
    v_smfmac_f32_16x16x64_bf16 v[20:23], v[36:39], a[152:159], v10
    ds_read_b128 v[28:31], v1 offset:31744
    s_waitcnt lgkmcnt(5)
    v_smfmac_f32_16x16x64_bf16 v[16:19], v[40:43], a[176:183], v10
    v_smfmac_f32_16x16x64_bf16 v[20:23], v[40:43], a[192:199], v10
    s_waitcnt lgkmcnt(4)
    v_smfmac_f32_16x16x64_bf16 v[16:19], v[44:47], a[184:191], v10
    v_smfmac_f32_16x16x64_bf16 v[20:23], v[44:47], a[200:207], v10
    s_waitcnt lgkmcnt(2)
    v_smfmac_f32_16x16x64_bf16 v[48:51], v[32:35], v[56:63], v10
    v_cvt_pk_bf16_f32 v16, v16, v17
    v_cvt_pk_bf16_f32 v17, v18, v19
    v_and_or_b32 v16, v16, -2, s92
    s_waitcnt lgkmcnt(0)
    v_smfmac_f32_16x16x64_bf16 v[48:51], v[36:39], v[24:31], v10
    s_add_u32 s43, s39, 16384
    buffer_store_dwordx2 v[16:17], v7, s[8:11], s43 offen sc1
    v_cvt_pk_bf16_f32 v20, v20, v21
    v_cvt_pk_bf16_f32 v21, v22, v23
    v_and_or_b32 v20, v20, -2, s92
    v_smfmac_f32_16x16x64_bf16 v[48:51], v[40:43], a[208:215], v10
    s_add_u32 s43, s39, 81920
    buffer_store_dwordx2 v[20:21], v7, s[8:11], s43 offen sc1
    v_cndmask_b32 v56, v32, v36, s[100:101]
    v_cndmask_b32 v57, v33, v37, s[100:101]
    v_cndmask_b32 v58, v34, v38, s[100:101]
    v_smfmac_f32_16x16x64_bf16 v[48:51], v[44:47], a[216:223], v10
    v_cndmask_b32 v59, v35, v39, s[100:101]
    v_cndmask_b32 v60, v40, v44, s[100:101]
    v_cndmask_b32 v61, v41, v45, s[100:101]
    v_smfmac_f32_16x16x64_bf16 v[52:55], v[32:35], a[160:167], v10
    v_cndmask_b32 v62, v42, v46, s[100:101]
    v_cndmask_b32 v63, v43, v47, s[100:101]
    v_mov_b64 v[24:25], 0
    v_smfmac_f32_16x16x64_bf16 v[52:55], v[36:39], a[168:175], v10
    v_mov_b64 v[26:27], 0
    s_nop 1
    v_smfmac_f32_16x16x64_bf16 v[24:27], v[56:59], a[240:247], v10
    v_cvt_pk_bf16_f32 v48, v48, v49
    v_cvt_pk_bf16_f32 v49, v50, v51
    v_smfmac_f32_16x16x64_bf16 v[24:27], v[60:63], a[248:255], v10
    v_and_or_b32 v48, v48, -2, s92
    v_smfmac_f32_16x16x64_bf16 v[52:55], v[40:43], a[224:231], v10
    s_add_u32 s43, s39, 147456
    buffer_store_dwordx2 v[48:49], v7, s[8:11], s43 offen sc1
    v_smfmac_f32_16x16x64_bf16 v[52:55], v[44:47], a[232:239], v10
    v_add_f32 v24, v24, v26
    v_add_f32 v25, v25, v27
    v_cvt_pk_bf16_f32 v24, v24, v25
    v_and_or_b32 v24, v24, -2, s92
    s_add_u32 s43, s39, 262144
    buffer_store_dword v24, v7, s[8:11], s43 offen offset:4 sc1
    s_nop 1
    v_cvt_pk_bf16_f32 v52, v52, v53
    v_cvt_pk_bf16_f32 v53, v54, v55
    v_and_or_b32 v52, v52, -2, s92
    s_add_u32 s43, s39, 212992
    buffer_store_dwordx2 v[52:53], v7, s[8:11], s43 offen sc1
    s_add_u32 s43, s39, s47
    s_mov_b32 s49, 0
    s_nop 15
    s_nop 15
    s_nop 15
    s_nop 11
    buffer_load_dwordx4 v[32:35], v0, s[8:11], s43 offen offset:0 sc1
    buffer_load_dwordx4 v[36:39], v0, s[8:11], s43 offen offset:1024 sc1
    buffer_load_dwordx4 v[40:43], v0, s[8:11], s43 offen offset:2048 sc1
    buffer_load_dwordx4 v[44:47], v0, s[8:11], s43 offen offset:3072 sc1
    v_mov_b32 v16, 0x3f80
    v_mov_b32 v17, 0x3f800000
    v_cndmask_b32 v16, v16, v17, s[66:67]
    v_cndmask_b32 v20, 0, v16, s[58:59]
    v_cndmask_b32 v21, 0, v16, s[60:61]
    v_cndmask_b32 v22, 0, v16, s[62:63]
    v_cndmask_b32 v23, 0, v16, s[64:65]
    v_mov_b32 v19, s92
    s_xor_b32 s92, s92, 1
    s_mov_b32 s45, s40
    s_mov_b32 s40, s41
    s_mov_b32 s41, s42
    s_mov_b32 s42, s93
    s_mov_b32 s93, s45
    s_add_u32 s38, s38, 1
    s_add_u32 s48, s48, 262144
    s_nop 15
    s_nop 15
    buffer_load_dwordx4 v[48:51], v0, s[8:11], s43 offen offset:0 sc1
    buffer_load_dwordx4 v[52:55], v0, s[8:11], s43 offen offset:1024 sc1
    buffer_load_dwordx4 v[56:59], v0, s[8:11], s43 offen offset:2048 sc1
    buffer_load_dwordx4 v[60:63], v0, s[8:11], s43 offen offset:3072 sc1
    s_waitcnt vmcnt(7)
    v_mfma_f32_16x16x32_bf16 v[24:27], v[20:23], v[32:35], 0
    v_bitop3_b32 v18, v32, v34, v19 bitop3:0x7e
    s_waitcnt vmcnt(6)
    v_mfma_f32_16x16x32_bf16 v[24:27], v[20:23], v[36:39], v[24:27]
    v_bitop3_b32 v16, v36, v38, v19 bitop3:0x7e
    v_or_b32 v18, v18, v16
    s_waitcnt vmcnt(5)
    v_mfma_f32_16x16x32_bf16 v[24:27], v[20:23], v[40:43], v[24:27]
    v_bitop3_b32 v16, v40, v42, v19 bitop3:0x7e
    v_or_b32 v18, v18, v16
    s_waitcnt vmcnt(4)
    v_mfma_f32_16x16x32_bf16 v[24:27], v[20:23], v[44:47], v[24:27]
    v_bitop3_b32 v16, v44, v46, v19 bitop3:0x7e
    v_or_b32 v18, v18, v16
    v_and_b32 v18, 1, v18
    v_cmp_ne_u32 vcc, 0, v18
    s_nop 3
    v_add_f32_dpp v28, v24, v24 row_ror:8 row_mask:0xf bank_mask:0xf
    v_add_f32_dpp v29, v25, v25 row_ror:8 row_mask:0xf bank_mask:0xf
    v_add_f32_dpp v30, v26, v26 row_ror:8 row_mask:0xf bank_mask:0xf
    v_add_f32_dpp v31, v27, v27 row_ror:8 row_mask:0xf bank_mask:0xf
    v_cvt_pk_bf16_f32 v28, v28, v29
    v_cvt_pk_bf16_f32 v29, v30, v31
    s_cbranch_vccnz L_rn0_s1
L_rp_s1:
    buffer_store_dwordx2 v[28:29], v9, s[8:11], s40 offen sc1
L_rd_s1:
    s_branch L_loop_s1
L_ga_s1:
    s_mov_b32 s49, 0
    s_add_u32 s43, s40, 1024
    buffer_load_dwordx4 v[60:63], v0, s[8:11], s43 offen sc1
    s_waitcnt vmcnt(3)
    s_branch L_gac1_s1
L_gaw0_s1:
    s_waitcnt vmcnt(1)
L_gac0_s1:
    ds_write_b128 v0, v[60:63] offset:1024
    v_max3_u32 v14, v60, v61, v62
    v_max_u32 v14, v14, v63
    v_cmp_le_u32 vcc, s51, v14
    s_cbranch_vccz L_ga3_s1
    s_and_b32 s43, s49, 15
    s_cmp_lg_u32 s43, 15
    s_cbranch_scc1 L_gan0_s1
    v_cmp_eq_u32 vcc, s51, v60
    v_cmp_eq_u32 s[44:45], s51, v61
    s_nop 0
    s_or_b64 vcc, vcc, s[44:45]
    v_cmp_eq_u32 s[44:45], s51, v62
    s_nop 0
    s_or_b64 vcc, vcc, s[44:45]
    v_cmp_eq_u32 s[44:45], s51, v63
    s_nop 0
    s_or_b64 vcc, vcc, s[44:45]
    s_cbranch_vccz L_ga3_s1
L_gan0_s1:
    s_add_u32 s43, s40, 1024
    buffer_load_dwordx4 v[60:63], v0, s[8:11], s43 offen sc1
    s_add_u32 s49, s49, 1
    s_cmp_gt_u32 s49, 4000000
    s_cbranch_scc1 L_fail
L_gaw1_s1:
    s_waitcnt vmcnt(1)
L_gac1_s1:
    ds_write_b128 v0, v[56:59] offset:1024
    v_max3_u32 v14, v56, v57, v58
    v_max_u32 v14, v14, v59
    v_cmp_le_u32 vcc, s51, v14
    s_cbranch_vccz L_ga3_s1
    s_and_b32 s43, s49, 15
    s_cmp_lg_u32 s43, 15
    s_cbranch_scc1 L_gan1_s1
    v_cmp_eq_u32 vcc, s51, v56
    v_cmp_eq_u32 s[44:45], s51, v57
    s_nop 0
    s_or_b64 vcc, vcc, s[44:45]
    v_cmp_eq_u32 s[44:45], s51, v58
    s_nop 0
    s_or_b64 vcc, vcc, s[44:45]
    v_cmp_eq_u32 s[44:45], s51, v59
    s_nop 0
    s_or_b64 vcc, vcc, s[44:45]
    s_cbranch_vccz L_ga3_s1
L_gan1_s1:
    s_add_u32 s43, s40, 1024
    buffer_load_dwordx4 v[56:59], v0, s[8:11], s43 offen sc1
    s_add_u32 s49, s49, 1
    s_cmp_gt_u32 s49, 4000000
    s_cbranch_scc1 L_fail
    s_branch L_gaw0_s1
L_ga3_s1:
    s_waitcnt lgkmcnt(0)
    s_waitcnt vmcnt(0)
    s_branch L_gar_s1
L_gb_s1:
    s_mov_b32 s49, 0
    s_add_u32 s43, s40, 5120
    buffer_load_dwordx4 v[32:35], v0, s[8:11], s43 offen sc1
    s_add_u32 s43, s40, 8448
    buffer_load_dword v12, v11, s[8:11], s43 offen sc1
    s_waitcnt vmcnt(2)
    s_branch L_gbc1_s1
L_gbw0_s1:
    s_waitcnt vmcnt(2)
L_gbc0_s1:
    ds_write_b128 v0, v[32:35] offset:5120
    ds_write_b32 v11, v12 offset:8448
    v_max3_u32 v14, v32, v33, v34
    v_max3_u32 v14, v14, v35, v12
    v_cmp_le_u32 vcc, s51, v14
    s_cbranch_vccz L_gb3_s1
    s_and_b32 s43, s49, 15
    s_cmp_lg_u32 s43, 15
    s_cbranch_scc1 L_gbn0_s1
    v_cmp_eq_u32 vcc, s51, v32
    v_cmp_eq_u32 s[44:45], s51, v33
    s_nop 0
    s_or_b64 vcc, vcc, s[44:45]
    v_cmp_eq_u32 s[44:45], s51, v34
    s_nop 0
    s_or_b64 vcc, vcc, s[44:45]
    v_cmp_eq_u32 s[44:45], s51, v35
    s_nop 0
    s_or_b64 vcc, vcc, s[44:45]
    v_cmp_eq_u32 s[44:45], s51, v12
    s_nop 0
    s_or_b64 vcc, vcc, s[44:45]
    s_cbranch_vccz L_gb3_s1
L_gbn0_s1:
    s_add_u32 s43, s40, 5120
    buffer_load_dwordx4 v[32:35], v0, s[8:11], s43 offen sc1
    s_add_u32 s43, s40, 8448
    buffer_load_dword v12, v11, s[8:11], s43 offen sc1
    s_add_u32 s49, s49, 1
    s_cmp_gt_u32 s49, 4000000
    s_cbranch_scc1 L_fail
L_gbw1_s1:
    s_waitcnt vmcnt(2)
L_gbc1_s1:
    ds_write_b128 v0, v[36:39] offset:5120
    ds_write_b32 v11, v13 offset:8448
    v_max3_u32 v14, v36, v37, v38
    v_max3_u32 v14, v14, v39, v13
    v_cmp_le_u32 vcc, s51, v14
    s_cbranch_vccz L_gb3_s1
    s_and_b32 s43, s49, 15
    s_cmp_lg_u32 s43, 15
    s_cbranch_scc1 L_gbn1_s1
    v_cmp_eq_u32 vcc, s51, v36
    v_cmp_eq_u32 s[44:45], s51, v37
    s_nop 0
    s_or_b64 vcc, vcc, s[44:45]
    v_cmp_eq_u32 s[44:45], s51, v38
    s_nop 0
    s_or_b64 vcc, vcc, s[44:45]
    v_cmp_eq_u32 s[44:45], s51, v39
    s_nop 0
    s_or_b64 vcc, vcc, s[44:45]
    v_cmp_eq_u32 s[44:45], s51, v13
    s_nop 0
    s_or_b64 vcc, vcc, s[44:45]
    s_cbranch_vccz L_gb3_s1
L_gbn1_s1:
    s_add_u32 s43, s40, 5120
    buffer_load_dwordx4 v[36:39], v0, s[8:11], s43 offen sc1
    s_add_u32 s43, s40, 8448
    buffer_load_dword v13, v11, s[8:11], s43 offen sc1
    s_add_u32 s49, s49, 1
    s_cmp_gt_u32 s49, 4000000
    s_cbranch_scc1 L_fail
    s_branch L_gbw0_s1
L_gb3_s1:
    s_waitcnt lgkmcnt(0)
    s_waitcnt vmcnt(0)
    s_branch L_gbr_s1
L_rw1_s1:
    s_waitcnt vmcnt(7)
    v_mfma_f32_16x16x32_bf16 v[24:27], v[20:23], v[48:51], 0
    v_bitop3_b32 v18, v48, v50, v19 bitop3:0x7e
    s_waitcnt vmcnt(6)
    v_mfma_f32_16x16x32_bf16 v[24:27], v[20:23], v[52:55], v[24:27]
    v_bitop3_b32 v16, v52, v54, v19 bitop3:0x7e
    v_or_b32 v18, v18, v16
    s_waitcnt vmcnt(5)
    v_mfma_f32_16x16x32_bf16 v[24:27], v[20:23], v[56:59], v[24:27]
    v_bitop3_b32 v16, v56, v58, v19 bitop3:0x7e
    v_or_b32 v18, v18, v16
    s_waitcnt vmcnt(4)
    v_mfma_f32_16x16x32_bf16 v[24:27], v[20:23], v[60:63], v[24:27]
    v_bitop3_b32 v16, v60, v62, v19 bitop3:0x7e
    v_or_b32 v18, v18, v16
    v_and_b32 v18, 1, v18
    v_cmp_ne_u32 vcc, 0, v18
    s_nop 3
    v_add_f32_dpp v28, v24, v24 row_ror:8 row_mask:0xf bank_mask:0xf
    v_add_f32_dpp v29, v25, v25 row_ror:8 row_mask:0xf bank_mask:0xf
    v_add_f32_dpp v30, v26, v26 row_ror:8 row_mask:0xf bank_mask:0xf
    v_add_f32_dpp v31, v27, v27 row_ror:8 row_mask:0xf bank_mask:0xf
    v_cvt_pk_bf16_f32 v28, v28, v29
    v_cvt_pk_bf16_f32 v29, v30, v31
    s_cbranch_vccz L_rp_s1
L_rn1_s1:
    buffer_load_dwordx4 v[48:51], v0, s[8:11], s43 offen offset:0 sc1
    buffer_load_dwordx4 v[52:55], v0, s[8:11], s43 offen offset:1024 sc1
    buffer_load_dwordx4 v[56:59], v0, s[8:11], s43 offen offset:2048 sc1
    buffer_load_dwordx4 v[60:63], v0, s[8:11], s43 offen offset:3072 sc1
    s_add_u32 s49, s49, 1
    s_cmp_gt_u32 s49, 4000000
    s_cbranch_scc1 L_fail
L_rw0_s1:
    s_waitcnt vmcnt(7)
    v_mfma_f32_16x16x32_bf16 v[24:27], v[20:23], v[32:35], 0
    v_bitop3_b32 v18, v32, v34, v19 bitop3:0x7e
    s_waitcnt vmcnt(6)
    v_mfma_f32_16x16x32_bf16 v[24:27], v[20:23], v[36:39], v[24:27]
    v_bitop3_b32 v16, v36, v38, v19 bitop3:0x7e
    v_or_b32 v18, v18, v16
    s_waitcnt vmcnt(5)
    v_mfma_f32_16x16x32_bf16 v[24:27], v[20:23], v[40:43], v[24:27]
    v_bitop3_b32 v16, v40, v42, v19 bitop3:0x7e
    v_or_b32 v18, v18, v16
    s_waitcnt vmcnt(4)
    v_mfma_f32_16x16x32_bf16 v[24:27], v[20:23], v[44:47], v[24:27]
    v_bitop3_b32 v16, v44, v46, v19 bitop3:0x7e
    v_or_b32 v18, v18, v16
    v_and_b32 v18, 1, v18
    v_cmp_ne_u32 vcc, 0, v18
    s_nop 3
    v_add_f32_dpp v28, v24, v24 row_ror:8 row_mask:0xf bank_mask:0xf
    v_add_f32_dpp v29, v25, v25 row_ror:8 row_mask:0xf bank_mask:0xf
    v_add_f32_dpp v30, v26, v26 row_ror:8 row_mask:0xf bank_mask:0xf
    v_add_f32_dpp v31, v27, v27 row_ror:8 row_mask:0xf bank_mask:0xf
    v_cvt_pk_bf16_f32 v28, v28, v29
    v_cvt_pk_bf16_f32 v29, v30, v31
    s_cbranch_vccz L_rp_s1
L_rn0_s1:
    buffer_load_dwordx4 v[32:35], v0, s[8:11], s43 offen offset:0 sc1
    buffer_load_dwordx4 v[36:39], v0, s[8:11], s43 offen offset:1024 sc1
    buffer_load_dwordx4 v[40:43], v0, s[8:11], s43 offen offset:2048 sc1
    buffer_load_dwordx4 v[44:47], v0, s[8:11], s43 offen offset:3072 sc1
    s_add_u32 s49, s49, 1
    s_cmp_gt_u32 s49, 4000000
    s_cbranch_scc1 L_fail
    s_branch L_rw1_s1
L_slow_s1:
    s_cmp_eq_u32 s46, 0x5105
    s_cbranch_scc1 L_pv3_s1
    s_mov_b32 s46, 0x5105
    s_nop 0
    v_mov_b32 v54, v52
    v_mov_b32 v55, v53
    s_nop 0
    v_max_f32_dpp v54, v54, v54 row_ror:1 row_mask:0xf bank_mask:0xf
    v_max_f32_dpp v55, v55, v55 row_ror:1 row_mask:0xf bank_mask:0xf
    s_nop 0
    v_max_f32_dpp v54, v54, v54 row_ror:2 row_mask:0xf bank_mask:0xf
    v_max_f32_dpp v55, v55, v55 row_ror:2 row_mask:0xf bank_mask:0xf
    s_nop 0
    v_max_f32_dpp v54, v54, v54 row_ror:4 row_mask:0xf bank_mask:0xf
    v_max_f32_dpp v55, v55, v55 row_ror:4 row_mask:0xf bank_mask:0xf
    s_nop 0
    v_max_f32_dpp v54, v54, v54 row_ror:8 row_mask:0xf bank_mask:0xf
    v_max_f32_dpp v55, v55, v55 row_ror:8 row_mask:0xf bank_mask:0xf
    v_and_b32 v35, 15, v11
    v_lshlrev_b32 v35, 1, v35
    ds_write_b64 v35, v[54:55] offset:16288
    s_waitcnt lgkmcnt(0)
    s_barrier
    ds_read_b64 v[16:17], v35 offset:16256
    ds_read_b64 v[18:19], v35 offset:16288
    ds_read_b64 v[20:21], v35 offset:16320
    s_waitcnt lgkmcnt(0)
    v_max3_f32 v54, v16, v18, v20
    v_max3_f32 v55, v17, v19, v21
    v_sub_f32 v54, v52, v54
    v_sub_f32 v55, v53, v55
    v_exp_f32 v54, v54
    v_exp_f32 v55, v55
    s_nop 0
    v_cvt_pk_bf16_f32 v54, v54, v55
    ds_write_b32 v11, v54 offset:15616
    s_waitcnt lgkmcnt(0)
    s_barrier
    s_branch L_pv_s1
L_pv2_s1:
    ds_read_b128 v[24:27], v0 offset:26624
    ds_read_b128 v[28:31], v0 offset:27648
    s_waitcnt lgkmcnt(0)
    v_mov_b32 v56, 0x3f803f80
    v_mov_b32 v57, 0x3f803f80
    v_mov_b32 v58, 0x3f803f80
    v_mov_b32 v59, 0x3f803f80
    s_nop 1
    v_mfma_f32_16x16x32_bf16 v[36:39], v[56:59], v[48:51], 0
    v_mfma_f32_16x16x32_bf16 v[16:19], v[24:27], v[48:51], 0
    v_mfma_f32_16x16x32_bf16 v[20:23], v[28:31], v[48:51], 0
    v_mfma_f32_16x16x16_bf16 v[36:39], v[32:33], v[54:55], v[36:39]
    v_mfma_f32_16x16x16_bf16 v[16:19], v[40:41], v[54:55], v[16:19]
    v_mfma_f32_16x16x16_bf16 v[20:23], v[44:45], v[54:55], v[20:23]
    s_nop 7
    s_branch L_pv4_s1
L_tail_s1:
    s_waitcnt lgkmcnt(0)
    v_smfmac_f32_16x16x64_bf16 v[44:47], v[60:63], a[120:127], v10
    ds_read_b128 v[16:19], v1 offset:16384
    ds_read_b128 v[20:23], v1 offset:17408
    v_smfmac_f32_16x16x64_bf16 v[40:43], v[48:51], a[128:135], v10
    ds_read_b128 v[24:27], v1 offset:18432
    ds_read_b128 v[28:31], v1 offset:19456
    v_smfmac_f32_16x16x64_bf16 v[44:47], v[48:51], a[136:143], v10
    ds_read_b64_tr_b16 v[60:61], v2 offset:0
    ds_read_b64_tr_b16 v[62:63], v3 offset:0
    v_smfmac_f32_16x16x64_bf16 v[40:43], v[56:59], a[32:39], v10
    ds_read_b64_tr_b16 v[48:49], v2 offset:2048
    ds_read_b64_tr_b16 v[50:51], v3 offset:2048
    v_smfmac_f32_16x16x64_bf16 v[44:47], v[56:59], a[40:47], v10
    ds_read_b64_tr_b16 v[56:57], v2 offset:3072
    ds_read_b64_tr_b16 v[58:59], v3 offset:3072
    s_waitcnt lgkmcnt(4)
    v_smfmac_f32_16x16x64_bf16 v[40:43], v[60:63], a[48:55], v10
    v_smfmac_f32_16x16x64_bf16 v[44:47], v[60:63], a[56:63], v10
    ds_read_b64_tr_b16 v[60:61], v2 offset:5120
    ds_read_b64_tr_b16 v[62:63], v3 offset:5120
    s_waitcnt lgkmcnt(4)
    v_smfmac_f32_16x16x64_bf16 v[40:43], v[48:51], v[16:23], v10
    v_smfmac_f32_16x16x64_bf16 v[44:47], v[48:51], v[24:31], v10
    s_waitcnt lgkmcnt(2)
    v_smfmac_f32_16x16x64_bf16 v[40:43], v[56:59], a[64:71], v10
    v_smfmac_f32_16x16x64_bf16 v[44:47], v[56:59], a[72:79], v10
    s_waitcnt lgkmcnt(0)
    v_smfmac_f32_16x16x64_bf16 v[40:43], v[60:63], a[80:87], v10
    v_smfmac_f32_16x16x64_bf16 v[44:47], v[60:63], a[88:95], v10
    s_nop 3
    v_add_f32 v40, v40, v42
    v_add_f32 v41, v41, v43
    v_cvt_pk_bf16_f32 v40, v40, v41
    s_nop 0
    v_add_f32 v44, v44, v46
    v_add_f32 v45, v45, v47
    v_cvt_pk_bf16_f32 v44, v44, v45
    ds_write_b32 v11, v40 offset:9728
    ds_write_b32 v11, v44 offset:9984
    s_waitcnt vmcnt(0)
    v_and_b32 v12, 0x200, v0
    v_mul_u32_u24 v12, 3, v12
    v_add_u32 v12, v12, v0
    ds_read_b128 v[12:15], v12 offset:9728
    s_waitcnt lgkmcnt(0)
    s_lshr_b32 s44, s48, 1
    s_add_u32 s44, s44, 0x4100400
    buffer_store_dwordx4 v[12:15], v0, s[8:11], s44 offen sc1
    s_waitcnt vmcnt(0)
    s_barrier
    s_branch L_end
L_cw2:
    v_and_b32 v24, 1, v18
    v_lshlrev_b32 v24, 1, v24
    v_xor_b32 v24, v24, v19
    v_xor_b32 v24, 0, v24
    v_lshlrev_b32 v25, 13, v18
    v_lshl_add_u32 v48, v24, 4, v25
    v_xor_b32 v24, 4, v24
    v_lshl_add_u32 v49, v24, 4, v25
    v_mul_u32_u24 v25, 1152, v18
    v_lshl_add_u32 v51, v24, 4, v25
    v_xor_b32 v24, 4, v24
    v_lshl_add_u32 v50, v24, 4, v25
    v_lshrrev_b32 v24, 3, v17
    v_mul_u32_u24 v24, 1152, v24
    v_and_b32 v25, 7, v17
    v_lshl_add_u32 v52, v25, 4, v24
    v_lshrrev_b32 v24, 1, v22
    v_and_b32 v25, 1, v22
    v_lshlrev_b32 v26, 15, v24
    v_lshl_add_u32 v26, v18, 10, v26
    v_lshl_add_u32 v26, v25, 8, v26
    v_lshl_add_u32 v26, v23, 3, v26
    v_add_u32 v26, 32768, v26
    v_lshl_add_u32 v27, v21, 1, v25
    v_lshl_add_u32 v27, v24, 2, v27
    v_xor_b32 v28, 4, v27
    v_lshl_add_u32 v53, v28, 5, v26
    v_add_u32 v55, 65536, v53
    v_xor_b32 v28, 5, v27
    v_lshl_add_u32 v54, v28, 5, v26
    v_add_u32 v56, 65536, v54
    v_lshlrev_b32 v26, 15, v21
    v_lshl_add_u32 v26, v20, 10, v26
    v_lshl_add_u32 v26, v25, 8, v26
    v_lshl_add_u32 v26, v23, 3, v26
    v_add_u32 v26, 32768, v26
    v_lshl_add_u32 v27, v20, 1, v25
    v_lshl_add_u32 v27, v21, 2, v27
    v_add_u32 v28, 4, v24
    v_xor_b32 v28, v28, v27
    v_lshl_add_u32 v57, v28, 5, v26
    v_add_u32 v58, 65536, v57
    v_lshlrev_b32 v26, 15, v24
    v_lshl_add_u32 v26, v21, 11, v26
    v_lshl_add_u32 v26, v20, 9, v26
    v_lshl_add_u32 v26, v25, 7, v26
    v_lshl_add_u32 v26, v23, 3, v26
    v_add_u32 v61, 32832, v26
    v_add_u32 v62, 65536, v61
    s_lshl_b32 s45, s36, 8
    s_mul_i32 s46, s36, 147456
    v_lshlrev_b32 v28, 1, v17
    v_lshlrev_b32 v29, 9, v20
    v_lshlrev_b32 v30, 3, v19
    v_add_u32 v29, v29, v30
    v_lshlrev_b32 v30, 2, v21
    v_add_u32 v29, v29, v30
    v_xor_b32 v29, 32, v29
    s_mov_b32 s43, 4608
    buffer_load_ushort v32, v28, s[32:35], s43 offen offset:0
    buffer_load_ushort v33, v28, s[32:35], s43 offen offset:128
    buffer_load_ushort v34, v28, s[32:35], s43 offen offset:256
    buffer_load_ushort v35, v28, s[32:35], s43 offen offset:384
    buffer_load_ushort v36, v28, s[32:35], s43 offen offset:512
    buffer_load_ushort v37, v28, s[32:35], s43 offen offset:640
    buffer_load_ushort v38, v28, s[32:35], s43 offen offset:768
    buffer_load_ushort v39, v28, s[32:35], s43 offen offset:896
    buffer_load_ushort v40, v28, s[32:35], s43 offen offset:1024
    s_mov_b32 s43, 5760
    buffer_load_ushort v41, v28, s[32:35], s43 offen offset:0
    buffer_load_ushort v42, v28, s[32:35], s43 offen offset:128
    buffer_load_ushort v43, v28, s[32:35], s43 offen offset:256
    buffer_load_ushort v44, v28, s[32:35], s43 offen offset:384
    buffer_load_ushort v45, v28, s[32:35], s43 offen offset:512
    buffer_load_ushort v46, v28, s[32:35], s43 offen offset:640
    buffer_load_ushort v47, v28, s[32:35], s43 offen offset:768
    buffer_load_ushort v12, v28, s[32:35], s43 offen offset:896
    buffer_load_ushort v13, v28, s[32:35], s43 offen offset:1024
    v_mov_b32 v63, v29
    s_waitcnt lgkmcnt(0)
    s_mov_b32 s38, 0
    s_mov_b32 s39, 0
    s_mov_b32 s40, 1048576
    s_mov_b32 s41, 1064960
    s_mov_b32 s42, 1081344
    s_lshl_b32 s48, s36, 13
    s_mov_b32 s94, 0xffbfffbf
    s_mov_b32 s96, 0x3f803f80
    s_mov_b32 s100, 0xcccccccc
    s_mov_b32 s101, 0xcccccccc
    s_mov_b32 s97, 0x3f803f80
    s_mov_b32 s98, 0x3f803f80
    s_mov_b32 s99, 0
    s_mov_b32 s95, 0xffbfffbf
    s_mov_b32 s54, 294912
    s_mov_b32 s92, 0
    s_mov_b32 s93, 1097728
    s_waitcnt vmcnt(46)
    s_barrier
    ds_read_b64_tr_b16 v[64:65], v53 offset:16384
    ds_read_b64_tr_b16 v[66:67], v53 offset:16896
    ds_read_b64_tr_b16 v[68:69], v55 offset:16384
    ds_read_b64_tr_b16 v[70:71], v55 offset:16896
    ds_read_b64_tr_b16 v[72:73], v54 offset:16384
    ds_read_b64_tr_b16 v[74:75], v54 offset:16896
    ds_read_b64_tr_b16 v[76:77], v56 offset:16384
    ds_read_b64_tr_b16 v[78:79], v56 offset:16896
    s_waitcnt lgkmcnt(0)
    s_waitcnt vmcnt(42)
    s_barrier
    s_mov_b32 m0, 0x1c000
    s_add_u32 s43, s45, 0x440000
    buffer_load_dwordx4 v48, s[16:19], s43 offen lds
    s_mov_b32 m0, 0x1c400
    s_add_u32 s43, s45, 0x448000
    buffer_load_dwordx4 v49, s[16:19], s43 offen lds
    s_mov_b32 m0, 0x1c800
    s_add_u32 s43, s45, 0x450000
    buffer_load_dwordx4 v48, s[16:19], s43 offen lds
    s_mov_b32 m0, 0x1cc00
    s_add_u32 s43, s45, 0x458000
    buffer_load_dwordx4 v49, s[16:19], s43 offen lds
    ds_read_b64_tr_b16 v[80:81], v53 offset:20480
    ds_read_b64_tr_b16 v[82:83], v53 offset:20992
    ds_read_b64_tr_b16 v[84:85], v55 offset:20480
    ds_read_b64_tr_b16 v[86:87], v55 offset:20992
    ds_read_b64_tr_b16 v[88:89], v54 offset:20480
    ds_read_b64_tr_b16 v[90:91], v54 offset:20992
    ds_read_b64_tr_b16 v[92:93], v56 offset:20480
    ds_read_b64_tr_b16 v[94:95], v56 offset:20992
    s_waitcnt lgkmcnt(0)
    s_getreg_b32 s43, hwreg(HW_REG_XCC_ID)
    s_and_b32 s43, s43, 7
    s_lshl_b32 s43, s43, 3
    s_lshl_b64 s[70:71], 1, s43
    v_mov_b32 v28, s70
    v_mov_b32 v29, s71
    v_mov_b32 v30, 0
    s_mov_b64 exec, 1
    buffer_atomic_add_x2 v[28:29], v30, s[12:15], 0 offen
    s_mov_b64 exec, -1
    s_waitcnt vmcnt(43)
    s_barrier
    s_mov_b32 m0, 0x1d000
    s_add_u32 s43, s45, 0x40000
    buffer_load_dwordx4 v48, s[20:23], s43 offen lds
    s_mov_b32 m0, 0x1d400
    s_add_u32 s43, s45, 0x48000
    buffer_load_dwordx4 v49, s[20:23], s43 offen lds
    s_mov_b32 m0, 0x1d800
    s_add_u32 s43, s45, 0x50000
    buffer_load_dwordx4 v48, s[20:23], s43 offen lds
    s_mov_b32 m0, 0x1dc00
    s_add_u32 s43, s45, 0x58000
    buffer_load_dwordx4 v49, s[20:23], s43 offen lds
    ds_read_b64_tr_b16 a[144:145], v53 offset:24576
    ds_read_b64_tr_b16 a[146:147], v53 offset:25088
    ds_read_b64_tr_b16 a[148:149], v55 offset:24576
    ds_read_b64_tr_b16 a[150:151], v55 offset:25088
    ds_read_b64_tr_b16 a[152:153], v54 offset:24576
    ds_read_b64_tr_b16 a[154:155], v54 offset:25088
    ds_read_b64_tr_b16 a[156:157], v56 offset:24576
    ds_read_b64_tr_b16 a[158:159], v56 offset:25088
    s_waitcnt lgkmcnt(0)
    s_waitcnt vmcnt(43)
    s_barrier
    s_mov_b32 m0, 0x1e000
    s_add_u32 s43, s45, 0xc0000
    buffer_load_dwordx4 v48, s[20:23], s43 offen lds
    s_mov_b32 m0, 0x1e400
    s_add_u32 s43, s45, 0xc8000
    buffer_load_dwordx4 v49, s[20:23], s43 offen lds
    s_mov_b32 m0, 0x1e800
    s_add_u32 s43, s45, 0xd0000
    buffer_load_dwordx4 v48, s[20:23], s43 offen lds
    s_mov_b32 m0, 0x1ec00
    s_add_u32 s43, s45, 0xd8000
    buffer_load_dwordx4 v49, s[20:23], s43 offen lds
    ds_read_b64_tr_b16 v[96:97], v53 offset:28672
    ds_read_b64_tr_b16 v[98:99], v53 offset:29184
    ds_read_b64_tr_b16 v[100:101], v55 offset:28672
    ds_read_b64_tr_b16 v[102:103], v55 offset:29184
    ds_read_b64_tr_b16 v[104:105], v54 offset:28672
    ds_read_b64_tr_b16 v[106:107], v54 offset:29184
    ds_read_b64_tr_b16 v[108:109], v56 offset:28672
    ds_read_b64_tr_b16 v[110:111], v56 offset:29184
    s_waitcnt lgkmcnt(0)
    s_waitcnt vmcnt(43)
    s_barrier
    s_mov_b32 m0, 0x1f000
    s_add_u32 s43, s45, 0x140000
    buffer_load_dwordx4 v48, s[20:23], s43 offen lds
    s_mov_b32 m0, 0x1f400
    s_add_u32 s43, s45, 0x148000
    buffer_load_dwordx4 v49, s[20:23], s43 offen lds
    s_mov_b32 m0, 0x1f800
    s_add_u32 s43, s45, 0x150000
    buffer_load_dwordx4 v48, s[20:23], s43 offen lds
    s_mov_b32 m0, 0x1fc00
    s_add_u32 s43, s45, 0x158000
    buffer_load_dwordx4 v49, s[20:23], s43 offen lds
    ds_read_b64_tr_b16 a[160:161], v53 offset:0
    ds_read_b64_tr_b16 a[162:163], v53 offset:512
    ds_read_b64_tr_b16 a[164:165], v55 offset:0
    ds_read_b64_tr_b16 a[166:167], v55 offset:512
    ds_read_b64_tr_b16 a[168:169], v54 offset:0
    ds_read_b64_tr_b16 a[170:171], v54 offset:512
    ds_read_b64_tr_b16 a[172:173], v56 offset:0
    ds_read_b64_tr_b16 a[174:175], v56 offset:512
    s_waitcnt lgkmcnt(0)
    s_waitcnt vmcnt(43)
    s_barrier
    s_mov_b32 m0, 0x18000
    s_add_u32 s43, s45, 0x1c0000
    buffer_load_dwordx4 v48, s[20:23], s43 offen lds
    s_mov_b32 m0, 0x18400
    s_add_u32 s43, s45, 0x1c8000
    buffer_load_dwordx4 v49, s[20:23], s43 offen lds
    s_mov_b32 m0, 0x18800
    s_add_u32 s43, s45, 0x1d0000
    buffer_load_dwordx4 v48, s[20:23], s43 offen lds
    s_mov_b32 m0, 0x18c00
    s_add_u32 s43, s45, 0x1d8000
    buffer_load_dwordx4 v49, s[20:23], s43 offen lds
    ds_read_b64_tr_b16 v[128:129], v53 offset:4096
    ds_read_b64_tr_b16 v[130:131], v53 offset:4608
    ds_read_b64_tr_b16 v[132:133], v55 offset:4096
    ds_read_b64_tr_b16 v[134:135], v55 offset:4608
    ds_read_b64_tr_b16 v[136:137], v54 offset:4096
    ds_read_b64_tr_b16 v[138:139], v54 offset:4608
    ds_read_b64_tr_b16 v[140:141], v56 offset:4096
    ds_read_b64_tr_b16 v[142:143], v56 offset:4608
    s_waitcnt lgkmcnt(0)
    s_waitcnt vmcnt(43)
    s_barrier
    s_mov_b32 m0, 0x19000
    s_add_u32 s43, s45, 0x240000
    buffer_load_dwordx4 v48, s[20:23], s43 offen lds
    s_mov_b32 m0, 0x19400
    s_add_u32 s43, s45, 0x248000
    buffer_load_dwordx4 v49, s[20:23], s43 offen lds
    s_mov_b32 m0, 0x19800
    s_add_u32 s43, s45, 0x250000
    buffer_load_dwordx4 v48, s[20:23], s43 offen lds
    s_mov_b32 m0, 0x19c00
    s_add_u32 s43, s45, 0x258000
    buffer_load_dwordx4 v49, s[20:23], s43 offen lds
    ds_read_b64_tr_b16 v[112:113], v53 offset:8192
    ds_read_b64_tr_b16 v[114:115], v53 offset:8704
    ds_read_b64_tr_b16 v[116:117], v55 offset:8192
    ds_read_b64_tr_b16 v[118:119], v55 offset:8704
    ds_read_b64_tr_b16 v[120:121], v54 offset:8192
    ds_read_b64_tr_b16 v[122:123], v54 offset:8704
    ds_read_b64_tr_b16 v[124:125], v56 offset:8192
    ds_read_b64_tr_b16 v[126:127], v56 offset:8704
    s_waitcnt lgkmcnt(0)
    s_waitcnt vmcnt(43)
    s_barrier
    s_mov_b32 m0, 0x1a000
    s_add_u32 s43, s45, 0x2c0000
    buffer_load_dwordx4 v48, s[20:23], s43 offen lds
    s_mov_b32 m0, 0x1a400
    s_add_u32 s43, s45, 0x2c8000
    buffer_load_dwordx4 v49, s[20:23], s43 offen lds
    s_mov_b32 m0, 0x1a800
    s_add_u32 s43, s45, 0x2d0000
    buffer_load_dwordx4 v48, s[20:23], s43 offen lds
    s_mov_b32 m0, 0x1ac00
    s_add_u32 s43, s45, 0x2d8000
    buffer_load_dwordx4 v49, s[20:23], s43 offen lds
    ds_read_b64_tr_b16 v[144:145], v53 offset:12288
    ds_read_b64_tr_b16 v[146:147], v53 offset:12800
    ds_read_b64_tr_b16 v[148:149], v55 offset:12288
    ds_read_b64_tr_b16 v[150:151], v55 offset:12800
    ds_read_b64_tr_b16 v[152:153], v54 offset:12288
    ds_read_b64_tr_b16 v[154:155], v54 offset:12800
    ds_read_b64_tr_b16 v[156:157], v56 offset:12288
    ds_read_b64_tr_b16 v[158:159], v56 offset:12800
    s_waitcnt lgkmcnt(0)
    s_waitcnt vmcnt(25)
    s_barrier
    s_mov_b32 m0, 0x1b000
    s_add_u32 s43, s45, 0x340000
    buffer_load_dwordx4 v48, s[20:23], s43 offen lds
    s_mov_b32 m0, 0x1b400
    s_add_u32 s43, s45, 0x348000
    buffer_load_dwordx4 v49, s[20:23], s43 offen lds
    s_mov_b32 m0, 0x1b800
    s_add_u32 s43, s45, 0x350000
    buffer_load_dwordx4 v48, s[20:23], s43 offen lds
    s_mov_b32 m0, 0x1bc00
    s_add_u32 s43, s45, 0x358000
    buffer_load_dwordx4 v49, s[20:23], s43 offen lds
    ds_read_b64_tr_b16 v[160:161], v53 offset:16384
    ds_read_b64_tr_b16 v[162:163], v53 offset:16896
    ds_read_b64_tr_b16 v[164:165], v55 offset:16384
    ds_read_b64_tr_b16 v[166:167], v55 offset:16896
    ds_read_b64_tr_b16 v[168:169], v54 offset:16384
    ds_read_b64_tr_b16 v[170:171], v54 offset:16896
    ds_read_b64_tr_b16 v[172:173], v56 offset:16384
    ds_read_b64_tr_b16 v[174:175], v56 offset:16896
    s_waitcnt lgkmcnt(0)
    v_mov_b32 v30, 0
    buffer_load_dword v26, v30, s[12:15], 0 offen offset:12 sc1
    s_waitcnt vmcnt(25)
    s_barrier
    s_mov_b32 m0, 0x1c000
    s_add_u32 s43, s45, 0x3c0000
    buffer_load_dwordx4 v48, s[20:23], s43 offen lds
    s_mov_b32 m0, 0x1c400
    s_add_u32 s43, s45, 0x3c8000
    buffer_load_dwordx4 v49, s[20:23], s43 offen lds
    s_mov_b32 m0, 0x1c800
    s_add_u32 s43, s45, 0x3d0000
    buffer_load_dwordx4 v48, s[20:23], s43 offen lds
    s_mov_b32 m0, 0x1cc00
    s_add_u32 s43, s45, 0x3d8000
    buffer_load_dwordx4 v49, s[20:23], s43 offen lds
    ds_read_b64_tr_b16 v[192:193], v53 offset:20480
    ds_read_b64_tr_b16 v[194:195], v53 offset:20992
    ds_read_b64_tr_b16 v[196:197], v55 offset:20480
    ds_read_b64_tr_b16 v[198:199], v55 offset:20992
    ds_read_b64_tr_b16 v[200:201], v54 offset:20480
    ds_read_b64_tr_b16 v[202:203], v54 offset:20992
    ds_read_b64_tr_b16 v[204:205], v56 offset:20480
    ds_read_b64_tr_b16 v[206:207], v56 offset:20992
    s_waitcnt lgkmcnt(0)
    ds_write_b16 v63, v32 offset:256
    ds_write_b16 v63, v33 offset:1280
    ds_write_b16 v63, v34 offset:2304
    ds_write_b16 v63, v35 offset:3328
    ds_write_b16 v63, v36 offset:4352
    ds_write_b16 v63, v37 offset:5376
    ds_write_b16 v63, v38 offset:6400
    ds_write_b16 v63, v39 offset:7424
    ds_write_b16 v63, v40 offset:8448
    ds_write_b16 v63, v41 offset:258
    ds_write_b16 v63, v42 offset:1282
    ds_write_b16 v63, v43 offset:2306
    ds_write_b16 v63, v44 offset:3330
    ds_write_b16 v63, v45 offset:4354
    ds_write_b16 v63, v46 offset:5378
    ds_write_b16 v63, v47 offset:6402
    ds_write_b16 v63, v12 offset:7426
    ds_write_b16 v63, v13 offset:8450
    s_waitcnt vmcnt(25)
    s_barrier
    s_mov_b32 m0, 0x1d000
    s_add_u32 s43, s45, 0x440000
    buffer_load_dwordx4 v48, s[20:23], s43 offen lds
    s_mov_b32 m0, 0x1d400
    s_add_u32 s43, s45, 0x448000
    buffer_load_dwordx4 v49, s[20:23], s43 offen lds
    s_mov_b32 m0, 0x1d800
    s_add_u32 s43, s45, 0x450000
    buffer_load_dwordx4 v48, s[20:23], s43 offen lds
    s_mov_b32 m0, 0x1dc00
    s_add_u32 s43, s45, 0x458000
    buffer_load_dwordx4 v49, s[20:23], s43 offen lds
    ds_read_b64_tr_b16 v[208:209], v53 offset:24576
    ds_read_b64_tr_b16 v[210:211], v53 offset:25088
    ds_read_b64_tr_b16 v[212:213], v55 offset:24576
    ds_read_b64_tr_b16 v[214:215], v55 offset:25088
    ds_read_b64_tr_b16 v[216:217], v54 offset:24576
    ds_read_b64_tr_b16 v[218:219], v54 offset:25088
    ds_read_b64_tr_b16 v[220:221], v56 offset:24576
    ds_read_b64_tr_b16 v[222:223], v56 offset:25088
    s_waitcnt lgkmcnt(0)
    s_waitcnt vmcnt(25)
    s_barrier
    s_mov_b32 m0, 0x1e000
    s_add_u32 s43, s45, 0x40000
    buffer_load_dwordx4 v48, s[24:27], s43 offen lds
    s_mov_b32 m0, 0x1e400
    s_add_u32 s43, s45, 0x48000
    buffer_load_dwordx4 v49, s[24:27], s43 offen lds
    s_mov_b32 m0, 0x1e800
    s_add_u32 s43, s45, 0x50000
    buffer_load_dwordx4 v48, s[24:27], s43 offen lds
    s_mov_b32 m0, 0x1ec00
    s_add_u32 s43, s45, 0x58000
    buffer_load_dwordx4 v49, s[24:27], s43 offen lds
    ds_read_b64_tr_b16 v[176:177], v53 offset:28672
    ds_read_b64_tr_b16 v[178:179], v53 offset:29184
    ds_read_b64_tr_b16 v[180:181], v55 offset:28672
    ds_read_b64_tr_b16 v[182:183], v55 offset:29184
    ds_read_b64_tr_b16 v[184:185], v54 offset:28672
    ds_read_b64_tr_b16 v[186:187], v54 offset:29184
    ds_read_b64_tr_b16 v[188:189], v56 offset:28672
    ds_read_b64_tr_b16 v[190:191], v56 offset:29184
    s_waitcnt lgkmcnt(0)
    s_waitcnt vmcnt(25)
    s_barrier
    s_mov_b32 m0, 0x1f000
    s_add_u32 s43, s45, 0xc0000
    buffer_load_dwordx4 v48, s[24:27], s43 offen lds
    s_mov_b32 m0, 0x1f400
    s_add_u32 s43, s45, 0xc8000
    buffer_load_dwordx4 v49, s[24:27], s43 offen lds
    s_mov_b32 m0, 0x1f800
    s_add_u32 s43, s45, 0xd0000
    buffer_load_dwordx4 v48, s[24:27], s43 offen lds
    s_mov_b32 m0, 0x1fc00
    s_add_u32 s43, s45, 0xd8000
    buffer_load_dwordx4 v49, s[24:27], s43 offen lds
    ds_read_b64_tr_b16 a[176:177], v53 offset:0
    ds_read_b64_tr_b16 a[178:179], v53 offset:512
    ds_read_b64_tr_b16 a[180:181], v55 offset:0
    ds_read_b64_tr_b16 a[182:183], v55 offset:512
    ds_read_b64_tr_b16 a[184:185], v54 offset:0
    ds_read_b64_tr_b16 a[186:187], v54 offset:512
    ds_read_b64_tr_b16 a[188:189], v56 offset:0
    ds_read_b64_tr_b16 a[190:191], v56 offset:512
    s_waitcnt lgkmcnt(0)
    s_waitcnt vmcnt(25)
    s_barrier
    s_mov_b32 m0, 0x18000
    s_add_u32 s43, s45, 0x140000
    buffer_load_dwordx4 v48, s[24:27], s43 offen lds
    s_mov_b32 m0, 0x18400
    s_add_u32 s43, s45, 0x148000
    buffer_load_dwordx4 v49, s[24:27], s43 offen lds
    s_mov_b32 m0, 0x18800
    s_add_u32 s43, s45, 0x150000
    buffer_load_dwordx4 v48, s[24:27], s43 offen lds
    s_mov_b32 m0, 0x18c00
    s_add_u32 s43, s45, 0x158000
    buffer_load_dwordx4 v49, s[24:27], s43 offen lds
    ds_read_b64_tr_b16 v[240:241], v53 offset:4096
    ds_read_b64_tr_b16 v[242:243], v53 offset:4608
    ds_read_b64_tr_b16 v[244:245], v55 offset:4096
    ds_read_b64_tr_b16 v[246:247], v55 offset:4608
    ds_read_b64_tr_b16 v[248:249], v54 offset:4096
    ds_read_b64_tr_b16 v[250:251], v54 offset:4608
    ds_read_b64_tr_b16 v[252:253], v56 offset:4096
    ds_read_b64_tr_b16 v[254:255], v56 offset:4608
    s_waitcnt lgkmcnt(0)
    s_waitcnt vmcnt(25)
    s_barrier
    s_mov_b32 m0, 0x19000
    s_add_u32 s43, s45, 0x1c0000
    buffer_load_dwordx4 v48, s[24:27], s43 offen lds
    s_mov_b32 m0, 0x19400
    s_add_u32 s43, s45, 0x1c8000
    buffer_load_dwordx4 v49, s[24:27], s43 offen lds
    s_mov_b32 m0, 0x19800
    s_add_u32 s43, s45, 0x1d0000
    buffer_load_dwordx4 v48, s[24:27], s43 offen lds
    s_mov_b32 m0, 0x19c00
    s_add_u32 s43, s45, 0x1d8000
    buffer_load_dwordx4 v49, s[24:27], s43 offen lds
    ds_read_b64_tr_b16 a[192:193], v53 offset:8192
    ds_read_b64_tr_b16 a[194:195], v53 offset:8704
    ds_read_b64_tr_b16 a[196:197], v55 offset:8192
    ds_read_b64_tr_b16 a[198:199], v55 offset:8704
    ds_read_b64_tr_b16 a[200:201], v54 offset:8192
    ds_read_b64_tr_b16 a[202:203], v54 offset:8704
    ds_read_b64_tr_b16 a[204:205], v56 offset:8192
    ds_read_b64_tr_b16 a[206:207], v56 offset:8704
    s_waitcnt lgkmcnt(0)
    s_waitcnt vmcnt(25)
    s_barrier
    s_mov_b32 m0, 0x1a000
    s_add_u32 s43, s45, 0x240000
    buffer_load_dwordx4 v48, s[24:27], s43 offen lds
    s_mov_b32 m0, 0x1a400
    s_add_u32 s43, s45, 0x248000
    buffer_load_dwordx4 v49, s[24:27], s43 offen lds
    s_mov_b32 m0, 0x1a800
    s_add_u32 s43, s45, 0x250000
    buffer_load_dwordx4 v48, s[24:27], s43 offen lds
    s_mov_b32 m0, 0x1ac00
    s_add_u32 s43, s45, 0x258000
    buffer_load_dwordx4 v49, s[24:27], s43 offen lds
    ds_read_b64_tr_b16 v[224:225], v53 offset:12288
    ds_read_b64_tr_b16 v[226:227], v53 offset:12800
    ds_read_b64_tr_b16 v[228:229], v55 offset:12288
    ds_read_b64_tr_b16 v[230:231], v55 offset:12800
    ds_read_b64_tr_b16 v[232:233], v54 offset:12288
    ds_read_b64_tr_b16 v[234:235], v54 offset:12800
    ds_read_b64_tr_b16 v[236:237], v56 offset:12288
    ds_read_b64_tr_b16 v[238:239], v56 offset:12800
    s_waitcnt lgkmcnt(0)
    s_waitcnt vmcnt(24)
    s_barrier
    s_mov_b32 m0, 0x1b000
    s_add_u32 s43, s45, 0x2c0000
    buffer_load_dwordx4 v48, s[24:27], s43 offen lds
    s_mov_b32 m0, 0x1b400
    s_add_u32 s43, s45, 0x2c8000
    buffer_load_dwordx4 v49, s[24:27], s43 offen lds
    s_mov_b32 m0, 0x1b800
    s_add_u32 s43, s45, 0x2d0000
    buffer_load_dwordx4 v48, s[24:27], s43 offen lds
    s_mov_b32 m0, 0x1bc00
    s_add_u32 s43, s45, 0x2d8000
    buffer_load_dwordx4 v49, s[24:27], s43 offen lds
    ds_read_b64_tr_b16 a[0:1], v53 offset:16384
    ds_read_b64_tr_b16 a[2:3], v53 offset:16896
    ds_read_b64_tr_b16 a[4:5], v55 offset:16384
    ds_read_b64_tr_b16 a[6:7], v55 offset:16896
    ds_read_b64_tr_b16 a[8:9], v54 offset:16384
    ds_read_b64_tr_b16 a[10:11], v54 offset:16896
    ds_read_b64_tr_b16 a[12:13], v56 offset:16384
    ds_read_b64_tr_b16 a[14:15], v56 offset:16896
    s_waitcnt lgkmcnt(0)
    s_waitcnt vmcnt(24)
    s_barrier
    s_mov_b32 m0, 0x1c000
    s_add_u32 s43, s45, 0x340000
    buffer_load_dwordx4 v48, s[24:27], s43 offen lds
    s_mov_b32 m0, 0x1c400
    s_add_u32 s43, s45, 0x348000
    buffer_load_dwordx4 v49, s[24:27], s43 offen lds
    s_mov_b32 m0, 0x1c800
    s_add_u32 s43, s45, 0x350000
    buffer_load_dwordx4 v48, s[24:27], s43 offen lds
    s_mov_b32 m0, 0x1cc00
    s_add_u32 s43, s45, 0x358000
    buffer_load_dwordx4 v49, s[24:27], s43 offen lds
    ds_read_b64_tr_b16 a[16:17], v53 offset:20480
    ds_read_b64_tr_b16 a[18:19], v53 offset:20992
    ds_read_b64_tr_b16 a[20:21], v55 offset:20480
    ds_read_b64_tr_b16 a[22:23], v55 offset:20992
    ds_read_b64_tr_b16 a[24:25], v54 offset:20480
    ds_read_b64_tr_b16 a[26:27], v54 offset:20992
    ds_read_b64_tr_b16 a[28:29], v56 offset:20480
    ds_read_b64_tr_b16 a[30:31], v56 offset:20992
    s_waitcnt lgkmcnt(0)
    s_waitcnt vmcnt(24)
    s_barrier
    s_mov_b32 m0, 0x1d000
    s_add_u32 s43, s45, 0x3c0000
    buffer_load_dwordx4 v48, s[24:27], s43 offen lds
    s_mov_b32 m0, 0x1d400
    s_add_u32 s43, s45, 0x3c8000
    buffer_load_dwordx4 v49, s[24:27], s43 offen lds
    s_mov_b32 m0, 0x1d800
    s_add_u32 s43, s45, 0x3d0000
    buffer_load_dwordx4 v48, s[24:27], s43 offen lds
    s_mov_b32 m0, 0x1dc00
    s_add_u32 s43, s45, 0x3d8000
    buffer_load_dwordx4 v49, s[24:27], s43 offen lds
    ds_read_b64_tr_b16 a[48:49], v53 offset:24576
    ds_read_b64_tr_b16 a[50:51], v53 offset:25088
    ds_read_b64_tr_b16 a[52:53], v55 offset:24576
    ds_read_b64_tr_b16 a[54:55], v55 offset:25088
    ds_read_b64_tr_b16 a[56:57], v54 offset:24576
    ds_read_b64_tr_b16 a[58:59], v54 offset:25088
    ds_read_b64_tr_b16 a[60:61], v56 offset:24576
    ds_read_b64_tr_b16 a[62:63], v56 offset:25088
    s_waitcnt lgkmcnt(0)
    s_waitcnt vmcnt(24)
    s_barrier
    s_mov_b32 m0, 0x1e000
    s_add_u32 s43, s46, 0x9000
    buffer_load_dwordx4 v50, s[28:31], s43 offen lds
    s_mov_b32 m0, 0x1e400
    s_add_u32 s43, s46, 0xa200
    buffer_load_dwordx4 v51, s[28:31], s43 offen lds
    s_mov_b32 m0, 0x1e800
    s_add_u32 s43, s46, 0xb400
    buffer_load_dwordx4 v50, s[28:31], s43 offen lds
    s_mov_b32 m0, 0x1ec00
    s_add_u32 s43, s46, 0xc600
    buffer_load_dwordx4 v51, s[28:31], s43 offen lds
    ds_read_b64_tr_b16 a[208:209], v53 offset:28672
    ds_read_b64_tr_b16 a[210:211], v53 offset:29184
    ds_read_b64_tr_b16 a[212:213], v55 offset:28672
    ds_read_b64_tr_b16 a[214:215], v55 offset:29184
    ds_read_b64_tr_b16 a[216:217], v54 offset:28672
    ds_read_b64_tr_b16 a[218:219], v54 offset:29184
    ds_read_b64_tr_b16 a[220:221], v56 offset:28672
    ds_read_b64_tr_b16 a[222:223], v56 offset:29184
    s_waitcnt lgkmcnt(0)
    s_waitcnt vmcnt(24)
    s_barrier
    s_mov_b32 m0, 0x1f000
    s_add_u32 s43, s46, 0x9200
    buffer_load_dwordx4 v50, s[28:31], s43 offen lds
    s_mov_b32 m0, 0x1f400
    s_add_u32 s43, s46, 0xa400
    buffer_load_dwordx4 v51, s[28:31], s43 offen lds
    s_mov_b32 m0, 0x1f800
    s_add_u32 s43, s46, 0xb600
    buffer_load_dwordx4 v50, s[28:31], s43 offen lds
    s_mov_b32 m0, 0x1fc00
    s_add_u32 s43, s46, 0xc800
    buffer_load_dwordx4 v51, s[28:31], s43 offen lds
    ds_read_b64_tr_b16 a[32:33], v53 offset:0
    ds_read_b64_tr_b16 a[34:35], v53 offset:512
    ds_read_b64_tr_b16 a[36:37], v55 offset:0
    ds_read_b64_tr_b16 a[38:39], v55 offset:512
    ds_read_b64_tr_b16 a[40:41], v54 offset:0
    ds_read_b64_tr_b16 a[42:43], v54 offset:512
    ds_read_b64_tr_b16 a[44:45], v56 offset:0
    ds_read_b64_tr_b16 a[46:47], v56 offset:512
    s_waitcnt lgkmcnt(0)
    s_waitcnt vmcnt(24)
    s_barrier
    s_mov_b32 m0, 0x18000
    s_add_u32 s43, s46, 0x9100
    buffer_load_dwordx4 v50, s[28:31], s43 offen lds
    s_mov_b32 m0, 0x18400
    s_add_u32 s43, s46, 0xa300
    buffer_load_dwordx4 v51, s[28:31], s43 offen lds
    s_mov_b32 m0, 0x18800
    s_add_u32 s43, s46, 0xb500
    buffer_load_dwordx4 v50, s[28:31], s43 offen lds
    s_mov_b32 m0, 0x18c00
    s_add_u32 s43, s46, 0xc700
    buffer_load_dwordx4 v51, s[28:31], s43 offen lds
    ds_read_b64_tr_b16 a[64:65], v53 offset:4096
    ds_read_b64_tr_b16 a[66:67], v53 offset:4608
    ds_read_b64_tr_b16 a[68:69], v55 offset:4096
    ds_read_b64_tr_b16 a[70:71], v55 offset:4608
    ds_read_b64_tr_b16 a[72:73], v54 offset:4096
    ds_read_b64_tr_b16 a[74:75], v54 offset:4608
    ds_read_b64_tr_b16 a[76:77], v56 offset:4096
    ds_read_b64_tr_b16 a[78:79], v56 offset:4608
    s_waitcnt lgkmcnt(0)
    s_waitcnt vmcnt(24)
    s_barrier
    s_mov_b32 m0, 0x19000
    s_add_u32 s43, s46, 0x9300
    buffer_load_dwordx4 v50, s[28:31], s43 offen lds
    s_mov_b32 m0, 0x19400
    s_add_u32 s43, s46, 0xa500
    buffer_load_dwordx4 v51, s[28:31], s43 offen lds
    s_mov_b32 m0, 0x19800
    s_add_u32 s43, s46, 0xb700
    buffer_load_dwordx4 v50, s[28:31], s43 offen lds
    s_mov_b32 m0, 0x19c00
    s_add_u32 s43, s46, 0xc900
    buffer_load_dwordx4 v51, s[28:31], s43 offen lds
    ds_read_b64_tr_b16 a[96:97], v53 offset:8192
    ds_read_b64_tr_b16 a[98:99], v53 offset:8704
    ds_read_b64_tr_b16 a[100:101], v55 offset:8192
    ds_read_b64_tr_b16 a[102:103], v55 offset:8704
    ds_read_b64_tr_b16 a[104:105], v54 offset:8192
    ds_read_b64_tr_b16 a[106:107], v54 offset:8704
    ds_read_b64_tr_b16 a[108:109], v56 offset:8192
    ds_read_b64_tr_b16 a[110:111], v56 offset:8704
    s_waitcnt lgkmcnt(0)
    s_waitcnt vmcnt(24)
    s_barrier
    s_mov_b32 m0, 0x1a000
    s_add_u32 s43, s46, 0x1b000
    buffer_load_dwordx4 v50, s[28:31], s43 offen lds
    s_mov_b32 m0, 0x1a400
    s_add_u32 s43, s46, 0x1c200
    buffer_load_dwordx4 v51, s[28:31], s43 offen lds
    s_mov_b32 m0, 0x1a800
    s_add_u32 s43, s46, 0x1d400
    buffer_load_dwordx4 v50, s[28:31], s43 offen lds
    s_mov_b32 m0, 0x1ac00
    s_add_u32 s43, s46, 0x1e600
    buffer_load_dwordx4 v51, s[28:31], s43 offen lds
    ds_read_b64_tr_b16 a[224:225], v53 offset:12288
    ds_read_b64_tr_b16 a[226:227], v53 offset:12800
    ds_read_b64_tr_b16 a[228:229], v55 offset:12288
    ds_read_b64_tr_b16 a[230:231], v55 offset:12800
    ds_read_b64_tr_b16 a[232:233], v54 offset:12288
    ds_read_b64_tr_b16 a[234:235], v54 offset:12800
    ds_read_b64_tr_b16 a[236:237], v56 offset:12288
    ds_read_b64_tr_b16 a[238:239], v56 offset:12800
    s_waitcnt lgkmcnt(0)
    s_waitcnt vmcnt(24)
    s_barrier
    s_mov_b32 m0, 0x1b000
    s_add_u32 s43, s46, 0x1b100
    buffer_load_dwordx4 v50, s[28:31], s43 offen lds
    s_mov_b32 m0, 0x1b400
    s_add_u32 s43, s46, 0x1c300
    buffer_load_dwordx4 v51, s[28:31], s43 offen lds
    s_mov_b32 m0, 0x1b800
    s_add_u32 s43, s46, 0x1d500
    buffer_load_dwordx4 v50, s[28:31], s43 offen lds
    s_mov_b32 m0, 0x1bc00
    s_add_u32 s43, s46, 0x1e700
    buffer_load_dwordx4 v51, s[28:31], s43 offen lds
    ds_read_b64_tr_b16 a[80:81], v53 offset:16384
    ds_read_b64_tr_b16 a[82:83], v53 offset:16896
    ds_read_b64_tr_b16 a[84:85], v55 offset:16384
    ds_read_b64_tr_b16 a[86:87], v55 offset:16896
    ds_read_b64_tr_b16 a[88:89], v54 offset:16384
    ds_read_b64_tr_b16 a[90:91], v54 offset:16896
    ds_read_b64_tr_b16 a[92:93], v56 offset:16384
    ds_read_b64_tr_b16 a[94:95], v56 offset:16896
    s_waitcnt lgkmcnt(0)
    s_waitcnt vmcnt(24)
    s_barrier
    s_mov_b32 m0, 0x1c000
    s_add_u32 s43, s46, 0x1b200
    buffer_load_dwordx4 v50, s[28:31], s43 offen lds
    s_mov_b32 m0, 0x1c400
    s_add_u32 s43, s46, 0x1c400
    buffer_load_dwordx4 v51, s[28:31], s43 offen lds
    s_mov_b32 m0, 0x1c800
    s_add_u32 s43, s46, 0x1d600
    buffer_load_dwordx4 v50, s[28:31], s43 offen lds
    s_mov_b32 m0, 0x1cc00
    s_add_u32 s43, s46, 0x1e800
    buffer_load_dwordx4 v51, s[28:31], s43 offen lds
    ds_read_b64_tr_b16 a[112:113], v53 offset:20480
    ds_read_b64_tr_b16 a[114:115], v53 offset:20992
    ds_read_b64_tr_b16 a[116:117], v55 offset:20480
    ds_read_b64_tr_b16 a[118:119], v55 offset:20992
    ds_read_b64_tr_b16 a[120:121], v54 offset:20480
    ds_read_b64_tr_b16 a[122:123], v54 offset:20992
    ds_read_b64_tr_b16 a[124:125], v56 offset:20480
    ds_read_b64_tr_b16 a[126:127], v56 offset:20992
    s_waitcnt lgkmcnt(0)
    s_waitcnt vmcnt(24)
    s_barrier
    s_mov_b32 m0, 0x1d000
    s_add_u32 s43, s46, 0x1b300
    buffer_load_dwordx4 v50, s[28:31], s43 offen lds
    s_mov_b32 m0, 0x1d400
    s_add_u32 s43, s46, 0x1c500
    buffer_load_dwordx4 v51, s[28:31], s43 offen lds
    s_mov_b32 m0, 0x1d800
    s_add_u32 s43, s46, 0x1d700
    buffer_load_dwordx4 v50, s[28:31], s43 offen lds
    s_mov_b32 m0, 0x1dc00
    s_add_u32 s43, s46, 0x1e900
    buffer_load_dwordx4 v51, s[28:31], s43 offen lds
    ds_read_b64_tr_b16 a[240:241], v57 offset:24576
    ds_read_b64_tr_b16 a[242:243], v57 offset:25088
    ds_read_b64_tr_b16 a[244:245], v57 offset:26624
    ds_read_b64_tr_b16 a[246:247], v57 offset:27136
    ds_read_b64_tr_b16 a[248:249], v58 offset:24576
    ds_read_b64_tr_b16 a[250:251], v58 offset:25088
    ds_read_b64_tr_b16 a[252:253], v58 offset:26624
    ds_read_b64_tr_b16 a[254:255], v58 offset:27136
    s_waitcnt lgkmcnt(0)
    s_waitcnt vmcnt(24)
    s_barrier
    s_mov_b32 m0, 0x1e000
    s_add_u32 s43, s46, 0x12400
    buffer_load_dwordx4 v52, s[28:31], s43 offen lds
    s_mov_b32 m0, 0x1e400
    s_add_u32 s43, s46, 0x14800
    buffer_load_dwordx4 v52, s[28:31], s43 offen lds
    s_mov_b32 m0, 0x1e800
    s_add_u32 s43, s46, 0x16c00
    buffer_load_dwordx4 v52, s[28:31], s43 offen lds
    s_mov_b32 m0, 0x1ec00
    s_add_u32 s43, s46, 0x19000
    buffer_load_dwordx4 v52, s[28:31], s43 offen lds
    ds_read_b64_tr_b16 a[128:129], v57 offset:28672
    ds_read_b64_tr_b16 a[130:131], v57 offset:29184
    ds_read_b64_tr_b16 a[132:133], v57 offset:30720
    ds_read_b64_tr_b16 a[134:135], v57 offset:31232
    ds_read_b64_tr_b16 a[136:137], v58 offset:28672
    ds_read_b64_tr_b16 a[138:139], v58 offset:29184
    ds_read_b64_tr_b16 a[140:141], v58 offset:30720
    ds_read_b64_tr_b16 a[142:143], v58 offset:31232
    s_waitcnt lgkmcnt(0)
    v_mov_b32 v30, 0
    buffer_load_dwordx2 v[24:25], v30, s[12:15], 0 offen sc1
    v_readfirstlane_b32 s55, v26
    s_lshl_b32 s44, s36, 7
    s_add_u32 s44, s44, 0x180000
    v_lshrrev_b32 v13, 2, v0
    v_and_b32 v13, 28, v13
    buffer_load_dword v14, v13, s[8:11], s44 offen sc1
    buffer_load_dword v27, v30, s[12:15], 0 offen offset:128 sc1
    s_waitcnt vmcnt(27)
    s_barrier
    s_mov_b32 m0, 0x1f000
    s_add_u32 s43, s45, 0x440000
    buffer_load_dwordx4 v48, s[24:27], s43 offen lds
    s_mov_b32 m0, 0x1f400
    s_add_u32 s43, s45, 0x448000
    buffer_load_dwordx4 v49, s[24:27], s43 offen lds
    s_mov_b32 m0, 0x1f800
    s_add_u32 s43, s45, 0x450000
    buffer_load_dwordx4 v48, s[24:27], s43 offen lds
    s_mov_b32 m0, 0x1fc00
    s_add_u32 s43, s45, 0x458000
    buffer_load_dwordx4 v49, s[24:27], s43 offen lds
    ds_read_b64_tr_b16 v[32:33], v57 offset:0
    ds_read_b64_tr_b16 v[34:35], v57 offset:512
    ds_read_b64_tr_b16 v[36:37], v57 offset:2048
    ds_read_b64_tr_b16 v[38:39], v57 offset:2560
    ds_read_b64_tr_b16 v[40:41], v58 offset:0
    ds_read_b64_tr_b16 v[42:43], v58 offset:512
    ds_read_b64_tr_b16 v[44:45], v58 offset:2048
    ds_read_b64_tr_b16 v[46:47], v58 offset:2560
    s_waitcnt lgkmcnt(0)
    s_waitcnt vmcnt(27)
    s_barrier
    ds_write_b128 v1, a[144:147] offset:0
    ds_write_b128 v1, a[148:151] offset:1024
    ds_write_b128 v1, a[152:155] offset:2048
    ds_write_b128 v1, a[156:159] offset:3072
    s_waitcnt lgkmcnt(0)
    v_accvgpr_write_b32 a144, v32
    v_accvgpr_write_b32 a145, v33
    v_accvgpr_write_b32 a146, v34
    v_accvgpr_write_b32 a147, v35
    v_accvgpr_write_b32 a148, v36
    v_accvgpr_write_b32 a149, v37
    v_accvgpr_write_b32 a150, v38
    v_accvgpr_write_b32 a151, v39
    v_accvgpr_write_b32 a152, v40
    v_accvgpr_write_b32 a153, v41
    v_accvgpr_write_b32 a154, v42
    v_accvgpr_write_b32 a155, v43
    v_accvgpr_write_b32 a156, v44
    v_accvgpr_write_b32 a157, v45
    v_accvgpr_write_b32 a158, v46
    v_accvgpr_write_b32 a159, v47
    ds_read_b64_tr_b16 v[32:33], v57 offset:4096
    ds_read_b64_tr_b16 v[34:35], v57 offset:4608
    ds_read_b64_tr_b16 v[36:37], v57 offset:6144
    ds_read_b64_tr_b16 v[38:39], v57 offset:6656
    ds_read_b64_tr_b16 v[40:41], v58 offset:4096
    ds_read_b64_tr_b16 v[42:43], v58 offset:4608
    ds_read_b64_tr_b16 v[44:45], v58 offset:6144
    ds_read_b64_tr_b16 v[46:47], v58 offset:6656
    s_waitcnt lgkmcnt(0)
    s_waitcnt vmcnt(23)
    s_barrier
    ds_write_b128 v1, a[160:163] offset:4096
    ds_write_b128 v1, a[164:167] offset:5120
    ds_write_b128 v1, a[168:171] offset:6144
    ds_write_b128 v1, a[172:175] offset:7168
    s_waitcnt lgkmcnt(0)
    v_accvgpr_write_b32 a160, v32
    v_accvgpr_write_b32 a161, v33
    v_accvgpr_write_b32 a162, v34
    v_accvgpr_write_b32 a163, v35
    v_accvgpr_write_b32 a164, v36
    v_accvgpr_write_b32 a165, v37
    v_accvgpr_write_b32 a166, v38
    v_accvgpr_write_b32 a167, v39
    v_accvgpr_write_b32 a168, v40
    v_accvgpr_write_b32 a169, v41
    v_accvgpr_write_b32 a170, v42
    v_accvgpr_write_b32 a171, v43
    v_accvgpr_write_b32 a172, v44
    v_accvgpr_write_b32 a173, v45
    v_accvgpr_write_b32 a174, v46
    v_accvgpr_write_b32 a175, v47
    ds_read_b64_tr_b16 v[32:33], v57 offset:8192
    ds_read_b64_tr_b16 v[34:35], v57 offset:8704
    ds_read_b64_tr_b16 v[36:37], v57 offset:10240
    ds_read_b64_tr_b16 v[38:39], v57 offset:10752
    ds_read_b64_tr_b16 v[40:41], v58 offset:8192
    ds_read_b64_tr_b16 v[42:43], v58 offset:8704
    ds_read_b64_tr_b16 v[44:45], v58 offset:10240
    ds_read_b64_tr_b16 v[46:47], v58 offset:10752
    s_waitcnt lgkmcnt(0)
    s_waitcnt vmcnt(19)
    s_barrier
    ds_write_b128 v1, a[176:179] offset:8192
    ds_write_b128 v1, a[180:183] offset:9216
    ds_write_b128 v1, a[184:187] offset:10240
    ds_write_b128 v1, a[188:191] offset:11264
    s_waitcnt lgkmcnt(0)
    v_accvgpr_write_b32 a176, v32
    v_accvgpr_write_b32 a177, v33
    v_accvgpr_write_b32 a178, v34
    v_accvgpr_write_b32 a179, v35
    v_accvgpr_write_b32 a180, v36
    v_accvgpr_write_b32 a181, v37
    v_accvgpr_write_b32 a182, v38
    v_accvgpr_write_b32 a183, v39
    v_accvgpr_write_b32 a184, v40
    v_accvgpr_write_b32 a185, v41
    v_accvgpr_write_b32 a186, v42
    v_accvgpr_write_b32 a187, v43
    v_accvgpr_write_b32 a188, v44
    v_accvgpr_write_b32 a189, v45
    v_accvgpr_write_b32 a190, v46
    v_accvgpr_write_b32 a191, v47
    ds_read_b64_tr_b16 v[32:33], v57 offset:12288
    ds_read_b64_tr_b16 v[34:35], v57 offset:12800
    ds_read_b64_tr_b16 v[36:37], v57 offset:14336
    ds_read_b64_tr_b16 v[38:39], v57 offset:14848
    ds_read_b64_tr_b16 v[40:41], v58 offset:12288
    ds_read_b64_tr_b16 v[42:43], v58 offset:12800
    ds_read_b64_tr_b16 v[44:45], v58 offset:14336
    ds_read_b64_tr_b16 v[46:47], v58 offset:14848
    s_waitcnt lgkmcnt(0)
    s_waitcnt vmcnt(15)
    s_barrier
    ds_write_b128 v1, a[192:195] offset:12288
    ds_write_b128 v1, a[196:199] offset:13312
    ds_write_b128 v1, a[200:203] offset:14336
    ds_write_b128 v1, a[204:207] offset:15360
    s_waitcnt lgkmcnt(0)
    v_accvgpr_write_b32 a192, v32
    v_accvgpr_write_b32 a193, v33
    v_accvgpr_write_b32 a194, v34
    v_accvgpr_write_b32 a195, v35
    v_accvgpr_write_b32 a196, v36
    v_accvgpr_write_b32 a197, v37
    v_accvgpr_write_b32 a198, v38
    v_accvgpr_write_b32 a199, v39
    v_accvgpr_write_b32 a200, v40
    v_accvgpr_write_b32 a201, v41
    v_accvgpr_write_b32 a202, v42
    v_accvgpr_write_b32 a203, v43
    v_accvgpr_write_b32 a204, v44
    v_accvgpr_write_b32 a205, v45
    v_accvgpr_write_b32 a206, v46
    v_accvgpr_write_b32 a207, v47
    ds_read_b64_tr_b16 v[32:33], v57 offset:16384
    ds_read_b64_tr_b16 v[34:35], v57 offset:16896
    ds_read_b64_tr_b16 v[36:37], v57 offset:18432
    ds_read_b64_tr_b16 v[38:39], v57 offset:18944
    ds_read_b64_tr_b16 v[40:41], v58 offset:16384
    ds_read_b64_tr_b16 v[42:43], v58 offset:16896
    ds_read_b64_tr_b16 v[44:45], v58 offset:18432
    ds_read_b64_tr_b16 v[46:47], v58 offset:18944
    s_waitcnt lgkmcnt(0)
    s_waitcnt vmcnt(11)
    s_barrier
    ds_write_b128 v1, a[208:211] offset:16384
    ds_write_b128 v1, a[212:215] offset:17408
    ds_write_b128 v1, a[216:219] offset:18432
    ds_write_b128 v1, a[220:223] offset:19456
    s_waitcnt lgkmcnt(0)
    v_accvgpr_write_b32 a208, v32
    v_accvgpr_write_b32 a209, v33
    v_accvgpr_write_b32 a210, v34
    v_accvgpr_write_b32 a211, v35
    v_accvgpr_write_b32 a212, v36
    v_accvgpr_write_b32 a213, v37
    v_accvgpr_write_b32 a214, v38
    v_accvgpr_write_b32 a215, v39
    v_accvgpr_write_b32 a216, v40
    v_accvgpr_write_b32 a217, v41
    v_accvgpr_write_b32 a218, v42
    v_accvgpr_write_b32 a219, v43
    v_accvgpr_write_b32 a220, v44
    v_accvgpr_write_b32 a221, v45
    v_accvgpr_write_b32 a222, v46
    v_accvgpr_write_b32 a223, v47
    ds_read_b64_tr_b16 v[32:33], v57 offset:20480
    ds_read_b64_tr_b16 v[34:35], v57 offset:20992
    ds_read_b64_tr_b16 v[36:37], v57 offset:22528
    ds_read_b64_tr_b16 v[38:39], v57 offset:23040
    ds_read_b64_tr_b16 v[40:41], v58 offset:20480
    ds_read_b64_tr_b16 v[42:43], v58 offset:20992
    ds_read_b64_tr_b16 v[44:45], v58 offset:22528
    ds_read_b64_tr_b16 v[46:47], v58 offset:23040
    s_waitcnt lgkmcnt(0)
    s_waitcnt vmcnt(7)
    s_barrier
    ds_write_b128 v1, a[224:227] offset:20480
    ds_write_b128 v1, a[228:231] offset:21504
    ds_write_b128 v1, a[232:235] offset:22528
    ds_write_b128 v1, a[236:239] offset:23552
    s_waitcnt lgkmcnt(0)
    v_accvgpr_write_b32 a224, v32
    v_accvgpr_write_b32 a225, v33
    v_accvgpr_write_b32 a226, v34
    v_accvgpr_write_b32 a227, v35
    v_accvgpr_write_b32 a228, v36
    v_accvgpr_write_b32 a229, v37
    v_accvgpr_write_b32 a230, v38
    v_accvgpr_write_b32 a231, v39
    v_accvgpr_write_b32 a232, v40
    v_accvgpr_write_b32 a233, v41
    v_accvgpr_write_b32 a234, v42
    v_accvgpr_write_b32 a235, v43
    v_accvgpr_write_b32 a236, v44
    v_accvgpr_write_b32 a237, v45
    v_accvgpr_write_b32 a238, v46
    v_accvgpr_write_b32 a239, v47
    ds_read_b64_tr_b16 v[32:33], v61 offset:24576
    ds_read_b64_tr_b16 v[34:35], v61 offset:24832
    ds_read_b64_tr_b16 v[36:37], v61 offset:25600
    ds_read_b64_tr_b16 v[38:39], v61 offset:25856
    ds_read_b64_tr_b16 v[40:41], v62 offset:24576
    ds_read_b64_tr_b16 v[42:43], v62 offset:24832
    ds_read_b64_tr_b16 v[44:45], v62 offset:25600
    ds_read_b64_tr_b16 v[46:47], v62 offset:25856
    s_waitcnt lgkmcnt(0)
    s_waitcnt vmcnt(4)
    s_mov_b32 s91, 1000
    v_readlane_b32 s44, v14, 0
    s_nop 0
    s_mul_i32 s44, s44, 7
    s_add_u32 s44, s44, 0
    s_min_u32 s91, s91, s44
    v_readlane_b32 s44, v14, 1
    s_nop 0
    s_mul_i32 s44, s44, 7
    s_add_u32 s44, s44, 1
    s_min_u32 s91, s91, s44
    v_readlane_b32 s44, v14, 2
    s_nop 0
    s_mul_i32 s44, s44, 7
    s_add_u32 s44, s44, 2
    s_min_u32 s91, s91, s44
    v_readlane_b32 s44, v14, 3
    s_nop 0
    s_mul_i32 s44, s44, 7
    s_add_u32 s44, s44, 3
    s_min_u32 s91, s91, s44
    v_readlane_b32 s44, v14, 4
    s_nop 0
    s_mul_i32 s44, s44, 7
    s_add_u32 s44, s44, 4
    s_min_u32 s91, s91, s44
    v_readlane_b32 s44, v14, 5
    s_nop 0
    s_mul_i32 s44, s44, 7
    s_add_u32 s44, s44, 5
    s_min_u32 s91, s91, s44
    v_readlane_b32 s44, v14, 6
    s_nop 0
    s_mul_i32 s44, s44, 7
    s_add_u32 s44, s44, 6
    s_min_u32 s91, s91, s44
    s_cmp_eq_u32 s55, 1
    s_cselect_b32 s91, s91, 0
    s_cmp_lt_u32 s91, 2
    s_cbranch_scc1 L_ek_2
    s_mov_b32 m0, 0x4000
    s_add_u32 s43, s48, 0x1000000
    buffer_load_dwordx4 v0, s[8:11], s43 offen offset:0 sc1 lds
    buffer_load_dwordx4 v0, s[8:11], s43 offen offset:1024 sc1 lds
    buffer_load_dwordx4 v0, s[8:11], s43 offen offset:2048 sc1 lds
    buffer_load_dwordx4 v0, s[8:11], s43 offen offset:3072 sc1 lds
    s_mov_b32 m0, 0x5000
    s_add_u32 s43, s48, 0x1001000
    buffer_load_dwordx4 v0, s[8:11], s43 offen offset:0 sc1 lds
    buffer_load_dwordx4 v0, s[8:11], s43 offen offset:1024 sc1 lds
    buffer_load_dwordx4 v0, s[8:11], s43 offen offset:2048 sc1 lds
    buffer_load_dwordx4 v0, s[8:11], s43 offen offset:3072 sc1 lds
L_ek_2:
    s_waitcnt vmcnt(0)
    s_barrier
    ds_write_b128 v1, a[240:243] offset:24576
    ds_write_b128 v1, a[244:247] offset:25600
    ds_write_b128 v1, a[248:251] offset:26624
    ds_write_b128 v1, a[252:255] offset:27648
    s_waitcnt lgkmcnt(0)
    v_accvgpr_write_b32 a240, v32
    v_accvgpr_write_b32 a241, v33
    v_accvgpr_write_b32 a242, v34
    v_accvgpr_write_b32 a243, v35
    v_accvgpr_write_b32 a244, v36
    v_accvgpr_write_b32 a245, v37
    v_accvgpr_write_b32 a246, v38
    v_accvgpr_write_b32 a247, v39
    v_accvgpr_write_b32 a248, v40
    v_accvgpr_write_b32 a249, v41
    v_accvgpr_write_b32 a250, v42
    v_accvgpr_write_b32 a251, v43
    v_accvgpr_write_b32 a252, v44
    v_accvgpr_write_b32 a253, v45
    v_accvgpr_write_b32 a254, v46
    v_accvgpr_write_b32 a255, v47
    ds_read_b64_tr_b16 v[32:33], v53 offset:28672
    ds_read_b64_tr_b16 v[34:35], v53 offset:29184
    ds_read_b64_tr_b16 v[36:37], v55 offset:28672
    ds_read_b64_tr_b16 v[38:39], v55 offset:29184
    ds_read_b64_tr_b16 v[40:41], v54 offset:28672
    ds_read_b64_tr_b16 v[42:43], v54 offset:29184
    ds_read_b64_tr_b16 v[44:45], v56 offset:28672
    ds_read_b64_tr_b16 v[46:47], v56 offset:29184
    s_waitcnt lgkmcnt(0)
    s_barrier
    ds_write_b128 v1, a[128:131] offset:28672
    ds_write_b128 v1, a[132:135] offset:29696
    ds_write_b128 v1, a[136:139] offset:30720
    ds_write_b128 v1, a[140:143] offset:31744
    s_waitcnt lgkmcnt(0)
    v_accvgpr_write_b32 a128, v32
    v_accvgpr_write_b32 a129, v33
    v_accvgpr_write_b32 a130, v34
    v_accvgpr_write_b32 a131, v35
    v_accvgpr_write_b32 a132, v36
    v_accvgpr_write_b32 a133, v37
    v_accvgpr_write_b32 a134, v38
    v_accvgpr_write_b32 a135, v39
    v_accvgpr_write_b32 a136, v40
    v_accvgpr_write_b32 a137, v41
    v_accvgpr_write_b32 a138, v42
    v_accvgpr_write_b32 a139, v43
    v_accvgpr_write_b32 a140, v44
    v_accvgpr_write_b32 a141, v45
    v_accvgpr_write_b32 a142, v46
    v_accvgpr_write_b32 a143, v47
    s_cmp_ge_u32 s91, 2
    s_cbranch_scc1 L_ek2
    s_mov_b32 s49, 0
    v_mov_b32 v28, 12
L_poll_17:
    buffer_load_dword v29, v28, s[12:15], 0 offen sc1
    s_add_u32 s49, s49, 1
    s_cmp_gt_u32 s49, 4000000
    s_cbranch_scc1 L_fail
    s_waitcnt vmcnt(0)
    v_readfirstlane_b32 s43, v29
    s_nop 0
    s_cmp_ge_u32 s43, 1
    s_cbranch_scc1 L_poll_17_d
    s_sleep 2
    s_branch L_poll_17
L_poll_17_d:
    s_mov_b32 s91, 0
    s_add_u32 s55, s38, 1
    s_min_u32 s55, s55, 63
    s_cmp_lt_u32 s55, s91
    s_cbranch_scc1 L_kf_16_d
    s_mov_b32 s49, 0
    s_lshl_b32 s44, s36, 7
    s_add_u32 s44, s44, 0x180000
    v_lshrrev_b32 v13, 2, v0
    v_and_b32 v13, 28, v13
L_kf_16:
    buffer_load_dword v14, v13, s[8:11], s44 offen sc1
    s_add_u32 s49, s49, 1
    s_cmp_gt_u32 s49, 4000000
    s_cbranch_scc1 L_fail
    s_mov_b32 s91, 1000
    s_waitcnt vmcnt(0)
    v_readlane_b32 s45, v14, 0
    s_nop 0
    s_mul_i32 s45, s45, 7
    s_add_u32 s45, s45, 0
    s_min_u32 s91, s91, s45
    v_readlane_b32 s45, v14, 1
    s_nop 0
    s_mul_i32 s45, s45, 7
    s_add_u32 s45, s45, 1
    s_min_u32 s91, s91, s45
    v_readlane_b32 s45, v14, 2
    s_nop 0
    s_mul_i32 s45, s45, 7
    s_add_u32 s45, s45, 2
    s_min_u32 s91, s91, s45
    v_readlane_b32 s45, v14, 3
    s_nop 0
    s_mul_i32 s45, s45, 7
    s_add_u32 s45, s45, 3
    s_min_u32 s91, s91, s45
    v_readlane_b32 s45, v14, 4
    s_nop 0
    s_mul_i32 s45, s45, 7
    s_add_u32 s45, s45, 4
    s_min_u32 s91, s91, s45
    v_readlane_b32 s45, v14, 5
    s_nop 0
    s_mul_i32 s45, s45, 7
    s_add_u32 s45, s45, 5
    s_min_u32 s91, s91, s45
    v_readlane_b32 s45, v14, 6
    s_nop 0
    s_mul_i32 s45, s45, 7
    s_add_u32 s45, s45, 6
    s_min_u32 s91, s91, s45
    s_cmp_lt_u32 s55, s91
    s_cbranch_scc0 L_kf_16
    v_lshlrev_b32 v13, 3, v0
L_kf_16_d:
    s_mov_b32 m0, 0x4000
    s_add_u32 s43, s48, 0x1000000
    buffer_load_dwordx4 v0, s[8:11], s43 offen offset:0 sc1 lds
    buffer_load_dwordx4 v0, s[8:11], s43 offen offset:1024 sc1 lds
    buffer_load_dwordx4 v0, s[8:11], s43 offen offset:2048 sc1 lds
    buffer_load_dwordx4 v0, s[8:11], s43 offen offset:3072 sc1 lds
    s_mov_b32 m0, 0x5000
    s_add_u32 s43, s48, 0x1001000
    buffer_load_dwordx4 v0, s[8:11], s43 offen offset:0 sc1 lds
    buffer_load_dwordx4 v0, s[8:11], s43 offen offset:1024 sc1 lds
    buffer_load_dwordx4 v0, s[8:11], s43 offen offset:2048 sc1 lds
    buffer_load_dwordx4 v0, s[8:11], s43 offen offset:3072 sc1 lds
L_ek2:
    v_mov_b32 v28, v24
    v_mov_b32 v29, v25
    v_mov_b32 v30, 0
    s_mov_b32 s49, 0
    s_branch L_sbe_2
    s_mov_b32 s49, 0
    v_mov_b32 v30, 0
L_sb_18:
    buffer_load_dwordx2 v[28:29], v30, s[12:15], 0 offen sc1
    s_add_u32 s49, s49, 1
    s_cmp_gt_u32 s49, 4000000
    s_cbranch_scc1 L_fail
    s_waitcnt vmcnt(0)
L_sbe_2:
    v_sad_u8 v31, v28, 0, 0
    v_sad_u8 v31, v29, 0, v31
    v_or_b32 v32, v28, v29
    v_readfirstlane_b32 s43, v31
    v_readfirstlane_b32 s44, v32
    s_cmp_lt_u32 s43, 32
    s_cbranch_scc1 L_sb_18
    s_and_b32 s90, s44, 0x20202020
    v_readfirstlane_b32 s43, v27
    s_nop 0
    s_cmp_ge_u32 s43, 28
    s_cbranch_scc1 L_ec
    s_mov_b32 s49, 0
    v_mov_b32 v28, 128
L_poll_19:
    buffer_load_dword v29, v28, s[12:15], 0 offen sc1
    s_add_u32 s49, s49, 1
    s_cmp_gt_u32 s49, 4000000
    s_cbranch_scc1 L_fail
    s_waitcnt vmcnt(0)
    v_readfirstlane_b32 s43, v29
    s_nop 0
    s_cmp_ge_u32 s43, 28
    s_cbranch_scc1 L_poll_19_d
    s_sleep 2
    s_branch L_poll_19
L_poll_19_d:
L_ec:
    s_waitcnt vmcnt(0)
    s_barrier
    s_mov_b32 s46, 0
    s_cmp_eq_u32 s90, 0
    s_cbranch_scc1 L_slowmode_2
    ds_read_b128 v[32:35], v0 offset:6144
    ds_read_b32 v12, v11 offset:8704
    ds_read_b128 v[40:43], v1 offset:0
    ds_read_b128 v[44:47], v1 offset:1024
    v_mov_b64 v[16:17], 0
    v_mov_b64 v[18:19], 0
    v_mov_b64 v[20:21], 0
    v_mov_b64 v[22:23], 0
    v_mov_b64 v[24:25], 0
    v_mov_b64 v[26:27], 0
    v_mov_b64 v[28:29], 0
    v_mov_b64 v[30:31], 0
    s_waitcnt vmcnt(0) lgkmcnt(0)
    s_nop 0
    s_branch L_gar_f2
L_loop_f2:
    s_barrier
    s_add_u32 s43, s40, 2048
    buffer_load_dwordx4 v[60:63], v0, s[8:11], s43 offen sc1
    v_mov_b64 v[16:17], 0
    v_mov_b64 v[18:19], 0
    v_mov_b64 v[20:21], 0
    v_mov_b64 v[22:23], 0
    v_mov_b64 v[24:25], 0
    v_mov_b64 v[26:27], 0
    v_mov_b64 v[28:29], 0
    v_mov_b64 v[30:31], 0
    s_nop 15
    s_nop 7
    s_add_u32 s43, s40, 2048
    buffer_load_dwordx4 v[56:59], v0, s[8:11], s43 offen sc1
    s_waitcnt vmcnt(1)
    ds_write_b128 v0, v[60:63] offset:2048
    v_max3_u32 v14, v60, v61, v62
    v_max_u32 v14, v14, v63
    v_cmp_le_u32 vcc, s51, v14
    s_add_u32 s43, s40, 6144
    buffer_load_dwordx4 v[32:35], v0, s[8:11], s43 offen sc1
    s_add_u32 s43, s40, 8704
    buffer_load_dword v12, v11, s[8:11], s43 offen sc1
    s_cbranch_vccnz L_ga_f2
L_gar_f2:
    ds_read_b64_tr_b16 v[48:49], v2 offset:2048
    ds_read_b64_tr_b16 v[50:51], v3 offset:2048
    ds_read_b128 v[40:43], v1 offset:0
    ds_read_b128 v[44:47], v1 offset:1024
    s_waitcnt lgkmcnt(4)
    s_barrier
    ds_read_b64_tr_b16 v[52:53], v2 offset:0
    ds_read_b64_tr_b16 v[54:55], v3 offset:0
    s_waitcnt lgkmcnt(4)
    s_waitcnt lgkmcnt(2)
    v_smfmac_f32_16x16x64_bf16 v[16:19], v[48:51], v[40:47], v10
    s_waitcnt vmcnt(2)
    ds_read_b64_tr_b16 v[56:57], v2 offset:1024
    ds_read_b64_tr_b16 v[58:59], v3 offset:1024
    v_smfmac_f32_16x16x64_bf16 v[24:27], v[48:51], v[176:183], v10
    ds_read_b64_tr_b16 v[60:61], v2 offset:3072
    ds_read_b64_tr_b16 v[62:63], v3 offset:3072
    v_smfmac_f32_16x16x64_bf16 v[28:31], v[48:51], v[184:191], v10
    ds_read_b128 v[40:43], v1 offset:2048
    ds_read_b128 v[44:47], v1 offset:3072
    s_waitcnt lgkmcnt(6)
    v_smfmac_f32_16x16x64_bf16 v[16:19], v[52:55], v[64:71], v10
    s_add_u32 s43, s40, 6144
    buffer_load_dwordx4 v[36:39], v0, s[8:11], s43 offen sc1
    s_add_u32 s43, s40, 8704
    buffer_load_dword v13, v11, s[8:11], s43 offen sc1
    v_smfmac_f32_16x16x64_bf16 v[20:23], v[52:55], v[72:79], v10
    v_smfmac_f32_16x16x64_bf16 v[24:27], v[52:55], v[192:199], v10
    s_waitcnt lgkmcnt(0)
    v_smfmac_f32_16x16x64_bf16 v[20:23], v[48:51], v[40:47], v10
    ds_read_b128 v[40:43], v1 offset:8192
    v_smfmac_f32_16x16x64_bf16 v[28:31], v[52:55], v[200:207], v10
    ds_read_b128 v[44:47], v1 offset:9216
    v_smfmac_f32_16x16x64_bf16 v[16:19], v[56:59], v[80:87], v10
    s_waitcnt vmcnt(2)
    ds_write_b128 v0, v[32:35] offset:6144
    v_max3_u32 v14, v32, v33, v34
    v_smfmac_f32_16x16x64_bf16 v[20:23], v[56:59], v[88:95], v10
    ds_write_b32 v11, v12 offset:8704
    v_max3_u32 v14, v14, v35, v12
    v_smfmac_f32_16x16x64_bf16 v[24:27], v[56:59], v[208:215], v10
    v_cmp_le_u32 vcc, s51, v14
    v_smfmac_f32_16x16x64_bf16 v[28:31], v[56:59], v[216:223], v10
    s_cbranch_vccnz L_gb_f2
L_gbr_f2:
    ds_read_b64_tr_b16 v[48:49], v2 offset:6144
    v_smfmac_f32_16x16x64_bf16 v[16:19], v[60:63], v[96:103], v10
    ds_read_b64_tr_b16 v[50:51], v3 offset:6144
    v_smfmac_f32_16x16x64_bf16 v[20:23], v[60:63], v[104:111], v10
    s_waitcnt lgkmcnt(2)
    s_barrier
    ds_read_b64_tr_b16 v[52:53], v2 offset:4096
    ds_read_b64_tr_b16 v[54:55], v3 offset:4096
    v_smfmac_f32_16x16x64_bf16 v[24:27], v[60:63], v[40:47], v10
    s_mov_b32 m0, 0x6000
    s_add_u32 s55, s48, 0x2000000
    buffer_load_dwordx4 v0, s[8:11], s55 offen sc1 lds
    ds_read_b64_tr_b16 v[56:57], v2 offset:5120
    ds_read_b64_tr_b16 v[58:59], v3 offset:5120
    s_waitcnt lgkmcnt(4)
    v_smfmac_f32_16x16x64_bf16 v[16:19], v[48:51], v[112:119], v10
    buffer_load_dwordx4 v0, s[8:11], s55 offen offset:1024 sc1 lds
    s_waitcnt vmcnt(2)
    ds_read_b128 v[32:35], v1 offset:10240
    ds_read_b128 v[36:39], v1 offset:11264
    v_smfmac_f32_16x16x64_bf16 v[20:23], v[48:51], v[120:127], v10
    buffer_load_dwordx4 v0, s[8:11], s55 offen offset:2048 sc1 lds
    ds_read_b128 v[40:43], v1 offset:4096
    ds_read_b128 v[44:47], v1 offset:5120
    v_smfmac_f32_16x16x64_bf16 v[24:27], v[48:51], v[224:231], v10
    buffer_load_dwordx4 v0, s[8:11], s55 offen offset:3072 sc1 lds
    v_smfmac_f32_16x16x64_bf16 v[28:31], v[48:51], v[232:239], v10
    ds_read_b64_tr_b16 v[48:49], v2 offset:8192
    ds_read_b64_tr_b16 v[50:51], v3 offset:8192
    s_waitcnt lgkmcnt(8)
    v_smfmac_f32_16x16x64_bf16 v[24:27], v[52:55], v[240:247], v10
    s_waitcnt lgkmcnt(4)
    v_smfmac_f32_16x16x64_bf16 v[28:31], v[60:63], v[32:39], v10
    ds_read_b64_tr_b16 v[60:61], v2 offset:7168
    s_waitcnt lgkmcnt(3)
    v_smfmac_f32_16x16x64_bf16 v[16:19], v[52:55], v[40:47], v10
    ds_read_b64_tr_b16 v[62:63], v3 offset:7168
    v_smfmac_f32_16x16x64_bf16 v[28:31], v[52:55], v[248:255], v10
    ds_read_b128 v[32:35], v1 offset:6144
    v_lshlrev_b32 v12, 3, v0
    v_smfmac_f32_16x16x64_bf16 v[16:19], v[56:59], v[128:135], v10
    s_mov_b32 m0, 0x3e80
    s_add_u32 s44, s48, 0x1040000
    buffer_load_dword v12, s[8:11], s44 offen sc1 lds
    ds_read_b128 v[36:39], v1 offset:7168
    v_and_b32 v12, 0x200, v0
    v_smfmac_f32_16x16x64_bf16 v[20:23], v[56:59], v[136:143], v10
    ds_read_b128 v[40:43], v1 offset:12288
    v_mul_u32_u24 v12, 3, v12
    s_waitcnt lgkmcnt(3)
    v_smfmac_f32_16x16x64_bf16 v[16:19], v[60:63], v[144:151], v10
    ds_read_b128 v[44:47], v1 offset:13312
    v_add_u32 v12, v12, v0
    s_waitcnt lgkmcnt(2)
    v_smfmac_f32_16x16x64_bf16 v[20:23], v[52:55], v[32:39], v10
    ds_read_b128 v[12:15], v12 offset:10240
    v_smfmac_f32_16x16x64_bf16 v[20:23], v[60:63], v[152:159], v10
    ds_read_b128 v[32:35], v1 offset:14336
    v_smfmac_f32_16x16x64_bf16 v[16:19], v[48:51], v[160:167], v10
    ds_read_b128 v[36:39], v1 offset:15360
    v_smfmac_f32_16x16x64_bf16 v[20:23], v[48:51], v[168:175], v10
    s_waitcnt lgkmcnt(3)
    v_smfmac_f32_16x16x64_bf16 v[24:27], v[56:59], v[40:47], v10
    s_waitcnt lgkmcnt(2)
    s_lshr_b32 s44, s48, 1
    s_add_u32 s44, s44, 0x40e0800
    buffer_store_dwordx4 v[12:15], v0, s[8:11], s44 offen sc1
    v_add_f32 v16, v16, v18
    v_add_f32 v17, v17, v19
    s_waitcnt lgkmcnt(0)
    v_smfmac_f32_16x16x64_bf16 v[28:31], v[56:59], v[32:39], v10
    ds_read_b128 v[32:35], v1 offset:22528
    v_cvt_pk_bf16_f32 v16, v16, v17
    v_add_f32 v20, v20, v22
    v_smfmac_f32_16x16x64_bf16 v[24:27], v[60:63], a[0:7], v10
    ds_read_b128 v[36:39], v1 offset:23552
    v_add_f32 v21, v21, v23
    v_cvt_pk_bf16_f32 v17, v20, v21
    v_smfmac_f32_16x16x64_bf16 v[24:27], v[48:51], a[16:23], v10
    ds_write_b64 v4, v[16:17] offset:10240
    v_mov_b64 v[40:41], 0
    v_mov_b64 v[42:43], 0
    v_smfmac_f32_16x16x64_bf16 v[28:31], v[60:63], a[8:15], v10
    ds_read_b128 v[16:19], v1 offset:20480
    v_mov_b64 v[44:45], 0
    v_mov_b64 v[46:47], 0
    v_smfmac_f32_16x16x64_bf16 v[28:31], v[48:51], a[24:31], v10
    ds_read_b128 v[20:23], v1 offset:21504
    v_add_f32 v24, v24, v26
    v_add_f32 v25, v25, v27
    v_cvt_pk_bf16_f32 v24, v24, v25
    v_smfmac_f32_16x16x64_bf16 v[40:43], v[52:55], a[96:103], v10
    s_add_u32 s55, s38, 2
    s_min_u32 s55, s55, 63
    s_cmp_lt_u32 s55, s91
    s_cbranch_scc1 L_kf_20_d
    s_mov_b32 s49, 0
    s_lshl_b32 s44, s36, 7
    s_add_u32 s44, s44, 0x180000
    v_lshrrev_b32 v13, 2, v0
    v_and_b32 v13, 28, v13
L_kf_20:
    buffer_load_dword v14, v13, s[8:11], s44 offen sc1
    s_add_u32 s49, s49, 1
    s_cmp_gt_u32 s49, 4000000
    s_cbranch_scc1 L_fail
    s_mov_b32 s91, 1000
    s_waitcnt vmcnt(0)
    v_readlane_b32 s45, v14, 0
    s_nop 0
    s_mul_i32 s45, s45, 7
    s_add_u32 s45, s45, 0
    s_min_u32 s91, s91, s45
    v_readlane_b32 s45, v14, 1
    s_nop 0
    s_mul_i32 s45, s45, 7
    s_add_u32 s45, s45, 1
    s_min_u32 s91, s91, s45
    v_readlane_b32 s45, v14, 2
    s_nop 0
    s_mul_i32 s45, s45, 7
    s_add_u32 s45, s45, 2
    s_min_u32 s91, s91, s45
    v_readlane_b32 s45, v14, 3
    s_nop 0
    s_mul_i32 s45, s45, 7
    s_add_u32 s45, s45, 3
    s_min_u32 s91, s91, s45
    v_readlane_b32 s45, v14, 4
    s_nop 0
    s_mul_i32 s45, s45, 7
    s_add_u32 s45, s45, 4
    s_min_u32 s91, s91, s45
    v_readlane_b32 s45, v14, 5
    s_nop 0
    s_mul_i32 s45, s45, 7
    s_add_u32 s45, s45, 5
    s_min_u32 s91, s91, s45
    v_readlane_b32 s45, v14, 6
    s_nop 0
    s_mul_i32 s45, s45, 7
    s_add_u32 s45, s45, 6
    s_min_u32 s91, s91, s45
    s_cmp_lt_u32 s55, s91
    s_cbranch_scc0 L_kf_20
L_kf_20_d:
    v_smfmac_f32_16x16x64_bf16 v[44:47], v[52:55], a[104:111], v10
    v_add_f32 v28, v28, v30
    v_add_f32 v29, v29, v31
    v_cvt_pk_bf16_f32 v25, v28, v29
    ds_write2st64_b32 v11, v24, v25 offset0:48 offset1:49
    s_waitcnt lgkmcnt(4)
    v_smfmac_f32_16x16x64_bf16 v[44:47], v[56:59], v[32:39], v10
    v_smfmac_f32_16x16x64_bf16 v[40:43], v[60:63], a[112:119], v10
    s_waitcnt lgkmcnt(1)
    v_smfmac_f32_16x16x64_bf16 v[40:43], v[56:59], v[16:23], v10
    ds_read_b64_tr_b16 v[56:57], v2 offset:2048
    ds_read_b64_tr_b16 v[58:59], v3 offset:2048
    s_waitcnt lgkmcnt(2)
    s_barrier
    s_cmp_eq_u32 s38, 63
    s_cbranch_scc1 L_tail_f2
    v_smfmac_f32_16x16x64_bf16 v[44:47], v[60:63], a[120:127], v10
    ds_read_b128 v[16:19], v1 offset:16384
    ds_read_b128 v[20:23], v1 offset:17408
    v_smfmac_f32_16x16x64_bf16 v[40:43], v[48:51], a[128:135], v10
    ds_read_b128 v[24:27], v1 offset:18432
    ds_read_b128 v[28:31], v1 offset:19456
    v_smfmac_f32_16x16x64_bf16 v[44:47], v[48:51], a[136:143], v10
    ds_read_b64_tr_b16 v[60:61], v2 offset:0
    ds_read_b64_tr_b16 v[62:63], v3 offset:0
    s_waitcnt lgkmcnt(6)
    v_smfmac_f32_16x16x64_bf16 v[40:43], v[56:59], a[32:39], v10
    ds_read_b64_tr_b16 v[48:49], v2 offset:1024
    ds_read_b64_tr_b16 v[50:51], v3 offset:1024
    v_smfmac_f32_16x16x64_bf16 v[44:47], v[56:59], a[40:47], v10
    ds_read_b64_tr_b16 v[56:57], v2 offset:3072
    ds_read_b64_tr_b16 v[58:59], v3 offset:3072
    s_waitcnt lgkmcnt(4)
    v_smfmac_f32_16x16x64_bf16 v[40:43], v[60:63], a[48:55], v10
    v_smfmac_f32_16x16x64_bf16 v[44:47], v[60:63], a[56:63], v10
    ds_read_b64_tr_b16 v[60:61], v2 offset:6144
    ds_read_b64_tr_b16 v[62:63], v3 offset:6144
    s_waitcnt lgkmcnt(4)
    v_smfmac_f32_16x16x64_bf16 v[40:43], v[48:51], v[16:23], v10
    v_smfmac_f32_16x16x64_bf16 v[44:47], v[48:51], v[24:31], v10
    s_waitcnt lgkmcnt(2)
    v_smfmac_f32_16x16x64_bf16 v[40:43], v[56:59], a[64:71], v10
    v_smfmac_f32_16x16x64_bf16 v[44:47], v[56:59], a[72:79], v10
    s_waitcnt lgkmcnt(0)
    v_smfmac_f32_16x16x64_bf16 v[40:43], v[60:63], a[80:87], v10
    v_smfmac_f32_16x16x64_bf16 v[44:47], v[60:63], a[88:95], v10
    s_waitcnt vmcnt(2)
    s_barrier
    s_cmp_ge_u32 s91, 64
    s_cbranch_scc1 L_kva_21
    s_lshl_b32 s44, s36, 7
    s_add_u32 s44, s44, 0x180000
    v_lshrrev_b32 v14, 2, v0
    v_and_b32 v14, 28, v14
    buffer_load_dword v15, v14, s[8:11], s44 offen sc1
L_kva_21:
L_pv_f2:
    ds_read_b64_tr_b16 v[48:49], v5 offset:15360
    ds_read_b64_tr_b16 v[50:51], v5 offset:15616
    ds_read_b64_tr_b16 v[54:55], v8 offset:15872
    s_cmp_eq_u32 s46, 0x5105
    s_cbranch_scc1 L_pv2_f2
    ds_read_b128 v[24:27], v0 offset:28672
    ds_read_b128 v[28:31], v0 offset:29696
    v_mov_b64 v[32:33], s[98:99]
    v_mov_b64 v[56:57], s[96:97]
    v_mov_b64 v[58:59], s[96:97]
    s_waitcnt lgkmcnt(0)
    s_nop 0
    v_mfma_f32_16x16x32_bf16 v[36:39], v[56:59], v[48:51], 0
    v_mfma_f32_16x16x32_bf16 v[16:19], v[24:27], v[48:51], 0
    v_add_f32 v40, v40, v42
    v_add_f32 v41, v41, v43
    v_mfma_f32_16x16x32_bf16 v[20:23], v[28:31], v[48:51], 0
    v_cvt_pk_bf16_f32 v40, v40, v41
    v_mov_b32 v41, 0
    v_mfma_f32_16x16x16_bf16 v[36:39], v[32:33], v[54:55], v[36:39]
    v_add_f32 v44, v44, v46
    v_add_f32 v45, v45, v47
    v_mfma_f32_16x16x16_bf16 v[16:19], v[40:41], v[54:55], v[16:19]
    v_cvt_pk_bf16_f32 v44, v44, v45
    v_mov_b32 v45, 0
    s_nop 1
    v_mfma_f32_16x16x16_bf16 v[20:23], v[44:45], v[54:55], v[20:23]
L_pv4_f2:
    ds_read_b128 v[56:59], v1 offset:24576
    ds_read_b128 v[60:63], v1 offset:25600
    ds_read_b128 v[24:27], v1 offset:26624
    ds_read_b128 v[28:31], v1 offset:27648
    v_rcp_f32 v34, v36
    v_cmp_ngt_f32 vcc, s69, v36
    v_cmp_nlt_f32 s[44:45], s68, v36
    v_cndmask_b32 v16, v18, v16, s[56:57]
    v_cndmask_b32 v17, v19, v17, s[56:57]
    s_or_b64 vcc, vcc, s[44:45]
    v_mul_f32 v16, v16, v34
    v_mul_f32 v17, v17, v34
    v_cndmask_b32 v20, v22, v20, s[56:57]
    v_cndmask_b32 v21, v23, v21, s[56:57]
    v_cvt_pk_bf16_f32 v16, v16, v17
    v_mul_f32 v20, v20, v34
    v_mul_f32 v21, v21, v34
    s_cbranch_vccnz L_slow_f2
L_pv3_f2:
    v_cvt_pk_bf16_f32 v20, v20, v21
    ds_write2_b32 v6, v16, v20 offset0:0 offset1:2
    s_mov_b32 s46, 0
    v_lshrrev_b32 v12, 1, v0
    v_and_b32 v12, 0x1e0, v12
    v_and_or_b32 v12, v0, 16, v12
    v_mov_b64 v[48:49], 0
    v_mov_b64 v[50:51], 0
    v_mov_b64 v[52:53], 0
    v_mov_b64 v[54:55], 0
    v_mov_b64 v[16:17], 0
    v_mov_b64 v[18:19], 0
    v_mov_b64 v[20:21], 0
    v_mov_b64 v[22:23], 0
    s_waitcnt lgkmcnt(0)
    s_barrier
    ds_read_b128 v[32:35], v12 offset:13312
    ds_read_b128 v[36:39], v12 offset:13824
    ds_write2st64_b32 v11, v40, v44 offset0:40 offset1:41
    ds_read_b128 v[40:43], v12 offset:14336
    ds_read_b128 v[44:47], v12 offset:14848
    s_waitcnt lgkmcnt(4)
    v_smfmac_f32_16x16x64_bf16 v[16:19], v[32:35], v[56:63], v10
    ds_read_b128 v[56:59], v1 offset:28672
    v_smfmac_f32_16x16x64_bf16 v[20:23], v[32:35], a[144:151], v10
    ds_read_b128 v[60:63], v1 offset:29696
    s_waitcnt lgkmcnt(5)
    v_smfmac_f32_16x16x64_bf16 v[16:19], v[36:39], v[24:31], v10
    ds_read_b128 v[24:27], v1 offset:30720
    v_smfmac_f32_16x16x64_bf16 v[20:23], v[36:39], a[152:159], v10
    ds_read_b128 v[28:31], v1 offset:31744
    s_waitcnt lgkmcnt(5)
    v_smfmac_f32_16x16x64_bf16 v[16:19], v[40:43], a[176:183], v10
    v_smfmac_f32_16x16x64_bf16 v[20:23], v[40:43], a[192:199], v10
    s_waitcnt lgkmcnt(4)
    v_smfmac_f32_16x16x64_bf16 v[16:19], v[44:47], a[184:191], v10
    v_smfmac_f32_16x16x64_bf16 v[20:23], v[44:47], a[200:207], v10
    s_waitcnt lgkmcnt(2)
    v_smfmac_f32_16x16x64_bf16 v[48:51], v[32:35], v[56:63], v10
    v_cvt_pk_bf16_f32 v16, v16, v17
    v_cvt_pk_bf16_f32 v17, v18, v19
    v_and_or_b32 v16, v16, -2, s92
    s_waitcnt lgkmcnt(0)
    v_smfmac_f32_16x16x64_bf16 v[48:51], v[36:39], v[24:31], v10
    s_add_u32 s43, s39, 32768
    buffer_store_dwordx2 v[16:17], v7, s[8:11], s43 offen
    v_cvt_pk_bf16_f32 v20, v20, v21
    v_cvt_pk_bf16_f32 v21, v22, v23
    v_and_or_b32 v20, v20, -2, s92
    v_smfmac_f32_16x16x64_bf16 v[48:51], v[40:43], a[208:215], v10
    s_add_u32 s43, s39, 98304
    buffer_store_dwordx2 v[20:21], v7, s[8:11], s43 offen
    v_cndmask_b32 v56, v32, v36, s[100:101]
    v_cndmask_b32 v57, v33, v37, s[100:101]
    v_cndmask_b32 v58, v34, v38, s[100:101]
    v_smfmac_f32_16x16x64_bf16 v[48:51], v[44:47], a[216:223], v10
    v_cndmask_b32 v59, v35, v39, s[100:101]
    v_cndmask_b32 v60, v40, v44, s[100:101]
    v_cndmask_b32 v61, v41, v45, s[100:101]
    v_smfmac_f32_16x16x64_bf16 v[52:55], v[32:35], a[160:167], v10
    v_cndmask_b32 v62, v42, v46, s[100:101]
    v_cndmask_b32 v63, v43, v47, s[100:101]
    v_mov_b64 v[24:25], 0
    v_smfmac_f32_16x16x64_bf16 v[52:55], v[36:39], a[168:175], v10
    v_mov_b64 v[26:27], 0
    s_nop 1
    v_smfmac_f32_16x16x64_bf16 v[24:27], v[56:59], a[240:247], v10
    v_cvt_pk_bf16_f32 v48, v48, v49
    v_cvt_pk_bf16_f32 v49, v50, v51
    v_smfmac_f32_16x16x64_bf16 v[24:27], v[60:63], a[248:255], v10
    v_and_or_b32 v48, v48, -2, s92
    v_smfmac_f32_16x16x64_bf16 v[52:55], v[40:43], a[224:231], v10
    s_add_u32 s43, s39, 163840
    buffer_store_dwordx2 v[48:49], v7, s[8:11], s43 offen
    v_smfmac_f32_16x16x64_bf16 v[52:55], v[44:47], a[232:239], v10
    v_add_f32 v24, v24, v26
    v_add_f32 v25, v25, v27
    v_cvt_pk_bf16_f32 v24, v24, v25
    v_and_or_b32 v24, v24, -2, s92
    s_add_u32 s43, s39, 278528
    buffer_store_dword v24, v7, s[8:11], s43 offen offset:0
    s_nop 1
    v_cvt_pk_bf16_f32 v52, v52, v53
    v_cvt_pk_bf16_f32 v53, v54, v55
    v_and_or_b32 v52, v52, -2, s92
    s_add_u32 s43, s39, 229376
    buffer_store_dwordx2 v[52:53], v7, s[8:11], s43 offen
    v_mov_b32 v19, s92
    s_xor_b32 s92, s92, 1
    s_mov_b32 s45, s40
    s_mov_b32 s40, s41
    s_mov_b32 s41, s42
    s_mov_b32 s42, s93
    s_mov_b32 s93, s45
    s_add_u32 s38, s38, 1
    s_add_u32 s48, s48, 262144
    s_cmp_ge_u32 s36, 8
    s_cbranch_scc1 L_rd_f2
    s_add_u32 s43, s39, s47
    s_mov_b32 s49, 0
    s_nop 15
    s_nop 15
    s_nop 15
    s_nop 1
    buffer_load_dwordx4 v[32:35], v0, s[8:11], s43 offen offset:0 sc1
    buffer_load_dwordx4 v[36:39], v0, s[8:11], s43 offen offset:1024 sc1
    buffer_load_dwordx4 v[40:43], v0, s[8:11], s43 offen offset:2048 sc1
    buffer_load_dwordx4 v[44:47], v0, s[8:11], s43 offen offset:3072 sc1
    v_mov_b32 v16, 0x3f80
    v_mov_b32 v17, 0x3f800000
    v_cndmask_b32 v16, v16, v17, s[66:67]
    v_cndmask_b32 v20, 0, v16, s[58:59]
    v_cndmask_b32 v21, 0, v16, s[60:61]
    v_cndmask_b32 v22, 0, v16, s[62:63]
    v_cndmask_b32 v23, 0, v16, s[64:65]
    s_nop 15
    s_nop 15
    buffer_load_dwordx4 v[48:51], v0, s[8:11], s43 offen offset:0 sc1
    buffer_load_dwordx4 v[52:55], v0, s[8:11], s43 offen offset:1024 sc1
    buffer_load_dwordx4 v[56:59], v0, s[8:11], s43 offen offset:2048 sc1
    buffer_load_dwordx4 v[60:63], v0, s[8:11], s43 offen offset:3072 sc1
    s_waitcnt vmcnt(7)
    v_mfma_f32_16x16x32_bf16 v[24:27], v[20:23], v[32:35], 0
    v_bitop3_b32 v16, v32, v33, v19 bitop3:0x7e
    v_bitop3_b32 v17, v34, v35, v19 bitop3:0x7e
    v_or_b32 v18, v16, v17
    s_waitcnt vmcnt(6)
    v_mfma_f32_16x16x32_bf16 v[24:27], v[20:23], v[36:39], v[24:27]
    v_bitop3_b32 v16, v36, v37, v19 bitop3:0x7e
    v_bitop3_b32 v17, v38, v39, v19 bitop3:0x7e
    v_or3_b32 v18, v16, v17, v18
    s_waitcnt vmcnt(5)
    v_mfma_f32_16x16x32_bf16 v[24:27], v[20:23], v[40:43], v[24:27]
    v_bitop3_b32 v16, v40, v41, v19 bitop3:0x7e
    v_bitop3_b32 v17, v42, v43, v19 bitop3:0x7e
    v_or3_b32 v18, v16, v17, v18
    s_waitcnt vmcnt(4)
    v_mfma_f32_16x16x32_bf16 v[24:27], v[20:23], v[44:47], v[24:27]
    v_bitop3_b32 v16, v44, v45, v19 bitop3:0x7e
    v_bitop3_b32 v17, v46, v47, v19 bitop3:0x7e
    v_or3_b32 v18, v16, v17, v18
    v_and_b32 v18, 1, v18
    v_cmp_ne_u32 vcc, 0, v18
    s_nop 2
    v_add_f32_dpp v28, v24, v24 row_ror:8 row_mask:0xf bank_mask:0xf
    v_add_f32_dpp v29, v25, v25 row_ror:8 row_mask:0xf bank_mask:0xf
    v_add_f32_dpp v30, v26, v26 row_ror:8 row_mask:0xf bank_mask:0xf
    v_add_f32_dpp v31, v27, v27 row_ror:8 row_mask:0xf bank_mask:0xf
    v_cvt_pk_bf16_f32 v28, v28, v29
    v_cvt_pk_bf16_f32 v29, v30, v31
    s_cbranch_vccnz L_rn0_f2
L_rp_f2:
    buffer_store_dwordx2 v[28:29], v9, s[8:11], s40 offen
L_rd_f2:
    s_cmp_ge_u32 s91, 64
    s_cbranch_scc1 L_kvb_22
    s_waitcnt vmcnt(0)
    s_mov_b32 s91, 1000
    v_readlane_b32 s44, v15, 0
    s_nop 0
    s_mul_i32 s44, s44, 7
    s_add_u32 s44, s44, 0
    s_min_u32 s91, s91, s44
    v_readlane_b32 s44, v15, 1
    s_nop 0
    s_mul_i32 s44, s44, 7
    s_add_u32 s44, s44, 1
    s_min_u32 s91, s91, s44
    v_readlane_b32 s44, v15, 2
    s_nop 0
    s_mul_i32 s44, s44, 7
    s_add_u32 s44, s44, 2
    s_min_u32 s91, s91, s44
    v_readlane_b32 s44, v15, 3
    s_nop 0
    s_mul_i32 s44, s44, 7
    s_add_u32 s44, s44, 3
    s_min_u32 s91, s91, s44
    v_readlane_b32 s44, v15, 4
    s_nop 0
    s_mul_i32 s44, s44, 7
    s_add_u32 s44, s44, 4
    s_min_u32 s91, s91, s44
    v_readlane_b32 s44, v15, 5
    s_nop 0
    s_mul_i32 s44, s44, 7
    s_add_u32 s44, s44, 5
    s_min_u32 s91, s91, s44
    v_readlane_b32 s44, v15, 6
    s_nop 0
    s_mul_i32 s44, s44, 7
    s_add_u32 s44, s44, 6
    s_min_u32 s91, s91, s44
L_kvb_22:
    s_nop 0
    s_branch L_loop_f2
L_ga_f2:
    s_mov_b32 s49, 0
    s_add_u32 s43, s40, 2048
    buffer_load_dwordx4 v[60:63], v0, s[8:11], s43 offen sc1
    s_waitcnt vmcnt(3)
    s_branch L_gac1_f2
L_gaw0_f2:
    s_waitcnt vmcnt(1)
L_gac0_f2:
    ds_write_b128 v0, v[60:63] offset:2048
    v_max3_u32 v14, v60, v61, v62
    v_max_u32 v14, v14, v63
    v_cmp_le_u32 vcc, s51, v14
    s_cbranch_vccz L_ga3_f2
    s_and_b32 s43, s49, 15
    s_cmp_lg_u32 s43, 15
    s_cbranch_scc1 L_gan0_f2
    v_cmp_eq_u32 vcc, s51, v60
    v_cmp_eq_u32 s[44:45], s51, v61
    s_nop 0
    s_or_b64 vcc, vcc, s[44:45]
    v_cmp_eq_u32 s[44:45], s51, v62
    s_nop 0
    s_or_b64 vcc, vcc, s[44:45]
    v_cmp_eq_u32 s[44:45], s51, v63
    s_nop 0
    s_or_b64 vcc, vcc, s[44:45]
    s_cbranch_vccz L_ga3_f2
L_gan0_f2:
    s_add_u32 s43, s40, 2048
    buffer_load_dwordx4 v[60:63], v0, s[8:11], s43 offen sc1
    s_add_u32 s49, s49, 1
    s_cmp_gt_u32 s49, 4000000
    s_cbranch_scc1 L_fail
L_gaw1_f2:
    s_waitcnt vmcnt(1)
L_gac1_f2:
    ds_write_b128 v0, v[56:59] offset:2048
    v_max3_u32 v14, v56, v57, v58
    v_max_u32 v14, v14, v59
    v_cmp_le_u32 vcc, s51, v14
    s_cbranch_vccz L_ga3_f2
    s_and_b32 s43, s49, 15
    s_cmp_lg_u32 s43, 15
    s_cbranch_scc1 L_gan1_f2
    v_cmp_eq_u32 vcc, s51, v56
    v_cmp_eq_u32 s[44:45], s51, v57
    s_nop 0
    s_or_b64 vcc, vcc, s[44:45]
    v_cmp_eq_u32 s[44:45], s51, v58
    s_nop 0
    s_or_b64 vcc, vcc, s[44:45]
    v_cmp_eq_u32 s[44:45], s51, v59
    s_nop 0
    s_or_b64 vcc, vcc, s[44:45]
    s_cbranch_vccz L_ga3_f2
L_gan1_f2:
    s_add_u32 s43, s40, 2048
    buffer_load_dwordx4 v[56:59], v0, s[8:11], s43 offen sc1
    s_add_u32 s49, s49, 1
    s_cmp_gt_u32 s49, 4000000
    s_cbranch_scc1 L_fail
    s_branch L_gaw0_f2
L_ga3_f2:
    s_waitcnt lgkmcnt(0)
    s_waitcnt vmcnt(0)
    s_branch L_gar_f2
L_gb_f2:
    s_mov_b32 s49, 0
    s_add_u32 s43, s40, 6144
    buffer_load_dwordx4 v[32:35], v0, s[8:11], s43 offen sc1
    s_add_u32 s43, s40, 8704
    buffer_load_dword v12, v11, s[8:11], s43 offen sc1
    s_waitcnt vmcnt(2)
    s_branch L_gbc1_f2
L_gbw0_f2:
    s_waitcnt vmcnt(2)
L_gbc0_f2:
    ds_write_b128 v0, v[32:35] offset:6144
    ds_write_b32 v11, v12 offset:8704
    v_max3_u32 v14, v32, v33, v34
    v_max3_u32 v14, v14, v35, v12
    v_cmp_le_u32 vcc, s51, v14
    s_cbranch_vccz L_gb3_f2
    s_and_b32 s43, s49, 15
    s_cmp_lg_u32 s43, 15
    s_cbranch_scc1 L_gbn0_f2
    v_cmp_eq_u32 vcc, s51, v32
    v_cmp_eq_u32 s[44:45], s51, v33
    s_nop 0
    s_or_b64 vcc, vcc, s[44:45]
    v_cmp_eq_u32 s[44:45], s51, v34
    s_nop 0
    s_or_b64 vcc, vcc, s[44:45]
    v_cmp_eq_u32 s[44:45], s51, v35
    s_nop 0
    s_or_b64 vcc, vcc, s[44:45]
    v_cmp_eq_u32 s[44:45], s51, v12
    s_nop 0
    s_or_b64 vcc, vcc, s[44:45]
    s_cbranch_vccz L_gb3_f2
L_gbn0_f2:
    s_add_u32 s43, s40, 6144
    buffer_load_dwordx4 v[32:35], v0, s[8:11], s43 offen sc1
    s_add_u32 s43, s40, 8704
    buffer_load_dword v12, v11, s[8:11], s43 offen sc1
    s_add_u32 s49, s49, 1
    s_cmp_gt_u32 s49, 4000000
    s_cbranch_scc1 L_fail
L_gbw1_f2:
    s_waitcnt vmcnt(2)
L_gbc1_f2:
    ds_write_b128 v0, v[36:39] offset:6144
    ds_write_b32 v11, v13 offset:8704
    v_max3_u32 v14, v36, v37, v38
    v_max3_u32 v14, v14, v39, v13
    v_cmp_le_u32 vcc, s51, v14
    s_cbranch_vccz L_gb3_f2
    s_and_b32 s43, s49, 15
    s_cmp_lg_u32 s43, 15
    s_cbranch_scc1 L_gbn1_f2
    v_cmp_eq_u32 vcc, s51, v36
    v_cmp_eq_u32 s[44:45], s51, v37
    s_nop 0
    s_or_b64 vcc, vcc, s[44:45]
    v_cmp_eq_u32 s[44:45], s51, v38
    s_nop 0
    s_or_b64 vcc, vcc, s[44:45]
    v_cmp_eq_u32 s[44:45], s51, v39
    s_nop 0
    s_or_b64 vcc, vcc, s[44:45]
    v_cmp_eq_u32 s[44:45], s51, v13
    s_nop 0
    s_or_b64 vcc, vcc, s[44:45]
    s_cbranch_vccz L_gb3_f2
L_gbn1_f2:
    s_add_u32 s43, s40, 6144
    buffer_load_dwordx4 v[36:39], v0, s[8:11], s43 offen sc1
    s_add_u32 s43, s40, 8704
    buffer_load_dword v13, v11, s[8:11], s43 offen sc1
    s_add_u32 s49, s49, 1
    s_cmp_gt_u32 s49, 4000000
    s_cbranch_scc1 L_fail
    s_branch L_gbw0_f2
L_gb3_f2:
    s_waitcnt lgkmcnt(0)
    s_waitcnt vmcnt(0)
    s_branch L_gbr_f2
L_rw1_f2:
    s_waitcnt vmcnt(7)
    v_mfma_f32_16x16x32_bf16 v[24:27], v[20:23], v[48:51], 0
    v_bitop3_b32 v16, v48, v49, v19 bitop3:0x7e
    v_bitop3_b32 v17, v50, v51, v19 bitop3:0x7e
    v_or_b32 v18, v16, v17
    s_waitcnt vmcnt(6)
    v_mfma_f32_16x16x32_bf16 v[24:27], v[20:23], v[52:55], v[24:27]
    v_bitop3_b32 v16, v52, v53, v19 bitop3:0x7e
    v_bitop3_b32 v17, v54, v55, v19 bitop3:0x7e
    v_or3_b32 v18, v16, v17, v18
    s_waitcnt vmcnt(5)
    v_mfma_f32_16x16x32_bf16 v[24:27], v[20:23], v[56:59], v[24:27]
    v_bitop3_b32 v16, v56, v57, v19 bitop3:0x7e
    v_bitop3_b32 v17, v58, v59, v19 bitop3:0x7e
    v_or3_b32 v18, v16, v17, v18
    s_waitcnt vmcnt(4)
    v_mfma_f32_16x16x32_bf16 v[24:27], v[20:23], v[60:63], v[24:27]
    v_bitop3_b32 v16, v60, v61, v19 bitop3:0x7e
    v_bitop3_b32 v17, v62, v63, v19 bitop3:0x7e
    v_or3_b32 v18, v16, v17, v18
    v_and_b32 v18, 1, v18
    v_cmp_ne_u32 vcc, 0, v18
    s_nop 2
    v_add_f32_dpp v28, v24, v24 row_ror:8 row_mask:0xf bank_mask:0xf
    v_add_f32_dpp v29, v25, v25 row_ror:8 row_mask:0xf bank_mask:0xf
    v_add_f32_dpp v30, v26, v26 row_ror:8 row_mask:0xf bank_mask:0xf
    v_add_f32_dpp v31, v27, v27 row_ror:8 row_mask:0xf bank_mask:0xf
    v_cvt_pk_bf16_f32 v28, v28, v29
    v_cvt_pk_bf16_f32 v29, v30, v31
    s_cbranch_vccz L_rp_f2
L_rn1_f2:
    buffer_load_dwordx4 v[48:51], v0, s[8:11], s43 offen offset:0 sc1
    buffer_load_dwordx4 v[52:55], v0, s[8:11], s43 offen offset:1024 sc1
    buffer_load_dwordx4 v[56:59], v0, s[8:11], s43 offen offset:2048 sc1
    buffer_load_dwordx4 v[60:63], v0, s[8:11], s43 offen offset:3072 sc1
    s_add_u32 s49, s49, 1
    s_cmp_gt_u32 s49, 4000000
    s_cbranch_scc1 L_fail
L_rw0_f2:
    s_waitcnt vmcnt(7)
    v_mfma_f32_16x16x32_bf16 v[24:27], v[20:23], v[32:35], 0
    v_bitop3_b32 v16, v32, v33, v19 bitop3:0x7e
    v_bitop3_b32 v17, v34, v35, v19 bitop3:0x7e
    v_or_b32 v18, v16, v17
    s_waitcnt vmcnt(6)
    v_mfma_f32_16x16x32_bf16 v[24:27], v[20:23], v[36:39], v[24:27]
    v_bitop3_b32 v16, v36, v37, v19 bitop3:0x7e
    v_bitop3_b32 v17, v38, v39, v19 bitop3:0x7e
    v_or3_b32 v18, v16, v17, v18
    s_waitcnt vmcnt(5)
    v_mfma_f32_16x16x32_bf16 v[24:27], v[20:23], v[40:43], v[24:27]
    v_bitop3_b32 v16, v40, v41, v19 bitop3:0x7e
    v_bitop3_b32 v17, v42, v43, v19 bitop3:0x7e
    v_or3_b32 v18, v16, v17, v18
    s_waitcnt vmcnt(4)
    v_mfma_f32_16x16x32_bf16 v[24:27], v[20:23], v[44:47], v[24:27]
    v_bitop3_b32 v16, v44, v45, v19 bitop3:0x7e
    v_bitop3_b32 v17, v46, v47, v19 bitop3:0x7e
    v_or3_b32 v18, v16, v17, v18
    v_and_b32 v18, 1, v18
    v_cmp_ne_u32 vcc, 0, v18
    s_nop 2
    v_add_f32_dpp v28, v24, v24 row_ror:8 row_mask:0xf bank_mask:0xf
    v_add_f32_dpp v29, v25, v25 row_ror:8 row_mask:0xf bank_mask:0xf
    v_add_f32_dpp v30, v26, v26 row_ror:8 row_mask:0xf bank_mask:0xf
    v_add_f32_dpp v31, v27, v27 row_ror:8 row_mask:0xf bank_mask:0xf
    v_cvt_pk_bf16_f32 v28, v28, v29
    v_cvt_pk_bf16_f32 v29, v30, v31
    s_cbranch_vccz L_rp_f2
L_rn0_f2:
    buffer_load_dwordx4 v[32:35], v0, s[8:11], s43 offen offset:0 sc1
    buffer_load_dwordx4 v[36:39], v0, s[8:11], s43 offen offset:1024 sc1
    buffer_load_dwordx4 v[40:43], v0, s[8:11], s43 offen offset:2048 sc1
    buffer_load_dwordx4 v[44:47], v0, s[8:11], s43 offen offset:3072 sc1
    s_add_u32 s49, s49, 1
    s_cmp_gt_u32 s49, 4000000
    s_cbranch_scc1 L_fail
    s_branch L_rw1_f2
L_slow_f2:
    s_cmp_eq_u32 s46, 0x5105
    s_cbranch_scc1 L_pv3_f2
    s_mov_b32 s46, 0x5105
    s_nop 0
    s_barrier
    s_barrier
    s_branch L_pv_f2
L_pv2_f2:
    ds_read_b128 v[24:27], v0 offset:28672
    ds_read_b128 v[28:31], v0 offset:29696
    s_waitcnt lgkmcnt(0)
    v_mov_b32 v56, 0x3f803f80
    v_mov_b32 v57, 0x3f803f80
    v_mov_b32 v58, 0x3f803f80
    v_mov_b32 v59, 0x3f803f80
    s_nop 1
    v_mfma_f32_16x16x32_bf16 v[36:39], v[56:59], v[48:51], 0
    v_mfma_f32_16x16x32_bf16 v[16:19], v[24:27], v[48:51], 0
    v_mfma_f32_16x16x32_bf16 v[20:23], v[28:31], v[48:51], 0
    v_mfma_f32_16x16x16_bf16 v[36:39], v[32:33], v[54:55], v[36:39]
    v_mfma_f32_16x16x16_bf16 v[16:19], v[40:41], v[54:55], v[16:19]
    v_mfma_f32_16x16x16_bf16 v[20:23], v[44:45], v[54:55], v[20:23]
    s_nop 7
    s_branch L_pv4_f2
L_tail_f2:
    s_waitcnt lgkmcnt(0)
    v_smfmac_f32_16x16x64_bf16 v[44:47], v[60:63], a[120:127], v10
    ds_read_b128 v[16:19], v1 offset:16384
    ds_read_b128 v[20:23], v1 offset:17408
    v_smfmac_f32_16x16x64_bf16 v[40:43], v[48:51], a[128:135], v10
    ds_read_b128 v[24:27], v1 offset:18432
    ds_read_b128 v[28:31], v1 offset:19456
    v_smfmac_f32_16x16x64_bf16 v[44:47], v[48:51], a[136:143], v10
    ds_read_b64_tr_b16 v[60:61], v2 offset:0
    ds_read_b64_tr_b16 v[62:63], v3 offset:0
    v_smfmac_f32_16x16x64_bf16 v[40:43], v[56:59], a[32:39], v10
    ds_read_b64_tr_b16 v[48:49], v2 offset:1024
    ds_read_b64_tr_b16 v[50:51], v3 offset:1024
    v_smfmac_f32_16x16x64_bf16 v[44:47], v[56:59], a[40:47], v10
    ds_read_b64_tr_b16 v[56:57], v2 offset:3072
    ds_read_b64_tr_b16 v[58:59], v3 offset:3072
    s_waitcnt lgkmcnt(4)
    v_smfmac_f32_16x16x64_bf16 v[40:43], v[60:63], a[48:55], v10
    v_smfmac_f32_16x16x64_bf16 v[44:47], v[60:63], a[56:63], v10
    ds_read_b64_tr_b16 v[60:61], v2 offset:6144
    ds_read_b64_tr_b16 v[62:63], v3 offset:6144
    s_waitcnt lgkmcnt(4)
    v_smfmac_f32_16x16x64_bf16 v[40:43], v[48:51], v[16:23], v10
    v_smfmac_f32_16x16x64_bf16 v[44:47], v[48:51], v[24:31], v10
    s_waitcnt lgkmcnt(2)
    v_smfmac_f32_16x16x64_bf16 v[40:43], v[56:59], a[64:71], v10
    v_smfmac_f32_16x16x64_bf16 v[44:47], v[56:59], a[72:79], v10
    s_waitcnt lgkmcnt(0)
    v_smfmac_f32_16x16x64_bf16 v[40:43], v[60:63], a[80:87], v10
    v_smfmac_f32_16x16x64_bf16 v[44:47], v[60:63], a[88:95], v10
    s_nop 3
    v_add_f32 v40, v40, v42
    v_add_f32 v41, v41, v43
    v_cvt_pk_bf16_f32 v40, v40, v41
    s_nop 0
    v_add_f32 v44, v44, v46
    v_add_f32 v45, v45, v47
    v_cvt_pk_bf16_f32 v44, v44, v45
    ds_write_b32 v11, v40 offset:10240
    ds_write_b32 v11, v44 offset:10496
    s_waitcnt vmcnt(0)
    v_and_b32 v12, 0x200, v0
    v_mul_u32_u24 v12, 3, v12
    v_add_u32 v12, v12, v0
    ds_read_b128 v[12:15], v12 offset:10240
    s_waitcnt lgkmcnt(0)
    s_lshr_b32 s44, s48, 1
    s_add_u32 s44, s44, 0x4100800
    buffer_store_dwordx4 v[12:15], v0, s[8:11], s44 offen sc1
    s_waitcnt vmcnt(0)
    s_barrier
    s_branch L_end
L_slowmode_2:
    ds_read_b128 v[32:35], v0 offset:6144
    ds_read_b32 v12, v11 offset:8704
    ds_read_b128 v[40:43], v1 offset:0
    ds_read_b128 v[44:47], v1 offset:1024
    v_mov_b64 v[16:17], 0
    v_mov_b64 v[18:19], 0
    v_mov_b64 v[20:21], 0
    v_mov_b64 v[22:23], 0
    v_mov_b64 v[24:25], 0
    v_mov_b64 v[26:27], 0
    v_mov_b64 v[28:29], 0
    v_mov_b64 v[30:31], 0
    s_waitcnt vmcnt(0) lgkmcnt(0)
    s_nop 0
    s_branch L_gar_s2
L_loop_s2:
    s_barrier
    s_add_u32 s43, s40, 2048
    buffer_load_dwordx4 v[60:63], v0, s[8:11], s43 offen sc1
    v_mov_b64 v[16:17], 0
    v_mov_b64 v[18:19], 0
    v_mov_b64 v[20:21], 0
    v_mov_b64 v[22:23], 0
    v_mov_b64 v[24:25], 0
    v_mov_b64 v[26:27], 0
    v_mov_b64 v[28:29], 0
    v_mov_b64 v[30:31], 0
    s_nop 15
    s_nop 7
    s_add_u32 s43, s40, 2048
    buffer_load_dwordx4 v[56:59], v0, s[8:11], s43 offen sc1
    s_waitcnt vmcnt(1)
    ds_write_b128 v0, v[60:63] offset:2048
    v_max3_u32 v14, v60, v61, v62
    v_max_u32 v14, v14, v63
    v_cmp_le_u32 vcc, s51, v14
    s_add_u32 s43, s40, 6144
    buffer_load_dwordx4 v[32:35], v0, s[8:11], s43 offen sc1
    s_add_u32 s43, s40, 8704
    buffer_load_dword v12, v11, s[8:11], s43 offen sc1
    s_cbranch_vccnz L_ga_s2
L_gar_s2:
    ds_read_b64_tr_b16 v[48:49], v2 offset:2048
    ds_read_b64_tr_b16 v[50:51], v3 offset:2048
    ds_read_b128 v[40:43], v1 offset:0
    ds_read_b128 v[44:47], v1 offset:1024
    s_waitcnt lgkmcnt(4)
    s_barrier
    ds_read_b64_tr_b16 v[52:53], v2 offset:0
    ds_read_b64_tr_b16 v[54:55], v3 offset:0
    s_waitcnt lgkmcnt(4)
    s_waitcnt lgkmcnt(2)
    v_smfmac_f32_16x16x64_bf16 v[16:19], v[48:51], v[40:47], v10
    s_waitcnt vmcnt(2)
    ds_read_b64_tr_b16 v[56:57], v2 offset:1024
    ds_read_b64_tr_b16 v[58:59], v3 offset:1024
    v_smfmac_f32_16x16x64_bf16 v[24:27], v[48:51], v[176:183], v10
    ds_read_b64_tr_b16 v[60:61], v2 offset:3072
    ds_read_b64_tr_b16 v[62:63], v3 offset:3072
    v_smfmac_f32_16x16x64_bf16 v[28:31], v[48:51], v[184:191], v10
    ds_read_b128 v[40:43], v1 offset:2048
    ds_read_b128 v[44:47], v1 offset:3072
    s_waitcnt lgkmcnt(6)
    v_smfmac_f32_16x16x64_bf16 v[16:19], v[52:55], v[64:71], v10
    s_add_u32 s43, s40, 6144
    buffer_load_dwordx4 v[36:39], v0, s[8:11], s43 offen sc1
    s_add_u32 s43, s40, 8704
    buffer_load_dword v13, v11, s[8:11], s43 offen sc1
    v_smfmac_f32_16x16x64_bf16 v[20:23], v[52:55], v[72:79], v10
    v_smfmac_f32_16x16x64_bf16 v[24:27], v[52:55], v[192:199], v10
    s_waitcnt lgkmcnt(0)
    v_smfmac_f32_16x16x64_bf16 v[20:23], v[48:51], v[40:47], v10
    ds_read_b128 v[40:43], v1 offset:8192
    v_smfmac_f32_16x16x64_bf16 v[28:31], v[52:55], v[200:207], v10
    ds_read_b128 v[44:47], v1 offset:9216
    v_smfmac_f32_16x16x64_bf16 v[16:19], v[56:59], v[80:87], v10
    s_waitcnt vmcnt(2)
    ds_write_b128 v0, v[32:35] offset:6144
    v_max3_u32 v14, v32, v33, v34
    v_smfmac_f32_16x16x64_bf16 v[20:23], v[56:59], v[88:95], v10
    ds_write_b32 v11, v12 offset:8704
    v_max3_u32 v14, v14, v35, v12
    v_smfmac_f32_16x16x64_bf16 v[24:27], v[56:59], v[208:215], v10
    v_cmp_le_u32 vcc, s51, v14
    v_smfmac_f32_16x16x64_bf16 v[28:31], v[56:59], v[216:223], v10
    s_cbranch_vccnz L_gb_s2
L_gbr_s2:
    ds_read_b64_tr_b16 v[48:49], v2 offset:6144
    v_smfmac_f32_16x16x64_bf16 v[16:19], v[60:63], v[96:103], v10
    ds_read_b64_tr_b16 v[50:51], v3 offset:6144
    v_smfmac_f32_16x16x64_bf16 v[20:23], v[60:63], v[104:111], v10
    s_waitcnt lgkmcnt(2)
    s_barrier
    ds_read_b64_tr_b16 v[52:53], v2 offset:4096
    ds_read_b64_tr_b16 v[54:55], v3 offset:4096
    v_smfmac_f32_16x16x64_bf16 v[24:27], v[60:63], v[40:47], v10
    s_mov_b32 m0, 0x6000
    s_add_u32 s55, s48, 0x2000000
    buffer_load_dwordx4 v0, s[8:11], s55 offen sc1 lds
    ds_read_b64_tr_b16 v[56:57], v2 offset:5120
    ds_read_b64_tr_b16 v[58:59], v3 offset:5120
    s_waitcnt lgkmcnt(4)
    v_smfmac_f32_16x16x64_bf16 v[16:19], v[48:51], v[112:119], v10
    buffer_load_dwordx4 v0, s[8:11], s55 offen offset:1024 sc1 lds
    s_waitcnt vmcnt(2)
    ds_read_b128 v[32:35], v1 offset:10240
    ds_read_b128 v[36:39], v1 offset:11264
    v_smfmac_f32_16x16x64_bf16 v[20:23], v[48:51], v[120:127], v10
    buffer_load_dwordx4 v0, s[8:11], s55 offen offset:2048 sc1 lds
    ds_read_b128 v[40:43], v1 offset:4096
    ds_read_b128 v[44:47], v1 offset:5120
    v_smfmac_f32_16x16x64_bf16 v[24:27], v[48:51], v[224:231], v10
    buffer_load_dwordx4 v0, s[8:11], s55 offen offset:3072 sc1 lds
    v_smfmac_f32_16x16x64_bf16 v[28:31], v[48:51], v[232:239], v10
    ds_read_b64_tr_b16 v[48:49], v2 offset:8192
    ds_read_b64_tr_b16 v[50:51], v3 offset:8192
    s_waitcnt lgkmcnt(8)
    v_smfmac_f32_16x16x64_bf16 v[24:27], v[52:55], v[240:247], v10
    s_waitcnt lgkmcnt(4)
    v_smfmac_f32_16x16x64_bf16 v[28:31], v[60:63], v[32:39], v10
    ds_read_b64_tr_b16 v[60:61], v2 offset:7168
    s_waitcnt lgkmcnt(3)
    v_smfmac_f32_16x16x64_bf16 v[16:19], v[52:55], v[40:47], v10
    ds_read_b64_tr_b16 v[62:63], v3 offset:7168
    v_smfmac_f32_16x16x64_bf16 v[28:31], v[52:55], v[248:255], v10
    ds_read_b128 v[32:35], v1 offset:6144
    v_lshlrev_b32 v12, 3, v0
    v_smfmac_f32_16x16x64_bf16 v[16:19], v[56:59], v[128:135], v10
    s_mov_b32 m0, 0x3e80
    s_add_u32 s44, s48, 0x1040000
    buffer_load_dword v12, s[8:11], s44 offen sc1 lds
    ds_read_b128 v[36:39], v1 offset:7168
    v_and_b32 v12, 0x200, v0
    v_smfmac_f32_16x16x64_bf16 v[20:23], v[56:59], v[136:143], v10
    ds_read_b128 v[40:43], v1 offset:12288
    v_mul_u32_u24 v12, 3, v12
    s_waitcnt lgkmcnt(3)
    v_smfmac_f32_16x16x64_bf16 v[16:19], v[60:63], v[144:151], v10
    ds_read_b128 v[44:47], v1 offset:13312
    v_add_u32 v12, v12, v0
    s_waitcnt lgkmcnt(2)
    v_smfmac_f32_16x16x64_bf16 v[20:23], v[52:55], v[32:39], v10
    ds_read_b128 v[12:15], v12 offset:10240
    v_smfmac_f32_16x16x64_bf16 v[20:23], v[60:63], v[152:159], v10
    ds_read_b128 v[32:35], v1 offset:14336
    v_smfmac_f32_16x16x64_bf16 v[16:19], v[48:51], v[160:167], v10
    ds_read_b128 v[36:39], v1 offset:15360
    v_smfmac_f32_16x16x64_bf16 v[20:23], v[48:51], v[168:175], v10
    s_waitcnt lgkmcnt(3)
    v_smfmac_f32_16x16x64_bf16 v[24:27], v[56:59], v[40:47], v10
    s_waitcnt lgkmcnt(2)
    s_lshr_b32 s44, s48, 1
    s_add_u32 s44, s44, 0x40e0800
    buffer_store_dwordx4 v[12:15], v0, s[8:11], s44 offen sc1
    v_add_f32 v16, v16, v18
    v_add_f32 v17, v17, v19
    s_waitcnt lgkmcnt(0)
    v_smfmac_f32_16x16x64_bf16 v[28:31], v[56:59], v[32:39], v10
    ds_read_b128 v[32:35], v1 offset:22528
    v_cvt_pk_bf16_f32 v16, v16, v17
    v_add_f32 v20, v20, v22
    v_smfmac_f32_16x16x64_bf16 v[24:27], v[60:63], a[0:7], v10
    ds_read_b128 v[36:39], v1 offset:23552
    v_add_f32 v21, v21, v23
    v_cvt_pk_bf16_f32 v17, v20, v21
    v_smfmac_f32_16x16x64_bf16 v[24:27], v[48:51], a[16:23], v10
    ds_write_b64 v4, v[16:17] offset:10240
    v_mov_b64 v[40:41], 0
    v_mov_b64 v[42:43], 0
    v_smfmac_f32_16x16x64_bf16 v[28:31], v[60:63], a[8:15], v10
    ds_read_b128 v[16:19], v1 offset:20480
    v_mov_b64 v[44:45], 0
    v_mov_b64 v[46:47], 0
    v_smfmac_f32_16x16x64_bf16 v[28:31], v[48:51], a[24:31], v10
    ds_read_b128 v[20:23], v1 offset:21504
    v_add_f32 v24, v24, v26
    v_add_f32 v25, v25, v27
    v_cvt_pk_bf16_f32 v24, v24, v25
    v_smfmac_f32_16x16x64_bf16 v[40:43], v[52:55], a[96:103], v10
    s_add_u32 s55, s38, 2
    s_min_u32 s55, s55, 63
    s_cmp_lt_u32 s55, s91
    s_cbranch_scc1 L_kf_23_d
    s_mov_b32 s49, 0
    s_lshl_b32 s44, s36, 7
    s_add_u32 s44, s44, 0x180000
    v_lshrrev_b32 v13, 2, v0
    v_and_b32 v13, 28, v13
L_kf_23:
    buffer_load_dword v14, v13, s[8:11], s44 offen sc1
    s_add_u32 s49, s49, 1
    s_cmp_gt_u32 s49, 4000000
    s_cbranch_scc1 L_fail
    s_mov_b32 s91, 1000
    s_waitcnt vmcnt(0)
    v_readlane_b32 s45, v14, 0
    s_nop 0
    s_mul_i32 s45, s45, 7
    s_add_u32 s45, s45, 0
    s_min_u32 s91, s91, s45
    v_readlane_b32 s45, v14, 1
    s_nop 0
    s_mul_i32 s45, s45, 7
    s_add_u32 s45, s45, 1
    s_min_u32 s91, s91, s45
    v_readlane_b32 s45, v14, 2
    s_nop 0
    s_mul_i32 s45, s45, 7
    s_add_u32 s45, s45, 2
    s_min_u32 s91, s91, s45
    v_readlane_b32 s45, v14, 3
    s_nop 0
    s_mul_i32 s45, s45, 7
    s_add_u32 s45, s45, 3
    s_min_u32 s91, s91, s45
    v_readlane_b32 s45, v14, 4
    s_nop 0
    s_mul_i32 s45, s45, 7
    s_add_u32 s45, s45, 4
    s_min_u32 s91, s91, s45
    v_readlane_b32 s45, v14, 5
    s_nop 0
    s_mul_i32 s45, s45, 7
    s_add_u32 s45, s45, 5
    s_min_u32 s91, s91, s45
    v_readlane_b32 s45, v14, 6
    s_nop 0
    s_mul_i32 s45, s45, 7
    s_add_u32 s45, s45, 6
    s_min_u32 s91, s91, s45
    s_cmp_lt_u32 s55, s91
    s_cbranch_scc0 L_kf_23
L_kf_23_d:
    v_smfmac_f32_16x16x64_bf16 v[44:47], v[52:55], a[104:111], v10
    v_add_f32 v28, v28, v30
    v_add_f32 v29, v29, v31
    v_cvt_pk_bf16_f32 v25, v28, v29
    ds_write2st64_b32 v11, v24, v25 offset0:48 offset1:49
    s_waitcnt lgkmcnt(4)
    v_smfmac_f32_16x16x64_bf16 v[44:47], v[56:59], v[32:39], v10
    v_smfmac_f32_16x16x64_bf16 v[40:43], v[60:63], a[112:119], v10
    s_waitcnt lgkmcnt(1)
    v_smfmac_f32_16x16x64_bf16 v[40:43], v[56:59], v[16:23], v10
    ds_read_b64_tr_b16 v[56:57], v2 offset:2048
    ds_read_b64_tr_b16 v[58:59], v3 offset:2048
    s_waitcnt lgkmcnt(2)
    s_barrier
    s_cmp_eq_u32 s38, 63
    s_cbranch_scc1 L_tail_s2
    v_smfmac_f32_16x16x64_bf16 v[44:47], v[60:63], a[120:127], v10
    ds_read_b128 v[16:19], v1 offset:16384
    ds_read_b128 v[20:23], v1 offset:17408
    v_smfmac_f32_16x16x64_bf16 v[40:43], v[48:51], a[128:135], v10
    ds_read_b128 v[24:27], v1 offset:18432
    ds_read_b128 v[28:31], v1 offset:19456
    v_smfmac_f32_16x16x64_bf16 v[44:47], v[48:51], a[136:143], v10
    ds_read_b64_tr_b16 v[60:61], v2 offset:0
    ds_read_b64_tr_b16 v[62:63], v3 offset:0
    s_waitcnt lgkmcnt(6)
    v_smfmac_f32_16x16x64_bf16 v[40:43], v[56:59], a[32:39], v10
    ds_read_b64_tr_b16 v[48:49], v2 offset:1024
    ds_read_b64_tr_b16 v[50:51], v3 offset:1024
    v_smfmac_f32_16x16x64_bf16 v[44:47], v[56:59], a[40:47], v10
    ds_read_b64_tr_b16 v[56:57], v2 offset:3072
    ds_read_b64_tr_b16 v[58:59], v3 offset:3072
    s_waitcnt lgkmcnt(4)
    v_smfmac_f32_16x16x64_bf16 v[40:43], v[60:63], a[48:55], v10
    v_smfmac_f32_16x16x64_bf16 v[44:47], v[60:63], a[56:63], v10
    ds_read_b64_tr_b16 v[60:61], v2 offset:6144
    ds_read_b64_tr_b16 v[62:63], v3 offset:6144
    s_waitcnt lgkmcnt(4)
    v_smfmac_f32_16x16x64_bf16 v[40:43], v[48:51], v[16:23], v10
    v_smfmac_f32_16x16x64_bf16 v[44:47], v[48:51], v[24:31], v10
    s_waitcnt lgkmcnt(2)
    v_smfmac_f32_16x16x64_bf16 v[40:43], v[56:59], a[64:71], v10
    v_smfmac_f32_16x16x64_bf16 v[44:47], v[56:59], a[72:79], v10
    s_waitcnt lgkmcnt(0)
    v_smfmac_f32_16x16x64_bf16 v[40:43], v[60:63], a[80:87], v10
    v_smfmac_f32_16x16x64_bf16 v[44:47], v[60:63], a[88:95], v10
    s_waitcnt vmcnt(2)
    s_barrier
    s_cmp_ge_u32 s91, 64
    s_cbranch_scc1 L_kva_24
    s_lshl_b32 s44, s36, 7
    s_add_u32 s44, s44, 0x180000
    v_lshrrev_b32 v14, 2, v0
    v_and_b32 v14, 28, v14
    buffer_load_dword v15, v14, s[8:11], s44 offen sc1
L_kva_24:
L_pv_s2:
    ds_read_b64_tr_b16 v[48:49], v5 offset:15360
    ds_read_b64_tr_b16 v[50:51], v5 offset:15616
    ds_read_b64_tr_b16 v[54:55], v8 offset:15872
    s_cmp_eq_u32 s46, 0x5105
    s_cbranch_scc1 L_pv2_s2
    ds_read_b128 v[24:27], v0 offset:28672
    ds_read_b128 v[28:31], v0 offset:29696
    v_mov_b64 v[32:33], s[98:99]
    v_mov_b64 v[56:57], s[96:97]
    v_mov_b64 v[58:59], s[96:97]
    s_waitcnt lgkmcnt(0)
    s_nop 0
    v_mfma_f32_16x16x32_bf16 v[36:39], v[56:59], v[48:51], 0
    v_mfma_f32_16x16x32_bf16 v[16:19], v[24:27], v[48:51], 0
    v_add_f32 v40, v40, v42
    v_add_f32 v41, v41, v43
    v_mfma_f32_16x16x32_bf16 v[20:23], v[28:31], v[48:51], 0
    v_cvt_pk_bf16_f32 v40, v40, v41
    v_mov_b32 v41, 0
    v_mfma_f32_16x16x16_bf16 v[36:39], v[32:33], v[54:55], v[36:39]
    v_add_f32 v44, v44, v46
    v_add_f32 v45, v45, v47
    v_mfma_f32_16x16x16_bf16 v[16:19], v[40:41], v[54:55], v[16:19]
    v_cvt_pk_bf16_f32 v44, v44, v45
    v_mov_b32 v45, 0
    s_nop 1
    v_mfma_f32_16x16x16_bf16 v[20:23], v[44:45], v[54:55], v[20:23]
L_pv4_s2:
    ds_read_b128 v[56:59], v1 offset:24576
    ds_read_b128 v[60:63], v1 offset:25600
    ds_read_b128 v[24:27], v1 offset:26624
    ds_read_b128 v[28:31], v1 offset:27648
    v_rcp_f32 v34, v36
    v_cmp_ngt_f32 vcc, s69, v36
    v_cmp_nlt_f32 s[44:45], s68, v36
    v_cndmask_b32 v16, v18, v16, s[56:57]
    v_cndmask_b32 v17, v19, v17, s[56:57]
    s_or_b64 vcc, vcc, s[44:45]
    v_mul_f32 v16, v16, v34
    v_mul_f32 v17, v17, v34
    v_cndmask_b32 v20, v22, v20, s[56:57]
    v_cndmask_b32 v21, v23, v21, s[56:57]
    v_cvt_pk_bf16_f32 v16, v16, v17
    v_mul_f32 v20, v20, v34
    v_mul_f32 v21, v21, v34
    s_cbranch_vccnz L_slow_s2
L_pv3_s2:
    v_cvt_pk_bf16_f32 v20, v20, v21
    ds_write2_b32 v6, v16, v20 offset0:0 offset1:2
    s_mov_b32 s46, 0
    v_lshrrev_b32 v12, 1, v0
    v_and_b32 v12, 0x1e0, v12
    v_and_or_b32 v12, v0, 16, v12
    v_mov_b64 v[48:49], 0
    v_mov_b64 v[50:51], 0
    v_mov_b64 v[52:53], 0
    v_mov_b64 v[54:55], 0
    v_mov_b64 v[16:17], 0
    v_mov_b64 v[18:19], 0
    v_mov_b64 v[20:21], 0
    v_mov_b64 v[22:23], 0
    s_waitcnt lgkmcnt(0)
    s_barrier
    ds_read_b128 v[32:35], v12 offset:13312
    ds_read_b128 v[36:39], v12 offset:13824
    ds_write2st64_b32 v11, v40, v44 offset0:40 offset1:41
    ds_read_b128 v[40:43], v12 offset:14336
    ds_read_b128 v[44:47], v12 offset:14848
    s_waitcnt lgkmcnt(4)
    v_smfmac_f32_16x16x64_bf16 v[16:19], v[32:35], v[56:63], v10
    ds_read_b128 v[56:59], v1 offset:28672
    v_smfmac_f32_16x16x64_bf16 v[20:23], v[32:35], a[144:151], v10
    ds_read_b128 v[60:63], v1 offset:29696
    s_waitcnt lgkmcnt(5)
    v_smfmac_f32_16x16x64_bf16 v[16:19], v[36:39], v[24:31], v10
    ds_read_b128 v[24:27], v1 offset:30720
    v_smfmac_f32_16x16x64_bf16 v[20:23], v[36:39], a[152:159], v10
    ds_read_b128 v[28:31], v1 offset:31744
    s_waitcnt lgkmcnt(5)
    v_smfmac_f32_16x16x64_bf16 v[16:19], v[40:43], a[176:183], v10
    v_smfmac_f32_16x16x64_bf16 v[20:23], v[40:43], a[192:199], v10
    s_waitcnt lgkmcnt(4)
    v_smfmac_f32_16x16x64_bf16 v[16:19], v[44:47], a[184:191], v10
    v_smfmac_f32_16x16x64_bf16 v[20:23], v[44:47], a[200:207], v10
    s_waitcnt lgkmcnt(2)
    v_smfmac_f32_16x16x64_bf16 v[48:51], v[32:35], v[56:63], v10
    v_cvt_pk_bf16_f32 v16, v16, v17
    v_cvt_pk_bf16_f32 v17, v18, v19
    v_and_or_b32 v16, v16, -2, s92
    s_waitcnt lgkmcnt(0)
    v_smfmac_f32_16x16x64_bf16 v[48:51], v[36:39], v[24:31], v10
    s_add_u32 s43, s39, 32768
    buffer_store_dwordx2 v[16:17], v7, s[8:11], s43 offen sc1
    v_cvt_pk_bf16_f32 v20, v20, v21
    v_cvt_pk_bf16_f32 v21, v22, v23
    v_and_or_b32 v20, v20, -2, s92
    v_smfmac_f32_16x16x64_bf16 v[48:51], v[40:43], a[208:215], v10
    s_add_u32 s43, s39, 98304
    buffer_store_dwordx2 v[20:21], v7, s[8:11], s43 offen sc1
    v_cndmask_b32 v56, v32, v36, s[100:101]
    v_cndmask_b32 v57, v33, v37, s[100:101]
    v_cndmask_b32 v58, v34, v38, s[100:101]
    v_smfmac_f32_16x16x64_bf16 v[48:51], v[44:47], a[216:223], v10
    v_cndmask_b32 v59, v35, v39, s[100:101]
    v_cndmask_b32 v60, v40, v44, s[100:101]
    v_cndmask_b32 v61, v41, v45, s[100:101]
    v_smfmac_f32_16x16x64_bf16 v[52:55], v[32:35], a[160:167], v10
    v_cndmask_b32 v62, v42, v46, s[100:101]
    v_cndmask_b32 v63, v43, v47, s[100:101]
    v_mov_b64 v[24:25], 0
    v_smfmac_f32_16x16x64_bf16 v[52:55], v[36:39], a[168:175], v10
    v_mov_b64 v[26:27], 0
    s_nop 1
    v_smfmac_f32_16x16x64_bf16 v[24:27], v[56:59], a[240:247], v10
    v_cvt_pk_bf16_f32 v48, v48, v49
    v_cvt_pk_bf16_f32 v49, v50, v51
    v_smfmac_f32_16x16x64_bf16 v[24:27], v[60:63], a[248:255], v10
    v_and_or_b32 v48, v48, -2, s92
    v_smfmac_f32_16x16x64_bf16 v[52:55], v[40:43], a[224:231], v10
    s_add_u32 s43, s39, 163840
    buffer_store_dwordx2 v[48:49], v7, s[8:11], s43 offen sc1
    v_smfmac_f32_16x16x64_bf16 v[52:55], v[44:47], a[232:239], v10
    v_add_f32 v24, v24, v26
    v_add_f32 v25, v25, v27
    v_cvt_pk_bf16_f32 v24, v24, v25
    v_and_or_b32 v24, v24, -2, s92
    s_add_u32 s43, s39, 278528
    buffer_store_dword v24, v7, s[8:11], s43 offen offset:0 sc1
    s_nop 1
    v_cvt_pk_bf16_f32 v52, v52, v53
    v_cvt_pk_bf16_f32 v53, v54, v55
    v_and_or_b32 v52, v52, -2, s92
    s_add_u32 s43, s39, 229376
    buffer_store_dwordx2 v[52:53], v7, s[8:11], s43 offen sc1
    v_mov_b32 v19, s92
    s_xor_b32 s92, s92, 1
    s_mov_b32 s45, s40
    s_mov_b32 s40, s41
    s_mov_b32 s41, s42
    s_mov_b32 s42, s93
    s_mov_b32 s93, s45
    s_add_u32 s38, s38, 1
    s_add_u32 s48, s48, 262144
    s_cmp_ge_u32 s36, 8
    s_cbranch_scc1 L_rd_s2
    s_add_u32 s43, s39, s47
    s_mov_b32 s49, 0
    s_nop 15
    s_nop 15
    s_nop 15
    s_nop 1
    buffer_load_dwordx4 v[32:35], v0, s[8:11], s43 offen offset:0 sc1
    buffer_load_dwordx4 v[36:39], v0, s[8:11], s43 offen offset:1024 sc1
    buffer_load_dwordx4 v[40:43], v0, s[8:11], s43 offen offset:2048 sc1
    buffer_load_dwordx4 v[44:47], v0, s[8:11], s43 offen offset:3072 sc1
    v_mov_b32 v16, 0x3f80
    v_mov_b32 v17, 0x3f800000
    v_cndmask_b32 v16, v16, v17, s[66:67]
    v_cndmask_b32 v20, 0, v16, s[58:59]
    v_cndmask_b32 v21, 0, v16, s[60:61]
    v_cndmask_b32 v22, 0, v16, s[62:63]
    v_cndmask_b32 v23, 0, v16, s[64:65]
    s_nop 15
    s_nop 15
    buffer_load_dwordx4 v[48:51], v0, s[8:11], s43 offen offset:0 sc1
    buffer_load_dwordx4 v[52:55], v0, s[8:11], s43 offen offset:1024 sc1
    buffer_load_dwordx4 v[56:59], v0, s[8:11], s43 offen offset:2048 sc1
    buffer_load_dwordx4 v[60:63], v0, s[8:11], s43 offen offset:3072 sc1
    s_waitcnt vmcnt(7)
    v_mfma_f32_16x16x32_bf16 v[24:27], v[20:23], v[32:35], 0
    v_bitop3_b32 v16, v32, v33, v19 bitop3:0x7e
    v_bitop3_b32 v17, v34, v35, v19 bitop3:0x7e
    v_or_b32 v18, v16, v17
    s_waitcnt vmcnt(6)
    v_mfma_f32_16x16x32_bf16 v[24:27], v[20:23], v[36:39], v[24:27]
    v_bitop3_b32 v16, v36, v37, v19 bitop3:0x7e
    v_bitop3_b32 v17, v38, v39, v19 bitop3:0x7e
    v_or3_b32 v18, v16, v17, v18
    s_waitcnt vmcnt(5)
    v_mfma_f32_16x16x32_bf16 v[24:27], v[20:23], v[40:43], v[24:27]
    v_bitop3_b32 v16, v40, v41, v19 bitop3:0x7e
    v_bitop3_b32 v17, v42, v43, v19 bitop3:0x7e
    v_or3_b32 v18, v16, v17, v18
    s_waitcnt vmcnt(4)
    v_mfma_f32_16x16x32_bf16 v[24:27], v[20:23], v[44:47], v[24:27]
    v_bitop3_b32 v16, v44, v45, v19 bitop3:0x7e
    v_bitop3_b32 v17, v46, v47, v19 bitop3:0x7e
    v_or3_b32 v18, v16, v17, v18
    v_and_b32 v18, 1, v18
    v_cmp_ne_u32 vcc, 0, v18
    s_nop 2
    v_add_f32_dpp v28, v24, v24 row_ror:8 row_mask:0xf bank_mask:0xf
    v_add_f32_dpp v29, v25, v25 row_ror:8 row_mask:0xf bank_mask:0xf
    v_add_f32_dpp v30, v26, v26 row_ror:8 row_mask:0xf bank_mask:0xf
    v_add_f32_dpp v31, v27, v27 row_ror:8 row_mask:0xf bank_mask:0xf
    v_cvt_pk_bf16_f32 v28, v28, v29
    v_cvt_pk_bf16_f32 v29, v30, v31
    s_cbranch_vccnz L_rn0_s2
L_rp_s2:
    buffer_store_dwordx2 v[28:29], v9, s[8:11], s40 offen sc1
L_rd_s2:
    s_cmp_ge_u32 s91, 64
    s_cbranch_scc1 L_kvb_25
    s_waitcnt vmcnt(0)
    s_mov_b32 s91, 1000
    v_readlane_b32 s44, v15, 0
    s_nop 0
    s_mul_i32 s44, s44, 7
    s_add_u32 s44, s44, 0
    s_min_u32 s91, s91, s44
    v_readlane_b32 s44, v15, 1
    s_nop 0
    s_mul_i32 s44, s44, 7
    s_add_u32 s44, s44, 1
    s_min_u32 s91, s91, s44
    v_readlane_b32 s44, v15, 2
    s_nop 0
    s_mul_i32 s44, s44, 7
    s_add_u32 s44, s44, 2
    s_min_u32 s91, s91, s44
    v_readlane_b32 s44, v15, 3
    s_nop 0
    s_mul_i32 s44, s44, 7
    s_add_u32 s44, s44, 3
    s_min_u32 s91, s91, s44
    v_readlane_b32 s44, v15, 4
    s_nop 0
    s_mul_i32 s44, s44, 7
    s_add_u32 s44, s44, 4
    s_min_u32 s91, s91, s44
    v_readlane_b32 s44, v15, 5
    s_nop 0
    s_mul_i32 s44, s44, 7
    s_add_u32 s44, s44, 5
    s_min_u32 s91, s91, s44
    v_readlane_b32 s44, v15, 6
    s_nop 0
    s_mul_i32 s44, s44, 7
    s_add_u32 s44, s44, 6
    s_min_u32 s91, s91, s44
L_kvb_25:
    s_nop 0
    s_branch L_loop_s2
L_ga_s2:
    s_mov_b32 s49, 0
    s_add_u32 s43, s40, 2048
    buffer_load_dwordx4 v[60:63], v0, s[8:11], s43 offen sc1
    s_waitcnt vmcnt(3)
    s_branch L_gac1_s2
L_gaw0_s2:
    s_waitcnt vmcnt(1)
L_gac0_s2:
    ds_write_b128 v0, v[60:63] offset:2048
    v_max3_u32 v14, v60, v61, v62
    v_max_u32 v14, v14, v63
    v_cmp_le_u32 vcc, s51, v14
    s_cbranch_vccz L_ga3_s2
    s_and_b32 s43, s49, 15
    s_cmp_lg_u32 s43, 15
    s_cbranch_scc1 L_gan0_s2
    v_cmp_eq_u32 vcc, s51, v60
    v_cmp_eq_u32 s[44:45], s51, v61
    s_nop 0
    s_or_b64 vcc, vcc, s[44:45]
    v_cmp_eq_u32 s[44:45], s51, v62
    s_nop 0
    s_or_b64 vcc, vcc, s[44:45]
    v_cmp_eq_u32 s[44:45], s51, v63
    s_nop 0
    s_or_b64 vcc, vcc, s[44:45]
    s_cbranch_vccz L_ga3_s2
L_gan0_s2:
    s_add_u32 s43, s40, 2048
    buffer_load_dwordx4 v[60:63], v0, s[8:11], s43 offen sc1
    s_add_u32 s49, s49, 1
    s_cmp_gt_u32 s49, 4000000
    s_cbranch_scc1 L_fail
L_gaw1_s2:
    s_waitcnt vmcnt(1)
L_gac1_s2:
    ds_write_b128 v0, v[56:59] offset:2048
    v_max3_u32 v14, v56, v57, v58
    v_max_u32 v14, v14, v59
    v_cmp_le_u32 vcc, s51, v14
    s_cbranch_vccz L_ga3_s2
    s_and_b32 s43, s49, 15
    s_cmp_lg_u32 s43, 15
    s_cbranch_scc1 L_gan1_s2
    v_cmp_eq_u32 vcc, s51, v56
    v_cmp_eq_u32 s[44:45], s51, v57
    s_nop 0
    s_or_b64 vcc, vcc, s[44:45]
    v_cmp_eq_u32 s[44:45], s51, v58
    s_nop 0
    s_or_b64 vcc, vcc, s[44:45]
    v_cmp_eq_u32 s[44:45], s51, v59
    s_nop 0
    s_or_b64 vcc, vcc, s[44:45]
    s_cbranch_vccz L_ga3_s2
L_gan1_s2:
    s_add_u32 s43, s40, 2048
    buffer_load_dwordx4 v[56:59], v0, s[8:11], s43 offen sc1
    s_add_u32 s49, s49, 1
    s_cmp_gt_u32 s49, 4000000
    s_cbranch_scc1 L_fail
    s_branch L_gaw0_s2
L_ga3_s2:
    s_waitcnt lgkmcnt(0)
    s_waitcnt vmcnt(0)
    s_branch L_gar_s2
L_gb_s2:
    s_mov_b32 s49, 0
    s_add_u32 s43, s40, 6144
    buffer_load_dwordx4 v[32:35], v0, s[8:11], s43 offen sc1
    s_add_u32 s43, s40, 8704
    buffer_load_dword v12, v11, s[8:11], s43 offen sc1
    s_waitcnt vmcnt(2)
    s_branch L_gbc1_s2
L_gbw0_s2:
    s_waitcnt vmcnt(2)
L_gbc0_s2:
    ds_write_b128 v0, v[32:35] offset:6144
    ds_write_b32 v11, v12 offset:8704
    v_max3_u32 v14, v32, v33, v34
    v_max3_u32 v14, v14, v35, v12
    v_cmp_le_u32 vcc, s51, v14
    s_cbranch_vccz L_gb3_s2
    s_and_b32 s43, s49, 15
    s_cmp_lg_u32 s43, 15
    s_cbranch_scc1 L_gbn0_s2
    v_cmp_eq_u32 vcc, s51, v32
    v_cmp_eq_u32 s[44:45], s51, v33
    s_nop 0
    s_or_b64 vcc, vcc, s[44:45]
    v_cmp_eq_u32 s[44:45], s51, v34
    s_nop 0
    s_or_b64 vcc, vcc, s[44:45]
    v_cmp_eq_u32 s[44:45], s51, v35
    s_nop 0
    s_or_b64 vcc, vcc, s[44:45]
    v_cmp_eq_u32 s[44:45], s51, v12
    s_nop 0
    s_or_b64 vcc, vcc, s[44:45]
    s_cbranch_vccz L_gb3_s2
L_gbn0_s2:
    s_add_u32 s43, s40, 6144
    buffer_load_dwordx4 v[32:35], v0, s[8:11], s43 offen sc1
    s_add_u32 s43, s40, 8704
    buffer_load_dword v12, v11, s[8:11], s43 offen sc1
    s_add_u32 s49, s49, 1
    s_cmp_gt_u32 s49, 4000000
    s_cbranch_scc1 L_fail
L_gbw1_s2:
    s_waitcnt vmcnt(2)
L_gbc1_s2:
    ds_write_b128 v0, v[36:39] offset:6144
    ds_write_b32 v11, v13 offset:8704
    v_max3_u32 v14, v36, v37, v38
    v_max3_u32 v14, v14, v39, v13
    v_cmp_le_u32 vcc, s51, v14
    s_cbranch_vccz L_gb3_s2
    s_and_b32 s43, s49, 15
    s_cmp_lg_u32 s43, 15
    s_cbranch_scc1 L_gbn1_s2
    v_cmp_eq_u32 vcc, s51, v36
    v_cmp_eq_u32 s[44:45], s51, v37
    s_nop 0
    s_or_b64 vcc, vcc, s[44:45]
    v_cmp_eq_u32 s[44:45], s51, v38
    s_nop 0
    s_or_b64 vcc, vcc, s[44:45]
    v_cmp_eq_u32 s[44:45], s51, v39
    s_nop 0
    s_or_b64 vcc, vcc, s[44:45]
    v_cmp_eq_u32 s[44:45], s51, v13
    s_nop 0
    s_or_b64 vcc, vcc, s[44:45]
    s_cbranch_vccz L_gb3_s2
L_gbn1_s2:
    s_add_u32 s43, s40, 6144
    buffer_load_dwordx4 v[36:39], v0, s[8:11], s43 offen sc1
    s_add_u32 s43, s40, 8704
    buffer_load_dword v13, v11, s[8:11], s43 offen sc1
    s_add_u32 s49, s49, 1
    s_cmp_gt_u32 s49, 4000000
    s_cbranch_scc1 L_fail
    s_branch L_gbw0_s2
L_gb3_s2:
    s_waitcnt lgkmcnt(0)
    s_waitcnt vmcnt(0)
    s_branch L_gbr_s2
L_rw1_s2:
    s_waitcnt vmcnt(7)
    v_mfma_f32_16x16x32_bf16 v[24:27], v[20:23], v[48:51], 0
    v_bitop3_b32 v16, v48, v49, v19 bitop3:0x7e
    v_bitop3_b32 v17, v50, v51, v19 bitop3:0x7e
    v_or_b32 v18, v16, v17
    s_waitcnt vmcnt(6)
    v_mfma_f32_16x16x32_bf16 v[24:27], v[20:23], v[52:55], v[24:27]
    v_bitop3_b32 v16, v52, v53, v19 bitop3:0x7e
    v_bitop3_b32 v17, v54, v55, v19 bitop3:0x7e
    v_or3_b32 v18, v16, v17, v18
    s_waitcnt vmcnt(5)
    v_mfma_f32_16x16x32_bf16 v[24:27], v[20:23], v[56:59], v[24:27]
    v_bitop3_b32 v16, v56, v57, v19 bitop3:0x7e
    v_bitop3_b32 v17, v58, v59, v19 bitop3:0x7e
    v_or3_b32 v18, v16, v17, v18
    s_waitcnt vmcnt(4)
    v_mfma_f32_16x16x32_bf16 v[24:27], v[20:23], v[60:63], v[24:27]
    v_bitop3_b32 v16, v60, v61, v19 bitop3:0x7e
    v_bitop3_b32 v17, v62, v63, v19 bitop3:0x7e
    v_or3_b32 v18, v16, v17, v18
    v_and_b32 v18, 1, v18
    v_cmp_ne_u32 vcc, 0, v18
    s_nop 2
    v_add_f32_dpp v28, v24, v24 row_ror:8 row_mask:0xf bank_mask:0xf
    v_add_f32_dpp v29, v25, v25 row_ror:8 row_mask:0xf bank_mask:0xf
    v_add_f32_dpp v30, v26, v26 row_ror:8 row_mask:0xf bank_mask:0xf
    v_add_f32_dpp v31, v27, v27 row_ror:8 row_mask:0xf bank_mask:0xf
    v_cvt_pk_bf16_f32 v28, v28, v29
    v_cvt_pk_bf16_f32 v29, v30, v31
    s_cbranch_vccz L_rp_s2
L_rn1_s2:
    buffer_load_dwordx4 v[48:51], v0, s[8:11], s43 offen offset:0 sc1
    buffer_load_dwordx4 v[52:55], v0, s[8:11], s43 offen offset:1024 sc1
    buffer_load_dwordx4 v[56:59], v0, s[8:11], s43 offen offset:2048 sc1
    buffer_load_dwordx4 v[60:63], v0, s[8:11], s43 offen offset:3072 sc1
    s_add_u32 s49, s49, 1
    s_cmp_gt_u32 s49, 4000000
    s_cbranch_scc1 L_fail
L_rw0_s2:
    s_waitcnt vmcnt(7)
    v_mfma_f32_16x16x32_bf16 v[24:27], v[20:23], v[32:35], 0
    v_bitop3_b32 v16, v32, v33, v19 bitop3:0x7e
    v_bitop3_b32 v17, v34, v35, v19 bitop3:0x7e
    v_or_b32 v18, v16, v17
    s_waitcnt vmcnt(6)
    v_mfma_f32_16x16x32_bf16 v[24:27], v[20:23], v[36:39], v[24:27]
    v_bitop3_b32 v16, v36, v37, v19 bitop3:0x7e
    v_bitop3_b32 v17, v38, v39, v19 bitop3:0x7e
    v_or3_b32 v18, v16, v17, v18
    s_waitcnt vmcnt(5)
    v_mfma_f32_16x16x32_bf16 v[24:27], v[20:23], v[40:43], v[24:27]
    v_bitop3_b32 v16, v40, v41, v19 bitop3:0x7e
    v_bitop3_b32 v17, v42, v43, v19 bitop3:0x7e
    v_or3_b32 v18, v16, v17, v18
    s_waitcnt vmcnt(4)
    v_mfma_f32_16x16x32_bf16 v[24:27], v[20:23], v[44:47], v[24:27]
    v_bitop3_b32 v16, v44, v45, v19 bitop3:0x7e
    v_bitop3_b32 v17, v46, v47, v19 bitop3:0x7e
    v_or3_b32 v18, v16, v17, v18
    v_and_b32 v18, 1, v18
    v_cmp_ne_u32 vcc, 0, v18
    s_nop 2
    v_add_f32_dpp v28, v24, v24 row_ror:8 row_mask:0xf bank_mask:0xf
    v_add_f32_dpp v29, v25, v25 row_ror:8 row_mask:0xf bank_mask:0xf
    v_add_f32_dpp v30, v26, v26 row_ror:8 row_mask:0xf bank_mask:0xf
    v_add_f32_dpp v31, v27, v27 row_ror:8 row_mask:0xf bank_mask:0xf
    v_cvt_pk_bf16_f32 v28, v28, v29
    v_cvt_pk_bf16_f32 v29, v30, v31
    s_cbranch_vccz L_rp_s2
L_rn0_s2:
    buffer_load_dwordx4 v[32:35], v0, s[8:11], s43 offen offset:0 sc1
    buffer_load_dwordx4 v[36:39], v0, s[8:11], s43 offen offset:1024 sc1
    buffer_load_dwordx4 v[40:43], v0, s[8:11], s43 offen offset:2048 sc1
    buffer_load_dwordx4 v[44:47], v0, s[8:11], s43 offen offset:3072 sc1
    s_add_u32 s49, s49, 1
    s_cmp_gt_u32 s49, 4000000
    s_cbranch_scc1 L_fail
    s_branch L_rw1_s2
L_slow_s2:
    s_cmp_eq_u32 s46, 0x5105
    s_cbranch_scc1 L_pv3_s2
    s_mov_b32 s46, 0x5105
    s_nop 0
    s_barrier
    s_barrier
    s_branch L_pv_s2
L_pv2_s2:
    ds_read_b128 v[24:27], v0 offset:28672
    ds_read_b128 v[28:31], v0 offset:29696
    s_waitcnt lgkmcnt(0)
    v_mov_b32 v56, 0x3f803f80
    v_mov_b32 v57, 0x3f803f80
    v_mov_b32 v58, 0x3f803f80
    v_mov_b32 v59, 0x3f803f80
    s_nop 1
    v_mfma_f32_16x16x32_bf16 v[36:39], v[56:59], v[48:51], 0
    v_mfma_f32_16x16x32_bf16 v[16:19], v[24:27], v[48:51], 0
    v_mfma_f32_16x16x32_bf16 v[20:23], v[28:31], v[48:51], 0
    v_mfma_f32_16x16x16_bf16 v[36:39], v[32:33], v[54:55], v[36:39]
    v_mfma_f32_16x16x16_bf16 v[16:19], v[40:41], v[54:55], v[16:19]
    v_mfma_f32_16x16x16_bf16 v[20:23], v[44:45], v[54:55], v[20:23]
    s_nop 7
    s_branch L_pv4_s2
L_tail_s2:
    s_waitcnt lgkmcnt(0)
    v_smfmac_f32_16x16x64_bf16 v[44:47], v[60:63], a[120:127], v10
    ds_read_b128 v[16:19], v1 offset:16384
    ds_read_b128 v[20:23], v1 offset:17408
    v_smfmac_f32_16x16x64_bf16 v[40:43], v[48:51], a[128:135], v10
    ds_read_b128 v[24:27], v1 offset:18432
    ds_read_b128 v[28:31], v1 offset:19456
    v_smfmac_f32_16x16x64_bf16 v[44:47], v[48:51], a[136:143], v10
    ds_read_b64_tr_b16 v[60:61], v2 offset:0
    ds_read_b64_tr_b16 v[62:63], v3 offset:0
    v_smfmac_f32_16x16x64_bf16 v[40:43], v[56:59], a[32:39], v10
    ds_read_b64_tr_b16 v[48:49], v2 offset:1024
    ds_read_b64_tr_b16 v[50:51], v3 offset:1024
    v_smfmac_f32_16x16x64_bf16 v[44:47], v[56:59], a[40:47], v10
    ds_read_b64_tr_b16 v[56:57], v2 offset:3072
    ds_read_b64_tr_b16 v[58:59], v3 offset:3072
    s_waitcnt lgkmcnt(4)
    v_smfmac_f32_16x16x64_bf16 v[40:43], v[60:63], a[48:55], v10
    v_smfmac_f32_16x16x64_bf16 v[44:47], v[60:63], a[56:63], v10
    ds_read_b64_tr_b16 v[60:61], v2 offset:6144
    ds_read_b64_tr_b16 v[62:63], v3 offset:6144
    s_waitcnt lgkmcnt(4)
    v_smfmac_f32_16x16x64_bf16 v[40:43], v[48:51], v[16:23], v10
    v_smfmac_f32_16x16x64_bf16 v[44:47], v[48:51], v[24:31], v10
    s_waitcnt lgkmcnt(2)
    v_smfmac_f32_16x16x64_bf16 v[40:43], v[56:59], a[64:71], v10
    v_smfmac_f32_16x16x64_bf16 v[44:47], v[56:59], a[72:79], v10
    s_waitcnt lgkmcnt(0)
    v_smfmac_f32_16x16x64_bf16 v[40:43], v[60:63], a[80:87], v10
    v_smfmac_f32_16x16x64_bf16 v[44:47], v[60:63], a[88:95], v10
    s_nop 3
    v_add_f32 v40, v40, v42
    v_add_f32 v41, v41, v43
    v_cvt_pk_bf16_f32 v40, v40, v41
    s_nop 0
    v_add_f32 v44, v44, v46
    v_add_f32 v45, v45, v47
    v_cvt_pk_bf16_f32 v44, v44, v45
    ds_write_b32 v11, v40 offset:10240
    ds_write_b32 v11, v44 offset:10496
    s_waitcnt vmcnt(0)
    v_and_b32 v12, 0x200, v0
    v_mul_u32_u24 v12, 3, v12
    v_add_u32 v12, v12, v0
    ds_read_b128 v[12:15], v12 offset:10240
    s_waitcnt lgkmcnt(0)
    s_lshr_b32 s44, s48, 1
    s_add_u32 s44, s44, 0x4100800
    buffer_store_dwordx4 v[12:15], v0, s[8:11], s44 offen sc1
    s_waitcnt vmcnt(0)
    s_barrier
    s_branch L_end
L_cw3:
    v_and_b32 v24, 1, v18
    v_lshlrev_b32 v24, 1, v24
    v_xor_b32 v24, v24, v19
    v_xor_b32 v24, 8, v24
    v_lshlrev_b32 v25, 13, v18
    v_lshl_add_u32 v48, v24, 4, v25
    v_xor_b32 v24, 4, v24
    v_lshl_add_u32 v49, v24, 4, v25
    v_mul_u32_u24 v25, 1152, v18
    v_lshl_add_u32 v51, v24, 4, v25
    v_xor_b32 v24, 4, v24
    v_lshl_add_u32 v50, v24, 4, v25
    v_lshrrev_b32 v24, 3, v17
    v_mul_u32_u24 v24, 1152, v24
    v_and_b32 v25, 7, v17
    v_lshl_add_u32 v52, v25, 4, v24
    v_lshrrev_b32 v24, 1, v22
    v_and_b32 v25, 1, v22
    v_lshlrev_b32 v26, 15, v24
    v_lshl_add_u32 v26, v18, 10, v26
    v_lshl_add_u32 v26, v25, 8, v26
    v_lshl_add_u32 v26, v23, 3, v26
    v_add_u32 v26, 32768, v26
    v_lshl_add_u32 v27, v21, 1, v25
    v_lshl_add_u32 v27, v24, 2, v27
    v_xor_b32 v28, 6, v27
    v_lshl_add_u32 v53, v28, 5, v26
    v_add_u32 v55, 65536, v53
    v_xor_b32 v28, 7, v27
    v_lshl_add_u32 v54, v28, 5, v26
    v_add_u32 v56, 65536, v54
    v_lshlrev_b32 v26, 15, v21
    v_lshl_add_u32 v26, v20, 10, v26
    v_lshl_add_u32 v26, v25, 8, v26
    v_lshl_add_u32 v26, v23, 3, v26
    v_add_u32 v26, 32768, v26
    v_lshl_add_u32 v27, v20, 1, v25
    v_lshl_add_u32 v27, v21, 2, v27
    v_add_u32 v28, 6, v24
    v_xor_b32 v28, v28, v27
    v_lshl_add_u32 v57, v28, 5, v26
    v_add_u32 v58, 65536, v57
    v_lshlrev_b32 v26, 15, v24
    v_lshl_add_u32 v26, v21, 11, v26
    v_lshl_add_u32 v26, v20, 9, v26
    v_lshl_add_u32 v26, v25, 7, v26
    v_lshl_add_u32 v26, v23, 3, v26
    v_add_u32 v61, 32864, v26
    v_add_u32 v62, 65536, v61
    s_lshl_b32 s45, s36, 8
    s_mul_i32 s46, s36, 147456
    v_lshlrev_b32 v28, 1, v17
    v_lshlrev_b32 v29, 9, v20
    v_lshlrev_b32 v30, 3, v19
    v_add_u32 v29, v29, v30
    v_lshlrev_b32 v30, 2, v21
    v_add_u32 v29, v29, v30
    v_xor_b32 v29, 32, v29
    s_mov_b32 s43, 6912
    buffer_load_ushort v32, v28, s[32:35], s43 offen offset:0
    buffer_load_ushort v33, v28, s[32:35], s43 offen offset:128
    buffer_load_ushort v34, v28, s[32:35], s43 offen offset:256
    buffer_load_ushort v35, v28, s[32:35], s43 offen offset:384
    buffer_load_ushort v36, v28, s[32:35], s43 offen offset:512
    buffer_load_ushort v37, v28, s[32:35], s43 offen offset:640
    buffer_load_ushort v38, v28, s[32:35], s43 offen offset:768
    buffer_load_ushort v39, v28, s[32:35], s43 offen offset:896
    buffer_load_ushort v40, v28, s[32:35], s43 offen offset:1024
    s_mov_b32 s43, 8064
    buffer_load_ushort v41, v28, s[32:35], s43 offen offset:0
    buffer_load_ushort v42, v28, s[32:35], s43 offen offset:128
    buffer_load_ushort v43, v28, s[32:35], s43 offen offset:256
    buffer_load_ushort v44, v28, s[32:35], s43 offen offset:384
    buffer_load_ushort v45, v28, s[32:35], s43 offen offset:512
    buffer_load_ushort v46, v28, s[32:35], s43 offen offset:640
    buffer_load_ushort v47, v28, s[32:35], s43 offen offset:768
    buffer_load_ushort v12, v28, s[32:35], s43 offen offset:896
    buffer_load_ushort v13, v28, s[32:35], s43 offen offset:1024
    v_mov_b32 v63, v29
    s_waitcnt lgkmcnt(0)
    v_lshlrev_b32 v28, 6, v18
    v_and_b32 v29, 1, v22
    v_lshlrev_b32 v29, 4, v29
    v_lshrrev_b32 v30, 1, v22
    v_lshlrev_b32 v30, 8, v30
    v_add3_u32 v28, v28, v29, v30
    v_and_b32 v30, 1, v17
    v_lshlrev_b32 v30, 3, v30
    v_add_u32 v9, v28, v30
    s_mov_b32 s38, 0
    s_mov_b32 s39, 0
    s_mov_b32 s40, 1048576
    s_mov_b32 s41, 1064960
    s_mov_b32 s42, 1081344
    s_lshl_b32 s48, s36, 13
    s_mov_b32 s94, 0xffbfffbf
    s_mov_b32 s96, 0x3f803f80
    s_mov_b32 s100, 0xcccccccc
    s_mov_b32 s101, 0xcccccccc
    s_mov_b32 s97, 0x3f803f80
    s_mov_b32 s98, 0x3f803f80
    s_mov_b32 s99, 0
    s_mov_b32 s95, 0xffbfffbf
    s_mov_b32 s54, 294912
    s_mov_b32 s92, 0
    s_mov_b32 s93, 1097728
    s_waitcnt vmcnt(46)
    s_barrier
    ds_read_b64_tr_b16 v[64:65], v53 offset:16384
    ds_read_b64_tr_b16 v[66:67], v53 offset:16896
    ds_read_b64_tr_b16 v[68:69], v55 offset:16384
    ds_read_b64_tr_b16 v[70:71], v55 offset:16896
    ds_read_b64_tr_b16 v[72:73], v54 offset:16384
    ds_read_b64_tr_b16 v[74:75], v54 offset:16896
    ds_read_b64_tr_b16 v[76:77], v56 offset:16384
    ds_read_b64_tr_b16 v[78:79], v56 offset:16896
    s_waitcnt lgkmcnt(0)
    s_waitcnt vmcnt(42)
    s_barrier
    s_mov_b32 m0, 0x24000
    s_add_u32 s43, s45, 0x460000
    buffer_load_dwordx4 v48, s[16:19], s43 offen lds
    s_mov_b32 m0, 0x24400
    s_add_u32 s43, s45, 0x468000
    buffer_load_dwordx4 v49, s[16:19], s43 offen lds
    s_mov_b32 m0, 0x24800
    s_add_u32 s43, s45, 0x470000
    buffer_load_dwordx4 v48, s[16:19], s43 offen lds
    s_mov_b32 m0, 0x24c00
    s_add_u32 s43, s45, 0x478000
    buffer_load_dwordx4 v49, s[16:19], s43 offen lds
    ds_read_b64_tr_b16 v[80:81], v53 offset:20480
    ds_read_b64_tr_b16 v[82:83], v53 offset:20992
    ds_read_b64_tr_b16 v[84:85], v55 offset:20480
    ds_read_b64_tr_b16 v[86:87], v55 offset:20992
    ds_read_b64_tr_b16 v[88:89], v54 offset:20480
    ds_read_b64_tr_b16 v[90:91], v54 offset:20992
    ds_read_b64_tr_b16 v[92:93], v56 offset:20480
    ds_read_b64_tr_b16 v[94:95], v56 offset:20992
    s_waitcnt lgkmcnt(0)
    s_waitcnt vmcnt(42)
    s_barrier
    s_mov_b32 m0, 0x25000
    s_add_u32 s43, s45, 0x60000
    buffer_load_dwordx4 v48, s[20:23], s43 offen lds
    s_mov_b32 m0, 0x25400
    s_add_u32 s43, s45, 0x68000
    buffer_load_dwordx4 v49, s[20:23], s43 offen lds
    s_mov_b32 m0, 0x25800
    s_add_u32 s43, s45, 0x70000
    buffer_load_dwordx4 v48, s[20:23], s43 offen lds
    s_mov_b32 m0, 0x25c00
    s_add_u32 s43, s45, 0x78000
    buffer_load_dwordx4 v49, s[20:23], s43 offen lds
    ds_read_b64_tr_b16 v[96:97], v53 offset:24576
    ds_read_b64_tr_b16 v[98:99], v53 offset:25088
    ds_read_b64_tr_b16 v[100:101], v55 offset:24576
    ds_read_b64_tr_b16 v[102:103], v55 offset:25088
    ds_read_b64_tr_b16 v[104:105], v54 offset:24576
    ds_read_b64_tr_b16 v[106:107], v54 offset:25088
    ds_read_b64_tr_b16 v[108:109], v56 offset:24576
    ds_read_b64_tr_b16 v[110:111], v56 offset:25088
    s_waitcnt lgkmcnt(0)
    s_waitcnt vmcnt(42)
    s_barrier
    s_mov_b32 m0, 0x26000
    s_add_u32 s43, s45, 0xe0000
    buffer_load_dwordx4 v48, s[20:23], s43 offen lds
    s_mov_b32 m0, 0x26400
    s_add_u32 s43, s45, 0xe8000
    buffer_load_dwordx4 v49, s[20:23], s43 offen lds
    s_mov_b32 m0, 0x26800
    s_add_u32 s43, s45, 0xf0000
    buffer_load_dwordx4 v48, s[20:23], s43 offen lds
    s_mov_b32 m0, 0x26c00
    s_add_u32 s43, s45, 0xf8000
    buffer_load_dwordx4 v49, s[20:23], s43 offen lds
    ds_read_b64_tr_b16 a[144:145], v53 offset:28672
    ds_read_b64_tr_b16 a[146:147], v53 offset:29184
    ds_read_b64_tr_b16 a[148:149], v55 offset:28672
    ds_read_b64_tr_b16 a[150:151], v55 offset:29184
    ds_read_b64_tr_b16 a[152:153], v54 offset:28672
    ds_read_b64_tr_b16 a[154:155], v54 offset:29184
    ds_read_b64_tr_b16 a[156:157], v56 offset:28672
    ds_read_b64_tr_b16 a[158:159], v56 offset:29184
    s_waitcnt lgkmcnt(0)
    s_waitcnt vmcnt(42)
    s_barrier
    s_mov_b32 m0, 0x27000
    s_add_u32 s43, s45, 0x160000
    buffer_load_dwordx4 v48, s[20:23], s43 offen lds
    s_mov_b32 m0, 0x27400
    s_add_u32 s43, s45, 0x168000
    buffer_load_dwordx4 v49, s[20:23], s43 offen lds
    s_mov_b32 m0, 0x27800
    s_add_u32 s43, s45, 0x170000
    buffer_load_dwordx4 v48, s[20:23], s43 offen lds
    s_mov_b32 m0, 0x27c00
    s_add_u32 s43, s45, 0x178000
    buffer_load_dwordx4 v49, s[20:23], s43 offen lds
    ds_read_b64_tr_b16 a[160:161], v53 offset:0
    ds_read_b64_tr_b16 a[162:163], v53 offset:512
    ds_read_b64_tr_b16 a[164:165], v55 offset:0
    ds_read_b64_tr_b16 a[166:167], v55 offset:512
    ds_read_b64_tr_b16 a[168:169], v54 offset:0
    ds_read_b64_tr_b16 a[170:171], v54 offset:512
    ds_read_b64_tr_b16 a[172:173], v56 offset:0
    ds_read_b64_tr_b16 a[174:175], v56 offset:512
    s_waitcnt lgkmcnt(0)
    s_waitcnt vmcnt(42)
    s_barrier
    s_mov_b32 m0, 0x20000
    s_add_u32 s43, s45, 0x1e0000
    buffer_load_dwordx4 v48, s[20:23], s43 offen lds
    s_mov_b32 m0, 0x20400
    s_add_u32 s43, s45, 0x1e8000
    buffer_load_dwordx4 v49, s[20:23], s43 offen lds
    s_mov_b32 m0, 0x20800
    s_add_u32 s43, s45, 0x1f0000
    buffer_load_dwordx4 v48, s[20:23], s43 offen lds
    s_mov_b32 m0, 0x20c00
    s_add_u32 s43, s45, 0x1f8000
    buffer_load_dwordx4 v49, s[20:23], s43 offen lds
    ds_read_b64_tr_b16 v[128:129], v53 offset:4096
    ds_read_b64_tr_b16 v[130:131], v53 offset:4608
    ds_read_b64_tr_b16 v[132:133], v55 offset:4096
    ds_read_b64_tr_b16 v[134:135], v55 offset:4608
    ds_read_b64_tr_b16 v[136:137], v54 offset:4096
    ds_read_b64_tr_b16 v[138:139], v54 offset:4608
    ds_read_b64_tr_b16 v[140:141], v56 offset:4096
    ds_read_b64_tr_b16 v[142:143], v56 offset:4608
    s_waitcnt lgkmcnt(0)
    s_waitcnt vmcnt(42)
    s_barrier
    s_mov_b32 m0, 0x21000
    s_add_u32 s43, s45, 0x260000
    buffer_load_dwordx4 v48, s[20:23], s43 offen lds
    s_mov_b32 m0, 0x21400
    s_add_u32 s43, s45, 0x268000
    buffer_load_dwordx4 v49, s[20:23], s43 offen lds
    s_mov_b32 m0, 0x21800
    s_add_u32 s43, s45, 0x270000
    buffer_load_dwordx4 v48, s[20:23], s43 offen lds
    s_mov_b32 m0, 0x21c00
    s_add_u32 s43, s45, 0x278000
    buffer_load_dwordx4 v49, s[20:23], s43 offen lds
    ds_read_b64_tr_b16 v[144:145], v53 offset:8192
    ds_read_b64_tr_b16 v[146:147], v53 offset:8704
    ds_read_b64_tr_b16 v[148:149], v55 offset:8192
    ds_read_b64_tr_b16 v[150:151], v55 offset:8704
    ds_read_b64_tr_b16 v[152:153], v54 offset:8192
    ds_read_b64_tr_b16 v[154:155], v54 offset:8704
    ds_read_b64_tr_b16 v[156:157], v56 offset:8192
    ds_read_b64_tr_b16 v[158:159], v56 offset:8704
    s_waitcnt lgkmcnt(0)
    s_waitcnt vmcnt(42)
    s_barrier
    s_mov_b32 m0, 0x22000
    s_add_u32 s43, s45, 0x2e0000
    buffer_load_dwordx4 v48, s[20:23], s43 offen lds
    s_mov_b32 m0, 0x22400
    s_add_u32 s43, s45, 0x2e8000
    buffer_load_dwordx4 v49, s[20:23], s43 offen lds
    s_mov_b32 m0, 0x22800
    s_add_u32 s43, s45, 0x2f0000
    buffer_load_dwordx4 v48, s[20:23], s43 offen lds
    s_mov_b32 m0, 0x22c00
    s_add_u32 s43, s45, 0x2f8000
    buffer_load_dwordx4 v49, s[20:23], s43 offen lds
    ds_read_b64_tr_b16 v[112:113], v53 offset:12288
    ds_read_b64_tr_b16 v[114:115], v53 offset:12800
    ds_read_b64_tr_b16 v[116:117], v55 offset:12288
    ds_read_b64_tr_b16 v[118:119], v55 offset:12800
    ds_read_b64_tr_b16 v[120:121], v54 offset:12288
    ds_read_b64_tr_b16 v[122:123], v54 offset:12800
    ds_read_b64_tr_b16 v[124:125], v56 offset:12288
    ds_read_b64_tr_b16 v[126:127], v56 offset:12800
    s_waitcnt lgkmcnt(0)
    s_waitcnt vmcnt(24)
    s_barrier
    s_mov_b32 m0, 0x23000
    s_add_u32 s43, s45, 0x360000
    buffer_load_dwordx4 v48, s[20:23], s43 offen lds
    s_mov_b32 m0, 0x23400
    s_add_u32 s43, s45, 0x368000
    buffer_load_dwordx4 v49, s[20:23], s43 offen lds
    s_mov_b32 m0, 0x23800
    s_add_u32 s43, s45, 0x370000
    buffer_load_dwordx4 v48, s[20:23], s43 offen lds
    s_mov_b32 m0, 0x23c00
    s_add_u32 s43, s45, 0x378000
    buffer_load_dwordx4 v49, s[20:23], s43 offen lds
    ds_read_b64_tr_b16 v[160:161], v53 offset:16384
    ds_read_b64_tr_b16 v[162:163], v53 offset:16896
    ds_read_b64_tr_b16 v[164:165], v55 offset:16384
    ds_read_b64_tr_b16 v[166:167], v55 offset:16896
    ds_read_b64_tr_b16 v[168:169], v54 offset:16384
    ds_read_b64_tr_b16 v[170:171], v54 offset:16896
    ds_read_b64_tr_b16 v[172:173], v56 offset:16384
    ds_read_b64_tr_b16 v[174:175], v56 offset:16896
    s_waitcnt lgkmcnt(0)
    s_waitcnt vmcnt(24)
    s_barrier
    s_mov_b32 m0, 0x24000
    s_add_u32 s43, s45, 0x3e0000
    buffer_load_dwordx4 v48, s[20:23], s43 offen lds
    s_mov_b32 m0, 0x24400
    s_add_u32 s43, s45, 0x3e8000
    buffer_load_dwordx4 v49, s[20:23], s43 offen lds
    s_mov_b32 m0, 0x24800
    s_add_u32 s43, s45, 0x3f0000
    buffer_load_dwordx4 v48, s[20:23], s43 offen lds
    s_mov_b32 m0, 0x24c00
    s_add_u32 s43, s45, 0x3f8000
    buffer_load_dwordx4 v49, s[20:23], s43 offen lds
    ds_read_b64_tr_b16 v[192:193], v53 offset:20480
    ds_read_b64_tr_b16 v[194:195], v53 offset:20992
    ds_read_b64_tr_b16 v[196:197], v55 offset:20480
    ds_read_b64_tr_b16 v[198:199], v55 offset:20992
    ds_read_b64_tr_b16 v[200:201], v54 offset:20480
    ds_read_b64_tr_b16 v[202:203], v54 offset:20992
    ds_read_b64_tr_b16 v[204:205], v56 offset:20480
    ds_read_b64_tr_b16 v[206:207], v56 offset:20992
    s_waitcnt lgkmcnt(0)
    ds_write_b16 v63, v32 offset:384
    ds_write_b16 v63, v33 offset:1408
    ds_write_b16 v63, v34 offset:2432
    ds_write_b16 v63, v35 offset:3456
    ds_write_b16 v63, v36 offset:4480
    ds_write_b16 v63, v37 offset:5504
    ds_write_b16 v63, v38 offset:6528
    ds_write_b16 v63, v39 offset:7552
    ds_write_b16 v63, v40 offset:8576
    ds_write_b16 v63, v41 offset:386
    ds_write_b16 v63, v42 offset:1410
    ds_write_b16 v63, v43 offset:2434
    ds_write_b16 v63, v44 offset:3458
    ds_write_b16 v63, v45 offset:4482
    ds_write_b16 v63, v46 offset:5506
    ds_write_b16 v63, v47 offset:6530
    ds_write_b16 v63, v12 offset:7554
    ds_write_b16 v63, v13 offset:8578
    s_waitcnt vmcnt(24)
    s_barrier
    s_mov_b32 m0, 0x25000
    s_add_u32 s43, s45, 0x460000
    buffer_load_dwordx4 v48, s[20:23], s43 offen lds
    s_mov_b32 m0, 0x25400
    s_add_u32 s43, s45, 0x468000
    buffer_load_dwordx4 v49, s[20:23], s43 offen lds
    s_mov_b32 m0, 0x25800
    s_add_u32 s43, s45, 0x470000
    buffer_load_dwordx4 v48, s[20:23], s43 offen lds
    s_mov_b32 m0, 0x25c00
    s_add_u32 s43, s45, 0x478000
    buffer_load_dwordx4 v49, s[20:23], s43 offen lds
    ds_read_b64_tr_b16 v[208:209], v53 offset:24576
    ds_read_b64_tr_b16 v[210:211], v53 offset:25088
    ds_read_b64_tr_b16 v[212:213], v55 offset:24576
    ds_read_b64_tr_b16 v[214:215], v55 offset:25088
    ds_read_b64_tr_b16 v[216:217], v54 offset:24576
    ds_read_b64_tr_b16 v[218:219], v54 offset:25088
    ds_read_b64_tr_b16 v[220:221], v56 offset:24576
    ds_read_b64_tr_b16 v[222:223], v56 offset:25088
    s_waitcnt lgkmcnt(0)
    s_waitcnt vmcnt(24)
    s_barrier
    s_mov_b32 m0, 0x26000
    s_add_u32 s43, s45, 0x60000
    buffer_load_dwordx4 v48, s[24:27], s43 offen lds
    s_mov_b32 m0, 0x26400
    s_add_u32 s43, s45, 0x68000
    buffer_load_dwordx4 v49, s[24:27], s43 offen lds
    s_mov_b32 m0, 0x26800
    s_add_u32 s43, s45, 0x70000
    buffer_load_dwordx4 v48, s[24:27], s43 offen lds
    s_mov_b32 m0, 0x26c00
    s_add_u32 s43, s45, 0x78000
    buffer_load_dwordx4 v49, s[24:27], s43 offen lds
    ds_read_b64_tr_b16 a[176:177], v53 offset:28672
    ds_read_b64_tr_b16 a[178:179], v53 offset:29184
    ds_read_b64_tr_b16 a[180:181], v55 offset:28672
    ds_read_b64_tr_b16 a[182:183], v55 offset:29184
    ds_read_b64_tr_b16 a[184:185], v54 offset:28672
    ds_read_b64_tr_b16 a[186:187], v54 offset:29184
    ds_read_b64_tr_b16 a[188:189], v56 offset:28672
    ds_read_b64_tr_b16 a[190:191], v56 offset:29184
    s_waitcnt lgkmcnt(0)
    s_waitcnt vmcnt(24)
    s_barrier
    s_mov_b32 m0, 0x27000
    s_add_u32 s43, s45, 0xe0000
    buffer_load_dwordx4 v48, s[24:27], s43 offen lds
    s_mov_b32 m0, 0x27400
    s_add_u32 s43, s45, 0xe8000
    buffer_load_dwordx4 v49, s[24:27], s43 offen lds
    s_mov_b32 m0, 0x27800
    s_add_u32 s43, s45, 0xf0000
    buffer_load_dwordx4 v48, s[24:27], s43 offen lds
    s_mov_b32 m0, 0x27c00
    s_add_u32 s43, s45, 0xf8000
    buffer_load_dwordx4 v49, s[24:27], s43 offen lds
    ds_read_b64_tr_b16 v[176:177], v53 offset:0
    ds_read_b64_tr_b16 v[178:179], v53 offset:512
    ds_read_b64_tr_b16 v[180:181], v55 offset:0
    ds_read_b64_tr_b16 v[182:183], v55 offset:512
    ds_read_b64_tr_b16 v[184:185], v54 offset:0
    ds_read_b64_tr_b16 v[186:187], v54 offset:512
    ds_read_b64_tr_b16 v[188:189], v56 offset:0
    ds_read_b64_tr_b16 v[190:191], v56 offset:512
    s_waitcnt lgkmcnt(0)
    s_waitcnt vmcnt(24)
    s_barrier
    s_mov_b32 m0, 0x20000
    s_add_u32 s43, s45, 0x160000
    buffer_load_dwordx4 v48, s[24:27], s43 offen lds
    s_mov_b32 m0, 0x20400
    s_add_u32 s43, s45, 0x168000
    buffer_load_dwordx4 v49, s[24:27], s43 offen lds
    s_mov_b32 m0, 0x20800
    s_add_u32 s43, s45, 0x170000
    buffer_load_dwordx4 v48, s[24:27], s43 offen lds
    s_mov_b32 m0, 0x20c00
    s_add_u32 s43, s45, 0x178000
    buffer_load_dwordx4 v49, s[24:27], s43 offen lds
    ds_read_b64_tr_b16 v[240:241], v53 offset:4096
    ds_read_b64_tr_b16 v[242:243], v53 offset:4608
    ds_read_b64_tr_b16 v[244:245], v55 offset:4096
    ds_read_b64_tr_b16 v[246:247], v55 offset:4608
    ds_read_b64_tr_b16 v[248:249], v54 offset:4096
    ds_read_b64_tr_b16 v[250:251], v54 offset:4608
    ds_read_b64_tr_b16 v[252:253], v56 offset:4096
    ds_read_b64_tr_b16 v[254:255], v56 offset:4608
    s_waitcnt lgkmcnt(0)
    s_waitcnt vmcnt(24)
    s_barrier
    s_mov_b32 m0, 0x21000
    s_add_u32 s43, s45, 0x1e0000
    buffer_load_dwordx4 v48, s[24:27], s43 offen lds
    s_mov_b32 m0, 0x21400
    s_add_u32 s43, s45, 0x1e8000
    buffer_load_dwordx4 v49, s[24:27], s43 offen lds
    s_mov_b32 m0, 0x21800
    s_add_u32 s43, s45, 0x1f0000
    buffer_load_dwordx4 v48, s[24:27], s43 offen lds
    s_mov_b32 m0, 0x21c00
    s_add_u32 s43, s45, 0x1f8000
    buffer_load_dwordx4 v49, s[24:27], s43 offen lds
    ds_read_b64_tr_b16 a[192:193], v53 offset:8192
    ds_read_b64_tr_b16 a[194:195], v53 offset:8704
    ds_read_b64_tr_b16 a[196:197], v55 offset:8192
    ds_read_b64_tr_b16 a[198:199], v55 offset:8704
    ds_read_b64_tr_b16 a[200:201], v54 offset:8192
    ds_read_b64_tr_b16 a[202:203], v54 offset:8704
    ds_read_b64_tr_b16 a[204:205], v56 offset:8192
    ds_read_b64_tr_b16 a[206:207], v56 offset:8704
    s_waitcnt lgkmcnt(0)
    s_waitcnt vmcnt(24)
    s_barrier
    s_mov_b32 m0, 0x22000
    s_add_u32 s43, s45, 0x260000
    buffer_load_dwordx4 v48, s[24:27], s43 offen lds
    s_mov_b32 m0, 0x22400
    s_add_u32 s43, s45, 0x268000
    buffer_load_dwordx4 v49, s[24:27], s43 offen lds
    s_mov_b32 m0, 0x22800
    s_add_u32 s43, s45, 0x270000
    buffer_load_dwordx4 v48, s[24:27], s43 offen lds
    s_mov_b32 m0, 0x22c00
    s_add_u32 s43, s45, 0x278000
    buffer_load_dwordx4 v49, s[24:27], s43 offen lds
    ds_read_b64_tr_b16 a[0:1], v53 offset:12288
    ds_read_b64_tr_b16 a[2:3], v53 offset:12800
    ds_read_b64_tr_b16 a[4:5], v55 offset:12288
    ds_read_b64_tr_b16 a[6:7], v55 offset:12800
    ds_read_b64_tr_b16 a[8:9], v54 offset:12288
    ds_read_b64_tr_b16 a[10:11], v54 offset:12800
    ds_read_b64_tr_b16 a[12:13], v56 offset:12288
    ds_read_b64_tr_b16 a[14:15], v56 offset:12800
    s_waitcnt lgkmcnt(0)
    s_waitcnt vmcnt(24)
    s_barrier
    s_mov_b32 m0, 0x23000
    s_add_u32 s43, s45, 0x2e0000
    buffer_load_dwordx4 v48, s[24:27], s43 offen lds
    s_mov_b32 m0, 0x23400
    s_add_u32 s43, s45, 0x2e8000
    buffer_load_dwordx4 v49, s[24:27], s43 offen lds
    s_mov_b32 m0, 0x23800
    s_add_u32 s43, s45, 0x2f0000
    buffer_load_dwordx4 v48, s[24:27], s43 offen lds
    s_mov_b32 m0, 0x23c00
    s_add_u32 s43, s45, 0x2f8000
    buffer_load_dwordx4 v49, s[24:27], s43 offen lds
    ds_read_b64_tr_b16 v[224:225], v53 offset:16384
    ds_read_b64_tr_b16 v[226:227], v53 offset:16896
    ds_read_b64_tr_b16 v[228:229], v55 offset:16384
    ds_read_b64_tr_b16 v[230:231], v55 offset:16896
    ds_read_b64_tr_b16 v[232:233], v54 offset:16384
    ds_read_b64_tr_b16 v[234:235], v54 offset:16896
    ds_read_b64_tr_b16 v[236:237], v56 offset:16384
    ds_read_b64_tr_b16 v[238:239], v56 offset:16896
    s_waitcnt lgkmcnt(0)
    s_waitcnt vmcnt(24)
    s_barrier
    s_mov_b32 m0, 0x24000
    s_add_u32 s43, s45, 0x360000
    buffer_load_dwordx4 v48, s[24:27], s43 offen lds
    s_mov_b32 m0, 0x24400
    s_add_u32 s43, s45, 0x368000
    buffer_load_dwordx4 v49, s[24:27], s43 offen lds
    s_mov_b32 m0, 0x24800
    s_add_u32 s43, s45, 0x370000
    buffer_load_dwordx4 v48, s[24:27], s43 offen lds
    s_mov_b32 m0, 0x24c00
    s_add_u32 s43, s45, 0x378000
    buffer_load_dwordx4 v49, s[24:27], s43 offen lds
    ds_read_b64_tr_b16 a[16:17], v53 offset:20480
    ds_read_b64_tr_b16 a[18:19], v53 offset:20992
    ds_read_b64_tr_b16 a[20:21], v55 offset:20480
    ds_read_b64_tr_b16 a[22:23], v55 offset:20992
    ds_read_b64_tr_b16 a[24:25], v54 offset:20480
    ds_read_b64_tr_b16 a[26:27], v54 offset:20992
    ds_read_b64_tr_b16 a[28:29], v56 offset:20480
    ds_read_b64_tr_b16 a[30:31], v56 offset:20992
    s_waitcnt lgkmcnt(0)
    s_waitcnt vmcnt(24)
    s_barrier
    s_mov_b32 m0, 0x25000
    s_add_u32 s43, s45, 0x3e0000
    buffer_load_dwordx4 v48, s[24:27], s43 offen lds
    s_mov_b32 m0, 0x25400
    s_add_u32 s43, s45, 0x3e8000
    buffer_load_dwordx4 v49, s[24:27], s43 offen lds
    s_mov_b32 m0, 0x25800
    s_add_u32 s43, s45, 0x3f0000
    buffer_load_dwordx4 v48, s[24:27], s43 offen lds
    s_mov_b32 m0, 0x25c00
    s_add_u32 s43, s45, 0x3f8000
    buffer_load_dwordx4 v49, s[24:27], s43 offen lds
    ds_read_b64_tr_b16 a[48:49], v53 offset:24576
    ds_read_b64_tr_b16 a[50:51], v53 offset:25088
    ds_read_b64_tr_b16 a[52:53], v55 offset:24576
    ds_read_b64_tr_b16 a[54:55], v55 offset:25088
    ds_read_b64_tr_b16 a[56:57], v54 offset:24576
    ds_read_b64_tr_b16 a[58:59], v54 offset:25088
    ds_read_b64_tr_b16 a[60:61], v56 offset:24576
    ds_read_b64_tr_b16 a[62:63], v56 offset:25088
    s_waitcnt lgkmcnt(0)
    s_waitcnt vmcnt(24)
    s_barrier
    s_mov_b32 m0, 0x26000
    s_add_u32 s43, s46, 0xd800
    buffer_load_dwordx4 v50, s[28:31], s43 offen lds
    s_mov_b32 m0, 0x26400
    s_add_u32 s43, s46, 0xea00
    buffer_load_dwordx4 v51, s[28:31], s43 offen lds
    s_mov_b32 m0, 0x26800
    s_add_u32 s43, s46, 0xfc00
    buffer_load_dwordx4 v50, s[28:31], s43 offen lds
    s_mov_b32 m0, 0x26c00
    s_add_u32 s43, s46, 0x10e00
    buffer_load_dwordx4 v51, s[28:31], s43 offen lds
    ds_read_b64_tr_b16 a[208:209], v53 offset:28672
    ds_read_b64_tr_b16 a[210:211], v53 offset:29184
    ds_read_b64_tr_b16 a[212:213], v55 offset:28672
    ds_read_b64_tr_b16 a[214:215], v55 offset:29184
    ds_read_b64_tr_b16 a[216:217], v54 offset:28672
    ds_read_b64_tr_b16 a[218:219], v54 offset:29184
    ds_read_b64_tr_b16 a[220:221], v56 offset:28672
    ds_read_b64_tr_b16 a[222:223], v56 offset:29184
    s_waitcnt lgkmcnt(0)
    s_waitcnt vmcnt(24)
    s_barrier
    s_mov_b32 m0, 0x27000
    s_add_u32 s43, s46, 0xda00
    buffer_load_dwordx4 v50, s[28:31], s43 offen lds
    s_mov_b32 m0, 0x27400
    s_add_u32 s43, s46, 0xec00
    buffer_load_dwordx4 v51, s[28:31], s43 offen lds
    s_mov_b32 m0, 0x27800
    s_add_u32 s43, s46, 0xfe00
    buffer_load_dwordx4 v50, s[28:31], s43 offen lds
    s_mov_b32 m0, 0x27c00
    s_add_u32 s43, s46, 0x11000
    buffer_load_dwordx4 v51, s[28:31], s43 offen lds
    ds_read_b64_tr_b16 a[64:65], v53 offset:0
    ds_read_b64_tr_b16 a[66:67], v53 offset:512
    ds_read_b64_tr_b16 a[68:69], v55 offset:0
    ds_read_b64_tr_b16 a[70:71], v55 offset:512
    ds_read_b64_tr_b16 a[72:73], v54 offset:0
    ds_read_b64_tr_b16 a[74:75], v54 offset:512
    ds_read_b64_tr_b16 a[76:77], v56 offset:0
    ds_read_b64_tr_b16 a[78:79], v56 offset:512
    s_waitcnt lgkmcnt(0)
    s_waitcnt vmcnt(24)
    s_barrier
    s_mov_b32 m0, 0x20000
    s_add_u32 s43, s46, 0xd900
    buffer_load_dwordx4 v50, s[28:31], s43 offen lds
    s_mov_b32 m0, 0x20400
    s_add_u32 s43, s46, 0xeb00
    buffer_load_dwordx4 v51, s[28:31], s43 offen lds
    s_mov_b32 m0, 0x20800
    s_add_u32 s43, s46, 0xfd00
    buffer_load_dwordx4 v50, s[28:31], s43 offen lds
    s_mov_b32 m0, 0x20c00
    s_add_u32 s43, s46, 0x10f00
    buffer_load_dwordx4 v51, s[28:31], s43 offen lds
    ds_read_b64_tr_b16 a[32:33], v53 offset:4096
    ds_read_b64_tr_b16 a[34:35], v53 offset:4608
    ds_read_b64_tr_b16 a[36:37], v55 offset:4096
    ds_read_b64_tr_b16 a[38:39], v55 offset:4608
    ds_read_b64_tr_b16 a[40:41], v54 offset:4096
    ds_read_b64_tr_b16 a[42:43], v54 offset:4608
    ds_read_b64_tr_b16 a[44:45], v56 offset:4096
    ds_read_b64_tr_b16 a[46:47], v56 offset:4608
    s_waitcnt lgkmcnt(0)
    s_waitcnt vmcnt(24)
    s_barrier
    s_mov_b32 m0, 0x21000
    s_add_u32 s43, s46, 0xdb00
    buffer_load_dwordx4 v50, s[28:31], s43 offen lds
    s_mov_b32 m0, 0x21400
    s_add_u32 s43, s46, 0xed00
    buffer_load_dwordx4 v51, s[28:31], s43 offen lds
    s_mov_b32 m0, 0x21800
    s_add_u32 s43, s46, 0xff00
    buffer_load_dwordx4 v50, s[28:31], s43 offen lds
    s_mov_b32 m0, 0x21c00
    s_add_u32 s43, s46, 0x11100
    buffer_load_dwordx4 v51, s[28:31], s43 offen lds
    ds_read_b64_tr_b16 a[96:97], v53 offset:8192
    ds_read_b64_tr_b16 a[98:99], v53 offset:8704
    ds_read_b64_tr_b16 a[100:101], v55 offset:8192
    ds_read_b64_tr_b16 a[102:103], v55 offset:8704
    ds_read_b64_tr_b16 a[104:105], v54 offset:8192
    ds_read_b64_tr_b16 a[106:107], v54 offset:8704
    ds_read_b64_tr_b16 a[108:109], v56 offset:8192
    ds_read_b64_tr_b16 a[110:111], v56 offset:8704
    s_waitcnt lgkmcnt(0)
    s_waitcnt vmcnt(24)
    s_barrier
    s_mov_b32 m0, 0x22000
    s_add_u32 s43, s46, 0x1f800
    buffer_load_dwordx4 v50, s[28:31], s43 offen lds
    s_mov_b32 m0, 0x22400
    s_add_u32 s43, s46, 0x20a00
    buffer_load_dwordx4 v51, s[28:31], s43 offen lds
    s_mov_b32 m0, 0x22800
    s_add_u32 s43, s46, 0x21c00
    buffer_load_dwordx4 v50, s[28:31], s43 offen lds
    s_mov_b32 m0, 0x22c00
    s_add_u32 s43, s46, 0x22e00
    buffer_load_dwordx4 v51, s[28:31], s43 offen lds
    ds_read_b64_tr_b16 a[224:225], v53 offset:12288
    ds_read_b64_tr_b16 a[226:227], v53 offset:12800
    ds_read_b64_tr_b16 a[228:229], v55 offset:12288
    ds_read_b64_tr_b16 a[230:231], v55 offset:12800
    ds_read_b64_tr_b16 a[232:233], v54 offset:12288
    ds_read_b64_tr_b16 a[234:235], v54 offset:12800
    ds_read_b64_tr_b16 a[236:237], v56 offset:12288
    ds_read_b64_tr_b16 a[238:239], v56 offset:12800
    s_waitcnt lgkmcnt(0)
    s_waitcnt vmcnt(24)
    s_barrier
    s_mov_b32 m0, 0x23000
    s_add_u32 s43, s46, 0x1f900
    buffer_load_dwordx4 v50, s[28:31], s43 offen lds
    s_mov_b32 m0, 0x23400
    s_add_u32 s43, s46, 0x20b00
    buffer_load_dwordx4 v51, s[28:31], s43 offen lds
    s_mov_b32 m0, 0x23800
    s_add_u32 s43, s46, 0x21d00
    buffer_load_dwordx4 v50, s[28:31], s43 offen lds
    s_mov_b32 m0, 0x23c00
    s_add_u32 s43, s46, 0x22f00
    buffer_load_dwordx4 v51, s[28:31], s43 offen lds
    ds_read_b64_tr_b16 a[112:113], v53 offset:16384
    ds_read_b64_tr_b16 a[114:115], v53 offset:16896
    ds_read_b64_tr_b16 a[116:117], v55 offset:16384
    ds_read_b64_tr_b16 a[118:119], v55 offset:16896
    ds_read_b64_tr_b16 a[120:121], v54 offset:16384
    ds_read_b64_tr_b16 a[122:123], v54 offset:16896
    ds_read_b64_tr_b16 a[124:125], v56 offset:16384
    ds_read_b64_tr_b16 a[126:127], v56 offset:16896
    s_waitcnt lgkmcnt(0)
    s_waitcnt vmcnt(24)
    s_barrier
    s_mov_b32 m0, 0x24000
    s_add_u32 s43, s46, 0x1fa00
    buffer_load_dwordx4 v50, s[28:31], s43 offen lds
    s_mov_b32 m0, 0x24400
    s_add_u32 s43, s46, 0x20c00
    buffer_load_dwordx4 v51, s[28:31], s43 offen lds
    s_mov_b32 m0, 0x24800
    s_add_u32 s43, s46, 0x21e00
    buffer_load_dwordx4 v50, s[28:31], s43 offen lds
    s_mov_b32 m0, 0x24c00
    s_add_u32 s43, s46, 0x23000
    buffer_load_dwordx4 v51, s[28:31], s43 offen lds
    ds_read_b64_tr_b16 a[80:81], v53 offset:20480
    ds_read_b64_tr_b16 a[82:83], v53 offset:20992
    ds_read_b64_tr_b16 a[84:85], v55 offset:20480
    ds_read_b64_tr_b16 a[86:87], v55 offset:20992
    ds_read_b64_tr_b16 a[88:89], v54 offset:20480
    ds_read_b64_tr_b16 a[90:91], v54 offset:20992
    ds_read_b64_tr_b16 a[92:93], v56 offset:20480
    ds_read_b64_tr_b16 a[94:95], v56 offset:20992
    s_waitcnt lgkmcnt(0)
    s_waitcnt vmcnt(24)
    s_barrier
    s_mov_b32 m0, 0x25000
    s_add_u32 s43, s46, 0x1fb00
    buffer_load_dwordx4 v50, s[28:31], s43 offen lds
    s_mov_b32 m0, 0x25400
    s_add_u32 s43, s46, 0x20d00
    buffer_load_dwordx4 v51, s[28:31], s43 offen lds
    s_mov_b32 m0, 0x25800
    s_add_u32 s43, s46, 0x21f00
    buffer_load_dwordx4 v50, s[28:31], s43 offen lds
    s_mov_b32 m0, 0x25c00
    s_add_u32 s43, s46, 0x23100
    buffer_load_dwordx4 v51, s[28:31], s43 offen lds
    ds_read_b64_tr_b16 a[240:241], v57 offset:24576
    ds_read_b64_tr_b16 a[242:243], v57 offset:25088
    ds_read_b64_tr_b16 a[244:245], v57 offset:26624
    ds_read_b64_tr_b16 a[246:247], v57 offset:27136
    ds_read_b64_tr_b16 a[248:249], v58 offset:24576
    ds_read_b64_tr_b16 a[250:251], v58 offset:25088
    ds_read_b64_tr_b16 a[252:253], v58 offset:26624
    ds_read_b64_tr_b16 a[254:255], v58 offset:27136
    s_waitcnt lgkmcnt(0)
    s_waitcnt vmcnt(24)
    s_barrier
    s_mov_b32 m0, 0x26000
    s_add_u32 s43, s46, 0x1b400
    buffer_load_dwordx4 v52, s[28:31], s43 offen lds
    s_mov_b32 m0, 0x26400
    s_add_u32 s43, s46, 0x1d800
    buffer_load_dwordx4 v52, s[28:31], s43 offen lds
    s_mov_b32 m0, 0x26800
    s_add_u32 s43, s46, 0x1fc00
    buffer_load_dwordx4 v52, s[28:31], s43 offen lds
    s_mov_b32 m0, 0x26c00
    s_add_u32 s43, s46, 0x22000
    buffer_load_dwordx4 v52, s[28:31], s43 offen lds
    ds_read_b64_tr_b16 a[128:129], v57 offset:28672
    ds_read_b64_tr_b16 a[130:131], v57 offset:29184
    ds_read_b64_tr_b16 a[132:133], v57 offset:30720
    ds_read_b64_tr_b16 a[134:135], v57 offset:31232
    ds_read_b64_tr_b16 a[136:137], v58 offset:28672
    ds_read_b64_tr_b16 a[138:139], v58 offset:29184
    ds_read_b64_tr_b16 a[140:141], v58 offset:30720
    ds_read_b64_tr_b16 a[142:143], v58 offset:31232
    s_waitcnt lgkmcnt(0)
    v_mov_b32 v30, 0
    buffer_load_dwordx2 v[24:25], v30, s[12:15], 0 offen sc1
    s_waitcnt vmcnt(25)
    s_barrier
    s_mov_b32 m0, 0x27000
    s_add_u32 s43, s45, 0x460000
    buffer_load_dwordx4 v48, s[24:27], s43 offen lds
    s_mov_b32 m0, 0x27400
    s_add_u32 s43, s45, 0x468000
    buffer_load_dwordx4 v49, s[24:27], s43 offen lds
    s_mov_b32 m0, 0x27800
    s_add_u32 s43, s45, 0x470000
    buffer_load_dwordx4 v48, s[24:27], s43 offen lds
    s_mov_b32 m0, 0x27c00
    s_add_u32 s43, s45, 0x478000
    buffer_load_dwordx4 v49, s[24:27], s43 offen lds
    ds_read_b64_tr_b16 v[32:33], v57 offset:0
    ds_read_b64_tr_b16 v[34:35], v57 offset:512
    ds_read_b64_tr_b16 v[36:37], v57 offset:2048
    ds_read_b64_tr_b16 v[38:39], v57 offset:2560
    ds_read_b64_tr_b16 v[40:41], v58 offset:0
    ds_read_b64_tr_b16 v[42:43], v58 offset:512
    ds_read_b64_tr_b16 v[44:45], v58 offset:2048
    ds_read_b64_tr_b16 v[46:47], v58 offset:2560
    s_waitcnt lgkmcnt(0)
    s_waitcnt vmcnt(25)
    s_barrier
    ds_write_b128 v1, a[144:147] offset:0
    ds_write_b128 v1, a[148:151] offset:1024
    ds_write_b128 v1, a[152:155] offset:2048
    ds_write_b128 v1, a[156:159] offset:3072
    s_waitcnt lgkmcnt(0)
    v_accvgpr_write_b32 a144, v32
    v_accvgpr_write_b32 a145, v33
    v_accvgpr_write_b32 a146, v34
    v_accvgpr_write_b32 a147, v35
    v_accvgpr_write_b32 a148, v36
    v_accvgpr_write_b32 a149, v37
    v_accvgpr_write_b32 a150, v38
    v_accvgpr_write_b32 a151, v39
    v_accvgpr_write_b32 a152, v40
    v_accvgpr_write_b32 a153, v41
    v_accvgpr_write_b32 a154, v42
    v_accvgpr_write_b32 a155, v43
    v_accvgpr_write_b32 a156, v44
    v_accvgpr_write_b32 a157, v45
    v_accvgpr_write_b32 a158, v46
    v_accvgpr_write_b32 a159, v47
    ds_read_b64_tr_b16 v[32:33], v57 offset:4096
    ds_read_b64_tr_b16 v[34:35], v57 offset:4608
    ds_read_b64_tr_b16 v[36:37], v57 offset:6144
    ds_read_b64_tr_b16 v[38:39], v57 offset:6656
    ds_read_b64_tr_b16 v[40:41], v58 offset:4096
    ds_read_b64_tr_b16 v[42:43], v58 offset:4608
    ds_read_b64_tr_b16 v[44:45], v58 offset:6144
    ds_read_b64_tr_b16 v[46:47], v58 offset:6656
    s_waitcnt lgkmcnt(0)
    s_waitcnt vmcnt(21)
    s_barrier
    ds_write_b128 v1, a[160:163] offset:4096
    ds_write_b128 v1, a[164:167] offset:5120
    ds_write_b128 v1, a[168:171] offset:6144
    ds_write_b128 v1, a[172:175] offset:7168
    s_waitcnt lgkmcnt(0)
    v_accvgpr_write_b32 a160, v32
    v_accvgpr_write_b32 a161, v33
    v_accvgpr_write_b32 a162, v34
    v_accvgpr_write_b32 a163, v35
    v_accvgpr_write_b32 a164, v36
    v_accvgpr_write_b32 a165, v37
    v_accvgpr_write_b32 a166, v38
    v_accvgpr_write_b32 a167, v39
    v_accvgpr_write_b32 a168, v40
    v_accvgpr_write_b32 a169, v41
    v_accvgpr_write_b32 a170, v42
    v_accvgpr_write_b32 a171, v43
    v_accvgpr_write_b32 a172, v44
    v_accvgpr_write_b32 a173, v45
    v_accvgpr_write_b32 a174, v46
    v_accvgpr_write_b32 a175, v47
    ds_read_b64_tr_b16 v[32:33], v57 offset:8192
    ds_read_b64_tr_b16 v[34:35], v57 offset:8704
    ds_read_b64_tr_b16 v[36:37], v57 offset:10240
    ds_read_b64_tr_b16 v[38:39], v57 offset:10752
    ds_read_b64_tr_b16 v[40:41], v58 offset:8192
    ds_read_b64_tr_b16 v[42:43], v58 offset:8704
    ds_read_b64_tr_b16 v[44:45], v58 offset:10240
    ds_read_b64_tr_b16 v[46:47], v58 offset:10752
    s_waitcnt lgkmcnt(0)
    s_waitcnt vmcnt(17)
    s_barrier
    ds_write_b128 v1, a[176:179] offset:8192
    ds_write_b128 v1, a[180:183] offset:9216
    ds_write_b128 v1, a[184:187] offset:10240
    ds_write_b128 v1, a[188:191] offset:11264
    s_waitcnt lgkmcnt(0)
    v_accvgpr_write_b32 a176, v32
    v_accvgpr_write_b32 a177, v33
    v_accvgpr_write_b32 a178, v34
    v_accvgpr_write_b32 a179, v35
    v_accvgpr_write_b32 a180, v36
    v_accvgpr_write_b32 a181, v37
    v_accvgpr_write_b32 a182, v38
    v_accvgpr_write_b32 a183, v39
    v_accvgpr_write_b32 a184, v40
    v_accvgpr_write_b32 a185, v41
    v_accvgpr_write_b32 a186, v42
    v_accvgpr_write_b32 a187, v43
    v_accvgpr_write_b32 a188, v44
    v_accvgpr_write_b32 a189, v45
    v_accvgpr_write_b32 a190, v46
    v_accvgpr_write_b32 a191, v47
    ds_read_b64_tr_b16 v[32:33], v57 offset:12288
    ds_read_b64_tr_b16 v[34:35], v57 offset:12800
    ds_read_b64_tr_b16 v[36:37], v57 offset:14336
    ds_read_b64_tr_b16 v[38:39], v57 offset:14848
    ds_read_b64_tr_b16 v[40:41], v58 offset:12288
    ds_read_b64_tr_b16 v[42:43], v58 offset:12800
    ds_read_b64_tr_b16 v[44:45], v58 offset:14336
    ds_read_b64_tr_b16 v[46:47], v58 offset:14848
    s_waitcnt lgkmcnt(0)
    s_waitcnt vmcnt(13)
    s_barrier
    ds_write_b128 v1, a[192:195] offset:12288
    ds_write_b128 v1, a[196:199] offset:13312
    ds_write_b128 v1, a[200:203] offset:14336
    ds_write_b128 v1, a[204:207] offset:15360
    s_waitcnt lgkmcnt(0)
    v_accvgpr_write_b32 a192, v32
    v_accvgpr_write_b32 a193, v33
    v_accvgpr_write_b32 a194, v34
    v_accvgpr_write_b32 a195, v35
    v_accvgpr_write_b32 a196, v36
    v_accvgpr_write_b32 a197, v37
    v_accvgpr_write_b32 a198, v38
    v_accvgpr_write_b32 a199, v39
    v_accvgpr_write_b32 a200, v40
    v_accvgpr_write_b32 a201, v41
    v_accvgpr_write_b32 a202, v42
    v_accvgpr_write_b32 a203, v43
    v_accvgpr_write_b32 a204, v44
    v_accvgpr_write_b32 a205, v45
    v_accvgpr_write_b32 a206, v46
    v_accvgpr_write_b32 a207, v47
    ds_read_b64_tr_b16 v[32:33], v57 offset:16384
    ds_read_b64_tr_b16 v[34:35], v57 offset:16896
    ds_read_b64_tr_b16 v[36:37], v57 offset:18432
    ds_read_b64_tr_b16 v[38:39], v57 offset:18944
    ds_read_b64_tr_b16 v[40:41], v58 offset:16384
    ds_read_b64_tr_b16 v[42:43], v58 offset:16896
    ds_read_b64_tr_b16 v[44:45], v58 offset:18432
    ds_read_b64_tr_b16 v[46:47], v58 offset:18944
    s_waitcnt lgkmcnt(0)
    s_waitcnt vmcnt(9)
    s_barrier
    ds_write_b128 v1, a[208:211] offset:16384
    ds_write_b128 v1, a[212:215] offset:17408
    ds_write_b128 v1, a[216:219] offset:18432
    ds_write_b128 v1, a[220:223] offset:19456
    s_waitcnt lgkmcnt(0)
    v_accvgpr_write_b32 a208, v32
    v_accvgpr_write_b32 a209, v33
    v_accvgpr_write_b32 a210, v34
    v_accvgpr_write_b32 a211, v35
    v_accvgpr_write_b32 a212, v36
    v_accvgpr_write_b32 a213, v37
    v_accvgpr_write_b32 a214, v38
    v_accvgpr_write_b32 a215, v39
    v_accvgpr_write_b32 a216, v40
    v_accvgpr_write_b32 a217, v41
    v_accvgpr_write_b32 a218, v42
    v_accvgpr_write_b32 a219, v43
    v_accvgpr_write_b32 a220, v44
    v_accvgpr_write_b32 a221, v45
    v_accvgpr_write_b32 a222, v46
    v_accvgpr_write_b32 a223, v47
    ds_read_b64_tr_b16 v[32:33], v57 offset:20480
    ds_read_b64_tr_b16 v[34:35], v57 offset:20992
    ds_read_b64_tr_b16 v[36:37], v57 offset:22528
    ds_read_b64_tr_b16 v[38:39], v57 offset:23040
    ds_read_b64_tr_b16 v[40:41], v58 offset:20480
    ds_read_b64_tr_b16 v[42:43], v58 offset:20992
    ds_read_b64_tr_b16 v[44:45], v58 offset:22528
    ds_read_b64_tr_b16 v[46:47], v58 offset:23040
    s_waitcnt lgkmcnt(0)
    s_waitcnt vmcnt(5)
    s_barrier
    ds_write_b128 v1, a[224:227] offset:20480
    ds_write_b128 v1, a[228:231] offset:21504
    ds_write_b128 v1, a[232:235] offset:22528
    ds_write_b128 v1, a[236:239] offset:23552
    s_waitcnt lgkmcnt(0)
    v_accvgpr_write_b32 a224, v32
    v_accvgpr_write_b32 a225, v33
    v_accvgpr_write_b32 a226, v34
    v_accvgpr_write_b32 a227, v35
    v_accvgpr_write_b32 a228, v36
    v_accvgpr_write_b32 a229, v37
    v_accvgpr_write_b32 a230, v38
    v_accvgpr_write_b32 a231, v39
    v_accvgpr_write_b32 a232, v40
    v_accvgpr_write_b32 a233, v41
    v_accvgpr_write_b32 a234, v42
    v_accvgpr_write_b32 a235, v43
    v_accvgpr_write_b32 a236, v44
    v_accvgpr_write_b32 a237, v45
    v_accvgpr_write_b32 a238, v46
    v_accvgpr_write_b32 a239, v47
    ds_read_b64_tr_b16 v[32:33], v61 offset:24576
    ds_read_b64_tr_b16 v[34:35], v61 offset:24832
    ds_read_b64_tr_b16 v[36:37], v61 offset:25600
    ds_read_b64_tr_b16 v[38:39], v61 offset:25856
    ds_read_b64_tr_b16 v[40:41], v62 offset:24576
    ds_read_b64_tr_b16 v[42:43], v62 offset:24832
    ds_read_b64_tr_b16 v[44:45], v62 offset:25600
    ds_read_b64_tr_b16 v[46:47], v62 offset:25856
    s_waitcnt lgkmcnt(0)
    s_waitcnt vmcnt(0)
    s_barrier
    ds_write_b128 v1, a[240:243] offset:24576
    ds_write_b128 v1, a[244:247] offset:25600
    ds_write_b128 v1, a[248:251] offset:26624
    ds_write_b128 v1, a[252:255] offset:27648
    s_waitcnt lgkmcnt(0)
    v_accvgpr_write_b32 a240, v32
    v_accvgpr_write_b32 a241, v33
    v_accvgpr_write_b32 a242, v34
    v_accvgpr_write_b32 a243, v35
    v_accvgpr_write_b32 a244, v36
    v_accvgpr_write_b32 a245, v37
    v_accvgpr_write_b32 a246, v38
    v_accvgpr_write_b32 a247, v39
    v_accvgpr_write_b32 a248, v40
    v_accvgpr_write_b32 a249, v41
    v_accvgpr_write_b32 a250, v42
    v_accvgpr_write_b32 a251, v43
    v_accvgpr_write_b32 a252, v44
    v_accvgpr_write_b32 a253, v45
    v_accvgpr_write_b32 a254, v46
    v_accvgpr_write_b32 a255, v47
    ds_read_b64_tr_b16 v[32:33], v53 offset:28672
    ds_read_b64_tr_b16 v[34:35], v53 offset:29184
    ds_read_b64_tr_b16 v[36:37], v55 offset:28672
    ds_read_b64_tr_b16 v[38:39], v55 offset:29184
    ds_read_b64_tr_b16 v[40:41], v54 offset:28672
    ds_read_b64_tr_b16 v[42:43], v54 offset:29184
    ds_read_b64_tr_b16 v[44:45], v56 offset:28672
    ds_read_b64_tr_b16 v[46:47], v56 offset:29184
    s_waitcnt lgkmcnt(0)
    s_barrier
    ds_write_b128 v1, a[128:131] offset:28672
    ds_write_b128 v1, a[132:135] offset:29696
    ds_write_b128 v1, a[136:139] offset:30720
    ds_write_b128 v1, a[140:143] offset:31744
    s_waitcnt lgkmcnt(0)
    v_accvgpr_write_b32 a128, v32
    v_accvgpr_write_b32 a129, v33
    v_accvgpr_write_b32 a130, v34
    v_accvgpr_write_b32 a131, v35
    v_accvgpr_write_b32 a132, v36
    v_accvgpr_write_b32 a133, v37
    v_accvgpr_write_b32 a134, v38
    v_accvgpr_write_b32 a135, v39
    v_accvgpr_write_b32 a136, v40
    v_accvgpr_write_b32 a137, v41
    v_accvgpr_write_b32 a138, v42
    v_accvgpr_write_b32 a139, v43
    v_accvgpr_write_b32 a140, v44
    v_accvgpr_write_b32 a141, v45
    v_accvgpr_write_b32 a142, v46
    v_accvgpr_write_b32 a143, v47
    v_mov_b32 v28, v24
    v_mov_b32 v29, v25
    v_mov_b32 v30, 0
    s_mov_b32 s49, 0
    s_branch L_sbe_3
    s_mov_b32 s49, 0
    v_mov_b32 v30, 0
L_sb_26:
    buffer_load_dwordx2 v[28:29], v30, s[12:15], 0 offen sc1
    s_add_u32 s49, s49, 1
    s_cmp_gt_u32 s49, 4000000
    s_cbranch_scc1 L_fail
    s_waitcnt vmcnt(0)
L_sbe_3:
    v_sad_u8 v31, v28, 0, 0
    v_sad_u8 v31, v29, 0, v31
    v_or_b32 v32, v28, v29
    v_readfirstlane_b32 s43, v31
    v_readfirstlane_b32 s44, v32
    s_cmp_lt_u32 s43, 32
    s_cbranch_scc1 L_sb_26
    s_and_b32 s90, s44, 0x20202020
    s_barrier
    s_mov_b32 s46, 0
    s_cmp_eq_u32 s90, 0
    s_cbranch_scc1 L_slowmode_3
    ds_read_b128 v[32:35], v0 offset:7168
    ds_read_b32 v12, v11 offset:8960
    ds_read_b128 v[40:43], v1 offset:0
    ds_read_b128 v[44:47], v1 offset:1024
    v_mov_b64 v[16:17], 0
    v_mov_b64 v[18:19], 0
    v_mov_b64 v[20:21], 0
    v_mov_b64 v[22:23], 0
    v_mov_b64 v[24:25], 0
    v_mov_b64 v[26:27], 0
    v_mov_b64 v[28:29], 0
    v_mov_b64 v[30:31], 0
    s_waitcnt vmcnt(0) lgkmcnt(0)
    s_nop 0
    s_branch L_gar_f3
L_loop_f3:
    s_barrier
    s_add_u32 s43, s40, 3072
    buffer_load_dwordx4 v[60:63], v0, s[8:11], s43 offen sc1
    v_mov_b64 v[16:17], 0
    v_mov_b64 v[18:19], 0
    v_mov_b64 v[20:21], 0
    v_mov_b64 v[22:23], 0
    v_mov_b64 v[24:25], 0
    v_mov_b64 v[26:27], 0
    v_mov_b64 v[28:29], 0
    v_mov_b64 v[30:31], 0
    s_nop 15
    s_nop 7
    s_add_u32 s43, s40, 3072
    buffer_load_dwordx4 v[56:59], v0, s[8:11], s43 offen sc1
    s_waitcnt vmcnt(1)
    ds_write_b128 v0, v[60:63] offset:3072
    v_max3_u32 v14, v60, v61, v62
    v_max_u32 v14, v14, v63
    v_cmp_le_u32 vcc, s51, v14
    s_add_u32 s43, s40, 7168
    buffer_load_dwordx4 v[32:35], v0, s[8:11], s43 offen sc1
    s_add_u32 s43, s40, 8960
    buffer_load_dword v12, v11, s[8:11], s43 offen sc1
    s_cbranch_vccnz L_ga_f3
L_gar_f3:
    ds_read_b64_tr_b16 v[48:49], v2 offset:3072
    ds_read_b64_tr_b16 v[50:51], v3 offset:3072
    ds_read_b128 v[40:43], v1 offset:0
    ds_read_b128 v[44:47], v1 offset:1024
    s_waitcnt lgkmcnt(4)
    s_barrier
    ds_read_b64_tr_b16 v[52:53], v2 offset:0
    ds_read_b64_tr_b16 v[54:55], v3 offset:0
    s_waitcnt lgkmcnt(4)
    s_waitcnt lgkmcnt(2)
    v_smfmac_f32_16x16x64_bf16 v[16:19], v[48:51], v[40:47], v10
    s_waitcnt vmcnt(2)
    ds_read_b64_tr_b16 v[56:57], v2 offset:1024
    ds_read_b64_tr_b16 v[58:59], v3 offset:1024
    v_smfmac_f32_16x16x64_bf16 v[24:27], v[48:51], v[176:183], v10
    ds_read_b64_tr_b16 v[60:61], v2 offset:2048
    ds_read_b64_tr_b16 v[62:63], v3 offset:2048
    v_smfmac_f32_16x16x64_bf16 v[28:31], v[48:51], v[184:191], v10
    ds_read_b128 v[40:43], v1 offset:2048
    ds_read_b128 v[44:47], v1 offset:3072
    s_waitcnt lgkmcnt(6)
    v_smfmac_f32_16x16x64_bf16 v[16:19], v[52:55], v[64:71], v10
    s_add_u32 s43, s40, 7168
    buffer_load_dwordx4 v[36:39], v0, s[8:11], s43 offen sc1
    s_add_u32 s43, s40, 8960
    buffer_load_dword v13, v11, s[8:11], s43 offen sc1
    v_smfmac_f32_16x16x64_bf16 v[20:23], v[52:55], v[72:79], v10
    v_smfmac_f32_16x16x64_bf16 v[24:27], v[52:55], v[192:199], v10
    s_waitcnt lgkmcnt(0)
    v_smfmac_f32_16x16x64_bf16 v[20:23], v[48:51], v[40:47], v10
    ds_read_b128 v[40:43], v1 offset:8192
    v_smfmac_f32_16x16x64_bf16 v[28:31], v[52:55], v[200:207], v10
    ds_read_b128 v[44:47], v1 offset:9216
    v_smfmac_f32_16x16x64_bf16 v[16:19], v[56:59], v[80:87], v10
    s_waitcnt vmcnt(2)
    ds_write_b128 v0, v[32:35] offset:7168
    v_max3_u32 v14, v32, v33, v34
    v_smfmac_f32_16x16x64_bf16 v[20:23], v[56:59], v[88:95], v10
    ds_write_b32 v11, v12 offset:8960
    v_max3_u32 v14, v14, v35, v12
    v_smfmac_f32_16x16x64_bf16 v[24:27], v[56:59], v[208:215], v10
    v_cmp_le_u32 vcc, s51, v14
    v_smfmac_f32_16x16x64_bf16 v[28:31], v[56:59], v[216:223], v10
    s_cbranch_vccnz L_gb_f3
L_gbr_f3:
    ds_read_b64_tr_b16 v[48:49], v2 offset:7168
    v_smfmac_f32_16x16x64_bf16 v[16:19], v[60:63], v[96:103], v10
    ds_read_b64_tr_b16 v[50:51], v3 offset:7168
    v_smfmac_f32_16x16x64_bf16 v[20:23], v[60:63], v[104:111], v10
    s_waitcnt lgkmcnt(2)
    s_barrier
    ds_read_b64_tr_b16 v[52:53], v2 offset:4096
    ds_read_b64_tr_b16 v[54:55], v3 offset:4096
    v_smfmac_f32_16x16x64_bf16 v[24:27], v[60:63], v[40:47], v10
    s_mov_b32 m0, 0x7000
    s_add_u32 s55, s48, 0x2001000
    buffer_load_dwordx4 v0, s[8:11], s55 offen sc1 lds
    ds_read_b64_tr_b16 v[56:57], v2 offset:5120
    ds_read_b64_tr_b16 v[58:59], v3 offset:5120
    s_waitcnt lgkmcnt(4)
    v_smfmac_f32_16x16x64_bf16 v[16:19], v[48:51], v[112:119], v10
    buffer_load_dwordx4 v0, s[8:11], s55 offen offset:1024 sc1 lds
    s_waitcnt vmcnt(2)
    ds_read_b128 v[32:35], v1 offset:10240
    ds_read_b128 v[36:39], v1 offset:11264
    v_smfmac_f32_16x16x64_bf16 v[20:23], v[48:51], v[120:127], v10
    buffer_load_dwordx4 v0, s[8:11], s55 offen offset:2048 sc1 lds
    ds_read_b128 v[40:43], v1 offset:4096
    ds_read_b128 v[44:47], v1 offset:5120
    v_smfmac_f32_16x16x64_bf16 v[24:27], v[48:51], v[224:231], v10
    buffer_load_dwordx4 v0, s[8:11], s55 offen offset:3072 sc1 lds
    v_smfmac_f32_16x16x64_bf16 v[28:31], v[48:51], v[232:239], v10
    ds_read_b64_tr_b16 v[48:49], v2 offset:8192
    ds_read_b64_tr_b16 v[50:51], v3 offset:8192
    s_waitcnt lgkmcnt(8)
    v_smfmac_f32_16x16x64_bf16 v[24:27], v[52:55], v[240:247], v10
    s_waitcnt lgkmcnt(4)
    v_smfmac_f32_16x16x64_bf16 v[28:31], v[60:63], v[32:39], v10
    ds_read_b64_tr_b16 v[60:61], v2 offset:6144
    s_waitcnt lgkmcnt(3)
    v_smfmac_f32_16x16x64_bf16 v[16:19], v[52:55], v[40:47], v10
    ds_read_b64_tr_b16 v[62:63], v3 offset:6144
    v_smfmac_f32_16x16x64_bf16 v[28:31], v[52:55], v[248:255], v10
    ds_read_b128 v[32:35], v1 offset:6144
    v_lshlrev_b32 v12, 3, v0
    v_smfmac_f32_16x16x64_bf16 v[16:19], v[56:59], v[128:135], v10
    s_mov_b32 m0, 0x3e80
    s_add_u32 s44, s48, 0x2040000
    buffer_load_dword v12, s[8:11], s44 offen sc1 lds
    ds_read_b128 v[36:39], v1 offset:7168
    v_and_b32 v12, 0x200, v0
    v_smfmac_f32_16x16x64_bf16 v[20:23], v[56:59], v[136:143], v10
    ds_read_b128 v[40:43], v1 offset:12288
    v_mul_u32_u24 v12, 3, v12
    s_waitcnt lgkmcnt(3)
    v_smfmac_f32_16x16x64_bf16 v[16:19], v[60:63], v[144:151], v10
    ds_read_b128 v[44:47], v1 offset:13312
    v_add_u32 v12, v12, v0
    s_waitcnt lgkmcnt(2)
    v_smfmac_f32_16x16x64_bf16 v[20:23], v[52:55], v[32:39], v10
    ds_read_b128 v[12:15], v12 offset:10752
    v_smfmac_f32_16x16x64_bf16 v[20:23], v[60:63], v[152:159], v10
    ds_read_b128 v[32:35], v1 offset:14336
    v_smfmac_f32_16x16x64_bf16 v[16:19], v[48:51], v[160:167], v10
    ds_read_b128 v[36:39], v1 offset:15360
    v_smfmac_f32_16x16x64_bf16 v[20:23], v[48:51], v[168:175], v10
    s_waitcnt lgkmcnt(3)
    v_smfmac_f32_16x16x64_bf16 v[24:27], v[56:59], v[40:47], v10
    s_waitcnt lgkmcnt(2)
    s_lshr_b32 s44, s48, 1
    s_add_u32 s44, s44, 0x40e0c00
    buffer_store_dwordx4 v[12:15], v0, s[8:11], s44 offen sc1
    v_add_f32 v16, v16, v18
    v_add_f32 v17, v17, v19
    s_waitcnt lgkmcnt(0)
    v_smfmac_f32_16x16x64_bf16 v[28:31], v[56:59], v[32:39], v10
    v_cvt_pk_bf16_f32 v16, v16, v17
    v_add_f32 v20, v20, v22
    v_smfmac_f32_16x16x64_bf16 v[24:27], v[60:63], a[0:7], v10
    ds_read_b128 v[32:35], v1 offset:22528
    v_add_f32 v21, v21, v23
    v_cvt_pk_bf16_f32 v17, v20, v21
    v_smfmac_f32_16x16x64_bf16 v[24:27], v[48:51], a[16:23], v10
    ds_read_b128 v[36:39], v1 offset:23552
    v_mov_b64 v[40:41], 0
    v_mov_b64 v[42:43], 0
    v_smfmac_f32_16x16x64_bf16 v[28:31], v[60:63], a[8:15], v10
    ds_write_b64 v4, v[16:17] offset:10752
    v_mov_b64 v[44:45], 0
    v_mov_b64 v[46:47], 0
    v_smfmac_f32_16x16x64_bf16 v[28:31], v[48:51], a[24:31], v10
    ds_read_b128 v[16:19], v1 offset:20480
    v_mov_b64 v[12:13], s[94:95]
    v_mov_b64 v[14:15], s[94:95]
    v_add_f32 v24, v24, v26
    v_add_f32 v25, v25, v27
    v_cvt_pk_bf16_f32 v24, v24, v25
    v_smfmac_f32_16x16x64_bf16 v[40:43], v[52:55], a[96:103], v10
    ds_read_b128 v[20:23], v1 offset:21504
    v_smfmac_f32_16x16x64_bf16 v[44:47], v[52:55], a[104:111], v10
    s_mul_i32 s45, s36, 288
    s_add_u32 s45, s93, s45
    s_mov_b64 exec, s[88:89]
    buffer_store_dwordx4 v[12:15], v0, s[8:11], s45 offen
    s_mov_b64 exec, -1
    v_add_f32 v28, v28, v30
    v_add_f32 v29, v29, v31
    v_cvt_pk_bf16_f32 v25, v28, v29
    ds_write2st64_b32 v11, v24, v25 offset0:50 offset1:51
    s_waitcnt lgkmcnt(4)
    v_smfmac_f32_16x16x64_bf16 v[44:47], v[56:59], v[32:39], v10
    v_mov_b64 v[52:53], 0
    v_mov_b64 v[54:55], 0
    v_smfmac_f32_16x16x64_bf16 v[40:43], v[60:63], a[112:119], v10
    s_waitcnt lgkmcnt(1)
    v_smfmac_f32_16x16x64_bf16 v[40:43], v[56:59], v[16:23], v10
    ds_read_b64_tr_b16 v[56:57], v2 offset:3072
    ds_read_b64_tr_b16 v[58:59], v3 offset:3072
    s_waitcnt lgkmcnt(2)
    s_barrier
    s_cmp_eq_u32 s38, 63
    s_cbranch_scc1 L_tail_f3
    ds_read_b64_tr_b16 v[32:33], v2 offset:9216
    ds_read_b64_tr_b16 v[34:35], v3 offset:9216
    ds_read_b64_tr_b16 v[36:37], v2 offset:10240
    ds_read_b64_tr_b16 v[38:39], v3 offset:10240
    ds_read_b64_tr_b16 v[16:17], v9 offset:11264
    ds_read_b64_tr_b16 v[18:19], v9 offset:11296
    ds_read_b64_tr_b16 v[20:21], v9 offset:11776
    ds_read_b64_tr_b16 v[22:23], v9 offset:11808
    ds_read_b64_tr_b16 v[24:25], v9 offset:12288
    ds_read_b64_tr_b16 v[26:27], v9 offset:12320
    ds_read_b64_tr_b16 v[28:29], v9 offset:12800
    ds_read_b64_tr_b16 v[30:31], v9 offset:12832
    v_smfmac_f32_16x16x64_bf16 v[44:47], v[60:63], a[120:127], v10
    ds_read_b64_tr_b16 v[60:61], v2 offset:0
    v_smfmac_f32_16x16x64_bf16 v[40:43], v[48:51], a[128:135], v10
    ds_read_b64_tr_b16 v[62:63], v3 offset:0
    v_smfmac_f32_16x16x64_bf16 v[44:47], v[48:51], a[136:143], v10
    ds_read_b64_tr_b16 v[48:49], v2 offset:1024
    s_waitcnt lgkmcnt(15)
    v_smfmac_f32_16x16x64_bf16 v[40:43], v[56:59], a[32:39], v10
    ds_read_b64_tr_b16 v[50:51], v3 offset:1024
    s_waitcnt lgkmcnt(4)
    v_smfmac_f32_16x16x64_bf16 v[52:55], v[32:35], v[16:23], v10
    v_smfmac_f32_16x16x64_bf16 v[52:55], v[36:39], v[24:31], v10
    ds_read_b128 v[16:19], v1 offset:16384
    ds_read_b128 v[20:23], v1 offset:17408
    v_smfmac_f32_16x16x64_bf16 v[44:47], v[56:59], a[40:47], v10
    ds_read_b128 v[24:27], v1 offset:18432
    ds_read_b128 v[28:31], v1 offset:19456
    s_waitcnt lgkmcnt(6)
    v_smfmac_f32_16x16x64_bf16 v[40:43], v[60:63], a[48:55], v10
    ds_read_b64_tr_b16 v[56:57], v2 offset:2048
    ds_read_b64_tr_b16 v[58:59], v3 offset:2048
    v_add_f32 v52, v52, v54
    v_add_f32 v53, v53, v55
    v_mul_f32 v52, s50, v52
    v_mul_f32 v53, s50, v53
    v_exp_f32 v54, v52
    v_exp_f32 v55, v53
    s_nop 0
    v_cvt_pk_bf16_f32 v54, v54, v55
    ds_write_b32 v11, v54 offset:15872
    v_smfmac_f32_16x16x64_bf16 v[44:47], v[60:63], a[56:63], v10
    ds_read_b64_tr_b16 v[60:61], v2 offset:7168
    ds_read_b64_tr_b16 v[62:63], v3 offset:7168
    s_waitcnt lgkmcnt(9)
    s_waitcnt lgkmcnt(7)
    v_smfmac_f32_16x16x64_bf16 v[40:43], v[48:51], v[16:23], v10
    s_waitcnt lgkmcnt(5)
    v_smfmac_f32_16x16x64_bf16 v[44:47], v[48:51], v[24:31], v10
    s_waitcnt lgkmcnt(2)
    s_waitcnt vmcnt(3)
    s_barrier
L_pv_f3:
    ds_read_b64_tr_b16 v[48:49], v5 offset:15360
    ds_read_b64_tr_b16 v[50:51], v5 offset:15616
    ds_read_b64_tr_b16 v[54:55], v8 offset:15872
    s_cmp_eq_u32 s46, 0x5105
    s_cbranch_scc1 L_pv2_f3
    ds_read_b128 v[24:27], v0 offset:30720
    ds_read_b128 v[28:31], v0 offset:31744
    v_smfmac_f32_16x16x64_bf16 v[40:43], v[56:59], a[64:71], v10
    v_mov_b64 v[32:33], s[98:99]
    v_smfmac_f32_16x16x64_bf16 v[44:47], v[56:59], a[72:79], v10
    s_waitcnt lgkmcnt(5)
    v_smfmac_f32_16x16x64_bf16 v[40:43], v[60:63], a[80:87], v10
    v_mov_b64 v[56:57], s[96:97]
    v_smfmac_f32_16x16x64_bf16 v[44:47], v[60:63], a[88:95], v10
    v_mov_b64 v[58:59], s[96:97]
    s_waitcnt lgkmcnt(0)
    s_nop 0
    v_mfma_f32_16x16x32_bf16 v[36:39], v[56:59], v[48:51], 0
    v_mfma_f32_16x16x32_bf16 v[16:19], v[24:27], v[48:51], 0
    v_add_f32 v40, v40, v42
    v_add_f32 v41, v41, v43
    v_mfma_f32_16x16x32_bf16 v[20:23], v[28:31], v[48:51], 0
    v_cvt_pk_bf16_f32 v40, v40, v41
    v_mov_b32 v41, 0
    v_mfma_f32_16x16x16_bf16 v[36:39], v[32:33], v[54:55], v[36:39]
    v_add_f32 v44, v44, v46
    v_add_f32 v45, v45, v47
    v_mfma_f32_16x16x16_bf16 v[16:19], v[40:41], v[54:55], v[16:19]
    v_cvt_pk_bf16_f32 v44, v44, v45
    v_mov_b32 v45, 0
    s_nop 1
    v_mfma_f32_16x16x16_bf16 v[20:23], v[44:45], v[54:55], v[20:23]
L_pv4_f3:
    ds_read_b128 v[56:59], v1 offset:24576
    ds_read_b128 v[60:63], v1 offset:25600
    ds_read_b128 v[24:27], v1 offset:26624
    ds_read_b128 v[28:31], v1 offset:27648
    v_rcp_f32 v34, v36
    v_cmp_ngt_f32 vcc, s69, v36
    v_cmp_nlt_f32 s[44:45], s68, v36
    v_cndmask_b32 v16, v18, v16, s[56:57]
    v_cndmask_b32 v17, v19, v17, s[56:57]
    s_or_b64 vcc, vcc, s[44:45]
    v_mul_f32 v16, v16, v34
    v_mul_f32 v17, v17, v34
    v_cndmask_b32 v20, v22, v20, s[56:57]
    v_cndmask_b32 v21, v23, v21, s[56:57]
    v_cvt_pk_bf16_f32 v16, v16, v17
    v_mul_f32 v20, v20, v34
    v_mul_f32 v21, v21, v34
    s_cbranch_vccnz L_slow_f3
L_pv3_f3:
    v_cvt_pk_bf16_f32 v20, v20, v21
    ds_write2_b32 v6, v16, v20 offset0:0 offset1:2
    s_mov_b32 s46, 0
    v_lshrrev_b32 v12, 1, v0
    v_and_b32 v12, 0x1e0, v12
    v_and_or_b32 v12, v0, 16, v12
    v_mov_b64 v[48:49], 0
    v_mov_b64 v[50:51], 0
    v_mov_b64 v[52:53], 0
    v_mov_b64 v[54:55], 0
    v_mov_b64 v[16:17], 0
    v_mov_b64 v[18:19], 0
    v_mov_b64 v[20:21], 0
    v_mov_b64 v[22:23], 0
    s_waitcnt lgkmcnt(0)
    s_barrier
    ds_read_b128 v[32:35], v12 offset:13312
    ds_read_b128 v[36:39], v12 offset:13824
    ds_write2st64_b32 v11, v40, v44 offset0:42 offset1:43
    ds_read_b128 v[40:43], v12 offset:14336
    ds_read_b128 v[44:47], v12 offset:14848
    s_waitcnt lgkmcnt(4)
    v_smfmac_f32_16x16x64_bf16 v[16:19], v[32:35], v[56:63], v10
    ds_read_b128 v[56:59], v1 offset:28672
    v_smfmac_f32_16x16x64_bf16 v[20:23], v[32:35], a[144:151], v10
    ds_read_b128 v[60:63], v1 offset:29696
    s_waitcnt lgkmcnt(5)
    v_smfmac_f32_16x16x64_bf16 v[16:19], v[36:39], v[24:31], v10
    ds_read_b128 v[24:27], v1 offset:30720
    v_smfmac_f32_16x16x64_bf16 v[20:23], v[36:39], a[152:159], v10
    ds_read_b128 v[28:31], v1 offset:31744
    s_waitcnt lgkmcnt(5)
    v_smfmac_f32_16x16x64_bf16 v[16:19], v[40:43], a[176:183], v10
    v_smfmac_f32_16x16x64_bf16 v[20:23], v[40:43], a[192:199], v10
    s_waitcnt lgkmcnt(4)
    v_smfmac_f32_16x16x64_bf16 v[16:19], v[44:47], a[184:191], v10
    v_smfmac_f32_16x16x64_bf16 v[20:23], v[44:47], a[200:207], v10
    s_waitcnt lgkmcnt(2)
    v_smfmac_f32_16x16x64_bf16 v[48:51], v[32:35], v[56:63], v10
    v_cvt_pk_bf16_f32 v16, v16, v17
    v_cvt_pk_bf16_f32 v17, v18, v19
    v_and_or_b32 v16, v16, -2, s92
    s_waitcnt lgkmcnt(0)
    v_smfmac_f32_16x16x64_bf16 v[48:51], v[36:39], v[24:31], v10
    s_add_u32 s43, s39, 49152
    buffer_store_dwordx2 v[16:17], v7, s[8:11], s43 offen
    v_cvt_pk_bf16_f32 v20, v20, v21
    v_cvt_pk_bf16_f32 v21, v22, v23
    v_and_or_b32 v20, v20, -2, s92
    v_smfmac_f32_16x16x64_bf16 v[48:51], v[40:43], a[208:215], v10
    s_add_u32 s43, s39, 114688
    buffer_store_dwordx2 v[20:21], v7, s[8:11], s43 offen
    v_cndmask_b32 v56, v32, v36, s[100:101]
    v_cndmask_b32 v57, v33, v37, s[100:101]
    v_cndmask_b32 v58, v34, v38, s[100:101]
    v_smfmac_f32_16x16x64_bf16 v[48:51], v[44:47], a[216:223], v10
    v_cndmask_b32 v59, v35, v39, s[100:101]
    v_cndmask_b32 v60, v40, v44, s[100:101]
    v_cndmask_b32 v61, v41, v45, s[100:101]
    v_smfmac_f32_16x16x64_bf16 v[52:55], v[32:35], a[160:167], v10
    v_cndmask_b32 v62, v42, v46, s[100:101]
    v_cndmask_b32 v63, v43, v47, s[100:101]
    v_mov_b64 v[24:25], 0
    v_smfmac_f32_16x16x64_bf16 v[52:55], v[36:39], a[168:175], v10
    v_mov_b64 v[26:27], 0
    s_nop 1
    v_smfmac_f32_16x16x64_bf16 v[24:27], v[56:59], a[240:247], v10
    v_cvt_pk_bf16_f32 v48, v48, v49
    v_cvt_pk_bf16_f32 v49, v50, v51
    v_smfmac_f32_16x16x64_bf16 v[24:27], v[60:63], a[248:255], v10
    v_and_or_b32 v48, v48, -2, s92
    v_smfmac_f32_16x16x64_bf16 v[52:55], v[40:43], a[224:231], v10
    s_add_u32 s43, s39, 180224
    buffer_store_dwordx2 v[48:49], v7, s[8:11], s43 offen
    v_smfmac_f32_16x16x64_bf16 v[52:55], v[44:47], a[232:239], v10
    v_add_f32 v24, v24, v26
    v_add_f32 v25, v25, v27
    v_cvt_pk_bf16_f32 v24, v24, v25
    v_and_or_b32 v24, v24, -2, s92
    s_add_u32 s43, s39, 278528
    buffer_store_dword v24, v7, s[8:11], s43 offen offset:4
    s_nop 1
    v_cvt_pk_bf16_f32 v52, v52, v53
    v_cvt_pk_bf16_f32 v53, v54, v55
    v_and_or_b32 v52, v52, -2, s92
    s_add_u32 s43, s39, 245760
    buffer_store_dwordx2 v[52:53], v7, s[8:11], s43 offen
    s_xor_b32 s92, s92, 1
    s_mov_b32 s45, s40
    s_mov_b32 s40, s41
    s_mov_b32 s41, s42
    s_mov_b32 s42, s93
    s_mov_b32 s93, s45
    s_add_u32 s38, s38, 1
    s_add_u32 s48, s48, 262144
    s_nop 0
    s_branch L_loop_f3
L_ga_f3:
    s_mov_b32 s49, 0
    s_add_u32 s43, s40, 3072
    buffer_load_dwordx4 v[60:63], v0, s[8:11], s43 offen sc1
    s_waitcnt vmcnt(3)
    s_branch L_gac1_f3
L_gaw0_f3:
    s_waitcnt vmcnt(1)
L_gac0_f3:
    ds_write_b128 v0, v[60:63] offset:3072
    v_max3_u32 v14, v60, v61, v62
    v_max_u32 v14, v14, v63
    v_cmp_le_u32 vcc, s51, v14
    s_cbranch_vccz L_ga3_f3
    s_and_b32 s43, s49, 15
    s_cmp_lg_u32 s43, 15
    s_cbranch_scc1 L_gan0_f3
    v_cmp_eq_u32 vcc, s51, v60
    v_cmp_eq_u32 s[44:45], s51, v61
    s_nop 0
    s_or_b64 vcc, vcc, s[44:45]
    v_cmp_eq_u32 s[44:45], s51, v62
    s_nop 0
    s_or_b64 vcc, vcc, s[44:45]
    v_cmp_eq_u32 s[44:45], s51, v63
    s_nop 0
    s_or_b64 vcc, vcc, s[44:45]
    s_cbranch_vccz L_ga3_f3
L_gan0_f3:
    s_add_u32 s43, s40, 3072
    buffer_load_dwordx4 v[60:63], v0, s[8:11], s43 offen sc1
    s_add_u32 s49, s49, 1
    s_cmp_gt_u32 s49, 4000000
    s_cbranch_scc1 L_fail
L_gaw1_f3:
    s_waitcnt vmcnt(1)
L_gac1_f3:
    ds_write_b128 v0, v[56:59] offset:3072
    v_max3_u32 v14, v56, v57, v58
    v_max_u32 v14, v14, v59
    v_cmp_le_u32 vcc, s51, v14
    s_cbranch_vccz L_ga3_f3
    s_and_b32 s43, s49, 15
    s_cmp_lg_u32 s43, 15
    s_cbranch_scc1 L_gan1_f3
    v_cmp_eq_u32 vcc, s51, v56
    v_cmp_eq_u32 s[44:45], s51, v57
    s_nop 0
    s_or_b64 vcc, vcc, s[44:45]
    v_cmp_eq_u32 s[44:45], s51, v58
    s_nop 0
    s_or_b64 vcc, vcc, s[44:45]
    v_cmp_eq_u32 s[44:45], s51, v59
    s_nop 0
    s_or_b64 vcc, vcc, s[44:45]
    s_cbranch_vccz L_ga3_f3
L_gan1_f3:
    s_add_u32 s43, s40, 3072
    buffer_load_dwordx4 v[56:59], v0, s[8:11], s43 offen sc1
    s_add_u32 s49, s49, 1
    s_cmp_gt_u32 s49, 4000000
    s_cbranch_scc1 L_fail
    s_branch L_gaw0_f3
L_ga3_f3:
    s_waitcnt lgkmcnt(0)
    s_waitcnt vmcnt(0)
    s_branch L_gar_f3
L_gb_f3:
    s_mov_b32 s49, 0
    s_add_u32 s43, s40, 7168
    buffer_load_dwordx4 v[32:35], v0, s[8:11], s43 offen sc1
    s_add_u32 s43, s40, 8960
    buffer_load_dword v12, v11, s[8:11], s43 offen sc1
    s_waitcnt vmcnt(2)
    s_branch L_gbc1_f3
L_gbw0_f3:
    s_waitcnt vmcnt(2)
L_gbc0_f3:
    ds_write_b128 v0, v[32:35] offset:7168
    ds_write_b32 v11, v12 offset:8960
    v_max3_u32 v14, v32, v33, v34
    v_max3_u32 v14, v14, v35, v12
    v_cmp_le_u32 vcc, s51, v14
    s_cbranch_vccz L_gb3_f3
    s_and_b32 s43, s49, 15
    s_cmp_lg_u32 s43, 15
    s_cbranch_scc1 L_gbn0_f3
    v_cmp_eq_u32 vcc, s51, v32
    v_cmp_eq_u32 s[44:45], s51, v33
    s_nop 0
    s_or_b64 vcc, vcc, s[44:45]
    v_cmp_eq_u32 s[44:45], s51, v34
    s_nop 0
    s_or_b64 vcc, vcc, s[44:45]
    v_cmp_eq_u32 s[44:45], s51, v35
    s_nop 0
    s_or_b64 vcc, vcc, s[44:45]
    v_cmp_eq_u32 s[44:45], s51, v12
    s_nop 0
    s_or_b64 vcc, vcc, s[44:45]
    s_cbranch_vccz L_gb3_f3
L_gbn0_f3:
    s_add_u32 s43, s40, 7168
    buffer_load_dwordx4 v[32:35], v0, s[8:11], s43 offen sc1
    s_add_u32 s43, s40, 8960
    buffer_load_dword v12, v11, s[8:11], s43 offen sc1
    s_add_u32 s49, s49, 1
    s_cmp_gt_u32 s49, 4000000
    s_cbranch_scc1 L_fail
L_gbw1_f3:
    s_waitcnt vmcnt(2)
L_gbc1_f3:
    ds_write_b128 v0, v[36:39] offset:7168
    ds_write_b32 v11, v13 offset:8960
    v_max3_u32 v14, v36, v37, v38
    v_max3_u32 v14, v14, v39, v13
    v_cmp_le_u32 vcc, s51, v14
    s_cbranch_vccz L_gb3_f3
    s_and_b32 s43, s49, 15
    s_cmp_lg_u32 s43, 15
    s_cbranch_scc1 L_gbn1_f3
    v_cmp_eq_u32 vcc, s51, v36
    v_cmp_eq_u32 s[44:45], s51, v37
    s_nop 0
    s_or_b64 vcc, vcc, s[44:45]
    v_cmp_eq_u32 s[44:45], s51, v38
    s_nop 0
    s_or_b64 vcc, vcc, s[44:45]
    v_cmp_eq_u32 s[44:45], s51, v39
    s_nop 0
    s_or_b64 vcc, vcc, s[44:45]
    v_cmp_eq_u32 s[44:45], s51, v13
    s_nop 0
    s_or_b64 vcc, vcc, s[44:45]
    s_cbranch_vccz L_gb3_f3
L_gbn1_f3:
    s_add_u32 s43, s40, 7168
    buffer_load_dwordx4 v[36:39], v0, s[8:11], s43 offen sc1
    s_add_u32 s43, s40, 8960
    buffer_load_dword v13, v11, s[8:11], s43 offen sc1
    s_add_u32 s49, s49, 1
    s_cmp_gt_u32 s49, 4000000
    s_cbranch_scc1 L_fail
    s_branch L_gbw0_f3
L_gb3_f3:
    s_waitcnt lgkmcnt(0)
    s_waitcnt vmcnt(0)
    s_branch L_gbr_f3
L_slow_f3:
    s_cmp_eq_u32 s46, 0x5105
    s_cbranch_scc1 L_pv3_f3
    s_mov_b32 s46, 0x5105
    s_nop 0
    v_mov_b32 v54, v52
    v_mov_b32 v55, v53
    s_nop 0
    v_max_f32_dpp v54, v54, v54 row_ror:1 row_mask:0xf bank_mask:0xf
    v_max_f32_dpp v55, v55, v55 row_ror:1 row_mask:0xf bank_mask:0xf
    s_nop 0
    v_max_f32_dpp v54, v54, v54 row_ror:2 row_mask:0xf bank_mask:0xf
    v_max_f32_dpp v55, v55, v55 row_ror:2 row_mask:0xf bank_mask:0xf
    s_nop 0
    v_max_f32_dpp v54, v54, v54 row_ror:4 row_mask:0xf bank_mask:0xf
    v_max_f32_dpp v55, v55, v55 row_ror:4 row_mask:0xf bank_mask:0xf
    s_nop 0
    v_max_f32_dpp v54, v54, v54 row_ror:8 row_mask:0xf bank_mask:0xf
    v_max_f32_dpp v55, v55, v55 row_ror:8 row_mask:0xf bank_mask:0xf
    v_and_b32 v35, 15, v11
    v_lshlrev_b32 v35, 1, v35
    ds_write_b64 v35, v[54:55] offset:16320
    s_waitcnt lgkmcnt(0)
    s_barrier
    ds_read_b64 v[16:17], v35 offset:16256
    ds_read_b64 v[18:19], v35 offset:16288
    ds_read_b64 v[20:21], v35 offset:16320
    s_waitcnt lgkmcnt(0)
    v_max3_f32 v54, v16, v18, v20
    v_max3_f32 v55, v17, v19, v21
    v_sub_f32 v54, v52, v54
    v_sub_f32 v55, v53, v55
    v_exp_f32 v54, v54
    v_exp_f32 v55, v55
    s_nop 0
    v_cvt_pk_bf16_f32 v54, v54, v55
    ds_write_b32 v11, v54 offset:15872
    s_waitcnt lgkmcnt(0)
    s_barrier
    s_branch L_pv_f3
L_pv2_f3:
    ds_read_b128 v[24:27], v0 offset:30720
    ds_read_b128 v[28:31], v0 offset:31744
    s_waitcnt lgkmcnt(0)
    v_mov_b32 v56, 0x3f803f80
    v_mov_b32 v57, 0x3f803f80
    v_mov_b32 v58, 0x3f803f80
    v_mov_b32 v59, 0x3f803f80
    s_nop 1
    v_mfma_f32_16x16x32_bf16 v[36:39], v[56:59], v[48:51], 0
    v_mfma_f32_16x16x32_bf16 v[16:19], v[24:27], v[48:51], 0
    v_mfma_f32_16x16x32_bf16 v[20:23], v[28:31], v[48:51], 0
    v_mfma_f32_16x16x16_bf16 v[36:39], v[32:33], v[54:55], v[36:39]
    v_mfma_f32_16x16x16_bf16 v[16:19], v[40:41], v[54:55], v[16:19]
    v_mfma_f32_16x16x16_bf16 v[20:23], v[44:45], v[54:55], v[20:23]
    s_nop 7
    s_branch L_pv4_f3
L_tail_f3:
    s_waitcnt lgkmcnt(0)
    v_smfmac_f32_16x16x64_bf16 v[44:47], v[60:63], a[120:127], v10
    ds_read_b128 v[16:19], v1 offset:16384
    ds_read_b128 v[20:23], v1 offset:17408
    v_smfmac_f32_16x16x64_bf16 v[40:43], v[48:51], a[128:135], v10
    ds_read_b128 v[24:27], v1 offset:18432
    ds_read_b128 v[28:31], v1 offset:19456
    v_smfmac_f32_16x16x64_bf16 v[44:47], v[48:51], a[136:143], v10
    ds_read_b64_tr_b16 v[60:61], v2 offset:0
    ds_read_b64_tr_b16 v[62:63], v3 offset:0
    v_smfmac_f32_16x16x64_bf16 v[40:43], v[56:59], a[32:39], v10
    ds_read_b64_tr_b16 v[48:49], v2 offset:1024
    ds_read_b64_tr_b16 v[50:51], v3 offset:1024
    v_smfmac_f32_16x16x64_bf16 v[44:47], v[56:59], a[40:47], v10
    ds_read_b64_tr_b16 v[56:57], v2 offset:2048
    ds_read_b64_tr_b16 v[58:59], v3 offset:2048
    s_waitcnt lgkmcnt(4)
    v_smfmac_f32_16x16x64_bf16 v[40:43], v[60:63], a[48:55], v10
    v_smfmac_f32_16x16x64_bf16 v[44:47], v[60:63], a[56:63], v10
    ds_read_b64_tr_b16 v[60:61], v2 offset:7168
    ds_read_b64_tr_b16 v[62:63], v3 offset:7168
    s_waitcnt lgkmcnt(4)
    v_smfmac_f32_16x16x64_bf16 v[40:43], v[48:51], v[16:23], v10
    v_smfmac_f32_16x16x64_bf16 v[44:47], v[48:51], v[24:31], v10
    s_waitcnt lgkmcnt(2)
    v_smfmac_f32_16x16x64_bf16 v[40:43], v[56:59], a[64:71], v10
    v_smfmac_f32_16x16x64_bf16 v[44:47], v[56:59], a[72:79], v10
    s_waitcnt lgkmcnt(0)
    v_smfmac_f32_16x16x64_bf16 v[40:43], v[60:63], a[80:87], v10
    v_smfmac_f32_16x16x64_bf16 v[44:47], v[60:63], a[88:95], v10
    s_nop 3
    v_add_f32 v40, v40, v42
    v_add_f32 v41, v41, v43
    v_cvt_pk_bf16_f32 v40, v40, v41
    s_nop 0
    v_add_f32 v44, v44, v46
    v_add_f32 v45, v45, v47
    v_cvt_pk_bf16_f32 v44, v44, v45
    ds_write_b32 v11, v40 offset:10752
    ds_write_b32 v11, v44 offset:11008
    s_waitcnt vmcnt(0)
    v_and_b32 v12, 0x200, v0
    v_mul_u32_u24 v12, 3, v12
    v_add_u32 v12, v12, v0
    ds_read_b128 v[12:15], v12 offset:10752
    s_waitcnt lgkmcnt(0)
    s_lshr_b32 s44, s48, 1
    s_add_u32 s44, s44, 0x4100c00
    buffer_store_dwordx4 v[12:15], v0, s[8:11], s44 offen sc1
    s_waitcnt vmcnt(0)
    s_barrier
    s_branch L_end
L_slowmode_3:
    ds_read_b128 v[32:35], v0 offset:7168
    ds_read_b32 v12, v11 offset:8960
    ds_read_b128 v[40:43], v1 offset:0
    ds_read_b128 v[44:47], v1 offset:1024
    v_mov_b64 v[16:17], 0
    v_mov_b64 v[18:19], 0
    v_mov_b64 v[20:21], 0
    v_mov_b64 v[22:23], 0
    v_mov_b64 v[24:25], 0
    v_mov_b64 v[26:27], 0
    v_mov_b64 v[28:29], 0
    v_mov_b64 v[30:31], 0
    s_waitcnt vmcnt(0) lgkmcnt(0)
    s_nop 0
    s_branch L_gar_s3
L_loop_s3:
    s_barrier
    s_add_u32 s43, s40, 3072
    buffer_load_dwordx4 v[60:63], v0, s[8:11], s43 offen sc1
    v_mov_b64 v[16:17], 0
    v_mov_b64 v[18:19], 0
    v_mov_b64 v[20:21], 0
    v_mov_b64 v[22:23], 0
    v_mov_b64 v[24:25], 0
    v_mov_b64 v[26:27], 0
    v_mov_b64 v[28:29], 0
    v_mov_b64 v[30:31], 0
    s_nop 15
    s_nop 7
    s_add_u32 s43, s40, 3072
    buffer_load_dwordx4 v[56:59], v0, s[8:11], s43 offen sc1
    s_waitcnt vmcnt(1)
    ds_write_b128 v0, v[60:63] offset:3072
    v_max3_u32 v14, v60, v61, v62
    v_max_u32 v14, v14, v63
    v_cmp_le_u32 vcc, s51, v14
    s_add_u32 s43, s40, 7168
    buffer_load_dwordx4 v[32:35], v0, s[8:11], s43 offen sc1
    s_add_u32 s43, s40, 8960
    buffer_load_dword v12, v11, s[8:11], s43 offen sc1
    s_cbranch_vccnz L_ga_s3
L_gar_s3:
    ds_read_b64_tr_b16 v[48:49], v2 offset:3072
    ds_read_b64_tr_b16 v[50:51], v3 offset:3072
    ds_read_b128 v[40:43], v1 offset:0
    ds_read_b128 v[44:47], v1 offset:1024
    s_waitcnt lgkmcnt(4)
    s_barrier
    ds_read_b64_tr_b16 v[52:53], v2 offset:0
    ds_read_b64_tr_b16 v[54:55], v3 offset:0
    s_waitcnt lgkmcnt(4)
    s_waitcnt lgkmcnt(2)
    v_smfmac_f32_16x16x64_bf16 v[16:19], v[48:51], v[40:47], v10
    s_waitcnt vmcnt(2)
    ds_read_b64_tr_b16 v[56:57], v2 offset:1024
    ds_read_b64_tr_b16 v[58:59], v3 offset:1024
    v_smfmac_f32_16x16x64_bf16 v[24:27], v[48:51], v[176:183], v10
    ds_read_b64_tr_b16 v[60:61], v2 offset:2048
    ds_read_b64_tr_b16 v[62:63], v3 offset:2048
    v_smfmac_f32_16x16x64_bf16 v[28:31], v[48:51], v[184:191], v10
    ds_read_b128 v[40:43], v1 offset:2048
    ds_read_b128 v[44:47], v1 offset:3072
    s_waitcnt lgkmcnt(6)
    v_smfmac_f32_16x16x64_bf16 v[16:19], v[52:55], v[64:71], v10
    s_add_u32 s43, s40, 7168
    buffer_load_dwordx4 v[36:39], v0, s[8:11], s43 offen sc1
    s_add_u32 s43, s40, 8960
    buffer_load_dword v13, v11, s[8:11], s43 offen sc1
    v_smfmac_f32_16x16x64_bf16 v[20:23], v[52:55], v[72:79], v10
    v_smfmac_f32_16x16x64_bf16 v[24:27], v[52:55], v[192:199], v10
    s_waitcnt lgkmcnt(0)
    v_smfmac_f32_16x16x64_bf16 v[20:23], v[48:51], v[40:47], v10
    ds_read_b128 v[40:43], v1 offset:8192
    v_smfmac_f32_16x16x64_bf16 v[28:31], v[52:55], v[200:207], v10
    ds_read_b128 v[44:47], v1 offset:9216
    v_smfmac_f32_16x16x64_bf16 v[16:19], v[56:59], v[80:87], v10
    s_waitcnt vmcnt(2)
    ds_write_b128 v0, v[32:35] offset:7168
    v_max3_u32 v14, v32, v33, v34
    v_smfmac_f32_16x16x64_bf16 v[20:23], v[56:59], v[88:95], v10
    ds_write_b32 v11, v12 offset:8960
    v_max3_u32 v14, v14, v35, v12
    v_smfmac_f32_16x16x64_bf16 v[24:27], v[56:59], v[208:215], v10
    v_cmp_le_u32 vcc, s51, v14
    v_smfmac_f32_16x16x64_bf16 v[28:31], v[56:59], v[216:223], v10
    s_cbranch_vccnz L_gb_s3
L_gbr_s3:
    ds_read_b64_tr_b16 v[48:49], v2 offset:7168
    v_smfmac_f32_16x16x64_bf16 v[16:19], v[60:63], v[96:103], v10
    ds_read_b64_tr_b16 v[50:51], v3 offset:7168
    v_smfmac_f32_16x16x64_bf16 v[20:23], v[60:63], v[104:111], v10
    s_waitcnt lgkmcnt(2)
    s_barrier
    ds_read_b64_tr_b16 v[52:53], v2 offset:4096
    ds_read_b64_tr_b16 v[54:55], v3 offset:4096
    v_smfmac_f32_16x16x64_bf16 v[24:27], v[60:63], v[40:47], v10
    s_mov_b32 m0, 0x7000
    s_add_u32 s55, s48, 0x2001000
    buffer_load_dwordx4 v0, s[8:11], s55 offen sc1 lds
    ds_read_b64_tr_b16 v[56:57], v2 offset:5120
    ds_read_b64_tr_b16 v[58:59], v3 offset:5120
    s_waitcnt lgkmcnt(4)
    v_smfmac_f32_16x16x64_bf16 v[16:19], v[48:51], v[112:119], v10
    buffer_load_dwordx4 v0, s[8:11], s55 offen offset:1024 sc1 lds
    s_waitcnt vmcnt(2)
    ds_read_b128 v[32:35], v1 offset:10240
    ds_read_b128 v[36:39], v1 offset:11264
    v_smfmac_f32_16x16x64_bf16 v[20:23], v[48:51], v[120:127], v10
    buffer_load_dwordx4 v0, s[8:11], s55 offen offset:2048 sc1 lds
    ds_read_b128 v[40:43], v1 offset:4096
    ds_read_b128 v[44:47], v1 offset:5120
    v_smfmac_f32_16x16x64_bf16 v[24:27], v[48:51], v[224:231], v10
    buffer_load_dwordx4 v0, s[8:11], s55 offen offset:3072 sc1 lds
    v_smfmac_f32_16x16x64_bf16 v[28:31], v[48:51], v[232:239], v10
    ds_read_b64_tr_b16 v[48:49], v2 offset:8192
    ds_read_b64_tr_b16 v[50:51], v3 offset:8192
    s_waitcnt lgkmcnt(8)
    v_smfmac_f32_16x16x64_bf16 v[24:27], v[52:55], v[240:247], v10
    s_waitcnt lgkmcnt(4)
    v_smfmac_f32_16x16x64_bf16 v[28:31], v[60:63], v[32:39], v10
    ds_read_b64_tr_b16 v[60:61], v2 offset:6144
    s_waitcnt lgkmcnt(3)
    v_smfmac_f32_16x16x64_bf16 v[16:19], v[52:55], v[40:47], v10
    ds_read_b64_tr_b16 v[62:63], v3 offset:6144
    v_smfmac_f32_16x16x64_bf16 v[28:31], v[52:55], v[248:255], v10
    ds_read_b128 v[32:35], v1 offset:6144
    v_lshlrev_b32 v12, 3, v0
    v_smfmac_f32_16x16x64_bf16 v[16:19], v[56:59], v[128:135], v10
    s_mov_b32 m0, 0x3e80
    s_add_u32 s44, s48, 0x2040000
    buffer_load_dword v12, s[8:11], s44 offen sc1 lds
    ds_read_b128 v[36:39], v1 offset:7168
    v_and_b32 v12, 0x200, v0
    v_smfmac_f32_16x16x64_bf16 v[20:23], v[56:59], v[136:143], v10
    ds_read_b128 v[40:43], v1 offset:12288
    v_mul_u32_u24 v12, 3, v12
    s_waitcnt lgkmcnt(3)
    v_smfmac_f32_16x16x64_bf16 v[16:19], v[60:63], v[144:151], v10
    ds_read_b128 v[44:47], v1 offset:13312
    v_add_u32 v12, v12, v0
    s_waitcnt lgkmcnt(2)
    v_smfmac_f32_16x16x64_bf16 v[20:23], v[52:55], v[32:39], v10
    ds_read_b128 v[12:15], v12 offset:10752
    v_smfmac_f32_16x16x64_bf16 v[20:23], v[60:63], v[152:159], v10
    ds_read_b128 v[32:35], v1 offset:14336
    v_smfmac_f32_16x16x64_bf16 v[16:19], v[48:51], v[160:167], v10
    ds_read_b128 v[36:39], v1 offset:15360
    v_smfmac_f32_16x16x64_bf16 v[20:23], v[48:51], v[168:175], v10
    s_waitcnt lgkmcnt(3)
    v_smfmac_f32_16x16x64_bf16 v[24:27], v[56:59], v[40:47], v10
    s_waitcnt lgkmcnt(2)
    s_lshr_b32 s44, s48, 1
    s_add_u32 s44, s44, 0x40e0c00
    buffer_store_dwordx4 v[12:15], v0, s[8:11], s44 offen sc1
    v_add_f32 v16, v16, v18
    v_add_f32 v17, v17, v19
    s_waitcnt lgkmcnt(0)
    v_smfmac_f32_16x16x64_bf16 v[28:31], v[56:59], v[32:39], v10
    v_cvt_pk_bf16_f32 v16, v16, v17
    v_add_f32 v20, v20, v22
    v_smfmac_f32_16x16x64_bf16 v[24:27], v[60:63], a[0:7], v10
    ds_read_b128 v[32:35], v1 offset:22528
    v_add_f32 v21, v21, v23
    v_cvt_pk_bf16_f32 v17, v20, v21
    v_smfmac_f32_16x16x64_bf16 v[24:27], v[48:51], a[16:23], v10
    ds_read_b128 v[36:39], v1 offset:23552
    v_mov_b64 v[40:41], 0
    v_mov_b64 v[42:43], 0
    v_smfmac_f32_16x16x64_bf16 v[28:31], v[60:63], a[8:15], v10
    ds_write_b64 v4, v[16:17] offset:10752
    v_mov_b64 v[44:45], 0
    v_mov_b64 v[46:47], 0
    v_smfmac_f32_16x16x64_bf16 v[28:31], v[48:51], a[24:31], v10
    ds_read_b128 v[16:19], v1 offset:20480
    v_mov_b64 v[12:13], s[94:95]
    v_mov_b64 v[14:15], s[94:95]
    v_add_f32 v24, v24, v26
    v_add_f32 v25, v25, v27
    v_cvt_pk_bf16_f32 v24, v24, v25
    v_smfmac_f32_16x16x64_bf16 v[40:43], v[52:55], a[96:103], v10
    ds_read_b128 v[20:23], v1 offset:21504
    v_smfmac_f32_16x16x64_bf16 v[44:47], v[52:55], a[104:111], v10
    s_mul_i32 s45, s36, 288
    s_add_u32 s45, s93, s45
    s_mov_b64 exec, s[88:89]
    buffer_store_dwordx4 v[12:15], v0, s[8:11], s45 offen sc1
    s_mov_b64 exec, -1
    v_add_f32 v28, v28, v30
    v_add_f32 v29, v29, v31
    v_cvt_pk_bf16_f32 v25, v28, v29
    ds_write2st64_b32 v11, v24, v25 offset0:50 offset1:51
    s_waitcnt lgkmcnt(4)
    v_smfmac_f32_16x16x64_bf16 v[44:47], v[56:59], v[32:39], v10
    v_mov_b64 v[52:53], 0
    v_mov_b64 v[54:55], 0
    v_smfmac_f32_16x16x64_bf16 v[40:43], v[60:63], a[112:119], v10
    s_waitcnt lgkmcnt(1)
    v_smfmac_f32_16x16x64_bf16 v[40:43], v[56:59], v[16:23], v10
    ds_read_b64_tr_b16 v[56:57], v2 offset:3072
    ds_read_b64_tr_b16 v[58:59], v3 offset:3072
    s_waitcnt lgkmcnt(2)
    s_barrier
    s_cmp_eq_u32 s38, 63
    s_cbranch_scc1 L_tail_s3
    ds_read_b64_tr_b16 v[32:33], v2 offset:9216
    ds_read_b64_tr_b16 v[34:35], v3 offset:9216
    ds_read_b64_tr_b16 v[36:37], v2 offset:10240
    ds_read_b64_tr_b16 v[38:39], v3 offset:10240
    ds_read_b64_tr_b16 v[16:17], v9 offset:11264
    ds_read_b64_tr_b16 v[18:19], v9 offset:11296
    ds_read_b64_tr_b16 v[20:21], v9 offset:11776
    ds_read_b64_tr_b16 v[22:23], v9 offset:11808
    ds_read_b64_tr_b16 v[24:25], v9 offset:12288
    ds_read_b64_tr_b16 v[26:27], v9 offset:12320
    ds_read_b64_tr_b16 v[28:29], v9 offset:12800
    ds_read_b64_tr_b16 v[30:31], v9 offset:12832
    v_smfmac_f32_16x16x64_bf16 v[44:47], v[60:63], a[120:127], v10
    ds_read_b64_tr_b16 v[60:61], v2 offset:0
    v_smfmac_f32_16x16x64_bf16 v[40:43], v[48:51], a[128:135], v10
    ds_read_b64_tr_b16 v[62:63], v3 offset:0
    v_smfmac_f32_16x16x64_bf16 v[44:47], v[48:51], a[136:143], v10
    ds_read_b64_tr_b16 v[48:49], v2 offset:1024
    s_waitcnt lgkmcnt(15)
    v_smfmac_f32_16x16x64_bf16 v[40:43], v[56:59], a[32:39], v10
    ds_read_b64_tr_b16 v[50:51], v3 offset:1024
    s_waitcnt lgkmcnt(4)
    v_smfmac_f32_16x16x64_bf16 v[52:55], v[32:35], v[16:23], v10
    v_smfmac_f32_16x16x64_bf16 v[52:55], v[36:39], v[24:31], v10
    ds_read_b128 v[16:19], v1 offset:16384
    ds_read_b128 v[20:23], v1 offset:17408
    v_smfmac_f32_16x16x64_bf16 v[44:47], v[56:59], a[40:47], v10
    ds_read_b128 v[24:27], v1 offset:18432
    ds_read_b128 v[28:31], v1 offset:19456
    s_waitcnt lgkmcnt(6)
    v_smfmac_f32_16x16x64_bf16 v[40:43], v[60:63], a[48:55], v10
    ds_read_b64_tr_b16 v[56:57], v2 offset:2048
    ds_read_b64_tr_b16 v[58:59], v3 offset:2048
    v_add_f32 v52, v52, v54
    v_add_f32 v53, v53, v55
    v_mul_f32 v52, s50, v52
    v_mul_f32 v53, s50, v53
    v_exp_f32 v54, v52
    v_exp_f32 v55, v53
    s_nop 0
    v_cvt_pk_bf16_f32 v54, v54, v55
    ds_write_b32 v11, v54 offset:15872
    v_smfmac_f32_16x16x64_bf16 v[44:47], v[60:63], a[56:63], v10
    ds_read_b64_tr_b16 v[60:61], v2 offset:7168
    ds_read_b64_tr_b16 v[62:63], v3 offset:7168
    s_waitcnt lgkmcnt(9)
    s_waitcnt lgkmcnt(7)
    v_smfmac_f32_16x16x64_bf16 v[40:43], v[48:51], v[16:23], v10
    s_waitcnt lgkmcnt(5)
    v_smfmac_f32_16x16x64_bf16 v[44:47], v[48:51], v[24:31], v10
    s_waitcnt lgkmcnt(2)
    s_waitcnt vmcnt(3)
    s_barrier
L_pv_s3:
    ds_read_b64_tr_b16 v[48:49], v5 offset:15360
    ds_read_b64_tr_b16 v[50:51], v5 offset:15616
    ds_read_b64_tr_b16 v[54:55], v8 offset:15872
    s_cmp_eq_u32 s46, 0x5105
    s_cbranch_scc1 L_pv2_s3
    ds_read_b128 v[24:27], v0 offset:30720
    ds_read_b128 v[28:31], v0 offset:31744
    v_smfmac_f32_16x16x64_bf16 v[40:43], v[56:59], a[64:71], v10
    v_mov_b64 v[32:33], s[98:99]
    v_smfmac_f32_16x16x64_bf16 v[44:47], v[56:59], a[72:79], v10
    s_waitcnt lgkmcnt(5)
    v_smfmac_f32_16x16x64_bf16 v[40:43], v[60:63], a[80:87], v10
    v_mov_b64 v[56:57], s[96:97]
    v_smfmac_f32_16x16x64_bf16 v[44:47], v[60:63], a[88:95], v10
    v_mov_b64 v[58:59], s[96:97]
    s_waitcnt lgkmcnt(0)
    s_nop 0
    v_mfma_f32_16x16x32_bf16 v[36:39], v[56:59], v[48:51], 0
    v_mfma_f32_16x16x32_bf16 v[16:19], v[24:27], v[48:51], 0
    v_add_f32 v40, v40, v42
    v_add_f32 v41, v41, v43
    v_mfma_f32_16x16x32_bf16 v[20:23], v[28:31], v[48:51], 0
    v_cvt_pk_bf16_f32 v40, v40, v41
    v_mov_b32 v41, 0
    v_mfma_f32_16x16x16_bf16 v[36:39], v[32:33], v[54:55], v[36:39]
    v_add_f32 v44, v44, v46
    v_add_f32 v45, v45, v47
    v_mfma_f32_16x16x16_bf16 v[16:19], v[40:41], v[54:55], v[16:19]
    v_cvt_pk_bf16_f32 v44, v44, v45
    v_mov_b32 v45, 0
    s_nop 1
    v_mfma_f32_16x16x16_bf16 v[20:23], v[44:45], v[54:55], v[20:23]
L_pv4_s3:
    ds_read_b128 v[56:59], v1 offset:24576
    ds_read_b128 v[60:63], v1 offset:25600
    ds_read_b128 v[24:27], v1 offset:26624
    ds_read_b128 v[28:31], v1 offset:27648
    v_rcp_f32 v34, v36
    v_cmp_ngt_f32 vcc, s69, v36
    v_cmp_nlt_f32 s[44:45], s68, v36
    v_cndmask_b32 v16, v18, v16, s[56:57]
    v_cndmask_b32 v17, v19, v17, s[56:57]
    s_or_b64 vcc, vcc, s[44:45]
    v_mul_f32 v16, v16, v34
    v_mul_f32 v17, v17, v34
    v_cndmask_b32 v20, v22, v20, s[56:57]
    v_cndmask_b32 v21, v23, v21, s[56:57]
    v_cvt_pk_bf16_f32 v16, v16, v17
    v_mul_f32 v20, v20, v34
    v_mul_f32 v21, v21, v34
    s_cbranch_vccnz L_slow_s3
L_pv3_s3:
    v_cvt_pk_bf16_f32 v20, v20, v21
    ds_write2_b32 v6, v16, v20 offset0:0 offset1:2
    s_mov_b32 s46, 0
    v_lshrrev_b32 v12, 1, v0
    v_and_b32 v12, 0x1e0, v12
    v_and_or_b32 v12, v0, 16, v12
    v_mov_b64 v[48:49], 0
    v_mov_b64 v[50:51], 0
    v_mov_b64 v[52:53], 0
    v_mov_b64 v[54:55], 0
    v_mov_b64 v[16:17], 0
    v_mov_b64 v[18:19], 0
    v_mov_b64 v[20:21], 0
    v_mov_b64 v[22:23], 0
    s_waitcnt lgkmcnt(0)
    s_barrier
    ds_read_b128 v[32:35], v12 offset:13312
    ds_read_b128 v[36:39], v12 offset:13824
    ds_write2st64_b32 v11, v40, v44 offset0:42 offset1:43
    ds_read_b128 v[40:43], v12 offset:14336
    ds_read_b128 v[44:47], v12 offset:14848
    s_waitcnt lgkmcnt(4)
    v_smfmac_f32_16x16x64_bf16 v[16:19], v[32:35], v[56:63], v10
    ds_read_b128 v[56:59], v1 offset:28672
    v_smfmac_f32_16x16x64_bf16 v[20:23], v[32:35], a[144:151], v10
    ds_read_b128 v[60:63], v1 offset:29696
    s_waitcnt lgkmcnt(5)
    v_smfmac_f32_16x16x64_bf16 v[16:19], v[36:39], v[24:31], v10
    ds_read_b128 v[24:27], v1 offset:30720
    v_smfmac_f32_16x16x64_bf16 v[20:23], v[36:39], a[152:159], v10
    ds_read_b128 v[28:31], v1 offset:31744
    s_waitcnt lgkmcnt(5)
    v_smfmac_f32_16x16x64_bf16 v[16:19], v[40:43], a[176:183], v10
    v_smfmac_f32_16x16x64_bf16 v[20:23], v[40:43], a[192:199], v10
    s_waitcnt lgkmcnt(4)
    v_smfmac_f32_16x16x64_bf16 v[16:19], v[44:47], a[184:191], v10
    v_smfmac_f32_16x16x64_bf16 v[20:23], v[44:47], a[200:207], v10
    s_waitcnt lgkmcnt(2)
    v_smfmac_f32_16x16x64_bf16 v[48:51], v[32:35], v[56:63], v10
    v_cvt_pk_bf16_f32 v16, v16, v17
    v_cvt_pk_bf16_f32 v17, v18, v19
    v_and_or_b32 v16, v16, -2, s92
    s_waitcnt lgkmcnt(0)
    v_smfmac_f32_16x16x64_bf16 v[48:51], v[36:39], v[24:31], v10
    s_add_u32 s43, s39, 49152
    buffer_store_dwordx2 v[16:17], v7, s[8:11], s43 offen sc1
    v_cvt_pk_bf16_f32 v20, v20, v21
    v_cvt_pk_bf16_f32 v21, v22, v23
    v_and_or_b32 v20, v20, -2, s92
    v_smfmac_f32_16x16x64_bf16 v[48:51], v[40:43], a[208:215], v10
    s_add_u32 s43, s39, 114688
    buffer_store_dwordx2 v[20:21], v7, s[8:11], s43 offen sc1
    v_cndmask_b32 v56, v32, v36, s[100:101]
    v_cndmask_b32 v57, v33, v37, s[100:101]
    v_cndmask_b32 v58, v34, v38, s[100:101]
    v_smfmac_f32_16x16x64_bf16 v[48:51], v[44:47], a[216:223], v10
    v_cndmask_b32 v59, v35, v39, s[100:101]
    v_cndmask_b32 v60, v40, v44, s[100:101]
    v_cndmask_b32 v61, v41, v45, s[100:101]
    v_smfmac_f32_16x16x64_bf16 v[52:55], v[32:35], a[160:167], v10
    v_cndmask_b32 v62, v42, v46, s[100:101]
    v_cndmask_b32 v63, v43, v47, s[100:101]
    v_mov_b64 v[24:25], 0
    v_smfmac_f32_16x16x64_bf16 v[52:55], v[36:39], a[168:175], v10
    v_mov_b64 v[26:27], 0
    s_nop 1
    v_smfmac_f32_16x16x64_bf16 v[24:27], v[56:59], a[240:247], v10
    v_cvt_pk_bf16_f32 v48, v48, v49
    v_cvt_pk_bf16_f32 v49, v50, v51
    v_smfmac_f32_16x16x64_bf16 v[24:27], v[60:63], a[248:255], v10
    v_and_or_b32 v48, v48, -2, s92
    v_smfmac_f32_16x16x64_bf16 v[52:55], v[40:43], a[224:231], v10
    s_add_u32 s43, s39, 180224
    buffer_store_dwordx2 v[48:49], v7, s[8:11], s43 offen sc1
    v_smfmac_f32_16x16x64_bf16 v[52:55], v[44:47], a[232:239], v10
    v_add_f32 v24, v24, v26
    v_add_f32 v25, v25, v27
    v_cvt_pk_bf16_f32 v24, v24, v25
    v_and_or_b32 v24, v24, -2, s92
    s_add_u32 s43, s39, 278528
    buffer_store_dword v24, v7, s[8:11], s43 offen offset:4 sc1
    s_nop 1
    v_cvt_pk_bf16_f32 v52, v52, v53
    v_cvt_pk_bf16_f32 v53, v54, v55
    v_and_or_b32 v52, v52, -2, s92
    s_add_u32 s43, s39, 245760
    buffer_store_dwordx2 v[52:53], v7, s[8:11], s43 offen sc1
    s_xor_b32 s92, s92, 1
    s_mov_b32 s45, s40
    s_mov_b32 s40, s41
    s_mov_b32 s41, s42
    s_mov_b32 s42, s93
    s_mov_b32 s93, s45
    s_add_u32 s38, s38, 1
    s_add_u32 s48, s48, 262144
    s_nop 0
    s_branch L_loop_s3
L_ga_s3:
    s_mov_b32 s49, 0
    s_add_u32 s43, s40, 3072
    buffer_load_dwordx4 v[60:63], v0, s[8:11], s43 offen sc1
    s_waitcnt vmcnt(3)
    s_branch L_gac1_s3
L_gaw0_s3:
    s_waitcnt vmcnt(1)
L_gac0_s3:
    ds_write_b128 v0, v[60:63] offset:3072
    v_max3_u32 v14, v60, v61, v62
    v_max_u32 v14, v14, v63
    v_cmp_le_u32 vcc, s51, v14
    s_cbranch_vccz L_ga3_s3
    s_and_b32 s43, s49, 15
    s_cmp_lg_u32 s43, 15
    s_cbranch_scc1 L_gan0_s3
    v_cmp_eq_u32 vcc, s51, v60
    v_cmp_eq_u32 s[44:45], s51, v61
    s_nop 0
    s_or_b64 vcc, vcc, s[44:45]
    v_cmp_eq_u32 s[44:45], s51, v62
    s_nop 0
    s_or_b64 vcc, vcc, s[44:45]
    v_cmp_eq_u32 s[44:45], s51, v63
    s_nop 0
    s_or_b64 vcc, vcc, s[44:45]
    s_cbranch_vccz L_ga3_s3
L_gan0_s3:
    s_add_u32 s43, s40, 3072
    buffer_load_dwordx4 v[60:63], v0, s[8:11], s43 offen sc1
    s_add_u32 s49, s49, 1
    s_cmp_gt_u32 s49, 4000000
    s_cbranch_scc1 L_fail
L_gaw1_s3:
    s_waitcnt vmcnt(1)
L_gac1_s3:
    ds_write_b128 v0, v[56:59] offset:3072
    v_max3_u32 v14, v56, v57, v58
    v_max_u32 v14, v14, v59
    v_cmp_le_u32 vcc, s51, v14
    s_cbranch_vccz L_ga3_s3
    s_and_b32 s43, s49, 15
    s_cmp_lg_u32 s43, 15
    s_cbranch_scc1 L_gan1_s3
    v_cmp_eq_u32 vcc, s51, v56
    v_cmp_eq_u32 s[44:45], s51, v57
    s_nop 0
    s_or_b64 vcc, vcc, s[44:45]
    v_cmp_eq_u32 s[44:45], s51, v58
    s_nop 0
    s_or_b64 vcc, vcc, s[44:45]
    v_cmp_eq_u32 s[44:45], s51, v59
    s_nop 0
    s_or_b64 vcc, vcc, s[44:45]
    s_cbranch_vccz L_ga3_s3
L_gan1_s3:
    s_add_u32 s43, s40, 3072
    buffer_load_dwordx4 v[56:59], v0, s[8:11], s43 offen sc1
    s_add_u32 s49, s49, 1
    s_cmp_gt_u32 s49, 4000000
    s_cbranch_scc1 L_fail
    s_branch L_gaw0_s3
L_ga3_s3:
    s_waitcnt lgkmcnt(0)
    s_waitcnt vmcnt(0)
    s_branch L_gar_s3
L_gb_s3:
    s_mov_b32 s49, 0
    s_add_u32 s43, s40, 7168
    buffer_load_dwordx4 v[32:35], v0, s[8:11], s43 offen sc1
    s_add_u32 s43, s40, 8960
    buffer_load_dword v12, v11, s[8:11], s43 offen sc1
    s_waitcnt vmcnt(2)
    s_branch L_gbc1_s3
L_gbw0_s3:
    s_waitcnt vmcnt(2)
L_gbc0_s3:
    ds_write_b128 v0, v[32:35] offset:7168
    ds_write_b32 v11, v12 offset:8960
    v_max3_u32 v14, v32, v33, v34
    v_max3_u32 v14, v14, v35, v12
    v_cmp_le_u32 vcc, s51, v14
    s_cbranch_vccz L_gb3_s3
    s_and_b32 s43, s49, 15
    s_cmp_lg_u32 s43, 15
    s_cbranch_scc1 L_gbn0_s3
    v_cmp_eq_u32 vcc, s51, v32
    v_cmp_eq_u32 s[44:45], s51, v33
    s_nop 0
    s_or_b64 vcc, vcc, s[44:45]
    v_cmp_eq_u32 s[44:45], s51, v34
    s_nop 0
    s_or_b64 vcc, vcc, s[44:45]
    v_cmp_eq_u32 s[44:45], s51, v35
    s_nop 0
    s_or_b64 vcc, vcc, s[44:45]
    v_cmp_eq_u32 s[44:45], s51, v12
    s_nop 0
    s_or_b64 vcc, vcc, s[44:45]
    s_cbranch_vccz L_gb3_s3
L_gbn0_s3:
    s_add_u32 s43, s40, 7168
    buffer_load_dwordx4 v[32:35], v0, s[8:11], s43 offen sc1
    s_add_u32 s43, s40, 8960
    buffer_load_dword v12, v11, s[8:11], s43 offen sc1
    s_add_u32 s49, s49, 1
    s_cmp_gt_u32 s49, 4000000
    s_cbranch_scc1 L_fail
L_gbw1_s3:
    s_waitcnt vmcnt(2)
L_gbc1_s3:
    ds_write_b128 v0, v[36:39] offset:7168
    ds_write_b32 v11, v13 offset:8960
    v_max3_u32 v14, v36, v37, v38
    v_max3_u32 v14, v14, v39, v13
    v_cmp_le_u32 vcc, s51, v14
    s_cbranch_vccz L_gb3_s3
    s_and_b32 s43, s49, 15
    s_cmp_lg_u32 s43, 15
    s_cbranch_scc1 L_gbn1_s3
    v_cmp_eq_u32 vcc, s51, v36
    v_cmp_eq_u32 s[44:45], s51, v37
    s_nop 0
    s_or_b64 vcc, vcc, s[44:45]
    v_cmp_eq_u32 s[44:45], s51, v38
    s_nop 0
    s_or_b64 vcc, vcc, s[44:45]
    v_cmp_eq_u32 s[44:45], s51, v39
    s_nop 0
    s_or_b64 vcc, vcc, s[44:45]
    v_cmp_eq_u32 s[44:45], s51, v13
    s_nop 0
    s_or_b64 vcc, vcc, s[44:45]
    s_cbranch_vccz L_gb3_s3
L_gbn1_s3:
    s_add_u32 s43, s40, 7168
    buffer_load_dwordx4 v[36:39], v0, s[8:11], s43 offen sc1
    s_add_u32 s43, s40, 8960
    buffer_load_dword v13, v11, s[8:11], s43 offen sc1
    s_add_u32 s49, s49, 1
    s_cmp_gt_u32 s49, 4000000
    s_cbranch_scc1 L_fail
    s_branch L_gbw0_s3
L_gb3_s3:
    s_waitcnt lgkmcnt(0)
    s_waitcnt vmcnt(0)
    s_branch L_gbr_s3
L_slow_s3:
    s_cmp_eq_u32 s46, 0x5105
    s_cbranch_scc1 L_pv3_s3
    s_mov_b32 s46, 0x5105
    s_nop 0
    v_mov_b32 v54, v52
    v_mov_b32 v55, v53
    s_nop 0
    v_max_f32_dpp v54, v54, v54 row_ror:1 row_mask:0xf bank_mask:0xf
    v_max_f32_dpp v55, v55, v55 row_ror:1 row_mask:0xf bank_mask:0xf
    s_nop 0
    v_max_f32_dpp v54, v54, v54 row_ror:2 row_mask:0xf bank_mask:0xf
    v_max_f32_dpp v55, v55, v55 row_ror:2 row_mask:0xf bank_mask:0xf
    s_nop 0
    v_max_f32_dpp v54, v54, v54 row_ror:4 row_mask:0xf bank_mask:0xf
    v_max_f32_dpp v55, v55, v55 row_ror:4 row_mask:0xf bank_mask:0xf
    s_nop 0
    v_max_f32_dpp v54, v54, v54 row_ror:8 row_mask:0xf bank_mask:0xf
    v_max_f32_dpp v55, v55, v55 row_ror:8 row_mask:0xf bank_mask:0xf
    v_and_b32 v35, 15, v11
    v_lshlrev_b32 v35, 1, v35
    ds_write_b64 v35, v[54:55] offset:16320
    s_waitcnt lgkmcnt(0)
    s_barrier
    ds_read_b64 v[16:17], v35 offset:16256
    ds_read_b64 v[18:19], v35 offset:16288
    ds_read_b64 v[20:21], v35 offset:16320
    s_waitcnt lgkmcnt(0)
    v_max3_f32 v54, v16, v18, v20
    v_max3_f32 v55, v17, v19, v21
    v_sub_f32 v54, v52, v54
    v_sub_f32 v55, v53, v55
    v_exp_f32 v54, v54
    v_exp_f32 v55, v55
    s_nop 0
    v_cvt_pk_bf16_f32 v54, v54, v55
    ds_write_b32 v11, v54 offset:15872
    s_waitcnt lgkmcnt(0)
    s_barrier
    s_branch L_pv_s3
L_pv2_s3:
    ds_read_b128 v[24:27], v0 offset:30720
    ds_read_b128 v[28:31], v0 offset:31744
    s_waitcnt lgkmcnt(0)
    v_mov_b32 v56, 0x3f803f80
    v_mov_b32 v57, 0x3f803f80
    v_mov_b32 v58, 0x3f803f80
    v_mov_b32 v59, 0x3f803f80
    s_nop 1
    v_mfma_f32_16x16x32_bf16 v[36:39], v[56:59], v[48:51], 0
    v_mfma_f32_16x16x32_bf16 v[16:19], v[24:27], v[48:51], 0
    v_mfma_f32_16x16x32_bf16 v[20:23], v[28:31], v[48:51], 0
    v_mfma_f32_16x16x16_bf16 v[36:39], v[32:33], v[54:55], v[36:39]
    v_mfma_f32_16x16x16_bf16 v[16:19], v[40:41], v[54:55], v[16:19]
    v_mfma_f32_16x16x16_bf16 v[20:23], v[44:45], v[54:55], v[20:23]
    s_nop 7
    s_branch L_pv4_s3
L_tail_s3:
    s_waitcnt lgkmcnt(0)
    v_smfmac_f32_16x16x64_bf16 v[44:47], v[60:63], a[120:127], v10
    ds_read_b128 v[16:19], v1 offset:16384
    ds_read_b128 v[20:23], v1 offset:17408
    v_smfmac_f32_16x16x64_bf16 v[40:43], v[48:51], a[128:135], v10
    ds_read_b128 v[24:27], v1 offset:18432
    ds_read_b128 v[28:31], v1 offset:19456
    v_smfmac_f32_16x16x64_bf16 v[44:47], v[48:51], a[136:143], v10
    ds_read_b64_tr_b16 v[60:61], v2 offset:0
    ds_read_b64_tr_b16 v[62:63], v3 offset:0
    v_smfmac_f32_16x16x64_bf16 v[40:43], v[56:59], a[32:39], v10
    ds_read_b64_tr_b16 v[48:49], v2 offset:1024
    ds_read_b64_tr_b16 v[50:51], v3 offset:1024
    v_smfmac_f32_16x16x64_bf16 v[44:47], v[56:59], a[40:47], v10
    ds_read_b64_tr_b16 v[56:57], v2 offset:2048
    ds_read_b64_tr_b16 v[58:59], v3 offset:2048
    s_waitcnt lgkmcnt(4)
    v_smfmac_f32_16x16x64_bf16 v[40:43], v[60:63], a[48:55], v10
    v_smfmac_f32_16x16x64_bf16 v[44:47], v[60:63], a[56:63], v10
    ds_read_b64_tr_b16 v[60:61], v2 offset:7168
    ds_read_b64_tr_b16 v[62:63], v3 offset:7168
    s_waitcnt lgkmcnt(4)
    v_smfmac_f32_16x16x64_bf16 v[40:43], v[48:51], v[16:23], v10
    v_smfmac_f32_16x16x64_bf16 v[44:47], v[48:51], v[24:31], v10
    s_waitcnt lgkmcnt(2)
    v_smfmac_f32_16x16x64_bf16 v[40:43], v[56:59], a[64:71], v10
    v_smfmac_f32_16x16x64_bf16 v[44:47], v[56:59], a[72:79], v10
    s_waitcnt lgkmcnt(0)
    v_smfmac_f32_16x16x64_bf16 v[40:43], v[60:63], a[80:87], v10
    v_smfmac_f32_16x16x64_bf16 v[44:47], v[60:63], a[88:95], v10
    s_nop 3
    v_add_f32 v40, v40, v42
    v_add_f32 v41, v41, v43
    v_cvt_pk_bf16_f32 v40, v40, v41
    s_nop 0
    v_add_f32 v44, v44, v46
    v_add_f32 v45, v45, v47
    v_cvt_pk_bf16_f32 v44, v44, v45
    ds_write_b32 v11, v40 offset:10752
    ds_write_b32 v11, v44 offset:11008
    s_waitcnt vmcnt(0)
    v_and_b32 v12, 0x200, v0
    v_mul_u32_u24 v12, 3, v12
    v_add_u32 v12, v12, v0
    ds_read_b128 v[12:15], v12 offset:10752
    s_waitcnt lgkmcnt(0)
    s_lshr_b32 s44, s48, 1
    s_add_u32 s44, s44, 0x4100c00
    buffer_store_dwordx4 v[12:15], v0, s[8:11], s44 offen sc1
    s_waitcnt vmcnt(0)
    s_barrier
    s_branch L_end
L_fail:
    s_mov_b64 exec, 1
    v_mov_b32 v24, 16
    v_mov_b32 v25, 1
    buffer_atomic_add v25, v24, s[12:15], 0 offen
L_end:
    s_endpgm
.section .rodata,"a"
.p2align 6
.amdhsa_kernel concat_heads__softmax_full_mha__memory_aug_recurrent_mem_tr__prompt_kernel
  .amdhsa_next_free_vgpr 512
  .amdhsa_next_free_sgpr 102
  .amdhsa_accum_offset 256
  .amdhsa_group_segment_fixed_size 0
  .amdhsa_kernarg_size 104
  .amdhsa_user_sgpr_count 2
  .amdhsa_user_sgpr_kernarg_segment_ptr 1
  .amdhsa_system_sgpr_workgroup_id_x 1
.end_amdhsa_kernel
```
